```python
import torch

def _softmax(x, axis=-1):
    return torch.softmax(x, dim=axis)

def _gelu(x):
    return torch.nn.functional.gelu(x, approximate='tanh')

def _silu(x):
    return torch.nn.functional.silu(x)

def _sigmoid(x):
    return torch.sigmoid(x)

def _layernorm(x, axis=-1, eps=1e-05):
    m = x.mean(dim=axis, keepdim=True)
    v = x.var(dim=axis, keepdim=True, unbiased=False)
    return (x - m) / torch.sqrt(v + eps)

def _scatter_add(tgt, idx, src, axis=0):
    return tgt.clone().index_add_(axis, idx, src)

def _segment_sum(src, seg, n):
    out = torch.zeros((n,) + src.shape[1:], dtype=src.dtype)
    return out.index_add_(0, seg, src)

def _pad(x, pw):
    flat = tuple((v for pair in reversed(pw) for v in pair))
    return torch.nn.functional.pad(x, flat)
kernel_name = 'adaLN_cond__sliding_block_cached__dense_activation_silu__prompt'

def setup_inputs():

    _w = lambda a: (lambda t: t.to(torch.bfloat16) if t.is_floating_point() else t)(torch.as_tensor(a))

    def _A_setup():
        B, Sq, D = (1, 2048, 512)
        Hq, Hkv, Sk, Dh = (32, 8, 2048, 128)
        assert Hq % Hkv == 0, (Hq, Hkv)
        return {'x': _w((lambda *s: torch.randn(*s, dtype=torch.bfloat16) * 0.05)(B, Sq, D)), 'k_cache': _w((lambda *s: torch.randn(*s, dtype=torch.bfloat16) * 1.6)(B, Hkv, Sk, Dh)), 'v_cache': _w((lambda *s: torch.randn(*s, dtype=torch.bfloat16) * 0.8)(B, Hkv, Sk, Dh)), 'wq': _w((lambda *s: torch.randn(*s, dtype=torch.bfloat16) * 1.6)(D, Hq * Dh) * D ** (-0.5)), 'wo': _w((lambda *s: torch.randn(*s, dtype=torch.bfloat16) * 0.8)(Hq * Dh, D) * (Hq * Dh) ** (-0.5))}
    _A_in = _A_setup()

    def _B_setup():
        B, S, D, F = (1, 2048, 512, 1792)
        return {'x': _w((lambda *s: torch.randn(*s, dtype=torch.bfloat16) * 0.05)(B, S, D)), 'w1': _w((lambda *s: torch.randn(*s, dtype=torch.bfloat16) * 1.6)(D, F) * D ** (-0.5)), 'w2': _w((lambda *s: torch.randn(*s, dtype=torch.bfloat16) * 0.2)(F, D) * F ** (-0.5))}
    _B_in = _B_setup()
    return {'A_x': _A_in['x'], 'A_k_cache': _A_in['k_cache'], 'A_v_cache': _A_in['v_cache'], 'A_wq': _A_in['wq'], 'A_wo': _A_in['wo'], 'B_x': _B_in['x'], 'B_w1': _B_in['w1'], 'B_w2': _B_in['w2'], 'c': _w((lambda *s: torch.randn(*s, dtype=torch.bfloat16) * 0.1)(1, 512) * 8.0), 'w_mod': _w((lambda *s: torch.randn(*s, dtype=torch.bfloat16) * 0.1)(512, 6 * 512) * 512 ** (-0.5) * 8.0)}

def reference(A_x, A_k_cache, A_v_cache, A_wq, A_wo, B_x, B_w1, B_w2, c, w_mod):

    def _A_ref(x, k_cache, v_cache, wq, wo):
        B, Sq, D = x.shape
        Hq, Dh = (32, 128)
        Hkv, Sk = (k_cache.shape[1], k_cache.shape[2])
        W = min(4096, max(256, Sk // 4))
        rep = Hq // Hkv
        q = (lambda x, *d: x.permute(*d))((x @ wq).reshape(B, Sq, Hq, Dh), 0, 2, 1, 3)
        k = (lambda x, n, axis: torch.repeat_interleave(x, n, dim=axis))(k_cache[:, :, Sk - W:, :], rep, axis=1)
        v = (lambda x, n, axis: torch.repeat_interleave(x, n, dim=axis))(v_cache[:, :, Sk - W:, :], rep, axis=1)
        scores = torch.einsum('bhqd,bhkd->bhqk', q, k) * Dh ** (-0.5)
        p = _softmax(scores, axis=-1)
        o = torch.einsum('bhqk,bhkd->bhqd', p, v)
        return (lambda x, *d: x.permute(*d))(o, 0, 2, 1, 3).reshape(B, Sq, Hq * Dh) @ wo

    def _B_ref(x, w1, w2):
        h = torch.einsum('bsd,df->bsf', x, w1)
        h = _silu(h)
        out = torch.einsum('bsf,fd->bsd', h, w2)
        return out
    x = A_x
    mod = (_silu(c) @ w_mod).reshape(c.shape[0], 6, 1, -1)
    sa, ca, ga, sb, cb, gb = (mod[:, 0].clone(), mod[:, 1].clone(), mod[:, 2].clone(), mod[:, 3].clone(), mod[:, 4].clone(), mod[:, 5].clone())
    h = _layernorm(x, axis=-1) * (1 + ca) + sa
    x = x + ga * _A_ref(h, A_k_cache, A_v_cache, A_wq, A_wo)
    h = _layernorm(x, axis=-1) * (1 + cb) + sb
    x = x + gb * _B_ref(h, B_w1, B_w2)
    return x
```

```asm
; @launch grid=(256,1,1) block=(256,1,1) lds=163840
.amdgcn_target "amdgcn-amd-amdhsa--gfx950"
.text
.globl adaLN_cond__sliding_block_cached__dense_activation_silu__prompt_kernel
.p2align 8
.type adaLN_cond__sliding_block_cached__dense_activation_silu__prompt_kernel,@function
adaLN_cond__sliding_block_cached__dense_activation_silu__prompt_kernel:
    s_cmp_ge_u32 s2, 256
    s_cbranch_scc1 L_end
    s_load_dwordx2 s[4:5], s[0:1], 0
    s_load_dwordx2 s[36:37], s[0:1], 72
    s_load_dwordx2 s[32:33], s[0:1], 64
    s_load_dwordx2 s[48:49], s[0:1], 96
    s_load_dwordx2 s[44:45], s[0:1], 88
    s_lshr_b32 s54, s2, 3
    s_cmp_ge_u32 s54, 29
    s_cbranch_scc0 L_nocode_1
    s_getpc_b64 s[66:67]
L_pc:
    s_sub_u32 s55, s54, 29
    s_lshl_b32 s55, s55, 15
    v_lshl_add_u32 v2, v0, 7, s55
    v_min_u32 v2, L_code_end - L_pc - 4, v2
    v_mov_b32 v3, s67
    v_add_co_u32 v2, vcc, s66, v2
    s_nop 1
    v_addc_co_u32 v3, vcc, 0, v3, vcc
    global_load_dword v28, v[2:3], off
L_nocode_1:
    v_lshrrev_b32 v1, 6, v0
    s_mov_b32 s6, 2097152
    s_mov_b32 s7, 0x20000
    s_mov_b32 s38, 3145728
    s_mov_b32 s39, 0x20000
    s_mov_b32 s34, 1024
    s_mov_b32 s35, 0x20000
    s_mov_b32 s50, 268435456
    s_mov_b32 s51, 0x20000
    s_mov_b32 s46, 256
    s_mov_b32 s47, 0x20000
    s_and_b32 s53, s2, 7
    v_readfirstlane_b32 s52, v1
    v_and_b32 v0, 63, v0
    s_lshr_b32 s55, s2, 4
    s_lshl2_add_u32 s97, s55, s52
    s_lshl3_add_u32 s96, s55, s53
    s_and_b32 s56, s54, 1
    s_lshl_b32 s57, s56, 8
    s_add_u32 s96, s96, s57
    s_lshr_b32 s54, s53, 2
    s_lshl4_add_u32 s54, s54, s55
    s_and_b32 s53, s53, 3
    s_lshl_b32 s58, s53, 11
    s_lshl1_add_u32 s53, s53, s56
    s_lshl2_add_u32 s57, s54, s52
    s_lshl_b32 s57, s57, 14
    s_add_u32 s57, s57, s58
    s_xor_b32 s55, s53, 7
    s_lshl_b32 s55, s55, 13
    s_xor_b32 s57, s57, s55
    v_lshlrev_b32 v24, 4, v0
    v_mov_b32 v30, 1
    s_cmp_lt_u32 s96, 48
    s_cbranch_scc1 L_prod_2
    s_cmp_lt_u32 s96, 256
    s_cbranch_scc1 L_nohelp_5
    v_mul_u32_u24 v2, 6144, v0
    s_and_b32 s60, s2, 7
    s_lshl_b32 s60, s60, 7
    s_lshr_b32 s56, s97, 5
    s_and_b32 s61, s97, 31
    s_mul_i32 s61, s61, 98304
    s_lshl_b32 s56, s56, 10
    s_add_u32 s61, s61, s56
    s_add_u32 s61, s61, s60
    s_lshr_b32 s56, s97, 4
    s_and_b32 s62, s97, 15
    s_mul_i32 s62, s62, 196608
    s_lshl_b32 s56, s56, 10
    s_add_u32 s62, s62, s56
    s_add_u32 s62, s62, s60
    s_waitcnt lgkmcnt(0)
    s_mov_b64 exec, 0xffff
    buffer_load_dword v28, v2, s[36:39], s61 offen
    s_mov_b32 exec_lo, -1
    buffer_load_dword v28, v2, s[36:39], s62 offen offset:2048
    s_mov_b64 exec, -1
L_x_6:
    s_xor_b32 s55, s57, 0
    buffer_load_dwordx4 v[64:67], v24, s[4:7], s55 offen
    s_xor_b32 s55, s57, 1024
    buffer_load_dwordx4 v[68:71], v24, s[4:7], s55 offen
    s_xor_b32 s55, s57, 2048
    buffer_load_dwordx4 v[72:75], v24, s[4:7], s55 offen
    s_xor_b32 s55, s57, 3072
    buffer_load_dwordx4 v[76:79], v24, s[4:7], s55 offen
    s_branch L_body_3
L_nohelp_5:
    s_lshr_b32 s55, s96, 4
    s_cmp_lg_u32 s55, 3
    s_waitcnt lgkmcnt(0)
    s_cbranch_scc1 L_x_6
    v_mov_b32 v32, 0
    v_mov_b32 v33, 0
    v_mov_b32 v34, 0
    v_mov_b32 v35, 0
    s_lshl2_add_u32 s56, s96, s52
    s_sub_u32 s56, s56, 192
    s_cmp_lg_u32 s56, 0
    s_cbranch_scc1 L_nz_7
    buffer_store_dwordx4 v[32:35], v24, s[48:51], 0 offen offset:0 sc1
    buffer_store_dwordx4 v[32:35], v24, s[48:51], 0 offen offset:1024 sc1
    buffer_store_dwordx4 v[32:35], v24, s[48:51], 0 offen offset:2048 sc1
    buffer_store_dwordx4 v[32:35], v24, s[48:51], 0 offen offset:3072 sc1
    s_mov_b64 exec, 1
    s_waitcnt vmcnt(0)
    buffer_store_dword v30, v0, s[44:47], 0 offen sc1
    s_mov_b64 exec, -1
L_nz_7:
    s_mul_i32 s55, s56, 5120
    s_add_u32 s55, s55, 65536
    buffer_store_dwordx4 v[32:35], v24, s[48:51], s55 offen offset:0 sc1
    buffer_store_dwordx4 v[32:35], v24, s[48:51], s55 offen offset:1024 sc1
    buffer_store_dwordx4 v[32:35], v24, s[48:51], s55 offen offset:2048 sc1
    buffer_store_dwordx4 v[32:35], v24, s[48:51], s55 offen offset:3072 sc1
    s_add_u32 s55, s55, 4096
    buffer_store_dwordx4 v[32:35], v24, s[48:51], s55 offen offset:0 sc1
    s_branch L_x_6
L_prod_2:
    s_lshl_b32 s66, s96, 7
    s_mul_i32 s56, s52, 786432
    s_add_u32 s66, s66, s56
    v_lshrrev_b32 v240, 4, v0
    v_mul_u32_u24 v240, 196608, v240
    v_bfe_u32 v241, v0, 3, 1
    v_mul_u32_u24 v241, 6144, v241
    v_add_u32 v240, v240, v241
    v_and_b32 v241, 7, v0
    v_lshl_add_u32 v240, v241, 4, v240
    v_lshlrev_b32 v241, 2, v0
    s_lshl_b32 s67, s52, 8
    s_waitcnt lgkmcnt(0)
    buffer_load_dword v232, v241, s[32:35], s67 offen
    buffer_load_dwordx4 v[128:131], v240, s[36:39], s66 offen
    s_add_u32 s66, s66, 12288
    buffer_load_dwordx4 v[132:135], v240, s[36:39], s66 offen
    s_add_u32 s66, s66, 12288
    buffer_load_dwordx4 v[136:139], v240, s[36:39], s66 offen
    s_add_u32 s66, s66, 12288
    buffer_load_dwordx4 v[140:143], v240, s[36:39], s66 offen
    s_add_u32 s66, s66, 12288
    buffer_load_dwordx4 v[144:147], v240, s[36:39], s66 offen
    s_add_u32 s66, s66, 12288
    buffer_load_dwordx4 v[148:151], v240, s[36:39], s66 offen
    s_add_u32 s66, s66, 12288
    buffer_load_dwordx4 v[152:155], v240, s[36:39], s66 offen
    s_add_u32 s66, s66, 12288
    buffer_load_dwordx4 v[156:159], v240, s[36:39], s66 offen
    s_add_u32 s66, s66, 12288
    s_branch L_pbody
.p2align  12
L_pbody:
    s_load_dwordx2 s[16:17], s[0:1], 24
    s_load_dwordx2 s[8:9], s[0:1], 8
    s_load_dwordx2 s[12:13], s[0:1], 16
    s_load_dwordx2 s[20:21], s[0:1], 32
    s_load_dwordx2 s[24:25], s[0:1], 48
    s_load_dwordx2 s[28:29], s[0:1], 56
    s_load_dwordx2 s[40:41], s[0:1], 80
    s_mov_b32 s18, 4194304
    s_mov_b32 s19, 0x20000
    s_mov_b32 s10, 4194304
    s_mov_b32 s11, 0x20000
    s_mov_b32 s14, 4194304
    s_mov_b32 s15, 0x20000
    s_mov_b32 s22, 4194304
    s_mov_b32 s23, 0x20000
    s_mov_b32 s26, 1835008
    s_mov_b32 s27, 0x20000
    s_mov_b32 s30, 1835008
    s_mov_b32 s31, 0x20000
    s_mov_b32 s42, 2097152
    s_mov_b32 s43, 0x20000
    s_lshr_b32 s99, s2, 3
    s_lshl2_add_u32 s99, s99, s52
    s_lshl3_add_u32 s3, s54, s53
    s_mov_b32 s59, 0xffff0000
    v_lshlrev_b32 v31, 2, v0
    s_lshl_b32 s62, s52, 12
    v_bfe_u32 v2, v0, 2, 2
    v_lshlrev_b32 v2, 13, v2
    v_bfe_u32 v25, v0, 4, 1
    v_lshl_add_u32 v2, v25, 6, v2
    v_lshrrev_b32 v25, 5, v0
    v_lshl_add_u32 v2, v25, 16, v2
    v_lshrrev_b32 v25, 4, v0
    v_and_b32 v25, 2, v25
    v_xor_b32 v25, v25, v0
    v_and_b32 v25, 3, v25
    v_lshl_add_u32 v2, v25, 4, v2
    v_add_u32 v3, 130048, v2
    v_add_u32 v4, 30720, v2
    v_add_u32 v5, 160768, v2
    s_lshl_b32 s60, s53, 10
    s_lshl_b32 s56, s52, 8
    s_add_u32 s60, s60, s56
    s_lshl_b32 s61, s53, 19
    s_add_u32 s63, s61, 393216
    s_add_u32 s63, s63, s62
    s_add_u32 s61, s61, s56
    v_and_b32 v10, 3, v0
    v_lshlrev_b32 v10, 4, v10
    v_bfe_u32 v25, v0, 2, 2
    v_lshl_add_u32 v10, v25, 8, v10
    v_lshrrev_b32 v25, 4, v0
    v_lshl_add_u32 v10, v25, 6, v10
    v_xor_b32 v11, 32, v10
    v_lshrrev_b32 v25, 4, v0
    v_and_b32 v26, 15, v0
    v_xor_b32 v27, v26, v25
    v_lshlrev_b32 v27, 4, v27
    v_lshl_add_u32 v6, v25, 8, v27
    v_xor_b32 v7, 64, v6
    v_xor_b32 v8, 128, v6
    v_xor_b32 v9, 192, v6
    v_mov_b32 v22, v6
    v_mov_b32 v23, v7
    v_lshrrev_b32 v27, 5, v0
    v_bfe_u32 v25, v0, 4, 1
    v_lshl_add_u32 v27, v25, 1, v27
    v_xor_b32 v27, v27, v26
    v_lshlrev_b32 v27, 4, v27
    v_lshl_add_u32 v18, v26, 8, v27
    v_add_u32 v18, 32768, v18
    v_xor_b32 v19, 64, v18
    v_xor_b32 v20, 128, v18
    v_xor_b32 v21, 192, v18
    v_bfe_u32 v26, v0, 2, 2
    v_lshlrev_b32 v26, 6, v26
    v_bfe_u32 v25, v0, 4, 1
    v_lshl_add_u32 v26, v25, 5, v26
    v_and_b32 v25, 3, v0
    v_lshl_add_u32 v26, v25, 3, v26
    v_lshrrev_b32 v25, 4, v0
    v_lshl_add_u32 v16, v25, 10, v26
    v_add_u32 v16, 32768, v16
    v_xor_b32 v17, 32, v16
    s_add_u32 s56, s62, 65536
    v_lshl_add_u32 v12, v25, 9, v26
    v_add_u32 v12, s56, v12
    v_xor_b32 v13, 32, v12
    v_add_u32 v14, 0x10000, v12
    v_add_u32 v15, 0x10000, v13
    s_lshl_b32 s55, s52, 14
    v_lshlrev_b32 v27, 8, v0
    v_and_b32 v25, 7, v0
    v_lshl_add_u32 v27, v25, 4, v27
    v_add_u32 v27, s55, v27
    s_lshr_b32 s55, s58, 6
    v_xor_b32 v27, s55, v27
    v_bfe_u32 v26, v0, 2, 3
    v_lshlrev_b32 v26, 13, v26
    v_and_b32 v25, 3, v0
    v_lshl_add_u32 v26, v25, 8, v26
    v_lshrrev_b32 v25, 5, v0
    v_lshl_add_u32 v26, v25, 10, v26
    v_and_b32 v32, 15, v0
    v_cmp_eq_u32 vcc, 0, v32
    v_mov_b32 v33, 0x3f803f80
    v_mov_b32 v48, 0
    v_mov_b32 v49, 0
    v_mov_b32 v50, 0
    v_mov_b32 v51, 0
    v_mov_b32 v52, 0
    v_mov_b32 v53, 0
    v_mov_b32 v54, 0
    v_mov_b32 v55, 0
    v_mov_b32 v56, 0
    v_mov_b32 v57, 0
    v_mov_b32 v58, 0
    v_mov_b32 v59, 0
    v_mov_b32 v60, 0
    v_mov_b32 v61, 0
    v_mov_b32 v62, 0
    v_mov_b32 v63, 0
    v_cndmask_b32 v32, 0, v33, vcc
    v_accvgpr_write_b32 a0, v32
    v_accvgpr_write_b32 a1, v32
    v_accvgpr_write_b32 a2, v32
    v_accvgpr_write_b32 a3, v32
    v_mov_b32_dpp v33, v32 row_ror:1 row_mask:0xf bank_mask:0xf
    v_accvgpr_write_b32 a4, v33
    v_accvgpr_write_b32 a5, v33
    v_accvgpr_write_b32 a6, v33
    v_accvgpr_write_b32 a7, v33
    v_mov_b32_dpp v32, v33 row_ror:1 row_mask:0xf bank_mask:0xf
    v_accvgpr_write_b32 a8, v32
    v_accvgpr_write_b32 a9, v32
    v_accvgpr_write_b32 a10, v32
    v_accvgpr_write_b32 a11, v32
    v_mov_b32_dpp v33, v32 row_ror:1 row_mask:0xf bank_mask:0xf
    v_accvgpr_write_b32 a12, v33
    v_accvgpr_write_b32 a13, v33
    v_accvgpr_write_b32 a14, v33
    v_accvgpr_write_b32 a15, v33
    v_mov_b32_dpp v32, v33 row_ror:1 row_mask:0xf bank_mask:0xf
    v_accvgpr_write_b32 a16, v32
    v_accvgpr_write_b32 a17, v32
    v_accvgpr_write_b32 a18, v32
    v_accvgpr_write_b32 a19, v32
    v_mov_b32_dpp v33, v32 row_ror:1 row_mask:0xf bank_mask:0xf
    v_accvgpr_write_b32 a20, v33
    v_accvgpr_write_b32 a21, v33
    v_accvgpr_write_b32 a22, v33
    v_accvgpr_write_b32 a23, v33
    v_mov_b32_dpp v32, v33 row_ror:1 row_mask:0xf bank_mask:0xf
    v_accvgpr_write_b32 a24, v32
    v_accvgpr_write_b32 a25, v32
    v_accvgpr_write_b32 a26, v32
    v_accvgpr_write_b32 a27, v32
    v_mov_b32_dpp v33, v32 row_ror:1 row_mask:0xf bank_mask:0xf
    v_accvgpr_write_b32 a28, v33
    v_accvgpr_write_b32 a29, v33
    v_accvgpr_write_b32 a30, v33
    v_accvgpr_write_b32 a31, v33
    v_mov_b32_dpp v32, v33 row_ror:1 row_mask:0xf bank_mask:0xf
    v_accvgpr_write_b32 a32, v32
    v_accvgpr_write_b32 a33, v32
    v_accvgpr_write_b32 a34, v32
    v_accvgpr_write_b32 a35, v32
    v_mov_b32_dpp v33, v32 row_ror:1 row_mask:0xf bank_mask:0xf
    v_accvgpr_write_b32 a36, v33
    v_accvgpr_write_b32 a37, v33
    v_accvgpr_write_b32 a38, v33
    v_accvgpr_write_b32 a39, v33
    v_mov_b32_dpp v32, v33 row_ror:1 row_mask:0xf bank_mask:0xf
    v_accvgpr_write_b32 a40, v32
    v_accvgpr_write_b32 a41, v32
    v_accvgpr_write_b32 a42, v32
    v_accvgpr_write_b32 a43, v32
    v_mov_b32_dpp v33, v32 row_ror:1 row_mask:0xf bank_mask:0xf
    v_accvgpr_write_b32 a44, v33
    v_accvgpr_write_b32 a45, v33
    v_accvgpr_write_b32 a46, v33
    v_accvgpr_write_b32 a47, v33
    v_mov_b32_dpp v32, v33 row_ror:1 row_mask:0xf bank_mask:0xf
    v_accvgpr_write_b32 a48, v32
    v_accvgpr_write_b32 a49, v32
    v_accvgpr_write_b32 a50, v32
    v_accvgpr_write_b32 a51, v32
    v_mov_b32_dpp v33, v32 row_ror:1 row_mask:0xf bank_mask:0xf
    v_accvgpr_write_b32 a52, v33
    v_accvgpr_write_b32 a53, v33
    v_accvgpr_write_b32 a54, v33
    v_accvgpr_write_b32 a55, v33
    v_mov_b32_dpp v32, v33 row_ror:1 row_mask:0xf bank_mask:0xf
    v_accvgpr_write_b32 a56, v32
    v_accvgpr_write_b32 a57, v32
    v_accvgpr_write_b32 a58, v32
    v_accvgpr_write_b32 a59, v32
    v_mov_b32_dpp v33, v32 row_ror:1 row_mask:0xf bank_mask:0xf
    v_accvgpr_write_b32 a60, v33
    v_accvgpr_write_b32 a61, v33
    v_accvgpr_write_b32 a62, v33
    v_accvgpr_write_b32 a63, v33
    s_waitcnt lgkmcnt(0)
    v_mov_b32 v224, 0
    v_mov_b32 v225, 0
    v_mov_b32 v226, 0
    v_mov_b32 v227, 0
    v_mov_b32 v228, 0
    v_mov_b32 v229, 0
    v_mov_b32 v230, 0
    v_mov_b32 v231, 0
    v_and_b32 v242, 7, v0
    v_lshlrev_b32 v242, 5, v242
    v_lshrrev_b32 v243, 4, v0
    v_lshl_add_u32 v242, v243, 3, v242
    v_bfe_u32 v243, v0, 3, 1
    v_lshl_add_u32 v242, v243, 10, v242
    v_add_u32 v242, s67, v242
    v_bfe_u32 v243, v0, 2, 1
    v_lshlrev_b32 v243, 10, v243
    v_lshrrev_b32 v244, 3, v0
    v_lshl_add_u32 v243, v244, 4, v243
    v_and_b32 v244, 3, v0
    v_lshl_add_u32 v243, v244, 2, v243
    s_and_b32 s55, s2, 7
    s_lshl_b32 s55, s55, 7
    s_lshl_b32 s69, s96, 8
    s_sub_u32 s55, s69, s55
    s_cmp_ge_u32 s96, 16
    s_cselect_b32 s69, s69, s55
    s_cselect_b64 vcc, -1, 0
    v_cndmask_b32 v243, v243, v31, vcc
    s_lshr_b32 s56, s96, 3
    s_mov_b32 s67, 0x3e0293ee
    s_cmp_eq_u32 s56, 2
    s_cselect_b32 s67, 1.0, s67
    s_cmp_ge_u32 s56, 3
    s_cselect_b32 s67, 0xbfb8aa3b, s67
    s_cmp_eq_u32 s56, 5
    s_cselect_b32 s67, 0xbf317218, s67
    s_mov_b32 s68, 0
    s_cmp_eq_u32 s56, 1
    s_cselect_b32 s68, 1.0, s68
    s_cmp_eq_u32 s56, 4
    s_cselect_b32 s68, 1.0, s68
    v_and_b32 v237, 8, v0
    v_lshlrev_b32 v237, 1, v237
    v_mov_b32 v238, 0xffff
    v_lshlrev_b32 v237, v237, v238
    s_waitcnt vmcnt(8)
    v_lshlrev_b32 v233, 16, v232
    v_and_b32 v234, s59, v232
    buffer_load_dwordx4 v[160:163], v240, s[36:39], s66 offen
    s_add_u32 s66, s66, 12288
    buffer_load_dwordx4 v[164:167], v240, s[36:39], s66 offen
    s_add_u32 s66, s66, 12288
    buffer_load_dwordx4 v[168:171], v240, s[36:39], s66 offen
    s_add_u32 s66, s66, 12288
    buffer_load_dwordx4 v[172:175], v240, s[36:39], s66 offen
    s_add_u32 s66, s66, 12288
    v_mul_f32 v235, 0xbfb8aa3b, v233
    v_mul_f32 v236, 0xbfb8aa3b, v234
    v_exp_f32 v235, v235
    v_exp_f32 v236, v236
    v_add_f32 v235, 1.0, v235
    v_add_f32 v236, 1.0, v236
    v_rcp_f32 v235, v235
    v_rcp_f32 v236, v236
    v_mul_f32 v233, v233, v235
    v_mul_f32 v234, v234, v236
    v_cvt_pk_bf16_f32 v232, v233, v234
    s_nop 1
    v_and_b32_dpp v192, v232, v237 row_newbcast:0 row_mask:0xf bank_mask:0xf
    v_and_b32_dpp v193, v232, v237 row_newbcast:1 row_mask:0xf bank_mask:0xf
    v_and_b32_dpp v194, v232, v237 row_newbcast:2 row_mask:0xf bank_mask:0xf
    v_and_b32_dpp v195, v232, v237 row_newbcast:3 row_mask:0xf bank_mask:0xf
    v_and_b32_dpp v196, v232, v237 row_newbcast:4 row_mask:0xf bank_mask:0xf
    v_and_b32_dpp v197, v232, v237 row_newbcast:5 row_mask:0xf bank_mask:0xf
    v_and_b32_dpp v198, v232, v237 row_newbcast:6 row_mask:0xf bank_mask:0xf
    v_and_b32_dpp v199, v232, v237 row_newbcast:7 row_mask:0xf bank_mask:0xf
    v_and_b32_dpp v200, v232, v237 row_newbcast:8 row_mask:0xf bank_mask:0xf
    v_and_b32_dpp v201, v232, v237 row_newbcast:9 row_mask:0xf bank_mask:0xf
    v_and_b32_dpp v202, v232, v237 row_newbcast:10 row_mask:0xf bank_mask:0xf
    v_and_b32_dpp v203, v232, v237 row_newbcast:11 row_mask:0xf bank_mask:0xf
    v_and_b32_dpp v204, v232, v237 row_newbcast:12 row_mask:0xf bank_mask:0xf
    v_and_b32_dpp v205, v232, v237 row_newbcast:13 row_mask:0xf bank_mask:0xf
    v_and_b32_dpp v206, v232, v237 row_newbcast:14 row_mask:0xf bank_mask:0xf
    v_and_b32_dpp v207, v232, v237 row_newbcast:15 row_mask:0xf bank_mask:0xf
    v_alignbit_b32 v208, v192, v192, 16
    v_alignbit_b32 v209, v193, v193, 16
    v_alignbit_b32 v210, v194, v194, 16
    v_alignbit_b32 v211, v195, v195, 16
    v_alignbit_b32 v212, v196, v196, 16
    v_alignbit_b32 v213, v197, v197, 16
    v_alignbit_b32 v214, v198, v198, 16
    v_alignbit_b32 v215, v199, v199, 16
    v_alignbit_b32 v216, v200, v200, 16
    v_alignbit_b32 v217, v201, v201, 16
    v_alignbit_b32 v218, v202, v202, 16
    v_alignbit_b32 v219, v203, v203, 16
    v_alignbit_b32 v220, v204, v204, 16
    v_alignbit_b32 v221, v205, v205, 16
    v_alignbit_b32 v222, v206, v206, 16
    v_alignbit_b32 v223, v207, v207, 16
    s_waitcnt vmcnt(11)
    v_dot2c_f32_bf16 v224, v128, v192
    v_dot2c_f32_bf16 v225, v128, v208
    v_dot2c_f32_bf16 v226, v129, v192
    v_dot2c_f32_bf16 v227, v129, v208
    v_dot2c_f32_bf16 v228, v130, v192
    v_dot2c_f32_bf16 v229, v130, v208
    v_dot2c_f32_bf16 v230, v131, v192
    v_dot2c_f32_bf16 v231, v131, v208
    buffer_load_dwordx4 v[176:179], v240, s[36:39], s66 offen
    s_add_u32 s66, s66, 12288
    s_waitcnt vmcnt(11)
    v_dot2c_f32_bf16 v224, v132, v193
    v_dot2c_f32_bf16 v225, v132, v209
    v_dot2c_f32_bf16 v226, v133, v193
    v_dot2c_f32_bf16 v227, v133, v209
    v_dot2c_f32_bf16 v228, v134, v193
    v_dot2c_f32_bf16 v229, v134, v209
    v_dot2c_f32_bf16 v230, v135, v193
    v_dot2c_f32_bf16 v231, v135, v209
    buffer_load_dwordx4 v[180:183], v240, s[36:39], s66 offen
    s_add_u32 s66, s66, 12288
    s_waitcnt vmcnt(11)
    v_dot2c_f32_bf16 v224, v136, v194
    v_dot2c_f32_bf16 v225, v136, v210
    v_dot2c_f32_bf16 v226, v137, v194
    v_dot2c_f32_bf16 v227, v137, v210
    v_dot2c_f32_bf16 v228, v138, v194
    v_dot2c_f32_bf16 v229, v138, v210
    v_dot2c_f32_bf16 v230, v139, v194
    v_dot2c_f32_bf16 v231, v139, v210
    buffer_load_dwordx4 v[184:187], v240, s[36:39], s66 offen
    s_add_u32 s66, s66, 12288
    s_waitcnt vmcnt(11)
    v_dot2c_f32_bf16 v224, v140, v195
    v_dot2c_f32_bf16 v225, v140, v211
    v_dot2c_f32_bf16 v226, v141, v195
    v_dot2c_f32_bf16 v227, v141, v211
    v_dot2c_f32_bf16 v228, v142, v195
    v_dot2c_f32_bf16 v229, v142, v211
    v_dot2c_f32_bf16 v230, v143, v195
    v_dot2c_f32_bf16 v231, v143, v211
    buffer_load_dwordx4 v[188:191], v240, s[36:39], s66 offen
    s_waitcnt vmcnt(11)
    v_dot2c_f32_bf16 v224, v144, v196
    v_dot2c_f32_bf16 v225, v144, v212
    v_dot2c_f32_bf16 v226, v145, v196
    v_dot2c_f32_bf16 v227, v145, v212
    v_dot2c_f32_bf16 v228, v146, v196
    v_dot2c_f32_bf16 v229, v146, v212
    v_dot2c_f32_bf16 v230, v147, v196
    v_dot2c_f32_bf16 v231, v147, v212
    s_waitcnt vmcnt(10)
    v_dot2c_f32_bf16 v224, v148, v197
    v_dot2c_f32_bf16 v225, v148, v213
    v_dot2c_f32_bf16 v226, v149, v197
    v_dot2c_f32_bf16 v227, v149, v213
    v_dot2c_f32_bf16 v228, v150, v197
    v_dot2c_f32_bf16 v229, v150, v213
    v_dot2c_f32_bf16 v230, v151, v197
    v_dot2c_f32_bf16 v231, v151, v213
    s_waitcnt vmcnt(9)
    v_dot2c_f32_bf16 v224, v152, v198
    v_dot2c_f32_bf16 v225, v152, v214
    v_dot2c_f32_bf16 v226, v153, v198
    v_dot2c_f32_bf16 v227, v153, v214
    v_dot2c_f32_bf16 v228, v154, v198
    v_dot2c_f32_bf16 v229, v154, v214
    v_dot2c_f32_bf16 v230, v155, v198
    v_dot2c_f32_bf16 v231, v155, v214
    s_waitcnt vmcnt(8)
    v_dot2c_f32_bf16 v224, v156, v199
    v_dot2c_f32_bf16 v225, v156, v215
    v_dot2c_f32_bf16 v226, v157, v199
    v_dot2c_f32_bf16 v227, v157, v215
    v_dot2c_f32_bf16 v228, v158, v199
    v_dot2c_f32_bf16 v229, v158, v215
    v_dot2c_f32_bf16 v230, v159, v199
    v_dot2c_f32_bf16 v231, v159, v215
    s_mov_b64 exec, 0
    s_cmp_eq_u32 s52, 0
    s_cbranch_scc1 L_hop1_0
    s_cmp_eq_u32 s52, 1
    s_cbranch_scc1 L_hop1_1
    s_cmp_eq_u32 s52, 2
    s_cbranch_scc1 L_hop1_2
    s_branch L_hopp_0
L_back1_1:
    s_waitcnt vmcnt(7)
    v_dot2c_f32_bf16 v224, v160, v200
    v_dot2c_f32_bf16 v225, v160, v216
    v_dot2c_f32_bf16 v226, v161, v200
    v_dot2c_f32_bf16 v227, v161, v216
    v_dot2c_f32_bf16 v228, v162, v200
    v_dot2c_f32_bf16 v229, v162, v216
    v_dot2c_f32_bf16 v230, v163, v200
    v_dot2c_f32_bf16 v231, v163, v216
    s_waitcnt vmcnt(6)
    v_dot2c_f32_bf16 v224, v164, v201
    v_dot2c_f32_bf16 v225, v164, v217
    v_dot2c_f32_bf16 v226, v165, v201
    v_dot2c_f32_bf16 v227, v165, v217
    v_dot2c_f32_bf16 v228, v166, v201
    v_dot2c_f32_bf16 v229, v166, v217
    v_dot2c_f32_bf16 v230, v167, v201
    v_dot2c_f32_bf16 v231, v167, v217
    s_waitcnt vmcnt(5)
    v_dot2c_f32_bf16 v224, v168, v202
    v_dot2c_f32_bf16 v225, v168, v218
    v_dot2c_f32_bf16 v226, v169, v202
    v_dot2c_f32_bf16 v227, v169, v218
    v_dot2c_f32_bf16 v228, v170, v202
    v_dot2c_f32_bf16 v229, v170, v218
    v_dot2c_f32_bf16 v230, v171, v202
    v_dot2c_f32_bf16 v231, v171, v218
    s_waitcnt vmcnt(4)
    v_dot2c_f32_bf16 v224, v172, v203
    v_dot2c_f32_bf16 v225, v172, v219
    v_dot2c_f32_bf16 v226, v173, v203
    v_dot2c_f32_bf16 v227, v173, v219
    v_dot2c_f32_bf16 v228, v174, v203
    v_dot2c_f32_bf16 v229, v174, v219
    v_dot2c_f32_bf16 v230, v175, v203
    v_dot2c_f32_bf16 v231, v175, v219
    buffer_load_dword v29, off, s[44:47], 0 sc1
    s_waitcnt vmcnt(4)
    v_dot2c_f32_bf16 v224, v176, v204
    v_dot2c_f32_bf16 v225, v176, v220
    v_dot2c_f32_bf16 v226, v177, v204
    v_dot2c_f32_bf16 v227, v177, v220
    v_dot2c_f32_bf16 v228, v178, v204
    v_dot2c_f32_bf16 v229, v178, v220
    v_dot2c_f32_bf16 v230, v179, v204
    v_dot2c_f32_bf16 v231, v179, v220
    s_xor_b32 s55, s57, 0
    buffer_load_dwordx4 v[64:67], v24, s[4:7], s55 offen
    s_xor_b32 s55, s57, 1024
    buffer_load_dwordx4 v[68:71], v24, s[4:7], s55 offen
    s_waitcnt vmcnt(5)
    v_dot2c_f32_bf16 v224, v180, v205
    v_dot2c_f32_bf16 v225, v180, v221
    v_dot2c_f32_bf16 v226, v181, v205
    v_dot2c_f32_bf16 v227, v181, v221
    v_dot2c_f32_bf16 v228, v182, v205
    v_dot2c_f32_bf16 v229, v182, v221
    v_dot2c_f32_bf16 v230, v183, v205
    v_dot2c_f32_bf16 v231, v183, v221
    s_xor_b32 s55, s57, 2048
    buffer_load_dwordx4 v[72:75], v24, s[4:7], s55 offen
    s_xor_b32 s55, s57, 3072
    buffer_load_dwordx4 v[76:79], v24, s[4:7], s55 offen
    s_waitcnt vmcnt(6)
    v_dot2c_f32_bf16 v224, v184, v206
    v_dot2c_f32_bf16 v225, v184, v222
    v_dot2c_f32_bf16 v226, v185, v206
    v_dot2c_f32_bf16 v227, v185, v222
    v_dot2c_f32_bf16 v228, v186, v206
    v_dot2c_f32_bf16 v229, v186, v222
    v_dot2c_f32_bf16 v230, v187, v206
    v_dot2c_f32_bf16 v231, v187, v222
    s_xor_b32 s55, s57, 4096
    buffer_load_dwordx4 v[80:83], v24, s[4:7], s55 offen
    s_xor_b32 s55, s57, 5120
    buffer_load_dwordx4 v[84:87], v24, s[4:7], s55 offen
    s_waitcnt vmcnt(7)
    v_dot2c_f32_bf16 v224, v188, v207
    v_dot2c_f32_bf16 v225, v188, v223
    v_dot2c_f32_bf16 v226, v189, v207
    v_dot2c_f32_bf16 v227, v189, v223
    v_dot2c_f32_bf16 v228, v190, v207
    v_dot2c_f32_bf16 v229, v190, v223
    v_dot2c_f32_bf16 v230, v191, v207
    v_dot2c_f32_bf16 v231, v191, v223
    s_xor_b32 s55, s57, 6144
    buffer_load_dwordx4 v[88:91], v24, s[4:7], s55 offen
    s_xor_b32 s55, s57, 7168
    buffer_load_dwordx4 v[92:95], v24, s[4:7], s55 offen
    v_permlane32_swap_b32 v224, v228
    v_permlane32_swap_b32 v225, v229
    v_permlane32_swap_b32 v226, v230
    v_permlane32_swap_b32 v227, v231
    v_add_f32 v224, v224, v228
    v_add_f32 v225, v225, v229
    v_add_f32 v226, v226, v230
    v_add_f32 v227, v227, v231
    s_nop 0
    v_permlane16_swap_b32 v224, v226
    v_permlane16_swap_b32 v225, v227
    v_add_f32 v224, v224, v226
    v_add_f32 v225, v225, v227
    s_nop 1
    v_add_f32_dpp v226, v225, v224 row_ror:8 row_mask:0xf bank_mask:0xf
    v_add_f32_dpp v227, v224, v225 row_ror:8 row_mask:0xf bank_mask:0xf
    ds_write_b64 v242, v[226:227]
    s_waitcnt lgkmcnt(0)
    s_barrier
    s_cmp_lg_u32 s52, 0
    s_cbranch_scc1 L_modskip_8
    ds_read_b32 v224, v31 offset:0
    ds_read_b32 v225, v31 offset:256
    ds_read_b32 v226, v31 offset:512
    ds_read_b32 v227, v31 offset:768
    s_waitcnt lgkmcnt(2)
    v_add_f32 v224, v224, v225
    s_waitcnt lgkmcnt(0)
    v_add_f32 v226, v226, v227
    v_add_f32 v224, v224, v226
    v_cvt_pk_bf16_f32 v224, v224, v224
    v_and_b32 v224, s59, v224
    v_add_f32 v224, s68, v224
    v_cvt_pk_bf16_f32 v224, v224, v224
    v_and_b32 v224, s59, v224
    v_mul_f32 v224, s67, v224
    v_or_b32 v224, 1, v224
    s_waitcnt vmcnt(8)
    v_cmp_eq_u32 vcc, 0, v29
    s_nop 0
    s_cbranch_vccz L_z_9
    s_mov_b64 exec, 0x1
    s_mov_b32 s98, 0x200000
L_poll_10:
    buffer_load_dword v29, v31, s[44:47], 0 offen offset:0 sc1
    s_sub_u32 s98, s98, 1
    s_cbranch_scc1 L_pollout_11
    s_waitcnt vmcnt(0)
    v_cmp_gt_u32 vcc, 1, v29
    s_nop 0
    s_cbranch_vccnz L_poll_10
L_pollout_11:
    s_waitcnt vmcnt(0)
    s_mov_b64 exec, -1
L_z_9:
    buffer_store_dword v224, v243, s[48:51], s69 offen offset:0 sc1
L_modskip_8:
    s_waitcnt vmcnt(7)
    v_mfma_f32_16x16x32_bf16 v[32:35], a[0:3], v[64:67], 0
    s_xor_b32 s55, s57, 8192
    buffer_load_dwordx4 v[96:99], v24, s[4:7], s55 offen
    v_lshlrev_b32 v128, 16, v64
    v_lshlrev_b32 v130, 16, v65
    v_lshlrev_b32 v132, 16, v66
    v_lshlrev_b32 v134, 16, v67
    v_dot2c_f32_bf16 v48, v64, v64
    v_and_b32 v129, s59, v64
    v_dot2c_f32_bf16 v48, v65, v65
    v_and_b32 v131, s59, v65
    v_dot2c_f32_bf16 v48, v66, v66
    v_and_b32 v133, s59, v66
    v_dot2c_f32_bf16 v48, v67, v67
    v_and_b32 v135, s59, v67
    s_waitcnt vmcnt(7)
    v_mfma_f32_16x16x32_bf16 v[32:35], a[4:7], v[68:71], v[32:35]
    s_xor_b32 s55, s57, 9216
    buffer_load_dwordx4 v[100:103], v24, s[4:7], s55 offen
    v_lshlrev_b32 v136, 16, v68
    v_lshlrev_b32 v138, 16, v69
    v_lshlrev_b32 v140, 16, v70
    v_lshlrev_b32 v142, 16, v71
    v_dot2c_f32_bf16 v49, v68, v68
    v_and_b32 v137, s59, v68
    v_dot2c_f32_bf16 v49, v69, v69
    v_and_b32 v139, s59, v69
    v_dot2c_f32_bf16 v49, v70, v70
    v_and_b32 v141, s59, v70
    v_dot2c_f32_bf16 v49, v71, v71
    v_and_b32 v143, s59, v71
    s_waitcnt vmcnt(7)
    v_mfma_f32_16x16x32_bf16 v[32:35], a[8:11], v[72:75], v[32:35]
    s_xor_b32 s55, s57, 10240
    buffer_load_dwordx4 v[104:107], v24, s[4:7], s55 offen
    v_lshlrev_b32 v144, 16, v72
    v_lshlrev_b32 v146, 16, v73
    v_lshlrev_b32 v148, 16, v74
    v_lshlrev_b32 v150, 16, v75
    v_dot2c_f32_bf16 v50, v72, v72
    v_and_b32 v145, s59, v72
    v_dot2c_f32_bf16 v50, v73, v73
    v_and_b32 v147, s59, v73
    v_dot2c_f32_bf16 v50, v74, v74
    v_and_b32 v149, s59, v74
    v_dot2c_f32_bf16 v50, v75, v75
    v_and_b32 v151, s59, v75
    s_waitcnt vmcnt(7)
    v_mfma_f32_16x16x32_bf16 v[32:35], a[12:15], v[76:79], v[32:35]
    s_xor_b32 s55, s57, 11264
    buffer_load_dwordx4 v[108:111], v24, s[4:7], s55 offen
    v_lshlrev_b32 v152, 16, v76
    v_lshlrev_b32 v154, 16, v77
    v_lshlrev_b32 v156, 16, v78
    v_lshlrev_b32 v158, 16, v79
    v_dot2c_f32_bf16 v51, v76, v76
    v_and_b32 v153, s59, v76
    v_dot2c_f32_bf16 v51, v77, v77
    v_and_b32 v155, s59, v77
    v_dot2c_f32_bf16 v51, v78, v78
    v_and_b32 v157, s59, v78
    v_dot2c_f32_bf16 v51, v79, v79
    v_and_b32 v159, s59, v79
    s_waitcnt vmcnt(7)
    v_mfma_f32_16x16x32_bf16 v[32:35], a[16:19], v[80:83], v[32:35]
    s_xor_b32 s55, s57, 12288
    buffer_load_dwordx4 v[112:115], v24, s[4:7], s55 offen
    v_lshlrev_b32 v160, 16, v80
    v_lshlrev_b32 v162, 16, v81
    v_lshlrev_b32 v164, 16, v82
    v_lshlrev_b32 v166, 16, v83
    v_dot2c_f32_bf16 v52, v80, v80
    v_and_b32 v161, s59, v80
    v_dot2c_f32_bf16 v52, v81, v81
    v_and_b32 v163, s59, v81
    v_dot2c_f32_bf16 v52, v82, v82
    v_and_b32 v165, s59, v82
    v_dot2c_f32_bf16 v52, v83, v83
    v_and_b32 v167, s59, v83
    s_waitcnt vmcnt(7)
    v_mfma_f32_16x16x32_bf16 v[32:35], a[20:23], v[84:87], v[32:35]
    s_xor_b32 s55, s57, 13312
    buffer_load_dwordx4 v[116:119], v24, s[4:7], s55 offen
    v_lshlrev_b32 v168, 16, v84
    v_lshlrev_b32 v170, 16, v85
    v_lshlrev_b32 v172, 16, v86
    v_lshlrev_b32 v174, 16, v87
    v_dot2c_f32_bf16 v53, v84, v84
    v_and_b32 v169, s59, v84
    v_dot2c_f32_bf16 v53, v85, v85
    v_and_b32 v171, s59, v85
    v_dot2c_f32_bf16 v53, v86, v86
    v_and_b32 v173, s59, v86
    v_dot2c_f32_bf16 v53, v87, v87
    v_and_b32 v175, s59, v87
    s_waitcnt vmcnt(7)
    v_mfma_f32_16x16x32_bf16 v[32:35], a[24:27], v[88:91], v[32:35]
    s_xor_b32 s55, s57, 14336
    buffer_load_dwordx4 v[120:123], v24, s[4:7], s55 offen
    v_lshlrev_b32 v176, 16, v88
    v_lshlrev_b32 v178, 16, v89
    v_lshlrev_b32 v180, 16, v90
    v_lshlrev_b32 v182, 16, v91
    v_dot2c_f32_bf16 v54, v88, v88
    v_and_b32 v177, s59, v88
    v_dot2c_f32_bf16 v54, v89, v89
    v_and_b32 v179, s59, v89
    v_dot2c_f32_bf16 v54, v90, v90
    v_and_b32 v181, s59, v90
    v_dot2c_f32_bf16 v54, v91, v91
    v_and_b32 v183, s59, v91
    s_waitcnt vmcnt(7)
    v_mfma_f32_16x16x32_bf16 v[32:35], a[28:31], v[92:95], v[32:35]
    s_xor_b32 s55, s57, 15360
    buffer_load_dwordx4 v[124:127], v24, s[4:7], s55 offen
    v_lshlrev_b32 v184, 16, v92
    v_lshlrev_b32 v186, 16, v93
    v_lshlrev_b32 v188, 16, v94
    v_lshlrev_b32 v190, 16, v95
    v_dot2c_f32_bf16 v55, v92, v92
    v_and_b32 v185, s59, v92
    v_dot2c_f32_bf16 v55, v93, v93
    v_and_b32 v187, s59, v93
    v_dot2c_f32_bf16 v55, v94, v94
    v_and_b32 v189, s59, v94
    v_dot2c_f32_bf16 v55, v95, v95
    v_and_b32 v191, s59, v95
    s_waitcnt vmcnt(7)
    v_mfma_f32_16x16x32_bf16 v[32:35], a[32:35], v[96:99], v[32:35]
    v_lshlrev_b32 v192, 16, v96
    v_lshlrev_b32 v194, 16, v97
    v_lshlrev_b32 v196, 16, v98
    v_lshlrev_b32 v198, 16, v99
    v_dot2c_f32_bf16 v56, v96, v96
    v_and_b32 v193, s59, v96
    v_dot2c_f32_bf16 v56, v97, v97
    v_and_b32 v195, s59, v97
    v_dot2c_f32_bf16 v56, v98, v98
    v_and_b32 v197, s59, v98
    v_dot2c_f32_bf16 v56, v99, v99
    v_and_b32 v199, s59, v99
    s_waitcnt vmcnt(6)
    v_mfma_f32_16x16x32_bf16 v[32:35], a[36:39], v[100:103], v[32:35]
    v_lshlrev_b32 v200, 16, v100
    v_lshlrev_b32 v202, 16, v101
    v_lshlrev_b32 v204, 16, v102
    v_lshlrev_b32 v206, 16, v103
    v_dot2c_f32_bf16 v57, v100, v100
    v_and_b32 v201, s59, v100
    v_dot2c_f32_bf16 v57, v101, v101
    v_and_b32 v203, s59, v101
    v_dot2c_f32_bf16 v57, v102, v102
    v_and_b32 v205, s59, v102
    v_dot2c_f32_bf16 v57, v103, v103
    v_and_b32 v207, s59, v103
    s_waitcnt vmcnt(5)
    v_mfma_f32_16x16x32_bf16 v[32:35], a[40:43], v[104:107], v[32:35]
    v_lshlrev_b32 v208, 16, v104
    v_lshlrev_b32 v210, 16, v105
    v_lshlrev_b32 v212, 16, v106
    v_lshlrev_b32 v214, 16, v107
    v_dot2c_f32_bf16 v58, v104, v104
    v_and_b32 v209, s59, v104
    v_dot2c_f32_bf16 v58, v105, v105
    v_and_b32 v211, s59, v105
    v_dot2c_f32_bf16 v58, v106, v106
    v_and_b32 v213, s59, v106
    v_dot2c_f32_bf16 v58, v107, v107
    v_and_b32 v215, s59, v107
    s_waitcnt vmcnt(4)
    v_mfma_f32_16x16x32_bf16 v[32:35], a[44:47], v[108:111], v[32:35]
    v_lshlrev_b32 v216, 16, v108
    v_lshlrev_b32 v218, 16, v109
    v_lshlrev_b32 v220, 16, v110
    v_lshlrev_b32 v222, 16, v111
    v_dot2c_f32_bf16 v59, v108, v108
    v_and_b32 v217, s59, v108
    v_dot2c_f32_bf16 v59, v109, v109
    v_and_b32 v219, s59, v109
    v_dot2c_f32_bf16 v59, v110, v110
    v_and_b32 v221, s59, v110
    v_dot2c_f32_bf16 v59, v111, v111
    v_and_b32 v223, s59, v111
    s_waitcnt vmcnt(3)
    v_mfma_f32_16x16x32_bf16 v[32:35], a[48:51], v[112:115], v[32:35]
    buffer_load_dword v29, off, s[44:47], 0 sc1
    s_add_u32 m0, s62, 131072
    s_add_u32 s56, s60, 0
    buffer_load_dwordx4 v2, s[16:19], s56 offen offset:0 lds
    buffer_load_dwordx4 v3, s[16:19], s56 offen offset:1024 lds
    buffer_load_dwordx4 v4, s[16:19], s56 offen offset:2048 lds
    buffer_load_dwordx4 v5, s[16:19], s56 offen offset:3072 lds
    v_lshlrev_b32 v224, 16, v112
    v_lshlrev_b32 v226, 16, v113
    v_lshlrev_b32 v228, 16, v114
    v_lshlrev_b32 v230, 16, v115
    v_dot2c_f32_bf16 v60, v112, v112
    v_and_b32 v225, s59, v112
    v_dot2c_f32_bf16 v60, v113, v113
    v_and_b32 v227, s59, v113
    v_dot2c_f32_bf16 v60, v114, v114
    v_and_b32 v229, s59, v114
    v_dot2c_f32_bf16 v60, v115, v115
    v_and_b32 v231, s59, v115
    s_waitcnt vmcnt(7)
    v_mfma_f32_16x16x32_bf16 v[32:35], a[52:55], v[116:119], v[32:35]
    s_add_u32 m0, s62, 147456
    s_add_u32 s56, s60, 262144
    buffer_load_dwordx4 v2, s[16:19], s56 offen offset:0 lds
    buffer_load_dwordx4 v3, s[16:19], s56 offen offset:1024 lds
    buffer_load_dwordx4 v4, s[16:19], s56 offen offset:2048 lds
    buffer_load_dwordx4 v5, s[16:19], s56 offen offset:3072 lds
    v_lshlrev_b32 v232, 16, v116
    v_lshlrev_b32 v234, 16, v117
    v_lshlrev_b32 v236, 16, v118
    v_lshlrev_b32 v238, 16, v119
    v_dot2c_f32_bf16 v61, v116, v116
    v_and_b32 v233, s59, v116
    v_dot2c_f32_bf16 v61, v117, v117
    v_and_b32 v235, s59, v117
    v_dot2c_f32_bf16 v61, v118, v118
    v_and_b32 v237, s59, v118
L_hopp_0:
    s_cbranch_execz L_hopp_1
    v_dot2c_f32_bf16 v61, v119, v119
    v_and_b32 v239, s59, v119
    s_waitcnt vmcnt(10)
    v_mfma_f32_16x16x32_bf16 v[32:35], a[56:59], v[120:123], v[32:35]
    s_add_u32 m0, s62, 65536
    s_add_u32 s56, s60, 524288
    buffer_load_dwordx4 v2, s[16:19], s56 offen offset:0 lds
    buffer_load_dwordx4 v3, s[16:19], s56 offen offset:1024 lds
    buffer_load_dwordx4 v4, s[16:19], s56 offen offset:2048 lds
    buffer_load_dwordx4 v5, s[16:19], s56 offen offset:3072 lds
    v_lshlrev_b32 v240, 16, v120
    v_lshlrev_b32 v242, 16, v121
    v_lshlrev_b32 v244, 16, v122
    v_lshlrev_b32 v246, 16, v123
    v_dot2c_f32_bf16 v62, v120, v120
    v_and_b32 v241, s59, v120
    v_dot2c_f32_bf16 v62, v121, v121
    v_and_b32 v243, s59, v121
    v_dot2c_f32_bf16 v62, v122, v122
    v_and_b32 v245, s59, v122
    v_dot2c_f32_bf16 v62, v123, v123
    v_and_b32 v247, s59, v123
    s_waitcnt vmcnt(13)
    v_mfma_f32_16x16x32_bf16 v[32:35], a[60:63], v[124:127], v[32:35]
    s_add_u32 m0, s62, 81920
    s_add_u32 s56, s60, 786432
    buffer_load_dwordx4 v2, s[16:19], s56 offen offset:0 lds
    buffer_load_dwordx4 v3, s[16:19], s56 offen offset:1024 lds
    buffer_load_dwordx4 v4, s[16:19], s56 offen offset:2048 lds
    buffer_load_dwordx4 v5, s[16:19], s56 offen offset:3072 lds
    v_lshlrev_b32 v248, 16, v124
    v_lshlrev_b32 v250, 16, v125
    v_lshlrev_b32 v252, 16, v126
    v_lshlrev_b32 v254, 16, v127
    v_dot2c_f32_bf16 v63, v124, v124
    v_and_b32 v249, s59, v124
    v_dot2c_f32_bf16 v63, v125, v125
    v_and_b32 v251, s59, v125
    v_dot2c_f32_bf16 v63, v126, v126
    v_and_b32 v253, s59, v126
    v_dot2c_f32_bf16 v63, v127, v127
    v_and_b32 v255, s59, v127
    s_branch L_prodj_4
.p2align 12
L_body_3:
    s_load_dwordx2 s[16:17], s[0:1], 24
    s_load_dwordx2 s[8:9], s[0:1], 8
    s_load_dwordx2 s[12:13], s[0:1], 16
    s_load_dwordx2 s[20:21], s[0:1], 32
    s_load_dwordx2 s[24:25], s[0:1], 48
    s_load_dwordx2 s[28:29], s[0:1], 56
    s_load_dwordx2 s[40:41], s[0:1], 80
    s_mov_b32 s18, 4194304
    s_mov_b32 s19, 0x20000
    s_mov_b32 s10, 4194304
    s_mov_b32 s11, 0x20000
    s_mov_b32 s14, 4194304
    s_mov_b32 s15, 0x20000
    s_mov_b32 s22, 4194304
    s_mov_b32 s23, 0x20000
    s_mov_b32 s26, 1835008
    s_mov_b32 s27, 0x20000
    s_mov_b32 s30, 1835008
    s_mov_b32 s31, 0x20000
    s_mov_b32 s42, 2097152
    s_mov_b32 s43, 0x20000
    s_lshr_b32 s99, s2, 3
    s_lshl2_add_u32 s99, s99, s52
    s_lshl3_add_u32 s3, s54, s53
    s_mov_b32 s59, 0xffff0000
    v_lshlrev_b32 v31, 2, v0
    s_lshl_b32 s62, s52, 12
    v_bfe_u32 v2, v0, 2, 2
    v_lshlrev_b32 v2, 13, v2
    v_bfe_u32 v25, v0, 4, 1
    v_lshl_add_u32 v2, v25, 6, v2
    v_lshrrev_b32 v25, 5, v0
    v_lshl_add_u32 v2, v25, 16, v2
    v_lshrrev_b32 v25, 4, v0
    v_and_b32 v25, 2, v25
    v_xor_b32 v25, v25, v0
    v_and_b32 v25, 3, v25
    v_lshl_add_u32 v2, v25, 4, v2
    v_add_u32 v3, 130048, v2
    v_add_u32 v4, 30720, v2
    v_add_u32 v5, 160768, v2
    s_lshl_b32 s60, s53, 10
    s_lshl_b32 s56, s52, 8
    s_add_u32 s60, s60, s56
    s_lshl_b32 s61, s53, 19
    s_add_u32 s63, s61, 393216
    s_add_u32 s63, s63, s62
    s_add_u32 s61, s61, s56
    v_and_b32 v10, 3, v0
    v_lshlrev_b32 v10, 4, v10
    v_bfe_u32 v25, v0, 2, 2
    v_lshl_add_u32 v10, v25, 8, v10
    v_lshrrev_b32 v25, 4, v0
    v_lshl_add_u32 v10, v25, 6, v10
    v_xor_b32 v11, 32, v10
    v_lshrrev_b32 v25, 4, v0
    v_and_b32 v26, 15, v0
    v_xor_b32 v27, v26, v25
    v_lshlrev_b32 v27, 4, v27
    v_lshl_add_u32 v6, v25, 8, v27
    v_xor_b32 v7, 64, v6
    v_xor_b32 v8, 128, v6
    v_xor_b32 v9, 192, v6
    v_mov_b32 v22, v6
    v_mov_b32 v23, v7
    v_lshrrev_b32 v27, 5, v0
    v_bfe_u32 v25, v0, 4, 1
    v_lshl_add_u32 v27, v25, 1, v27
    v_xor_b32 v27, v27, v26
    v_lshlrev_b32 v27, 4, v27
    v_lshl_add_u32 v18, v26, 8, v27
    v_add_u32 v18, 32768, v18
    v_xor_b32 v19, 64, v18
    v_xor_b32 v20, 128, v18
    v_xor_b32 v21, 192, v18
    v_bfe_u32 v26, v0, 2, 2
    v_lshlrev_b32 v26, 6, v26
    v_bfe_u32 v25, v0, 4, 1
    v_lshl_add_u32 v26, v25, 5, v26
    v_and_b32 v25, 3, v0
    v_lshl_add_u32 v26, v25, 3, v26
    v_lshrrev_b32 v25, 4, v0
    v_lshl_add_u32 v16, v25, 10, v26
    v_add_u32 v16, 32768, v16
    v_xor_b32 v17, 32, v16
    s_add_u32 s56, s62, 65536
    v_lshl_add_u32 v12, v25, 9, v26
    v_add_u32 v12, s56, v12
    v_xor_b32 v13, 32, v12
    v_add_u32 v14, 0x10000, v12
    v_add_u32 v15, 0x10000, v13
    s_lshl_b32 s55, s52, 14
    v_lshlrev_b32 v27, 8, v0
    v_and_b32 v25, 7, v0
    v_lshl_add_u32 v27, v25, 4, v27
    v_add_u32 v27, s55, v27
    s_lshr_b32 s55, s58, 6
    v_xor_b32 v27, s55, v27
    v_bfe_u32 v26, v0, 2, 3
    v_lshlrev_b32 v26, 13, v26
    v_and_b32 v25, 3, v0
    v_lshl_add_u32 v26, v25, 8, v26
    v_lshrrev_b32 v25, 5, v0
    v_lshl_add_u32 v26, v25, 10, v26
    v_and_b32 v32, 15, v0
    v_cmp_eq_u32 vcc, 0, v32
    v_mov_b32 v33, 0x3f803f80
    v_mov_b32 v48, 0
    v_mov_b32 v49, 0
    v_mov_b32 v50, 0
    v_mov_b32 v51, 0
    v_mov_b32 v52, 0
    v_mov_b32 v53, 0
    v_mov_b32 v54, 0
    v_mov_b32 v55, 0
    v_mov_b32 v56, 0
    v_mov_b32 v57, 0
    v_mov_b32 v58, 0
    v_mov_b32 v59, 0
    v_mov_b32 v60, 0
    v_mov_b32 v61, 0
    v_mov_b32 v62, 0
    v_mov_b32 v63, 0
    v_cndmask_b32 v32, 0, v33, vcc
    v_accvgpr_write_b32 a0, v32
    v_accvgpr_write_b32 a1, v32
    v_accvgpr_write_b32 a2, v32
    v_accvgpr_write_b32 a3, v32
    v_mov_b32_dpp v33, v32 row_ror:1 row_mask:0xf bank_mask:0xf
    v_accvgpr_write_b32 a4, v33
    v_accvgpr_write_b32 a5, v33
    v_accvgpr_write_b32 a6, v33
    v_accvgpr_write_b32 a7, v33
    v_mov_b32_dpp v32, v33 row_ror:1 row_mask:0xf bank_mask:0xf
    v_accvgpr_write_b32 a8, v32
    v_accvgpr_write_b32 a9, v32
    v_accvgpr_write_b32 a10, v32
    v_accvgpr_write_b32 a11, v32
    v_mov_b32_dpp v33, v32 row_ror:1 row_mask:0xf bank_mask:0xf
    v_accvgpr_write_b32 a12, v33
    v_accvgpr_write_b32 a13, v33
    v_accvgpr_write_b32 a14, v33
    v_accvgpr_write_b32 a15, v33
    v_mov_b32_dpp v32, v33 row_ror:1 row_mask:0xf bank_mask:0xf
    v_accvgpr_write_b32 a16, v32
    v_accvgpr_write_b32 a17, v32
    v_accvgpr_write_b32 a18, v32
    v_accvgpr_write_b32 a19, v32
    v_mov_b32_dpp v33, v32 row_ror:1 row_mask:0xf bank_mask:0xf
    v_accvgpr_write_b32 a20, v33
    v_accvgpr_write_b32 a21, v33
    v_accvgpr_write_b32 a22, v33
    v_accvgpr_write_b32 a23, v33
    v_mov_b32_dpp v32, v33 row_ror:1 row_mask:0xf bank_mask:0xf
    v_accvgpr_write_b32 a24, v32
    v_accvgpr_write_b32 a25, v32
    v_accvgpr_write_b32 a26, v32
    v_accvgpr_write_b32 a27, v32
    v_mov_b32_dpp v33, v32 row_ror:1 row_mask:0xf bank_mask:0xf
    v_accvgpr_write_b32 a28, v33
    v_accvgpr_write_b32 a29, v33
    v_accvgpr_write_b32 a30, v33
    v_accvgpr_write_b32 a31, v33
    v_mov_b32_dpp v32, v33 row_ror:1 row_mask:0xf bank_mask:0xf
    v_accvgpr_write_b32 a32, v32
    v_accvgpr_write_b32 a33, v32
    v_accvgpr_write_b32 a34, v32
    v_accvgpr_write_b32 a35, v32
    v_mov_b32_dpp v33, v32 row_ror:1 row_mask:0xf bank_mask:0xf
    v_accvgpr_write_b32 a36, v33
    v_accvgpr_write_b32 a37, v33
    v_accvgpr_write_b32 a38, v33
    v_accvgpr_write_b32 a39, v33
    v_mov_b32_dpp v32, v33 row_ror:1 row_mask:0xf bank_mask:0xf
    v_accvgpr_write_b32 a40, v32
    v_accvgpr_write_b32 a41, v32
    v_accvgpr_write_b32 a42, v32
    v_accvgpr_write_b32 a43, v32
    v_mov_b32_dpp v33, v32 row_ror:1 row_mask:0xf bank_mask:0xf
    v_accvgpr_write_b32 a44, v33
    v_accvgpr_write_b32 a45, v33
    v_accvgpr_write_b32 a46, v33
    v_accvgpr_write_b32 a47, v33
    v_mov_b32_dpp v32, v33 row_ror:1 row_mask:0xf bank_mask:0xf
    v_accvgpr_write_b32 a48, v32
    v_accvgpr_write_b32 a49, v32
    v_accvgpr_write_b32 a50, v32
    v_accvgpr_write_b32 a51, v32
    v_mov_b32_dpp v33, v32 row_ror:1 row_mask:0xf bank_mask:0xf
    v_accvgpr_write_b32 a52, v33
    v_accvgpr_write_b32 a53, v33
    v_accvgpr_write_b32 a54, v33
    v_accvgpr_write_b32 a55, v33
    v_mov_b32_dpp v32, v33 row_ror:1 row_mask:0xf bank_mask:0xf
    v_accvgpr_write_b32 a56, v32
    v_accvgpr_write_b32 a57, v32
    v_accvgpr_write_b32 a58, v32
    v_accvgpr_write_b32 a59, v32
    v_mov_b32_dpp v33, v32 row_ror:1 row_mask:0xf bank_mask:0xf
    v_accvgpr_write_b32 a60, v33
    v_accvgpr_write_b32 a61, v33
    v_accvgpr_write_b32 a62, v33
    v_accvgpr_write_b32 a63, v33
    s_waitcnt lgkmcnt(0)
    v_mov_b32 v240, 0
    v_mov_b32 v243, 0
    s_sub_u32 s55, s96, 256
    s_cmp_lt_u32 s55, 48
    s_cselect_b32 s64, 1, 0
    s_cselect_b32 exec_hi, 4095, 0
    s_mov_b32 exec_lo, 4095
    s_sub_u32 s64, s53, s64
    s_mul_i32 s55, s97, 24576
    s_lshl_b32 s56, s64, 10
    s_add_u32 s55, s55, s56
    buffer_load_dword v28, v26, s[16:19], s55 offen
    s_mov_b64 exec, -1
    s_mov_b64 exec, 0
    s_cmp_eq_u32 s52, 0
    s_cbranch_scc1 L_hop1_0
    s_cmp_eq_u32 s52, 1
    s_cbranch_scc1 L_hop1_1
    s_cmp_eq_u32 s52, 2
    s_cbranch_scc1 L_hop1_2
    s_branch L_hop1_3
L_back1_0:
    s_mov_b64 exec, -1
    s_cmp_lt_u32 s96, 48
    s_cbranch_scc1 L_back1_1
    s_waitcnt vmcnt(4)
    v_mfma_f32_16x16x32_bf16 v[32:35], a[0:3], v[64:67], 0
    s_xor_b32 s55, s57, 4096
    buffer_load_dwordx4 v[80:83], v24, s[4:7], s55 offen
    v_lshlrev_b32 v128, 16, v64
    v_lshlrev_b32 v130, 16, v65
    v_lshlrev_b32 v132, 16, v66
    v_lshlrev_b32 v134, 16, v67
    v_dot2c_f32_bf16 v48, v64, v64
    v_and_b32 v129, s59, v64
    v_dot2c_f32_bf16 v48, v65, v65
    v_and_b32 v131, s59, v65
    v_dot2c_f32_bf16 v48, v66, v66
    v_and_b32 v133, s59, v66
    v_dot2c_f32_bf16 v48, v67, v67
    v_and_b32 v135, s59, v67
    s_waitcnt vmcnt(4)
    v_mfma_f32_16x16x32_bf16 v[32:35], a[4:7], v[68:71], v[32:35]
    s_xor_b32 s55, s57, 5120
    buffer_load_dwordx4 v[84:87], v24, s[4:7], s55 offen
    v_lshlrev_b32 v136, 16, v68
    v_lshlrev_b32 v138, 16, v69
    v_lshlrev_b32 v140, 16, v70
    v_lshlrev_b32 v142, 16, v71
    v_dot2c_f32_bf16 v49, v68, v68
    v_and_b32 v137, s59, v68
    v_dot2c_f32_bf16 v49, v69, v69
    v_and_b32 v139, s59, v69
    v_dot2c_f32_bf16 v49, v70, v70
    v_and_b32 v141, s59, v70
    v_dot2c_f32_bf16 v49, v71, v71
    v_and_b32 v143, s59, v71
    s_waitcnt vmcnt(4)
    v_mfma_f32_16x16x32_bf16 v[32:35], a[8:11], v[72:75], v[32:35]
    s_xor_b32 s55, s57, 6144
    buffer_load_dwordx4 v[88:91], v24, s[4:7], s55 offen
    v_lshlrev_b32 v144, 16, v72
    v_lshlrev_b32 v146, 16, v73
    v_lshlrev_b32 v148, 16, v74
    v_lshlrev_b32 v150, 16, v75
    v_dot2c_f32_bf16 v50, v72, v72
    v_and_b32 v145, s59, v72
    v_dot2c_f32_bf16 v50, v73, v73
    v_and_b32 v147, s59, v73
    v_dot2c_f32_bf16 v50, v74, v74
    v_and_b32 v149, s59, v74
    v_dot2c_f32_bf16 v50, v75, v75
    v_and_b32 v151, s59, v75
    s_waitcnt vmcnt(4)
    v_mfma_f32_16x16x32_bf16 v[32:35], a[12:15], v[76:79], v[32:35]
    s_xor_b32 s55, s57, 7168
    buffer_load_dwordx4 v[92:95], v24, s[4:7], s55 offen
    v_lshlrev_b32 v152, 16, v76
    v_lshlrev_b32 v154, 16, v77
    v_lshlrev_b32 v156, 16, v78
    v_lshlrev_b32 v158, 16, v79
    v_dot2c_f32_bf16 v51, v76, v76
    v_and_b32 v153, s59, v76
    v_dot2c_f32_bf16 v51, v77, v77
    v_and_b32 v155, s59, v77
    v_dot2c_f32_bf16 v51, v78, v78
    v_and_b32 v157, s59, v78
    v_dot2c_f32_bf16 v51, v79, v79
    v_and_b32 v159, s59, v79
    s_waitcnt vmcnt(3)
    v_mfma_f32_16x16x32_bf16 v[32:35], a[16:19], v[80:83], v[32:35]
    s_xor_b32 s55, s57, 8192
    buffer_load_dwordx4 v[96:99], v24, s[4:7], s55 offen
    v_lshlrev_b32 v160, 16, v80
    v_lshlrev_b32 v162, 16, v81
    v_lshlrev_b32 v164, 16, v82
    v_lshlrev_b32 v166, 16, v83
    v_dot2c_f32_bf16 v52, v80, v80
    v_and_b32 v161, s59, v80
    v_dot2c_f32_bf16 v52, v81, v81
    v_and_b32 v163, s59, v81
    v_dot2c_f32_bf16 v52, v82, v82
    v_and_b32 v165, s59, v82
    v_dot2c_f32_bf16 v52, v83, v83
    v_and_b32 v167, s59, v83
    s_waitcnt vmcnt(3)
    v_mfma_f32_16x16x32_bf16 v[32:35], a[20:23], v[84:87], v[32:35]
    s_xor_b32 s55, s57, 9216
    buffer_load_dwordx4 v[100:103], v24, s[4:7], s55 offen
    v_lshlrev_b32 v168, 16, v84
    v_lshlrev_b32 v170, 16, v85
    v_lshlrev_b32 v172, 16, v86
    v_lshlrev_b32 v174, 16, v87
    v_dot2c_f32_bf16 v53, v84, v84
    v_and_b32 v169, s59, v84
    v_dot2c_f32_bf16 v53, v85, v85
    v_and_b32 v171, s59, v85
    v_dot2c_f32_bf16 v53, v86, v86
    v_and_b32 v173, s59, v86
    v_dot2c_f32_bf16 v53, v87, v87
    v_and_b32 v175, s59, v87
    s_waitcnt vmcnt(3)
    v_mfma_f32_16x16x32_bf16 v[32:35], a[24:27], v[88:91], v[32:35]
    s_xor_b32 s55, s57, 10240
    buffer_load_dwordx4 v[104:107], v24, s[4:7], s55 offen
    v_lshlrev_b32 v176, 16, v88
    v_lshlrev_b32 v178, 16, v89
    v_lshlrev_b32 v180, 16, v90
    v_lshlrev_b32 v182, 16, v91
    v_dot2c_f32_bf16 v54, v88, v88
    v_and_b32 v177, s59, v88
    v_dot2c_f32_bf16 v54, v89, v89
    v_and_b32 v179, s59, v89
    v_dot2c_f32_bf16 v54, v90, v90
    v_and_b32 v181, s59, v90
    v_dot2c_f32_bf16 v54, v91, v91
    v_and_b32 v183, s59, v91
    s_waitcnt vmcnt(3)
    v_mfma_f32_16x16x32_bf16 v[32:35], a[28:31], v[92:95], v[32:35]
    s_xor_b32 s55, s57, 11264
    buffer_load_dwordx4 v[108:111], v24, s[4:7], s55 offen
    v_lshlrev_b32 v184, 16, v92
    v_lshlrev_b32 v186, 16, v93
    v_lshlrev_b32 v188, 16, v94
    v_lshlrev_b32 v190, 16, v95
    v_dot2c_f32_bf16 v55, v92, v92
    v_and_b32 v185, s59, v92
    v_dot2c_f32_bf16 v55, v93, v93
    v_and_b32 v187, s59, v93
    v_dot2c_f32_bf16 v55, v94, v94
    v_and_b32 v189, s59, v94
    v_dot2c_f32_bf16 v55, v95, v95
    v_and_b32 v191, s59, v95
    s_waitcnt vmcnt(3)
    v_mfma_f32_16x16x32_bf16 v[32:35], a[32:35], v[96:99], v[32:35]
    s_xor_b32 s55, s57, 12288
    buffer_load_dwordx4 v[112:115], v24, s[4:7], s55 offen
    v_lshlrev_b32 v192, 16, v96
    v_lshlrev_b32 v194, 16, v97
    v_lshlrev_b32 v196, 16, v98
    v_lshlrev_b32 v198, 16, v99
    v_dot2c_f32_bf16 v56, v96, v96
    v_and_b32 v193, s59, v96
    v_dot2c_f32_bf16 v56, v97, v97
    v_and_b32 v195, s59, v97
    v_dot2c_f32_bf16 v56, v98, v98
    v_and_b32 v197, s59, v98
    v_dot2c_f32_bf16 v56, v99, v99
    v_and_b32 v199, s59, v99
    s_waitcnt vmcnt(3)
    v_mfma_f32_16x16x32_bf16 v[32:35], a[36:39], v[100:103], v[32:35]
    s_xor_b32 s55, s57, 13312
    buffer_load_dwordx4 v[116:119], v24, s[4:7], s55 offen
    v_lshlrev_b32 v200, 16, v100
    v_lshlrev_b32 v202, 16, v101
    v_lshlrev_b32 v204, 16, v102
    v_lshlrev_b32 v206, 16, v103
    v_dot2c_f32_bf16 v57, v100, v100
    v_and_b32 v201, s59, v100
    v_dot2c_f32_bf16 v57, v101, v101
    v_and_b32 v203, s59, v101
    v_dot2c_f32_bf16 v57, v102, v102
    v_and_b32 v205, s59, v102
    v_dot2c_f32_bf16 v57, v103, v103
    v_and_b32 v207, s59, v103
    s_waitcnt vmcnt(3)
    v_mfma_f32_16x16x32_bf16 v[32:35], a[40:43], v[104:107], v[32:35]
    s_xor_b32 s55, s57, 14336
    buffer_load_dwordx4 v[120:123], v24, s[4:7], s55 offen
    v_lshlrev_b32 v208, 16, v104
    v_lshlrev_b32 v210, 16, v105
    v_lshlrev_b32 v212, 16, v106
    v_lshlrev_b32 v214, 16, v107
    v_dot2c_f32_bf16 v58, v104, v104
    v_and_b32 v209, s59, v104
    v_dot2c_f32_bf16 v58, v105, v105
    v_and_b32 v211, s59, v105
    v_dot2c_f32_bf16 v58, v106, v106
    v_and_b32 v213, s59, v106
    v_dot2c_f32_bf16 v58, v107, v107
    v_and_b32 v215, s59, v107
    s_waitcnt vmcnt(3)
    v_mfma_f32_16x16x32_bf16 v[32:35], a[44:47], v[108:111], v[32:35]
    s_xor_b32 s55, s57, 15360
    buffer_load_dwordx4 v[124:127], v24, s[4:7], s55 offen
    v_lshlrev_b32 v216, 16, v108
    v_lshlrev_b32 v218, 16, v109
    v_lshlrev_b32 v220, 16, v110
    v_lshlrev_b32 v222, 16, v111
    v_dot2c_f32_bf16 v59, v108, v108
    v_and_b32 v217, s59, v108
    v_dot2c_f32_bf16 v59, v109, v109
    v_and_b32 v219, s59, v109
    v_dot2c_f32_bf16 v59, v110, v110
    v_and_b32 v221, s59, v110
    v_dot2c_f32_bf16 v59, v111, v111
    v_and_b32 v223, s59, v111
    s_waitcnt vmcnt(3)
    v_mfma_f32_16x16x32_bf16 v[32:35], a[48:51], v[112:115], v[32:35]
    buffer_load_dword v29, off, s[44:47], 0 sc1
    s_add_u32 m0, s62, 131072
    s_add_u32 s56, s60, 0
    buffer_load_dwordx4 v2, s[16:19], s56 offen offset:0 lds
    buffer_load_dwordx4 v3, s[16:19], s56 offen offset:1024 lds
    buffer_load_dwordx4 v4, s[16:19], s56 offen offset:2048 lds
    buffer_load_dwordx4 v5, s[16:19], s56 offen offset:3072 lds
    v_lshlrev_b32 v224, 16, v112
    v_lshlrev_b32 v226, 16, v113
    v_lshlrev_b32 v228, 16, v114
    v_lshlrev_b32 v230, 16, v115
    v_dot2c_f32_bf16 v60, v112, v112
    v_and_b32 v225, s59, v112
    v_dot2c_f32_bf16 v60, v113, v113
    v_and_b32 v227, s59, v113
    v_dot2c_f32_bf16 v60, v114, v114
    v_and_b32 v229, s59, v114
    v_dot2c_f32_bf16 v60, v115, v115
    v_and_b32 v231, s59, v115
    s_waitcnt vmcnt(7)
    v_mfma_f32_16x16x32_bf16 v[32:35], a[52:55], v[116:119], v[32:35]
    s_add_u32 m0, s62, 147456
    s_add_u32 s56, s60, 262144
    buffer_load_dwordx4 v2, s[16:19], s56 offen offset:0 lds
    buffer_load_dwordx4 v3, s[16:19], s56 offen offset:1024 lds
    buffer_load_dwordx4 v4, s[16:19], s56 offen offset:2048 lds
    buffer_load_dwordx4 v5, s[16:19], s56 offen offset:3072 lds
    v_lshlrev_b32 v232, 16, v116
    v_lshlrev_b32 v234, 16, v117
    v_lshlrev_b32 v236, 16, v118
    v_lshlrev_b32 v238, 16, v119
    v_dot2c_f32_bf16 v61, v116, v116
    v_and_b32 v233, s59, v116
    v_dot2c_f32_bf16 v61, v117, v117
    v_and_b32 v235, s59, v117
    v_dot2c_f32_bf16 v61, v118, v118
    v_and_b32 v237, s59, v118
    v_dot2c_f32_bf16 v61, v119, v119
    v_and_b32 v239, s59, v119
    s_waitcnt vmcnt(10)
    v_mfma_f32_16x16x32_bf16 v[32:35], a[56:59], v[120:123], v[32:35]
    s_add_u32 m0, s62, 65536
    s_add_u32 s56, s60, 524288
    buffer_load_dwordx4 v2, s[16:19], s56 offen offset:0 lds
    buffer_load_dwordx4 v3, s[16:19], s56 offen offset:1024 lds
    buffer_load_dwordx4 v4, s[16:19], s56 offen offset:2048 lds
    buffer_load_dwordx4 v5, s[16:19], s56 offen offset:3072 lds
    v_lshlrev_b32 v240, 16, v120
    v_lshlrev_b32 v242, 16, v121
    v_lshlrev_b32 v244, 16, v122
    v_lshlrev_b32 v246, 16, v123
    v_dot2c_f32_bf16 v62, v120, v120
    v_and_b32 v241, s59, v120
    v_dot2c_f32_bf16 v62, v121, v121
    v_and_b32 v243, s59, v121
    v_dot2c_f32_bf16 v62, v122, v122
    v_and_b32 v245, s59, v122
    v_dot2c_f32_bf16 v62, v123, v123
    v_and_b32 v247, s59, v123
    s_waitcnt vmcnt(13)
    v_mfma_f32_16x16x32_bf16 v[32:35], a[60:63], v[124:127], v[32:35]
    s_add_u32 m0, s62, 81920
    s_add_u32 s56, s60, 786432
    buffer_load_dwordx4 v2, s[16:19], s56 offen offset:0 lds
    buffer_load_dwordx4 v3, s[16:19], s56 offen offset:1024 lds
    buffer_load_dwordx4 v4, s[16:19], s56 offen offset:2048 lds
    buffer_load_dwordx4 v5, s[16:19], s56 offen offset:3072 lds
    v_lshlrev_b32 v248, 16, v124
    v_lshlrev_b32 v250, 16, v125
    v_lshlrev_b32 v252, 16, v126
    v_lshlrev_b32 v254, 16, v127
    v_dot2c_f32_bf16 v63, v124, v124
    v_and_b32 v249, s59, v124
    v_dot2c_f32_bf16 v63, v125, v125
    v_and_b32 v251, s59, v125
    v_dot2c_f32_bf16 v63, v126, v126
    v_and_b32 v253, s59, v126
    v_dot2c_f32_bf16 v63, v127, v127
    v_and_b32 v255, s59, v127
L_prodj_4:
L_hopp_1:
    s_cbranch_execz L_hop1_3
    v_permlane32_swap_b32 v48, v56
    v_permlane32_swap_b32 v49, v57
    v_permlane32_swap_b32 v50, v58
    v_permlane32_swap_b32 v51, v59
    v_permlane32_swap_b32 v52, v60
    v_permlane32_swap_b32 v53, v61
    v_permlane32_swap_b32 v54, v62
    v_permlane32_swap_b32 v55, v63
    v_add_f32 v48, v48, v56
    v_add_f32 v49, v49, v57
    v_add_f32 v50, v50, v58
    v_add_f32 v51, v51, v59
    v_add_f32 v52, v52, v60
    v_add_f32 v53, v53, v61
    v_add_f32 v54, v54, v62
    v_add_f32 v55, v55, v63
    s_add_u32 m0, s62, 98304
    s_add_u32 s56, s60, 1048576
    buffer_load_dwordx4 v2, s[16:19], s56 offen offset:0 lds
    v_permlane16_swap_b32 v48, v52
    v_permlane16_swap_b32 v49, v53
    v_permlane16_swap_b32 v50, v54
    v_permlane16_swap_b32 v51, v55
    v_add_f32 v48, v48, v52
    v_add_f32 v49, v49, v53
    v_add_f32 v50, v50, v54
    v_add_f32 v51, v51, v55
    v_add_f32_dpp v32, v32, v32 row_ror:8 row_mask:0xf bank_mask:0xf
    v_add_f32_dpp v33, v33, v33 row_ror:8 row_mask:0xf bank_mask:0xf
    v_add_f32_dpp v34, v34, v34 row_ror:8 row_mask:0xf bank_mask:0xf
    v_add_f32_dpp v35, v35, v35 row_ror:8 row_mask:0xf bank_mask:0xf
    v_add_f32_dpp v48, v48, v48 row_ror:8 row_mask:0xf bank_mask:0xf
    v_add_f32_dpp v49, v49, v49 row_ror:8 row_mask:0xf bank_mask:0xf
    v_add_f32_dpp v50, v50, v50 row_ror:8 row_mask:0xf bank_mask:0xf
    v_add_f32_dpp v51, v51, v51 row_ror:8 row_mask:0xf bank_mask:0xf
    buffer_load_dwordx4 v3, s[16:19], s56 offen offset:1024 lds
    v_add_f32_dpp v32, v32, v32 row_ror:4 row_mask:0xf bank_mask:0xf
    v_add_f32_dpp v33, v33, v33 row_ror:4 row_mask:0xf bank_mask:0xf
    v_add_f32_dpp v34, v34, v34 row_ror:4 row_mask:0xf bank_mask:0xf
    v_add_f32_dpp v35, v35, v35 row_ror:4 row_mask:0xf bank_mask:0xf
    v_add_f32_dpp v48, v48, v48 row_ror:4 row_mask:0xf bank_mask:0xf
    v_add_f32_dpp v49, v49, v49 row_ror:4 row_mask:0xf bank_mask:0xf
    v_add_f32_dpp v50, v50, v50 row_ror:4 row_mask:0xf bank_mask:0xf
    v_add_f32_dpp v51, v51, v51 row_ror:4 row_mask:0xf bank_mask:0xf
    v_add_f32_dpp v32, v32, v32 row_ror:2 row_mask:0xf bank_mask:0xf
    v_add_f32_dpp v33, v33, v33 row_ror:2 row_mask:0xf bank_mask:0xf
    v_add_f32_dpp v34, v34, v34 row_ror:2 row_mask:0xf bank_mask:0xf
    v_add_f32_dpp v35, v35, v35 row_ror:2 row_mask:0xf bank_mask:0xf
    v_add_f32_dpp v48, v48, v48 row_ror:2 row_mask:0xf bank_mask:0xf
    v_add_f32_dpp v49, v49, v49 row_ror:2 row_mask:0xf bank_mask:0xf
    v_add_f32_dpp v50, v50, v50 row_ror:2 row_mask:0xf bank_mask:0xf
    v_add_f32_dpp v51, v51, v51 row_ror:2 row_mask:0xf bank_mask:0xf
    buffer_load_dwordx4 v4, s[16:19], s56 offen offset:2048 lds
    v_add_f32_dpp v32, v32, v32 row_ror:1 row_mask:0xf bank_mask:0xf
    v_add_f32_dpp v33, v33, v33 row_ror:1 row_mask:0xf bank_mask:0xf
    v_add_f32_dpp v34, v34, v34 row_ror:1 row_mask:0xf bank_mask:0xf
    v_add_f32_dpp v35, v35, v35 row_ror:1 row_mask:0xf bank_mask:0xf
    v_add_f32_dpp v48, v48, v48 row_ror:1 row_mask:0xf bank_mask:0xf
    v_add_f32_dpp v49, v49, v49 row_ror:1 row_mask:0xf bank_mask:0xf
    v_add_f32_dpp v50, v50, v50 row_ror:1 row_mask:0xf bank_mask:0xf
    v_add_f32_dpp v51, v51, v51 row_ror:1 row_mask:0xf bank_mask:0xf
    v_mul_f32 v32, 0xbb000000, v32
    v_mul_f32 v33, 0xbb000000, v33
    v_mul_f32 v34, 0xbb000000, v34
    v_mul_f32 v35, 0xbb000000, v35
    v_mul_f32 v48, 0x3b000000, v48
    v_mul_f32 v49, 0x3b000000, v49
    v_mul_f32 v50, 0x3b000000, v50
    v_mul_f32 v51, 0x3b000000, v51
    buffer_load_dwordx4 v5, s[16:19], s56 offen offset:3072 lds
    v_fma_f32 v48, -v32, v32, v48
    v_fma_f32 v49, -v33, v33, v49
    v_fma_f32 v50, -v34, v34, v50
    v_fma_f32 v51, -v35, v35, v51
    v_max_f32 v48, 0, v48
    v_max_f32 v49, 0, v49
    v_max_f32 v50, 0, v50
    v_max_f32 v51, 0, v51
    v_add_f32 v48, 0x3727c5ac, v48
    v_add_f32 v49, 0x3727c5ac, v49
    v_add_f32 v50, 0x3727c5ac, v50
    v_add_f32 v51, 0x3727c5ac, v51
    v_rsq_f32 v48, v48
    v_rsq_f32 v49, v49
    v_rsq_f32 v50, v50
    v_rsq_f32 v51, v51
    s_add_u32 m0, s62, 114688
    s_add_u32 s56, s60, 1310720
    buffer_load_dwordx4 v2, s[16:19], s56 offen offset:0 lds
    v_mul_f32 v32, v32, v48
    v_mul_f32 v33, v33, v49
    v_mul_f32 v34, v34, v50
    v_mul_f32 v35, v35, v51
    v_readlane_b32 s64, v48, 0
    v_readlane_b32 s65, v32, 0
    v_readlane_b32 s66, v49, 0
    v_readlane_b32 s67, v33, 0
    v_readlane_b32 s68, v50, 0
    v_readlane_b32 s69, v34, 0
    v_readlane_b32 s70, v51, 0
    v_readlane_b32 s71, v35, 0
    v_readlane_b32 s72, v48, 16
    v_readlane_b32 s73, v32, 16
    v_readlane_b32 s74, v49, 16
    v_readlane_b32 s75, v33, 16
    buffer_load_dwordx4 v3, s[16:19], s56 offen offset:1024 lds
    v_readlane_b32 s76, v50, 16
    v_readlane_b32 s77, v34, 16
    v_readlane_b32 s78, v51, 16
    v_readlane_b32 s79, v35, 16
    v_readlane_b32 s80, v48, 32
    v_readlane_b32 s81, v32, 32
    v_readlane_b32 s82, v49, 32
    v_readlane_b32 s83, v33, 32
    v_readlane_b32 s84, v50, 32
    v_readlane_b32 s85, v34, 32
    v_readlane_b32 s86, v51, 32
    v_readlane_b32 s87, v35, 32
    v_readlane_b32 s88, v48, 48
    v_readlane_b32 s89, v32, 48
    v_readlane_b32 s90, v49, 48
    v_readlane_b32 s91, v33, 48
    buffer_load_dwordx4 v4, s[16:19], s56 offen offset:2048 lds
    v_readlane_b32 s92, v50, 48
    v_readlane_b32 s93, v34, 48
    v_readlane_b32 s94, v51, 48
    v_readlane_b32 s95, v35, 48
    s_waitcnt vmcnt(23)
    v_cmp_eq_u32 vcc, 0, v29
    s_nop 0
    s_cbranch_vccz L_z_12
    s_mov_b64 exec, 0x1
    s_mov_b32 s98, 0x200000
L_poll_13:
    buffer_load_dword v29, v31, s[44:47], 0 offen offset:0 sc1
    s_sub_u32 s98, s98, 1
    s_cbranch_scc1 L_pollout_14
    s_waitcnt vmcnt(0)
    v_cmp_gt_u32 vcc, 1, v29
    s_nop 0
    s_cbranch_vccnz L_poll_13
L_pollout_14:
    s_waitcnt vmcnt(0)
    s_mov_b64 exec, -1
L_z_12:
    buffer_load_dwordx4 v[96:99], v24, s[48:51], 0 offen offset:0 sc1
    buffer_load_dwordx4 v[100:103], v24, s[48:51], 0 offen offset:1024 sc1
    buffer_load_dwordx4 v[104:107], v24, s[48:51], 0 offen offset:2048 sc1
    buffer_load_dwordx4 v[108:111], v24, s[48:51], 0 offen offset:3072 sc1
    v_pk_fma_f32 v[128:129], v[128:129], s[64:65], s[64:65] op_sel:[0,0,1] op_sel_hi:[1,0,1]
    v_pk_fma_f32 v[130:131], v[130:131], s[64:65], s[64:65] op_sel:[0,0,1] op_sel_hi:[1,0,1]
    v_pk_fma_f32 v[132:133], v[132:133], s[64:65], s[64:65] op_sel:[0,0,1] op_sel_hi:[1,0,1]
    v_pk_fma_f32 v[134:135], v[134:135], s[64:65], s[64:65] op_sel:[0,0,1] op_sel_hi:[1,0,1]
    v_pk_fma_f32 v[136:137], v[136:137], s[66:67], s[66:67] op_sel:[0,0,1] op_sel_hi:[1,0,1]
    v_pk_fma_f32 v[138:139], v[138:139], s[66:67], s[66:67] op_sel:[0,0,1] op_sel_hi:[1,0,1]
    v_pk_fma_f32 v[140:141], v[140:141], s[66:67], s[66:67] op_sel:[0,0,1] op_sel_hi:[1,0,1]
    v_pk_fma_f32 v[142:143], v[142:143], s[66:67], s[66:67] op_sel:[0,0,1] op_sel_hi:[1,0,1]
    v_pk_fma_f32 v[144:145], v[144:145], s[68:69], s[68:69] op_sel:[0,0,1] op_sel_hi:[1,0,1]
    v_pk_fma_f32 v[146:147], v[146:147], s[68:69], s[68:69] op_sel:[0,0,1] op_sel_hi:[1,0,1]
    v_pk_fma_f32 v[148:149], v[148:149], s[68:69], s[68:69] op_sel:[0,0,1] op_sel_hi:[1,0,1]
    v_pk_fma_f32 v[150:151], v[150:151], s[68:69], s[68:69] op_sel:[0,0,1] op_sel_hi:[1,0,1]
    buffer_load_dwordx4 v5, s[16:19], s56 offen offset:3072 lds
    v_pk_fma_f32 v[152:153], v[152:153], s[70:71], s[70:71] op_sel:[0,0,1] op_sel_hi:[1,0,1]
    v_pk_fma_f32 v[154:155], v[154:155], s[70:71], s[70:71] op_sel:[0,0,1] op_sel_hi:[1,0,1]
    v_pk_fma_f32 v[156:157], v[156:157], s[70:71], s[70:71] op_sel:[0,0,1] op_sel_hi:[1,0,1]
    v_pk_fma_f32 v[158:159], v[158:159], s[70:71], s[70:71] op_sel:[0,0,1] op_sel_hi:[1,0,1]
    v_pk_fma_f32 v[160:161], v[160:161], s[72:73], s[72:73] op_sel:[0,0,1] op_sel_hi:[1,0,1]
    v_pk_fma_f32 v[162:163], v[162:163], s[72:73], s[72:73] op_sel:[0,0,1] op_sel_hi:[1,0,1]
    v_pk_fma_f32 v[164:165], v[164:165], s[72:73], s[72:73] op_sel:[0,0,1] op_sel_hi:[1,0,1]
    v_pk_fma_f32 v[166:167], v[166:167], s[72:73], s[72:73] op_sel:[0,0,1] op_sel_hi:[1,0,1]
    v_pk_fma_f32 v[168:169], v[168:169], s[74:75], s[74:75] op_sel:[0,0,1] op_sel_hi:[1,0,1]
    v_pk_fma_f32 v[170:171], v[170:171], s[74:75], s[74:75] op_sel:[0,0,1] op_sel_hi:[1,0,1]
    v_pk_fma_f32 v[172:173], v[172:173], s[74:75], s[74:75] op_sel:[0,0,1] op_sel_hi:[1,0,1]
    v_pk_fma_f32 v[174:175], v[174:175], s[74:75], s[74:75] op_sel:[0,0,1] op_sel_hi:[1,0,1]
    v_pk_fma_f32 v[176:177], v[176:177], s[76:77], s[76:77] op_sel:[0,0,1] op_sel_hi:[1,0,1]
    v_pk_fma_f32 v[178:179], v[178:179], s[76:77], s[76:77] op_sel:[0,0,1] op_sel_hi:[1,0,1]
    v_pk_fma_f32 v[180:181], v[180:181], s[76:77], s[76:77] op_sel:[0,0,1] op_sel_hi:[1,0,1]
    v_pk_fma_f32 v[182:183], v[182:183], s[76:77], s[76:77] op_sel:[0,0,1] op_sel_hi:[1,0,1]
    v_pk_fma_f32 v[184:185], v[184:185], s[78:79], s[78:79] op_sel:[0,0,1] op_sel_hi:[1,0,1]
    v_pk_fma_f32 v[186:187], v[186:187], s[78:79], s[78:79] op_sel:[0,0,1] op_sel_hi:[1,0,1]
    v_pk_fma_f32 v[188:189], v[188:189], s[78:79], s[78:79] op_sel:[0,0,1] op_sel_hi:[1,0,1]
    v_pk_fma_f32 v[190:191], v[190:191], s[78:79], s[78:79] op_sel:[0,0,1] op_sel_hi:[1,0,1]
    v_pk_fma_f32 v[192:193], v[192:193], s[80:81], s[80:81] op_sel:[0,0,1] op_sel_hi:[1,0,1]
    v_pk_fma_f32 v[194:195], v[194:195], s[80:81], s[80:81] op_sel:[0,0,1] op_sel_hi:[1,0,1]
    v_pk_fma_f32 v[196:197], v[196:197], s[80:81], s[80:81] op_sel:[0,0,1] op_sel_hi:[1,0,1]
    v_pk_fma_f32 v[198:199], v[198:199], s[80:81], s[80:81] op_sel:[0,0,1] op_sel_hi:[1,0,1]
L_hop1_0:
    s_cbranch_execz L_hop1_4
    v_pk_fma_f32 v[200:201], v[200:201], s[82:83], s[82:83] op_sel:[0,0,1] op_sel_hi:[1,0,1]
    v_pk_fma_f32 v[202:203], v[202:203], s[82:83], s[82:83] op_sel:[0,0,1] op_sel_hi:[1,0,1]
    v_pk_fma_f32 v[204:205], v[204:205], s[82:83], s[82:83] op_sel:[0,0,1] op_sel_hi:[1,0,1]
    v_pk_fma_f32 v[206:207], v[206:207], s[82:83], s[82:83] op_sel:[0,0,1] op_sel_hi:[1,0,1]
    v_pk_fma_f32 v[208:209], v[208:209], s[84:85], s[84:85] op_sel:[0,0,1] op_sel_hi:[1,0,1]
    v_pk_fma_f32 v[210:211], v[210:211], s[84:85], s[84:85] op_sel:[0,0,1] op_sel_hi:[1,0,1]
    v_pk_fma_f32 v[212:213], v[212:213], s[84:85], s[84:85] op_sel:[0,0,1] op_sel_hi:[1,0,1]
    v_pk_fma_f32 v[214:215], v[214:215], s[84:85], s[84:85] op_sel:[0,0,1] op_sel_hi:[1,0,1]
    v_pk_fma_f32 v[216:217], v[216:217], s[86:87], s[86:87] op_sel:[0,0,1] op_sel_hi:[1,0,1]
    v_pk_fma_f32 v[218:219], v[218:219], s[86:87], s[86:87] op_sel:[0,0,1] op_sel_hi:[1,0,1]
    v_pk_fma_f32 v[220:221], v[220:221], s[86:87], s[86:87] op_sel:[0,0,1] op_sel_hi:[1,0,1]
    v_pk_fma_f32 v[222:223], v[222:223], s[86:87], s[86:87] op_sel:[0,0,1] op_sel_hi:[1,0,1]
    v_pk_fma_f32 v[224:225], v[224:225], s[88:89], s[88:89] op_sel:[0,0,1] op_sel_hi:[1,0,1]
    v_pk_fma_f32 v[226:227], v[226:227], s[88:89], s[88:89] op_sel:[0,0,1] op_sel_hi:[1,0,1]
    v_pk_fma_f32 v[228:229], v[228:229], s[88:89], s[88:89] op_sel:[0,0,1] op_sel_hi:[1,0,1]
    v_pk_fma_f32 v[230:231], v[230:231], s[88:89], s[88:89] op_sel:[0,0,1] op_sel_hi:[1,0,1]
    v_pk_fma_f32 v[232:233], v[232:233], s[90:91], s[90:91] op_sel:[0,0,1] op_sel_hi:[1,0,1]
    v_pk_fma_f32 v[234:235], v[234:235], s[90:91], s[90:91] op_sel:[0,0,1] op_sel_hi:[1,0,1]
    v_pk_fma_f32 v[236:237], v[236:237], s[90:91], s[90:91] op_sel:[0,0,1] op_sel_hi:[1,0,1]
    v_pk_fma_f32 v[238:239], v[238:239], s[90:91], s[90:91] op_sel:[0,0,1] op_sel_hi:[1,0,1]
    v_pk_fma_f32 v[240:241], v[240:241], s[92:93], s[92:93] op_sel:[0,0,1] op_sel_hi:[1,0,1]
    v_pk_fma_f32 v[242:243], v[242:243], s[92:93], s[92:93] op_sel:[0,0,1] op_sel_hi:[1,0,1]
    v_pk_fma_f32 v[244:245], v[244:245], s[92:93], s[92:93] op_sel:[0,0,1] op_sel_hi:[1,0,1]
    v_pk_fma_f32 v[246:247], v[246:247], s[92:93], s[92:93] op_sel:[0,0,1] op_sel_hi:[1,0,1]
    v_pk_fma_f32 v[248:249], v[248:249], s[94:95], s[94:95] op_sel:[0,0,1] op_sel_hi:[1,0,1]
    v_pk_fma_f32 v[250:251], v[250:251], s[94:95], s[94:95] op_sel:[0,0,1] op_sel_hi:[1,0,1]
    v_pk_fma_f32 v[252:253], v[252:253], s[94:95], s[94:95] op_sel:[0,0,1] op_sel_hi:[1,0,1]
    v_pk_fma_f32 v[254:255], v[254:255], s[94:95], s[94:95] op_sel:[0,0,1] op_sel_hi:[1,0,1]
    s_mov_b32 s98, 0x200000
    s_waitcnt vmcnt(1)
L_mv_15:
    v_min3_u32 v48, v96, v97, v98
    v_min3_u32 v49, v99, v100, v101
    v_min3_u32 v50, v102, v103, v104
    v_min3_u32 v51, v105, v106, v107
    v_min3_u32 v52, v108, v109, v110
    v_min3_u32 v48, v48, v49, v111
    v_min3_u32 v50, v50, v51, v52
    v_min_u32 v48, v48, v50
    v_cmp_eq_u32 vcc, 0, v48
    s_nop 0
    s_cbranch_vccz L_mvok_16
    buffer_load_dwordx4 v[96:99], v24, s[48:51], 0 offen offset:0 sc1
    buffer_load_dwordx4 v[100:103], v24, s[48:51], 0 offen offset:1024 sc1
    buffer_load_dwordx4 v[104:107], v24, s[48:51], 0 offen offset:2048 sc1
    buffer_load_dwordx4 v[108:111], v24, s[48:51], 0 offen offset:3072 sc1
    s_sub_u32 s98, s98, 1
    s_waitcnt vmcnt(0)
    s_cbranch_scc0 L_mv_15
L_mvok_16:
    v_pk_fma_f32 v[128:129], v[128:129], v[104:105], v[96:97]
    v_pk_fma_f32 v[130:131], v[130:131], v[106:107], v[98:99]
    v_pk_fma_f32 v[132:133], v[132:133], v[108:109], v[100:101]
    v_pk_fma_f32 v[134:135], v[134:135], v[110:111], v[102:103]
    v_xor_b32 v32, 0, v27
    v_cvt_pk_bf16_f32 v64, v128, v129
    v_cvt_pk_bf16_f32 v65, v130, v131
    v_cvt_pk_bf16_f32 v66, v132, v133
    v_cvt_pk_bf16_f32 v67, v134, v135
    ds_write_b128 v32, v[64:67]
    v_lshlrev_b32 v24, 7, v0
    s_lshl_b32 s56, s53, 10
    s_mov_b32 exec_hi, 0
    s_mov_b32 exec_lo, 1048575
    s_mul_i32 s55, s97, 40960
    s_add_u32 s55, s55, s56
    s_add_u32 s55, s55, 1572864
    buffer_load_dword v28, v26, s[16:19], s55 offen
    s_mov_b32 exec_lo, -1
    s_lshl_b32 s55, s97, 16
    s_add_u32 s55, s55, s56
    buffer_load_dword v28, v26, s[16:19], s55 offen offset:128
    s_mov_b32 exec_lo, 15
    s_mul_i32 s55, s97, 512
    s_lshl_b32 s56, s53, 19
    s_add_u32 s55, s55, s56
    s_add_u32 s55, s55, 393216
    buffer_load_dword v28, v24, s[8:11], s55 offen
    buffer_load_dword v28, v24, s[12:15], s55 offen
    s_mov_b64 exec, -1
    v_pk_fma_f32 v[136:137], v[136:137], v[104:105], v[96:97]
    v_pk_fma_f32 v[138:139], v[138:139], v[106:107], v[98:99]
    v_pk_fma_f32 v[140:141], v[140:141], v[108:109], v[100:101]
    v_pk_fma_f32 v[142:143], v[142:143], v[110:111], v[102:103]
    v_xor_b32 v33, 16, v27
    v_cvt_pk_bf16_f32 v68, v136, v137
    v_cvt_pk_bf16_f32 v69, v138, v139
    v_cvt_pk_bf16_f32 v70, v140, v141
    v_cvt_pk_bf16_f32 v71, v142, v143
    ds_write_b128 v33, v[68:71]
    v_pk_fma_f32 v[144:145], v[144:145], v[104:105], v[96:97]
    v_pk_fma_f32 v[146:147], v[146:147], v[106:107], v[98:99]
    v_pk_fma_f32 v[148:149], v[148:149], v[108:109], v[100:101]
    v_pk_fma_f32 v[150:151], v[150:151], v[110:111], v[102:103]
    v_xor_b32 v34, 32, v27
    v_cvt_pk_bf16_f32 v72, v144, v145
    v_cvt_pk_bf16_f32 v73, v146, v147
    v_cvt_pk_bf16_f32 v74, v148, v149
    v_cvt_pk_bf16_f32 v75, v150, v151
    ds_write_b128 v34, v[72:75]
    v_pk_fma_f32 v[152:153], v[152:153], v[104:105], v[96:97]
    v_pk_fma_f32 v[154:155], v[154:155], v[106:107], v[98:99]
    v_pk_fma_f32 v[156:157], v[156:157], v[108:109], v[100:101]
    v_pk_fma_f32 v[158:159], v[158:159], v[110:111], v[102:103]
    v_xor_b32 v35, 48, v27
    v_cvt_pk_bf16_f32 v76, v152, v153
    v_cvt_pk_bf16_f32 v77, v154, v155
    v_cvt_pk_bf16_f32 v78, v156, v157
    v_cvt_pk_bf16_f32 v79, v158, v159
    ds_write_b128 v35, v[76:79]
    v_pk_fma_f32 v[160:161], v[160:161], v[104:105], v[96:97]
    v_pk_fma_f32 v[162:163], v[162:163], v[106:107], v[98:99]
    v_pk_fma_f32 v[164:165], v[164:165], v[108:109], v[100:101]
    v_pk_fma_f32 v[166:167], v[166:167], v[110:111], v[102:103]
    v_xor_b32 v36, 64, v27
    v_cvt_pk_bf16_f32 v80, v160, v161
    v_cvt_pk_bf16_f32 v81, v162, v163
    v_cvt_pk_bf16_f32 v82, v164, v165
    v_cvt_pk_bf16_f32 v83, v166, v167
    ds_write_b128 v36, v[80:83]
    v_pk_fma_f32 v[168:169], v[168:169], v[104:105], v[96:97]
    v_pk_fma_f32 v[170:171], v[170:171], v[106:107], v[98:99]
    v_pk_fma_f32 v[172:173], v[172:173], v[108:109], v[100:101]
    v_pk_fma_f32 v[174:175], v[174:175], v[110:111], v[102:103]
    v_xor_b32 v37, 80, v27
    v_cvt_pk_bf16_f32 v84, v168, v169
    v_cvt_pk_bf16_f32 v85, v170, v171
    v_cvt_pk_bf16_f32 v86, v172, v173
    v_cvt_pk_bf16_f32 v87, v174, v175
    ds_write_b128 v37, v[84:87]
    v_pk_fma_f32 v[176:177], v[176:177], v[104:105], v[96:97]
    v_pk_fma_f32 v[178:179], v[178:179], v[106:107], v[98:99]
    v_pk_fma_f32 v[180:181], v[180:181], v[108:109], v[100:101]
    v_pk_fma_f32 v[182:183], v[182:183], v[110:111], v[102:103]
    v_xor_b32 v38, 96, v27
    v_cvt_pk_bf16_f32 v88, v176, v177
    v_cvt_pk_bf16_f32 v89, v178, v179
    v_cvt_pk_bf16_f32 v90, v180, v181
    v_cvt_pk_bf16_f32 v91, v182, v183
    ds_write_b128 v38, v[88:91]
    v_pk_fma_f32 v[184:185], v[184:185], v[104:105], v[96:97]
    v_pk_fma_f32 v[186:187], v[186:187], v[106:107], v[98:99]
    v_pk_fma_f32 v[188:189], v[188:189], v[108:109], v[100:101]
    v_pk_fma_f32 v[190:191], v[190:191], v[110:111], v[102:103]
    v_xor_b32 v39, 112, v27
    v_cvt_pk_bf16_f32 v92, v184, v185
    v_cvt_pk_bf16_f32 v93, v186, v187
    v_cvt_pk_bf16_f32 v94, v188, v189
    v_cvt_pk_bf16_f32 v95, v190, v191
    ds_write_b128 v39, v[92:95]
    v_pk_fma_f32 v[192:193], v[192:193], v[104:105], v[96:97]
    v_pk_fma_f32 v[194:195], v[194:195], v[106:107], v[98:99]
    v_pk_fma_f32 v[196:197], v[196:197], v[108:109], v[100:101]
    v_pk_fma_f32 v[198:199], v[198:199], v[110:111], v[102:103]
    v_xor_b32 v40, 128, v27
    v_cvt_pk_bf16_f32 v64, v192, v193
    v_cvt_pk_bf16_f32 v65, v194, v195
    v_cvt_pk_bf16_f32 v66, v196, v197
    v_cvt_pk_bf16_f32 v67, v198, v199
    ds_write_b128 v40, v[64:67]
    v_pk_fma_f32 v[200:201], v[200:201], v[104:105], v[96:97]
    v_pk_fma_f32 v[202:203], v[202:203], v[106:107], v[98:99]
    v_pk_fma_f32 v[204:205], v[204:205], v[108:109], v[100:101]
    v_pk_fma_f32 v[206:207], v[206:207], v[110:111], v[102:103]
    v_xor_b32 v41, 144, v27
    v_cvt_pk_bf16_f32 v68, v200, v201
    v_cvt_pk_bf16_f32 v69, v202, v203
    v_cvt_pk_bf16_f32 v70, v204, v205
    v_cvt_pk_bf16_f32 v71, v206, v207
    ds_write_b128 v41, v[68:71]
    v_pk_fma_f32 v[208:209], v[208:209], v[104:105], v[96:97]
    v_pk_fma_f32 v[210:211], v[210:211], v[106:107], v[98:99]
    v_pk_fma_f32 v[212:213], v[212:213], v[108:109], v[100:101]
    v_pk_fma_f32 v[214:215], v[214:215], v[110:111], v[102:103]
    v_xor_b32 v42, 160, v27
    v_cvt_pk_bf16_f32 v72, v208, v209
    v_cvt_pk_bf16_f32 v73, v210, v211
    v_cvt_pk_bf16_f32 v74, v212, v213
    v_cvt_pk_bf16_f32 v75, v214, v215
    ds_write_b128 v42, v[72:75]
    v_pk_fma_f32 v[216:217], v[216:217], v[104:105], v[96:97]
    v_pk_fma_f32 v[218:219], v[218:219], v[106:107], v[98:99]
    v_pk_fma_f32 v[220:221], v[220:221], v[108:109], v[100:101]
    v_pk_fma_f32 v[222:223], v[222:223], v[110:111], v[102:103]
    v_xor_b32 v43, 176, v27
    v_cvt_pk_bf16_f32 v76, v216, v217
    v_cvt_pk_bf16_f32 v77, v218, v219
    v_cvt_pk_bf16_f32 v78, v220, v221
    v_cvt_pk_bf16_f32 v79, v222, v223
    ds_write_b128 v43, v[76:79]
    v_pk_fma_f32 v[224:225], v[224:225], v[104:105], v[96:97]
    v_pk_fma_f32 v[226:227], v[226:227], v[106:107], v[98:99]
    v_pk_fma_f32 v[228:229], v[228:229], v[108:109], v[100:101]
    v_pk_fma_f32 v[230:231], v[230:231], v[110:111], v[102:103]
    v_xor_b32 v44, 192, v27
    v_cvt_pk_bf16_f32 v80, v224, v225
    v_cvt_pk_bf16_f32 v81, v226, v227
    v_cvt_pk_bf16_f32 v82, v228, v229
    v_cvt_pk_bf16_f32 v83, v230, v231
    ds_write_b128 v44, v[80:83]
    v_pk_fma_f32 v[232:233], v[232:233], v[104:105], v[96:97]
    v_pk_fma_f32 v[234:235], v[234:235], v[106:107], v[98:99]
    v_pk_fma_f32 v[236:237], v[236:237], v[108:109], v[100:101]
    v_pk_fma_f32 v[238:239], v[238:239], v[110:111], v[102:103]
    v_xor_b32 v45, 208, v27
    v_cvt_pk_bf16_f32 v84, v232, v233
    v_cvt_pk_bf16_f32 v85, v234, v235
    v_cvt_pk_bf16_f32 v86, v236, v237
    v_cvt_pk_bf16_f32 v87, v238, v239
    ds_write_b128 v45, v[84:87]
    v_pk_fma_f32 v[240:241], v[240:241], v[104:105], v[96:97]
    v_pk_fma_f32 v[242:243], v[242:243], v[106:107], v[98:99]
    v_pk_fma_f32 v[244:245], v[244:245], v[108:109], v[100:101]
    v_pk_fma_f32 v[246:247], v[246:247], v[110:111], v[102:103]
    v_xor_b32 v46, 224, v27
    v_cvt_pk_bf16_f32 v88, v240, v241
    v_cvt_pk_bf16_f32 v89, v242, v243
    v_cvt_pk_bf16_f32 v90, v244, v245
    v_cvt_pk_bf16_f32 v91, v246, v247
    ds_write_b128 v46, v[88:91]
    v_pk_fma_f32 v[248:249], v[248:249], v[104:105], v[96:97]
    v_pk_fma_f32 v[250:251], v[250:251], v[106:107], v[98:99]
    v_pk_fma_f32 v[252:253], v[252:253], v[108:109], v[100:101]
    v_pk_fma_f32 v[254:255], v[254:255], v[110:111], v[102:103]
    v_xor_b32 v47, 240, v27
    v_cvt_pk_bf16_f32 v92, v248, v249
    v_cvt_pk_bf16_f32 v93, v250, v251
    v_cvt_pk_bf16_f32 v94, v252, v253
    v_cvt_pk_bf16_f32 v95, v254, v255
    ds_write_b128 v47, v[92:95]
    s_waitcnt lgkmcnt(0)
    s_barrier
    ds_read_b128 a[0:3], v22 offset:0
    ds_read_b128 a[4:7], v22 offset:16384
    ds_read_b128 a[8:11], v22 offset:32768
    ds_read_b128 a[12:15], v22 offset:49152
    ds_read_b64_tr_b16 v[96:97], v14 offset:0
    ds_read_b64_tr_b16 v[98:99], v14 offset:2048
    ds_read_b64_tr_b16 v[100:101], v15 offset:0
    ds_read_b64_tr_b16 v[102:103], v15 offset:2048
    ds_read_b64_tr_b16 v[104:105], v14 offset:256
    ds_read_b64_tr_b16 v[106:107], v14 offset:2304
    ds_read_b64_tr_b16 v[108:109], v15 offset:256
    ds_read_b64_tr_b16 v[110:111], v15 offset:2304
    ds_read_b128 a[16:19], v23 offset:1024
    ds_read_b128 a[20:23], v23 offset:17408
    ds_read_b128 a[24:27], v23 offset:33792
    ds_read_b128 a[28:31], v23 offset:50176
    ds_read_b128 a[32:35], v22 offset:2048
    s_waitcnt lgkmcnt(11)
    v_mfma_f32_16x16x32_bf16 v[128:131], v[96:99], a[0:3], 0
    s_waitcnt lgkmcnt(9)
    v_mfma_f32_16x16x32_bf16 v[144:147], v[96:99], a[4:7], 0
    ds_read_b64_tr_b16 v[112:113], v14 offset:16384
    v_mfma_f32_16x16x32_bf16 v[160:163], v[96:99], a[8:11], 0
    s_add_u32 s83, s60, 1572864
    ds_read_b64_tr_b16 v[114:115], v14 offset:18432
    v_mfma_f32_16x16x32_bf16 v[176:179], v[96:99], a[12:15], 0
    s_waitcnt lgkmcnt(7)
    ds_read_b128 a[48:51], v23 offset:3072
    v_mfma_f32_16x16x32_bf16 v[132:135], v[100:103], a[0:3], 0
    v_mfma_f32_16x16x32_bf16 v[148:151], v[100:103], a[4:7], 0
    s_add_u32 m0, s62, 131072
    ds_read_b64_tr_b16 v[116:117], v15 offset:16384
    v_mfma_f32_16x16x32_bf16 v[164:167], v[100:103], a[8:11], 0
    ds_read_b64_tr_b16 v[118:119], v15 offset:18432
    v_mfma_f32_16x16x32_bf16 v[180:183], v[100:103], a[12:15], 0
    s_add_u32 s82, s60, 1835008
    ds_read_b128 a[36:39], v22 offset:18432
    v_mfma_f32_16x16x32_bf16 v[136:139], v[104:107], a[0:3], 0
    buffer_load_dwordx4 v2, s[16:19], s83 offen offset:0 lds
    v_mfma_f32_16x16x32_bf16 v[152:155], v[104:107], a[4:7], 0
    ds_read_b64_tr_b16 v[120:121], v14 offset:16640
    v_mfma_f32_16x16x32_bf16 v[168:171], v[104:107], a[8:11], 0
    ds_read_b64_tr_b16 v[122:123], v14 offset:18688
    v_mfma_f32_16x16x32_bf16 v[184:187], v[104:107], a[12:15], 0
    ds_read_b128 a[52:55], v23 offset:19456
    v_mfma_f32_16x16x32_bf16 v[140:143], v[108:111], a[0:3], 0
    buffer_load_dwordx4 v3, s[16:19], s83 offen offset:1024 lds
    v_mfma_f32_16x16x32_bf16 v[156:159], v[108:111], a[4:7], 0
    ds_read_b64_tr_b16 v[124:125], v15 offset:16640
    v_mfma_f32_16x16x32_bf16 v[172:175], v[108:111], a[8:11], 0
    ds_read_b64_tr_b16 v[126:127], v15 offset:18688
    v_mfma_f32_16x16x32_bf16 v[188:191], v[108:111], a[12:15], 0
    s_waitcnt lgkmcnt(9)
    ds_read_b64_tr_b16 v[96:97], v12 offset:0
    v_mfma_f32_16x16x32_bf16 v[128:131], v[112:115], a[16:19], v[128:131]
    ds_read_b64_tr_b16 v[98:99], v12 offset:2048
    v_mfma_f32_16x16x32_bf16 v[144:147], v[112:115], a[20:23], v[144:147]
    ds_read_b64_tr_b16 v[100:101], v12 offset:16384
    v_mfma_f32_16x16x32_bf16 v[160:163], v[112:115], a[24:27], v[160:163]
    ds_read_b64_tr_b16 v[102:103], v12 offset:18432
    v_mfma_f32_16x16x32_bf16 v[176:179], v[112:115], a[28:31], v[176:179]
    s_waitcnt lgkmcnt(10)
    ds_read_b128 a[40:43], v22 offset:34816
    v_mfma_f32_16x16x32_bf16 v[132:135], v[116:119], a[16:19], v[132:135]
    ds_read_b128 a[56:59], v23 offset:35840
    v_mfma_f32_16x16x32_bf16 v[148:151], v[116:119], a[20:23], v[148:151]
    ds_read_b64_tr_b16 v[104:105], v13 offset:0
    v_mfma_f32_16x16x32_bf16 v[164:167], v[116:119], a[24:27], v[164:167]
    ds_read_b64_tr_b16 v[106:107], v13 offset:2048
    v_mfma_f32_16x16x32_bf16 v[180:183], v[116:119], a[28:31], v[180:183]
    s_waitcnt lgkmcnt(11)
    ds_read_b128 a[44:47], v22 offset:51200
    v_mfma_f32_16x16x32_bf16 v[136:139], v[120:123], a[16:19], v[136:139]
    buffer_load_dwordx4 v4, s[16:19], s83 offen offset:2048 lds
    v_mfma_f32_16x16x32_bf16 v[152:155], v[120:123], a[20:23], v[152:155]
    ds_read_b64_tr_b16 v[108:109], v13 offset:16384
    v_mfma_f32_16x16x32_bf16 v[168:171], v[120:123], a[24:27], v[168:171]
    ds_read_b64_tr_b16 v[110:111], v13 offset:18432
    v_mfma_f32_16x16x32_bf16 v[184:187], v[120:123], a[28:31], v[184:187]
    s_waitcnt lgkmcnt(11)
    ds_read_b128 a[60:63], v23 offset:52224
    v_mfma_f32_16x16x32_bf16 v[140:143], v[124:127], a[16:19], v[140:143]
    buffer_load_dwordx4 v5, s[16:19], s83 offen offset:3072 lds
    v_mfma_f32_16x16x32_bf16 v[156:159], v[124:127], a[20:23], v[156:159]
    ds_read_b64_tr_b16 v[112:113], v12 offset:256
    v_mfma_f32_16x16x32_bf16 v[172:175], v[124:127], a[24:27], v[172:175]
    s_add_u32 m0, s62, 147456
    ds_read_b64_tr_b16 v[114:115], v12 offset:2304
    v_mfma_f32_16x16x32_bf16 v[188:191], v[124:127], a[28:31], v[188:191]
    s_waitcnt lgkmcnt(12)
    s_add_u32 s83, s60, 2097152
    ds_read_b128 a[64:67], v22 offset:4096
    v_mfma_f32_16x16x32_bf16 v[128:131], v[96:99], a[32:35], v[128:131]
    s_waitcnt lgkmcnt(11)
    buffer_load_dwordx4 v2, s[16:19], s82 offen offset:0 lds
    v_mfma_f32_16x16x32_bf16 v[128:131], v[100:103], a[48:51], v[128:131]
    ds_read_b64_tr_b16 v[116:117], v12 offset:16640
    v_mfma_f32_16x16x32_bf16 v[144:147], v[96:99], a[36:39], v[144:147]
    ds_read_b64_tr_b16 v[118:119], v12 offset:18688
    v_mfma_f32_16x16x32_bf16 v[144:147], v[100:103], a[52:55], v[144:147]
    s_waitcnt lgkmcnt(11)
    ds_read_b128 a[80:83], v23 offset:5120
    v_mfma_f32_16x16x32_bf16 v[160:163], v[96:99], a[40:43], v[160:163]
    buffer_load_dwordx4 v3, s[16:19], s82 offen offset:1024 lds
    v_mfma_f32_16x16x32_bf16 v[160:163], v[100:103], a[56:59], v[160:163]
    s_waitcnt lgkmcnt(9)
    ds_read_b64_tr_b16 v[120:121], v13 offset:256
    v_mfma_f32_16x16x32_bf16 v[176:179], v[96:99], a[44:47], v[176:179]
    s_waitcnt lgkmcnt(7)
    ds_read_b64_tr_b16 v[122:123], v13 offset:2304
    v_mfma_f32_16x16x32_bf16 v[176:179], v[100:103], a[60:63], v[176:179]
    ds_read_b128 a[68:71], v22 offset:20480
    v_mfma_f32_16x16x32_bf16 v[132:135], v[104:107], a[32:35], v[132:135]
    buffer_load_dwordx4 v4, s[16:19], s82 offen offset:2048 lds
    v_mfma_f32_16x16x32_bf16 v[132:135], v[108:111], a[48:51], v[132:135]
    ds_read_b64_tr_b16 v[124:125], v13 offset:16640
    v_mfma_f32_16x16x32_bf16 v[148:151], v[104:107], a[36:39], v[148:151]
    ds_read_b64_tr_b16 v[126:127], v13 offset:18688
    v_mfma_f32_16x16x32_bf16 v[148:151], v[108:111], a[52:55], v[148:151]
    ds_read_b128 a[84:87], v23 offset:21504
    v_mfma_f32_16x16x32_bf16 v[164:167], v[104:107], a[40:43], v[164:167]
    buffer_load_dwordx4 v5, s[16:19], s82 offen offset:3072 lds
    v_mfma_f32_16x16x32_bf16 v[164:167], v[108:111], a[56:59], v[164:167]
    ds_read_b64_tr_b16 v[96:97], v12 offset:32768
    v_mfma_f32_16x16x32_bf16 v[180:183], v[104:107], a[44:47], v[180:183]
    s_waitcnt lgkmcnt(5)
    ds_read_b64_tr_b16 v[98:99], v12 offset:34816
    v_mfma_f32_16x16x32_bf16 v[180:183], v[108:111], a[60:63], v[180:183]
    s_add_u32 m0, s62, 65536
    ds_read_b128 a[72:75], v22 offset:36864
    v_mfma_f32_16x16x32_bf16 v[136:139], v[112:115], a[32:35], v[136:139]
    buffer_load_dwordx4 v2, s[16:19], s83 offen offset:0 lds
    v_mfma_f32_16x16x32_bf16 v[136:139], v[116:119], a[48:51], v[136:139]
    s_waitcnt vmcnt(13)
    ds_read_b64_tr_b16 v[100:101], v12 offset:49152
    v_mfma_f32_16x16x32_bf16 v[152:155], v[112:115], a[36:39], v[152:155]
    s_add_u32 s82, s60, 2359296
    ds_read_b64_tr_b16 v[102:103], v12 offset:51200
    v_mfma_f32_16x16x32_bf16 v[152:155], v[116:119], a[52:55], v[152:155]
    ds_read_b128 a[88:91], v23 offset:37888
    v_mfma_f32_16x16x32_bf16 v[168:171], v[112:115], a[40:43], v[168:171]
    buffer_load_dwordx4 v3, s[16:19], s83 offen offset:1024 lds
    v_mfma_f32_16x16x32_bf16 v[168:171], v[116:119], a[56:59], v[168:171]
    ds_read_b64_tr_b16 v[104:105], v13 offset:32768
    v_mfma_f32_16x16x32_bf16 v[184:187], v[112:115], a[44:47], v[184:187]
    ds_read_b64_tr_b16 v[106:107], v13 offset:34816
    v_mfma_f32_16x16x32_bf16 v[184:187], v[116:119], a[60:63], v[184:187]
    s_waitcnt lgkmcnt(9)
    ds_read_b128 a[76:79], v22 offset:53248
    v_mfma_f32_16x16x32_bf16 v[140:143], v[120:123], a[32:35], v[140:143]
    buffer_load_dwordx4 v4, s[16:19], s83 offen offset:2048 lds
    v_mfma_f32_16x16x32_bf16 v[140:143], v[124:127], a[48:51], v[140:143]
    ds_read_b64_tr_b16 v[108:109], v13 offset:49152
    v_mfma_f32_16x16x32_bf16 v[156:159], v[120:123], a[36:39], v[156:159]
    ds_read_b64_tr_b16 v[110:111], v13 offset:51200
    v_mfma_f32_16x16x32_bf16 v[156:159], v[124:127], a[52:55], v[156:159]
    ds_read_b128 a[92:95], v23 offset:54272
    v_mfma_f32_16x16x32_bf16 v[172:175], v[120:123], a[40:43], v[172:175]
    buffer_load_dwordx4 v5, s[16:19], s83 offen offset:3072 lds
    v_mfma_f32_16x16x32_bf16 v[172:175], v[124:127], a[56:59], v[172:175]
    ds_read_b64_tr_b16 v[112:113], v12 offset:33024
    v_mfma_f32_16x16x32_bf16 v[188:191], v[120:123], a[44:47], v[188:191]
    s_add_u32 m0, s62, 81920
    ds_read_b64_tr_b16 v[114:115], v12 offset:35072
    v_mfma_f32_16x16x32_bf16 v[188:191], v[124:127], a[60:63], v[188:191]
    s_waitcnt lgkmcnt(12)
    s_add_u32 s83, s60, 2621440
    ds_read_b128 a[96:99], v22 offset:6144
    v_mfma_f32_16x16x32_bf16 v[128:131], v[96:99], a[64:67], v[128:131]
    s_waitcnt lgkmcnt(10)
    buffer_load_dwordx4 v2, s[16:19], s82 offen offset:0 lds
    v_mfma_f32_16x16x32_bf16 v[128:131], v[100:103], a[80:83], v[128:131]
    ds_read_b64_tr_b16 v[116:117], v12 offset:49408
    v_mfma_f32_16x16x32_bf16 v[144:147], v[96:99], a[68:71], v[144:147]
    ds_read_b64_tr_b16 v[118:119], v12 offset:51456
    v_mfma_f32_16x16x32_bf16 v[144:147], v[100:103], a[84:87], v[144:147]
    s_waitcnt lgkmcnt(11)
    ds_read_b128 a[112:115], v23 offset:7168
    v_mfma_f32_16x16x32_bf16 v[160:163], v[96:99], a[72:75], v[160:163]
    buffer_load_dwordx4 v3, s[16:19], s82 offen offset:1024 lds
    v_mfma_f32_16x16x32_bf16 v[160:163], v[100:103], a[88:91], v[160:163]
    s_waitcnt lgkmcnt(9)
    ds_read_b64_tr_b16 v[120:121], v13 offset:33024
    v_mfma_f32_16x16x32_bf16 v[176:179], v[96:99], a[76:79], v[176:179]
    s_waitcnt lgkmcnt(7)
    ds_read_b64_tr_b16 v[122:123], v13 offset:35072
    v_mfma_f32_16x16x32_bf16 v[176:179], v[100:103], a[92:95], v[176:179]
    ds_read_b128 a[100:103], v22 offset:22528
    v_mfma_f32_16x16x32_bf16 v[132:135], v[104:107], a[64:67], v[132:135]
    buffer_load_dwordx4 v4, s[16:19], s82 offen offset:2048 lds
    v_mfma_f32_16x16x32_bf16 v[132:135], v[108:111], a[80:83], v[132:135]
    ds_read_b64_tr_b16 v[124:125], v13 offset:49408
    v_mfma_f32_16x16x32_bf16 v[148:151], v[104:107], a[68:71], v[148:151]
    ds_read_b64_tr_b16 v[126:127], v13 offset:51456
    v_mfma_f32_16x16x32_bf16 v[148:151], v[108:111], a[84:87], v[148:151]
    ds_read_b128 a[116:119], v23 offset:23552
    v_mfma_f32_16x16x32_bf16 v[164:167], v[104:107], a[72:75], v[164:167]
    buffer_load_dwordx4 v5, s[16:19], s82 offen offset:3072 lds
    v_mfma_f32_16x16x32_bf16 v[164:167], v[108:111], a[88:91], v[164:167]
    s_waitcnt vmcnt(12)
    ds_read_b64_tr_b16 v[96:97], v14 offset:0
    v_mfma_f32_16x16x32_bf16 v[180:183], v[104:107], a[76:79], v[180:183]
    s_waitcnt lgkmcnt(5)
    ds_read_b64_tr_b16 v[98:99], v14 offset:2048
    v_mfma_f32_16x16x32_bf16 v[180:183], v[108:111], a[92:95], v[180:183]
    s_add_u32 m0, s62, 98304
    ds_read_b128 a[104:107], v22 offset:38912
    v_mfma_f32_16x16x32_bf16 v[136:139], v[112:115], a[64:67], v[136:139]
    buffer_load_dwordx4 v2, s[16:19], s83 offen offset:0 lds
    v_mfma_f32_16x16x32_bf16 v[136:139], v[116:119], a[80:83], v[136:139]
    s_waitcnt vmcnt(9)
    ds_read_b64_tr_b16 v[100:101], v14 offset:16384
    v_mfma_f32_16x16x32_bf16 v[152:155], v[112:115], a[68:71], v[152:155]
    s_add_u32 s82, s60, 2883584
    ds_read_b64_tr_b16 v[102:103], v14 offset:18432
    v_mfma_f32_16x16x32_bf16 v[152:155], v[116:119], a[84:87], v[152:155]
    ds_read_b128 a[120:123], v23 offset:39936
    v_mfma_f32_16x16x32_bf16 v[168:171], v[112:115], a[72:75], v[168:171]
    buffer_load_dwordx4 v3, s[16:19], s83 offen offset:1024 lds
    v_mfma_f32_16x16x32_bf16 v[168:171], v[116:119], a[88:91], v[168:171]
    ds_read_b64_tr_b16 v[104:105], v15 offset:0
    v_mfma_f32_16x16x32_bf16 v[184:187], v[112:115], a[76:79], v[184:187]
    ds_read_b64_tr_b16 v[106:107], v15 offset:2048
    v_mfma_f32_16x16x32_bf16 v[184:187], v[116:119], a[92:95], v[184:187]
    s_waitcnt lgkmcnt(9)
    ds_read_b128 a[108:111], v22 offset:55296
    v_mfma_f32_16x16x32_bf16 v[140:143], v[120:123], a[64:67], v[140:143]
    buffer_load_dwordx4 v4, s[16:19], s83 offen offset:2048 lds
    v_mfma_f32_16x16x32_bf16 v[140:143], v[124:127], a[80:83], v[140:143]
    ds_read_b64_tr_b16 v[108:109], v15 offset:16384
    v_mfma_f32_16x16x32_bf16 v[156:159], v[120:123], a[68:71], v[156:159]
    ds_read_b64_tr_b16 v[110:111], v15 offset:18432
    v_mfma_f32_16x16x32_bf16 v[156:159], v[124:127], a[84:87], v[156:159]
    ds_read_b128 a[124:127], v23 offset:56320
    v_mfma_f32_16x16x32_bf16 v[172:175], v[120:123], a[72:75], v[172:175]
    buffer_load_dwordx4 v5, s[16:19], s83 offen offset:3072 lds
    v_mfma_f32_16x16x32_bf16 v[172:175], v[124:127], a[88:91], v[172:175]
    ds_read_b64_tr_b16 v[112:113], v14 offset:256
    v_mfma_f32_16x16x32_bf16 v[188:191], v[120:123], a[76:79], v[188:191]
    s_add_u32 m0, s62, 114688
    ds_read_b64_tr_b16 v[114:115], v14 offset:2304
    v_mfma_f32_16x16x32_bf16 v[188:191], v[124:127], a[92:95], v[188:191]
    s_waitcnt lgkmcnt(12)
    s_add_u32 s83, s60, 3145728
    ds_read_b128 a[128:131], v22 offset:8192
    v_mfma_f32_16x16x32_bf16 v[128:131], v[96:99], a[96:99], v[128:131]
    s_waitcnt lgkmcnt(10)
    buffer_load_dwordx4 v2, s[16:19], s82 offen offset:0 lds
    v_mfma_f32_16x16x32_bf16 v[128:131], v[100:103], a[112:115], v[128:131]
    ds_read_b64_tr_b16 v[116:117], v14 offset:16640
    v_mfma_f32_16x16x32_bf16 v[144:147], v[96:99], a[100:103], v[144:147]
    ds_read_b64_tr_b16 v[118:119], v14 offset:18688
    v_mfma_f32_16x16x32_bf16 v[144:147], v[100:103], a[116:119], v[144:147]
    s_waitcnt lgkmcnt(11)
    ds_read_b128 a[144:147], v23 offset:9216
    v_mfma_f32_16x16x32_bf16 v[160:163], v[96:99], a[104:107], v[160:163]
    buffer_load_dwordx4 v3, s[16:19], s82 offen offset:1024 lds
    v_mfma_f32_16x16x32_bf16 v[160:163], v[100:103], a[120:123], v[160:163]
    s_waitcnt lgkmcnt(9)
    ds_read_b64_tr_b16 v[120:121], v15 offset:256
    v_mfma_f32_16x16x32_bf16 v[176:179], v[96:99], a[108:111], v[176:179]
    s_waitcnt lgkmcnt(7)
    ds_read_b64_tr_b16 v[122:123], v15 offset:2304
    v_mfma_f32_16x16x32_bf16 v[176:179], v[100:103], a[124:127], v[176:179]
    ds_read_b128 a[132:135], v22 offset:24576
    v_mfma_f32_16x16x32_bf16 v[132:135], v[104:107], a[96:99], v[132:135]
    buffer_load_dwordx4 v4, s[16:19], s82 offen offset:2048 lds
    v_mfma_f32_16x16x32_bf16 v[132:135], v[108:111], a[112:115], v[132:135]
    ds_read_b64_tr_b16 v[124:125], v15 offset:16640
    v_mfma_f32_16x16x32_bf16 v[148:151], v[104:107], a[100:103], v[148:151]
    ds_read_b64_tr_b16 v[126:127], v15 offset:18688
    v_mfma_f32_16x16x32_bf16 v[148:151], v[108:111], a[116:119], v[148:151]
    ds_read_b128 a[148:151], v23 offset:25600
    v_mfma_f32_16x16x32_bf16 v[164:167], v[104:107], a[104:107], v[164:167]
    buffer_load_dwordx4 v5, s[16:19], s82 offen offset:3072 lds
    v_mfma_f32_16x16x32_bf16 v[164:167], v[108:111], a[120:123], v[164:167]
    s_waitcnt vmcnt(12)
    ds_read_b64_tr_b16 v[96:97], v12 offset:0
    v_mfma_f32_16x16x32_bf16 v[180:183], v[104:107], a[108:111], v[180:183]
    s_waitcnt lgkmcnt(5)
    ds_read_b64_tr_b16 v[98:99], v12 offset:2048
    v_mfma_f32_16x16x32_bf16 v[180:183], v[108:111], a[124:127], v[180:183]
    s_add_u32 m0, s62, 131072
    ds_read_b128 a[136:139], v22 offset:40960
    v_mfma_f32_16x16x32_bf16 v[136:139], v[112:115], a[96:99], v[136:139]
    buffer_load_dwordx4 v2, s[16:19], s83 offen offset:0 lds
    v_mfma_f32_16x16x32_bf16 v[136:139], v[116:119], a[112:115], v[136:139]
    s_waitcnt vmcnt(9)
    ds_read_b64_tr_b16 v[100:101], v12 offset:16384
    v_mfma_f32_16x16x32_bf16 v[152:155], v[112:115], a[100:103], v[152:155]
    s_add_u32 s82, s60, 3407872
    ds_read_b64_tr_b16 v[102:103], v12 offset:18432
    v_mfma_f32_16x16x32_bf16 v[152:155], v[116:119], a[116:119], v[152:155]
    ds_read_b128 a[152:155], v23 offset:41984
    v_mfma_f32_16x16x32_bf16 v[168:171], v[112:115], a[104:107], v[168:171]
    buffer_load_dwordx4 v3, s[16:19], s83 offen offset:1024 lds
    v_mfma_f32_16x16x32_bf16 v[168:171], v[116:119], a[120:123], v[168:171]
    ds_read_b64_tr_b16 v[104:105], v13 offset:0
    v_mfma_f32_16x16x32_bf16 v[184:187], v[112:115], a[108:111], v[184:187]
    ds_read_b64_tr_b16 v[106:107], v13 offset:2048
    v_mfma_f32_16x16x32_bf16 v[184:187], v[116:119], a[124:127], v[184:187]
    s_waitcnt lgkmcnt(9)
    ds_read_b128 a[140:143], v22 offset:57344
    v_mfma_f32_16x16x32_bf16 v[140:143], v[120:123], a[96:99], v[140:143]
    buffer_load_dwordx4 v4, s[16:19], s83 offen offset:2048 lds
    v_mfma_f32_16x16x32_bf16 v[140:143], v[124:127], a[112:115], v[140:143]
    ds_read_b64_tr_b16 v[108:109], v13 offset:16384
    v_mfma_f32_16x16x32_bf16 v[156:159], v[120:123], a[100:103], v[156:159]
    ds_read_b64_tr_b16 v[110:111], v13 offset:18432
    v_mfma_f32_16x16x32_bf16 v[156:159], v[124:127], a[116:119], v[156:159]
    ds_read_b128 a[156:159], v23 offset:58368
    v_mfma_f32_16x16x32_bf16 v[172:175], v[120:123], a[104:107], v[172:175]
    buffer_load_dwordx4 v5, s[16:19], s83 offen offset:3072 lds
    v_mfma_f32_16x16x32_bf16 v[172:175], v[124:127], a[120:123], v[172:175]
L_hop1_1:
    s_cbranch_execz L_hop1_5
    ds_read_b64_tr_b16 v[112:113], v12 offset:256
    v_mfma_f32_16x16x32_bf16 v[188:191], v[120:123], a[108:111], v[188:191]
    s_add_u32 m0, s62, 147456
    ds_read_b64_tr_b16 v[114:115], v12 offset:2304
    v_mfma_f32_16x16x32_bf16 v[188:191], v[124:127], a[124:127], v[188:191]
    s_waitcnt lgkmcnt(12)
    s_add_u32 s83, s60, 3670016
    ds_read_b128 a[160:163], v22 offset:10240
    v_mfma_f32_16x16x32_bf16 v[128:131], v[96:99], a[128:131], v[128:131]
    s_waitcnt lgkmcnt(10)
    buffer_load_dwordx4 v2, s[16:19], s82 offen offset:0 lds
    v_mfma_f32_16x16x32_bf16 v[128:131], v[100:103], a[144:147], v[128:131]
    ds_read_b64_tr_b16 v[116:117], v12 offset:16640
    v_mfma_f32_16x16x32_bf16 v[144:147], v[96:99], a[132:135], v[144:147]
    ds_read_b64_tr_b16 v[118:119], v12 offset:18688
    v_mfma_f32_16x16x32_bf16 v[144:147], v[100:103], a[148:151], v[144:147]
    s_waitcnt lgkmcnt(11)
    ds_read_b128 a[176:179], v23 offset:11264
    v_mfma_f32_16x16x32_bf16 v[160:163], v[96:99], a[136:139], v[160:163]
    buffer_load_dwordx4 v3, s[16:19], s82 offen offset:1024 lds
    v_mfma_f32_16x16x32_bf16 v[160:163], v[100:103], a[152:155], v[160:163]
    s_waitcnt lgkmcnt(9)
    ds_read_b64_tr_b16 v[120:121], v13 offset:256
    v_mfma_f32_16x16x32_bf16 v[176:179], v[96:99], a[140:143], v[176:179]
    s_waitcnt lgkmcnt(7)
    ds_read_b64_tr_b16 v[122:123], v13 offset:2304
    v_mfma_f32_16x16x32_bf16 v[176:179], v[100:103], a[156:159], v[176:179]
    ds_read_b128 a[164:167], v22 offset:26624
    v_mfma_f32_16x16x32_bf16 v[132:135], v[104:107], a[128:131], v[132:135]
    buffer_load_dwordx4 v4, s[16:19], s82 offen offset:2048 lds
    v_mfma_f32_16x16x32_bf16 v[132:135], v[108:111], a[144:147], v[132:135]
    ds_read_b64_tr_b16 v[124:125], v13 offset:16640
    v_mfma_f32_16x16x32_bf16 v[148:151], v[104:107], a[132:135], v[148:151]
    ds_read_b64_tr_b16 v[126:127], v13 offset:18688
    v_mfma_f32_16x16x32_bf16 v[148:151], v[108:111], a[148:151], v[148:151]
    ds_read_b128 a[180:183], v23 offset:27648
    v_mfma_f32_16x16x32_bf16 v[164:167], v[104:107], a[136:139], v[164:167]
    buffer_load_dwordx4 v5, s[16:19], s82 offen offset:3072 lds
    v_mfma_f32_16x16x32_bf16 v[164:167], v[108:111], a[152:155], v[164:167]
    s_waitcnt vmcnt(12)
    ds_read_b64_tr_b16 v[96:97], v12 offset:32768
    v_mfma_f32_16x16x32_bf16 v[180:183], v[104:107], a[140:143], v[180:183]
    s_waitcnt lgkmcnt(5)
    ds_read_b64_tr_b16 v[98:99], v12 offset:34816
    v_mfma_f32_16x16x32_bf16 v[180:183], v[108:111], a[156:159], v[180:183]
    s_add_u32 m0, s62, 65536
    ds_read_b128 a[168:171], v22 offset:43008
    v_mfma_f32_16x16x32_bf16 v[136:139], v[112:115], a[128:131], v[136:139]
    buffer_load_dwordx4 v2, s[16:19], s83 offen offset:0 lds
    v_mfma_f32_16x16x32_bf16 v[136:139], v[116:119], a[144:147], v[136:139]
    s_waitcnt vmcnt(9)
    ds_read_b64_tr_b16 v[100:101], v12 offset:49152
    v_mfma_f32_16x16x32_bf16 v[152:155], v[112:115], a[132:135], v[152:155]
    s_add_u32 s82, s60, 3932160
    ds_read_b64_tr_b16 v[102:103], v12 offset:51200
    v_mfma_f32_16x16x32_bf16 v[152:155], v[116:119], a[148:151], v[152:155]
    ds_read_b128 a[184:187], v23 offset:44032
    v_mfma_f32_16x16x32_bf16 v[168:171], v[112:115], a[136:139], v[168:171]
    buffer_load_dwordx4 v3, s[16:19], s83 offen offset:1024 lds
    v_mfma_f32_16x16x32_bf16 v[168:171], v[116:119], a[152:155], v[168:171]
    ds_read_b64_tr_b16 v[104:105], v13 offset:32768
    v_mfma_f32_16x16x32_bf16 v[184:187], v[112:115], a[140:143], v[184:187]
    ds_read_b64_tr_b16 v[106:107], v13 offset:34816
    v_mfma_f32_16x16x32_bf16 v[184:187], v[116:119], a[156:159], v[184:187]
    s_waitcnt lgkmcnt(9)
    ds_read_b128 a[172:175], v22 offset:59392
    v_mfma_f32_16x16x32_bf16 v[140:143], v[120:123], a[128:131], v[140:143]
    buffer_load_dwordx4 v4, s[16:19], s83 offen offset:2048 lds
    v_mfma_f32_16x16x32_bf16 v[140:143], v[124:127], a[144:147], v[140:143]
    ds_read_b64_tr_b16 v[108:109], v13 offset:49152
    v_mfma_f32_16x16x32_bf16 v[156:159], v[120:123], a[132:135], v[156:159]
    ds_read_b64_tr_b16 v[110:111], v13 offset:51200
    v_mfma_f32_16x16x32_bf16 v[156:159], v[124:127], a[148:151], v[156:159]
    ds_read_b128 a[188:191], v23 offset:60416
    v_mfma_f32_16x16x32_bf16 v[172:175], v[120:123], a[136:139], v[172:175]
    buffer_load_dwordx4 v5, s[16:19], s83 offen offset:3072 lds
    v_mfma_f32_16x16x32_bf16 v[172:175], v[124:127], a[152:155], v[172:175]
    ds_read_b64_tr_b16 v[112:113], v12 offset:33024
    v_mfma_f32_16x16x32_bf16 v[188:191], v[120:123], a[140:143], v[188:191]
    s_add_u32 m0, s62, 81920
    ds_read_b64_tr_b16 v[114:115], v12 offset:35072
    v_mfma_f32_16x16x32_bf16 v[188:191], v[124:127], a[156:159], v[188:191]
    s_waitcnt lgkmcnt(12)
    s_add_u32 s83, s60, 128
    ds_read_b128 a[192:195], v22 offset:12288
    v_mfma_f32_16x16x32_bf16 v[128:131], v[96:99], a[160:163], v[128:131]
    s_waitcnt lgkmcnt(10)
    buffer_load_dwordx4 v2, s[16:19], s82 offen offset:0 lds
    v_mfma_f32_16x16x32_bf16 v[128:131], v[100:103], a[176:179], v[128:131]
    ds_read_b64_tr_b16 v[116:117], v12 offset:49408
    v_mfma_f32_16x16x32_bf16 v[144:147], v[96:99], a[164:167], v[144:147]
    ds_read_b64_tr_b16 v[118:119], v12 offset:51456
    v_mfma_f32_16x16x32_bf16 v[144:147], v[100:103], a[180:183], v[144:147]
    s_waitcnt lgkmcnt(11)
    ds_read_b128 a[208:211], v23 offset:13312
    v_mfma_f32_16x16x32_bf16 v[160:163], v[96:99], a[168:171], v[160:163]
    buffer_load_dwordx4 v3, s[16:19], s82 offen offset:1024 lds
    v_mfma_f32_16x16x32_bf16 v[160:163], v[100:103], a[184:187], v[160:163]
    s_waitcnt lgkmcnt(9)
    ds_read_b64_tr_b16 v[120:121], v13 offset:33024
    v_mfma_f32_16x16x32_bf16 v[176:179], v[96:99], a[172:175], v[176:179]
    s_waitcnt lgkmcnt(7)
    ds_read_b64_tr_b16 v[122:123], v13 offset:35072
    v_mfma_f32_16x16x32_bf16 v[176:179], v[100:103], a[188:191], v[176:179]
    ds_read_b128 a[196:199], v22 offset:28672
    v_mfma_f32_16x16x32_bf16 v[132:135], v[104:107], a[160:163], v[132:135]
    buffer_load_dwordx4 v4, s[16:19], s82 offen offset:2048 lds
    v_mfma_f32_16x16x32_bf16 v[132:135], v[108:111], a[176:179], v[132:135]
    ds_read_b64_tr_b16 v[124:125], v13 offset:49408
    v_mfma_f32_16x16x32_bf16 v[148:151], v[104:107], a[164:167], v[148:151]
    ds_read_b64_tr_b16 v[126:127], v13 offset:51456
    v_mfma_f32_16x16x32_bf16 v[148:151], v[108:111], a[180:183], v[148:151]
    ds_read_b128 a[212:215], v23 offset:29696
    v_mfma_f32_16x16x32_bf16 v[164:167], v[104:107], a[168:171], v[164:167]
    buffer_load_dwordx4 v5, s[16:19], s82 offen offset:3072 lds
    v_mfma_f32_16x16x32_bf16 v[164:167], v[108:111], a[184:187], v[164:167]
    s_waitcnt vmcnt(12)
    ds_read_b64_tr_b16 v[96:97], v14 offset:0
    v_mfma_f32_16x16x32_bf16 v[180:183], v[104:107], a[172:175], v[180:183]
    s_waitcnt lgkmcnt(5)
    ds_read_b64_tr_b16 v[98:99], v14 offset:2048
    v_mfma_f32_16x16x32_bf16 v[180:183], v[108:111], a[188:191], v[180:183]
    s_add_u32 m0, s62, 98304
    ds_read_b128 a[200:203], v22 offset:45056
    v_mfma_f32_16x16x32_bf16 v[136:139], v[112:115], a[160:163], v[136:139]
    buffer_load_dwordx4 v2, s[16:19], s83 offen offset:0 lds
    v_mfma_f32_16x16x32_bf16 v[136:139], v[116:119], a[176:179], v[136:139]
    s_waitcnt vmcnt(9)
    ds_read_b64_tr_b16 v[100:101], v14 offset:16384
    v_mfma_f32_16x16x32_bf16 v[152:155], v[112:115], a[164:167], v[152:155]
    s_add_u32 s82, s60, 262272
    ds_read_b64_tr_b16 v[102:103], v14 offset:18432
    v_mfma_f32_16x16x32_bf16 v[152:155], v[116:119], a[180:183], v[152:155]
    ds_read_b128 a[216:219], v23 offset:46080
    v_mfma_f32_16x16x32_bf16 v[168:171], v[112:115], a[168:171], v[168:171]
    buffer_load_dwordx4 v3, s[16:19], s83 offen offset:1024 lds
    v_mfma_f32_16x16x32_bf16 v[168:171], v[116:119], a[184:187], v[168:171]
    ds_read_b64_tr_b16 v[104:105], v15 offset:0
    v_mfma_f32_16x16x32_bf16 v[184:187], v[112:115], a[172:175], v[184:187]
    ds_read_b64_tr_b16 v[106:107], v15 offset:2048
    v_mfma_f32_16x16x32_bf16 v[184:187], v[116:119], a[188:191], v[184:187]
    s_waitcnt lgkmcnt(9)
    ds_read_b128 a[204:207], v22 offset:61440
    v_mfma_f32_16x16x32_bf16 v[140:143], v[120:123], a[160:163], v[140:143]
    buffer_load_dwordx4 v4, s[16:19], s83 offen offset:2048 lds
    v_mfma_f32_16x16x32_bf16 v[140:143], v[124:127], a[176:179], v[140:143]
    ds_read_b64_tr_b16 v[108:109], v15 offset:16384
    v_mfma_f32_16x16x32_bf16 v[156:159], v[120:123], a[164:167], v[156:159]
    ds_read_b64_tr_b16 v[110:111], v15 offset:18432
    v_mfma_f32_16x16x32_bf16 v[156:159], v[124:127], a[180:183], v[156:159]
    ds_read_b128 a[220:223], v23 offset:62464
    v_mfma_f32_16x16x32_bf16 v[172:175], v[120:123], a[168:171], v[172:175]
    buffer_load_dwordx4 v5, s[16:19], s83 offen offset:3072 lds
    v_mfma_f32_16x16x32_bf16 v[172:175], v[124:127], a[184:187], v[172:175]
    ds_read_b64_tr_b16 v[112:113], v14 offset:256
    v_mfma_f32_16x16x32_bf16 v[188:191], v[120:123], a[172:175], v[188:191]
    s_add_u32 m0, s62, 114688
    ds_read_b64_tr_b16 v[114:115], v14 offset:2304
    v_mfma_f32_16x16x32_bf16 v[188:191], v[124:127], a[188:191], v[188:191]
    s_waitcnt lgkmcnt(12)
    s_add_u32 s83, s60, 524416
    ds_read_b128 a[224:227], v22 offset:14336
    v_mfma_f32_16x16x32_bf16 v[128:131], v[96:99], a[192:195], v[128:131]
    s_waitcnt lgkmcnt(10)
    buffer_load_dwordx4 v2, s[16:19], s82 offen offset:0 lds
    v_mfma_f32_16x16x32_bf16 v[128:131], v[100:103], a[208:211], v[128:131]
    ds_read_b64_tr_b16 v[116:117], v14 offset:16640
    v_mfma_f32_16x16x32_bf16 v[144:147], v[96:99], a[196:199], v[144:147]
    ds_read_b64_tr_b16 v[118:119], v14 offset:18688
    v_mfma_f32_16x16x32_bf16 v[144:147], v[100:103], a[212:215], v[144:147]
    s_waitcnt lgkmcnt(11)
    ds_read_b128 a[240:243], v23 offset:15360
    v_mfma_f32_16x16x32_bf16 v[160:163], v[96:99], a[200:203], v[160:163]
    buffer_load_dwordx4 v3, s[16:19], s82 offen offset:1024 lds
    v_mfma_f32_16x16x32_bf16 v[160:163], v[100:103], a[216:219], v[160:163]
    s_waitcnt lgkmcnt(9)
    ds_read_b64_tr_b16 v[120:121], v15 offset:256
    v_mfma_f32_16x16x32_bf16 v[176:179], v[96:99], a[204:207], v[176:179]
    s_waitcnt lgkmcnt(7)
    ds_read_b64_tr_b16 v[122:123], v15 offset:2304
    v_mfma_f32_16x16x32_bf16 v[176:179], v[100:103], a[220:223], v[176:179]
    ds_read_b128 a[228:231], v22 offset:30720
    v_mfma_f32_16x16x32_bf16 v[132:135], v[104:107], a[192:195], v[132:135]
    buffer_load_dwordx4 v4, s[16:19], s82 offen offset:2048 lds
    v_mfma_f32_16x16x32_bf16 v[132:135], v[108:111], a[208:211], v[132:135]
    ds_read_b64_tr_b16 v[124:125], v15 offset:16640
    v_mfma_f32_16x16x32_bf16 v[148:151], v[104:107], a[196:199], v[148:151]
    ds_read_b64_tr_b16 v[126:127], v15 offset:18688
    v_mfma_f32_16x16x32_bf16 v[148:151], v[108:111], a[212:215], v[148:151]
    ds_read_b128 a[244:247], v23 offset:31744
    v_mfma_f32_16x16x32_bf16 v[164:167], v[104:107], a[200:203], v[164:167]
    buffer_load_dwordx4 v5, s[16:19], s82 offen offset:3072 lds
    v_mfma_f32_16x16x32_bf16 v[164:167], v[108:111], a[216:219], v[164:167]
    s_waitcnt vmcnt(12)
    ds_read_b64_tr_b16 v[96:97], v12 offset:0
    v_mfma_f32_16x16x32_bf16 v[180:183], v[104:107], a[204:207], v[180:183]
    s_waitcnt lgkmcnt(5)
    ds_read_b64_tr_b16 v[98:99], v12 offset:2048
    v_mfma_f32_16x16x32_bf16 v[180:183], v[108:111], a[220:223], v[180:183]
    s_add_u32 m0, s62, 131072
    ds_read_b128 a[232:235], v22 offset:47104
    v_mfma_f32_16x16x32_bf16 v[136:139], v[112:115], a[192:195], v[136:139]
    buffer_load_dwordx4 v2, s[16:19], s83 offen offset:0 lds
    v_mfma_f32_16x16x32_bf16 v[136:139], v[116:119], a[208:211], v[136:139]
    s_waitcnt vmcnt(9)
    ds_read_b64_tr_b16 v[100:101], v12 offset:16384
    v_mfma_f32_16x16x32_bf16 v[152:155], v[112:115], a[196:199], v[152:155]
    s_add_u32 s82, s60, 786560
    ds_read_b64_tr_b16 v[102:103], v12 offset:18432
    v_mfma_f32_16x16x32_bf16 v[152:155], v[116:119], a[212:215], v[152:155]
    ds_read_b128 a[248:251], v23 offset:48128
    v_mfma_f32_16x16x32_bf16 v[168:171], v[112:115], a[200:203], v[168:171]
    buffer_load_dwordx4 v3, s[16:19], s83 offen offset:1024 lds
    v_mfma_f32_16x16x32_bf16 v[168:171], v[116:119], a[216:219], v[168:171]
    ds_read_b64_tr_b16 v[104:105], v13 offset:0
    v_mfma_f32_16x16x32_bf16 v[184:187], v[112:115], a[204:207], v[184:187]
    ds_read_b64_tr_b16 v[106:107], v13 offset:2048
    v_mfma_f32_16x16x32_bf16 v[184:187], v[116:119], a[220:223], v[184:187]
    s_waitcnt lgkmcnt(9)
    ds_read_b128 a[236:239], v22 offset:63488
    v_mfma_f32_16x16x32_bf16 v[140:143], v[120:123], a[192:195], v[140:143]
    buffer_load_dwordx4 v4, s[16:19], s83 offen offset:2048 lds
    v_mfma_f32_16x16x32_bf16 v[140:143], v[124:127], a[208:211], v[140:143]
    ds_read_b64_tr_b16 v[108:109], v13 offset:16384
    v_mfma_f32_16x16x32_bf16 v[156:159], v[120:123], a[196:199], v[156:159]
    ds_read_b64_tr_b16 v[110:111], v13 offset:18432
    v_mfma_f32_16x16x32_bf16 v[156:159], v[124:127], a[212:215], v[156:159]
    ds_read_b128 a[252:255], v23 offset:64512
    v_mfma_f32_16x16x32_bf16 v[172:175], v[120:123], a[200:203], v[172:175]
    buffer_load_dwordx4 v5, s[16:19], s83 offen offset:3072 lds
    v_mfma_f32_16x16x32_bf16 v[172:175], v[124:127], a[216:219], v[172:175]
    ds_read_b64_tr_b16 v[112:113], v12 offset:256
    v_mfma_f32_16x16x32_bf16 v[188:191], v[120:123], a[204:207], v[188:191]
    s_add_u32 m0, s62, 147456
    ds_read_b64_tr_b16 v[114:115], v12 offset:2304
    v_mfma_f32_16x16x32_bf16 v[188:191], v[124:127], a[220:223], v[188:191]
    s_waitcnt lgkmcnt(12)
    buffer_load_dwordx4 v2, s[16:19], s82 offen offset:0 lds
    v_mfma_f32_16x16x32_bf16 v[128:131], v[96:99], a[224:227], v[128:131]
    s_waitcnt lgkmcnt(9)
    v_mfma_f32_16x16x32_bf16 v[128:131], v[100:103], a[240:243], v[128:131]
    s_add_u32 s83, s60, 1048704
    ds_read_b64_tr_b16 v[116:117], v12 offset:16640
    v_mfma_f32_16x16x32_bf16 v[144:147], v[96:99], a[228:231], v[144:147]
    ds_read_b64_tr_b16 v[118:119], v12 offset:18688
    v_mfma_f32_16x16x32_bf16 v[144:147], v[100:103], a[244:247], v[144:147]
    buffer_load_dwordx4 v3, s[16:19], s82 offen offset:1024 lds
    v_mfma_f32_16x16x32_bf16 v[160:163], v[96:99], a[232:235], v[160:163]
    s_waitcnt lgkmcnt(10)
    v_mfma_f32_16x16x32_bf16 v[160:163], v[100:103], a[248:251], v[160:163]
    s_waitcnt lgkmcnt(7)
    ds_read_b64_tr_b16 v[120:121], v13 offset:256
    v_mfma_f32_16x16x32_bf16 v[176:179], v[96:99], a[236:239], v[176:179]
    s_waitcnt lgkmcnt(5)
    ds_read_b64_tr_b16 v[122:123], v13 offset:2304
    v_mfma_f32_16x16x32_bf16 v[176:179], v[100:103], a[252:255], v[176:179]
    buffer_load_dwordx4 v4, s[16:19], s82 offen offset:2048 lds
    v_mfma_f32_16x16x32_bf16 v[132:135], v[104:107], a[224:227], v[132:135]
    v_mfma_f32_16x16x32_bf16 v[132:135], v[108:111], a[240:243], v[132:135]
    ds_read_b64_tr_b16 v[124:125], v13 offset:16640
    v_mfma_f32_16x16x32_bf16 v[148:151], v[104:107], a[228:231], v[148:151]
    ds_read_b64_tr_b16 v[126:127], v13 offset:18688
    v_mfma_f32_16x16x32_bf16 v[148:151], v[108:111], a[244:247], v[148:151]
    buffer_load_dwordx4 v5, s[16:19], s82 offen offset:3072 lds
    v_mfma_f32_16x16x32_bf16 v[164:167], v[104:107], a[232:235], v[164:167]
    s_add_u32 s82, s60, 1310848
    v_mfma_f32_16x16x32_bf16 v[164:167], v[108:111], a[248:251], v[164:167]
    s_waitcnt vmcnt(12)
    ds_read_b64_tr_b16 v[96:97], v12 offset:32768
    v_mfma_f32_16x16x32_bf16 v[180:183], v[104:107], a[236:239], v[180:183]
    s_waitcnt lgkmcnt(3)
    ds_read_b64_tr_b16 v[98:99], v12 offset:34816
    v_mfma_f32_16x16x32_bf16 v[180:183], v[108:111], a[252:255], v[180:183]
    s_add_u32 m0, s62, 65536
    v_mfma_f32_16x16x32_bf16 v[136:139], v[112:115], a[224:227], v[136:139]
    buffer_load_dwordx4 v2, s[16:19], s83 offen offset:0 lds
    v_mfma_f32_16x16x32_bf16 v[136:139], v[116:119], a[240:243], v[136:139]
    s_waitcnt vmcnt(9)
    ds_read_b64_tr_b16 v[100:101], v12 offset:49152
    v_mfma_f32_16x16x32_bf16 v[152:155], v[112:115], a[228:231], v[152:155]
    ds_read_b64_tr_b16 v[102:103], v12 offset:51200
    v_mfma_f32_16x16x32_bf16 v[152:155], v[116:119], a[244:247], v[152:155]
    buffer_load_dwordx4 v3, s[16:19], s83 offen offset:1024 lds
    v_mfma_f32_16x16x32_bf16 v[168:171], v[112:115], a[232:235], v[168:171]
    v_mfma_f32_16x16x32_bf16 v[168:171], v[116:119], a[248:251], v[168:171]
    ds_read_b64_tr_b16 v[104:105], v13 offset:32768
    v_mfma_f32_16x16x32_bf16 v[184:187], v[112:115], a[236:239], v[184:187]
    ds_read_b64_tr_b16 v[106:107], v13 offset:34816
    v_mfma_f32_16x16x32_bf16 v[184:187], v[116:119], a[252:255], v[184:187]
    buffer_load_dwordx4 v4, s[16:19], s83 offen offset:2048 lds
    v_mfma_f32_16x16x32_bf16 v[140:143], v[120:123], a[224:227], v[140:143]
    s_waitcnt lgkmcnt(6)
    v_mfma_f32_16x16x32_bf16 v[140:143], v[124:127], a[240:243], v[140:143]
    ds_read_b64_tr_b16 v[108:109], v13 offset:49152
    v_mfma_f32_16x16x32_bf16 v[156:159], v[120:123], a[228:231], v[156:159]
    ds_read_b64_tr_b16 v[110:111], v13 offset:51200
    v_mfma_f32_16x16x32_bf16 v[156:159], v[124:127], a[244:247], v[156:159]
    buffer_load_dwordx4 v5, s[16:19], s83 offen offset:3072 lds
    v_mfma_f32_16x16x32_bf16 v[172:175], v[120:123], a[232:235], v[172:175]
    s_waitcnt lgkmcnt(6)
    v_mfma_f32_16x16x32_bf16 v[172:175], v[124:127], a[248:251], v[172:175]
    ds_read_b64_tr_b16 v[112:113], v12 offset:33024
    v_mfma_f32_16x16x32_bf16 v[188:191], v[120:123], a[236:239], v[188:191]
    s_add_u32 m0, s62, 81920
    ds_read_b64_tr_b16 v[114:115], v12 offset:35072
    v_mfma_f32_16x16x32_bf16 v[188:191], v[124:127], a[252:255], v[188:191]
    buffer_load_dwordx4 v2, s[16:19], s82 offen offset:0 lds
    v_mfma_f32_16x16x32_bf16 v[192:195], v[96:99], a[0:3], 0
    s_waitcnt lgkmcnt(6)
    v_mfma_f32_16x16x32_bf16 v[192:195], v[100:103], a[16:19], v[192:195]
    s_add_u32 s83, s60, 1572992
    ds_read_b64_tr_b16 v[116:117], v12 offset:49408
    v_mfma_f32_16x16x32_bf16 v[208:211], v[96:99], a[4:7], 0
    s_waitcnt lgkmcnt(0)
    s_barrier
    ds_read_b64_tr_b16 v[118:119], v12 offset:51456
    v_mfma_f32_16x16x32_bf16 v[208:211], v[100:103], a[20:23], v[208:211]
    buffer_load_dwordx4 v3, s[16:19], s82 offen offset:1024 lds
    v_mfma_f32_16x16x32_bf16 v[224:227], v[96:99], a[8:11], 0
    v_mfma_f32_16x16x32_bf16 v[224:227], v[100:103], a[24:27], v[224:227]
    ds_read_b64_tr_b16 v[120:121], v13 offset:33024
    v_cvt_pk_bf16_f32 v32, v128, v129
    v_mfma_f32_16x16x32_bf16 v[240:243], v[96:99], a[12:15], 0
    ds_read_b64_tr_b16 v[122:123], v13 offset:35072
    v_cvt_pk_bf16_f32 v33, v130, v131
    v_mfma_f32_16x16x32_bf16 v[240:243], v[100:103], a[28:31], v[240:243]
    buffer_load_dwordx4 v4, s[16:19], s82 offen offset:2048 lds
    v_mfma_f32_16x16x32_bf16 v[196:199], v[104:107], a[0:3], 0
    v_cvt_pk_bf16_f32 v34, v132, v133
    v_cvt_pk_bf16_f32 v35, v134, v135
    v_mfma_f32_16x16x32_bf16 v[196:199], v[108:111], a[16:19], v[196:199]
    ds_read_b64_tr_b16 v[124:125], v13 offset:49408
    v_cvt_pk_bf16_f32 v48, v136, v137
    v_mfma_f32_16x16x32_bf16 v[212:215], v[104:107], a[4:7], 0
    ds_read_b64_tr_b16 v[126:127], v13 offset:51456
    v_cvt_pk_bf16_f32 v49, v138, v139
    v_mfma_f32_16x16x32_bf16 v[212:215], v[108:111], a[20:23], v[212:215]
    buffer_load_dwordx4 v5, s[16:19], s82 offen offset:3072 lds
    v_mfma_f32_16x16x32_bf16 v[228:231], v[104:107], a[8:11], 0
    s_add_u32 s82, s60, 1835136
    v_cvt_pk_bf16_f32 v50, v140, v141
    v_cvt_pk_bf16_f32 v51, v142, v143
    v_mfma_f32_16x16x32_bf16 v[228:231], v[108:111], a[24:27], v[228:231]
    s_waitcnt vmcnt(12)
    ds_read_b64_tr_b16 v[96:97], v14 offset:0
    v_mfma_f32_16x16x32_bf16 v[244:247], v[104:107], a[12:15], 0
    s_waitcnt lgkmcnt(3)
    ds_read_b64_tr_b16 v[98:99], v14 offset:2048
    v_mfma_f32_16x16x32_bf16 v[244:247], v[108:111], a[28:31], v[244:247]
    s_add_u32 m0, s62, 98304
    v_permlane16_swap_b32 v32, v34
    v_mfma_f32_16x16x32_bf16 v[200:203], v[112:115], a[0:3], 0
    buffer_load_dwordx4 v2, s[16:19], s83 offen offset:0 lds
    v_mfma_f32_16x16x32_bf16 v[200:203], v[116:119], a[16:19], v[200:203]
    s_waitcnt vmcnt(9)
    ds_read_b64_tr_b16 v[100:101], v14 offset:16384
    v_mfma_f32_16x16x32_bf16 v[216:219], v[112:115], a[4:7], 0
    s_lshr_b32 s57, s2, 3
    ds_read_b64_tr_b16 v[102:103], v14 offset:18432
    v_mfma_f32_16x16x32_bf16 v[216:219], v[116:119], a[20:23], v[216:219]
    buffer_load_dwordx4 v3, s[16:19], s83 offen offset:1024 lds
    v_mfma_f32_16x16x32_bf16 v[232:235], v[112:115], a[8:11], 0
    s_mul_i32 s73, s57, 37
    v_permlane16_swap_b32 v33, v35
    v_mfma_f32_16x16x32_bf16 v[232:235], v[116:119], a[24:27], v[232:235]
    s_lshr_b32 s73, s73, 8
    ds_read_b64_tr_b16 v[104:105], v15 offset:0
    v_mfma_f32_16x16x32_bf16 v[248:251], v[112:115], a[12:15], 0
    s_and_b32 s55, s2, 1
    ds_read_b64_tr_b16 v[106:107], v15 offset:2048
    v_mfma_f32_16x16x32_bf16 v[248:251], v[116:119], a[28:31], v[248:251]
    buffer_load_dwordx4 v4, s[16:19], s83 offen offset:2048 lds
    v_mfma_f32_16x16x32_bf16 v[204:207], v[120:123], a[0:3], 0
    s_waitcnt lgkmcnt(6)
    s_sub_u32 s55, s55, s73
    v_permlane16_swap_b32 v48, v50
    v_mfma_f32_16x16x32_bf16 v[204:207], v[124:127], a[16:19], v[204:207]
    s_mul_i32 s75, s55, 7
    ds_read_b64_tr_b16 v[108:109], v15 offset:16384
    v_mfma_f32_16x16x32_bf16 v[220:223], v[120:123], a[4:7], 0
    s_add_u32 s75, s57, s75
    ds_read_b64_tr_b16 v[110:111], v15 offset:18432
    v_mfma_f32_16x16x32_bf16 v[220:223], v[124:127], a[20:23], v[220:223]
    buffer_load_dwordx4 v5, s[16:19], s83 offen offset:3072 lds
    v_mfma_f32_16x16x32_bf16 v[236:239], v[120:123], a[8:11], 0
    s_bfe_u32 s55, s2, 0x20001
    v_permlane16_swap_b32 v49, v51
    v_mfma_f32_16x16x32_bf16 v[236:239], v[124:127], a[24:27], v[236:239]
    ds_read_b64_tr_b16 v[112:113], v14 offset:256
    v_cvt_pk_bf16_f32 v36, v144, v145
    v_mfma_f32_16x16x32_bf16 v[252:255], v[120:123], a[12:15], 0
    s_add_u32 m0, s62, 114688
    ds_read_b64_tr_b16 v[114:115], v14 offset:2304
    v_cvt_pk_bf16_f32 v37, v146, v147
    v_mfma_f32_16x16x32_bf16 v[252:255], v[124:127], a[28:31], v[252:255]
    s_waitcnt lgkmcnt(8)
    buffer_load_dwordx4 v2, s[16:19], s82 offen offset:0 lds
    v_mfma_f32_16x16x32_bf16 v[192:195], v[96:99], a[32:35], v[192:195]
    s_waitcnt lgkmcnt(6)
    s_lshl2_add_u32 s73, s55, s73
    v_cvt_pk_bf16_f32 v38, v148, v149
    v_cvt_pk_bf16_f32 v39, v150, v151
    v_mfma_f32_16x16x32_bf16 v[192:195], v[100:103], a[48:51], v[192:195]
    s_add_u32 s83, s60, 2097280
    ds_read_b64_tr_b16 v[116:117], v14 offset:16640
    v_cvt_pk_bf16_f32 v52, v152, v153
    v_mfma_f32_16x16x32_bf16 v[208:211], v[96:99], a[36:39], v[208:211]
    s_lshr_b32 s55, s52, 1
    ds_read_b64_tr_b16 v[118:119], v14 offset:18688
    v_cvt_pk_bf16_f32 v53, v154, v155
    v_mfma_f32_16x16x32_bf16 v[208:211], v[100:103], a[52:55], v[208:211]
    buffer_load_dwordx4 v3, s[16:19], s82 offen offset:1024 lds
    v_mfma_f32_16x16x32_bf16 v[224:227], v[96:99], a[40:43], v[224:227]
    s_lshl1_add_u32 s74, s73, s55
    v_cvt_pk_bf16_f32 v54, v156, v157
    v_cvt_pk_bf16_f32 v55, v158, v159
    v_mfma_f32_16x16x32_bf16 v[224:227], v[100:103], a[56:59], v[224:227]
    s_and_b32 s58, s52, 1
    ds_read_b64_tr_b16 v[120:121], v15 offset:256
    v_mfma_f32_16x16x32_bf16 v[240:243], v[96:99], a[44:47], v[240:243]
    s_lshl1_add_u32 s58, s75, s58
    ds_read_b64_tr_b16 v[122:123], v15 offset:2304
    v_mfma_f32_16x16x32_bf16 v[240:243], v[100:103], a[60:63], v[240:243]
    s_waitcnt lgkmcnt(8)
    buffer_load_dwordx4 v4, s[16:19], s82 offen offset:2048 lds
    v_mfma_f32_16x16x32_bf16 v[196:199], v[104:107], a[32:35], v[196:199]
    s_waitcnt lgkmcnt(6)
    s_mul_i32 s92, s74, 229376
    v_permlane16_swap_b32 v36, v38
    v_mfma_f32_16x16x32_bf16 v[196:199], v[108:111], a[48:51], v[196:199]
    s_lshl_b32 s55, s58, 11
    ds_read_b64_tr_b16 v[124:125], v15 offset:16640
    v_mfma_f32_16x16x32_bf16 v[212:215], v[104:107], a[36:39], v[212:215]
    s_add_u32 s92, s92, s55
    ds_read_b64_tr_b16 v[126:127], v15 offset:18688
    v_mfma_f32_16x16x32_bf16 v[212:215], v[108:111], a[52:55], v[212:215]
    buffer_load_dwordx4 v5, s[16:19], s82 offen offset:3072 lds
    v_mfma_f32_16x16x32_bf16 v[228:231], v[104:107], a[40:43], v[228:231]
    s_add_u32 s82, s60, 2359424
    v_permlane16_swap_b32 v37, v39
    v_mfma_f32_16x16x32_bf16 v[228:231], v[108:111], a[56:59], v[228:231]
    s_waitcnt vmcnt(12)
    ds_read_b64_tr_b16 v[96:97], v12 offset:0
    v_mfma_f32_16x16x32_bf16 v[244:247], v[104:107], a[44:47], v[244:247]
    s_waitcnt lgkmcnt(3)
    ds_read_b64_tr_b16 v[98:99], v12 offset:2048
    v_mfma_f32_16x16x32_bf16 v[244:247], v[108:111], a[60:63], v[244:247]
    s_add_u32 m0, s62, 131072
    v_permlane16_swap_b32 v52, v54
    v_mfma_f32_16x16x32_bf16 v[200:203], v[112:115], a[32:35], v[200:203]
    buffer_load_dwordx4 v2, s[16:19], s83 offen offset:0 lds
    v_mfma_f32_16x16x32_bf16 v[200:203], v[116:119], a[48:51], v[200:203]
    s_waitcnt vmcnt(9)
    ds_read_b64_tr_b16 v[100:101], v12 offset:16384
    v_mfma_f32_16x16x32_bf16 v[216:219], v[112:115], a[36:39], v[216:219]
    s_add_u32 s92, s92, 6291456
    ds_read_b64_tr_b16 v[102:103], v12 offset:18432
    v_mfma_f32_16x16x32_bf16 v[216:219], v[116:119], a[52:55], v[216:219]
    buffer_load_dwordx4 v3, s[16:19], s83 offen offset:1024 lds
    v_mfma_f32_16x16x32_bf16 v[232:235], v[112:115], a[40:43], v[232:235]
    s_lshl_b32 s70, s74, 12
    v_permlane16_swap_b32 v53, v55
    v_mfma_f32_16x16x32_bf16 v[232:235], v[116:119], a[56:59], v[232:235]
    s_lshl_b32 s55, s58, 7
    ds_read_b64_tr_b16 v[104:105], v13 offset:0
    v_cvt_pk_bf16_f32 v40, v160, v161
    v_mfma_f32_16x16x32_bf16 v[248:251], v[112:115], a[44:47], v[248:251]
    s_add_u32 s70, s70, s55
    ds_read_b64_tr_b16 v[106:107], v13 offset:2048
    v_cvt_pk_bf16_f32 v41, v162, v163
    v_mfma_f32_16x16x32_bf16 v[248:251], v[116:119], a[60:63], v[248:251]
    buffer_load_dwordx4 v4, s[16:19], s83 offen offset:2048 lds
    v_mfma_f32_16x16x32_bf16 v[204:207], v[120:123], a[32:35], v[204:207]
    s_waitcnt lgkmcnt(6)
    s_add_u32 s70, s70, 229376
    v_cvt_pk_bf16_f32 v42, v164, v165
    v_cvt_pk_bf16_f32 v43, v166, v167
    v_mfma_f32_16x16x32_bf16 v[204:207], v[124:127], a[48:51], v[204:207]
    s_lshl2_add_u32 s55, s2, s52
    ds_read_b64_tr_b16 v[108:109], v13 offset:16384
    v_cvt_pk_bf16_f32 v56, v168, v169
    v_mfma_f32_16x16x32_bf16 v[220:223], v[120:123], a[36:39], v[220:223]
    s_lshl_b32 s55, s55, 12
    ds_read_b64_tr_b16 v[110:111], v13 offset:18432
    v_cvt_pk_bf16_f32 v57, v170, v171
    v_mfma_f32_16x16x32_bf16 v[220:223], v[124:127], a[52:55], v[220:223]
    buffer_load_dwordx4 v5, s[16:19], s83 offen offset:3072 lds
    v_mfma_f32_16x16x32_bf16 v[236:239], v[120:123], a[40:43], v[236:239]
    s_add_u32 s55, s55, -2621440
    v_cvt_pk_bf16_f32 v58, v172, v173
    v_cvt_pk_bf16_f32 v59, v174, v175
    s_cmp_ge_u32 s2, 224
    s_cselect_b32 s92, s55, s92
    s_cselect_b32 s70, s55, s70
    v_mfma_f32_16x16x32_bf16 v[236:239], v[124:127], a[56:59], v[236:239]
    ds_read_b64_tr_b16 v[112:113], v12 offset:256
    v_mfma_f32_16x16x32_bf16 v[252:255], v[120:123], a[44:47], v[252:255]
    s_add_u32 m0, s62, 147456
    ds_read_b64_tr_b16 v[114:115], v12 offset:2304
    v_mfma_f32_16x16x32_bf16 v[252:255], v[124:127], a[60:63], v[252:255]
    s_waitcnt lgkmcnt(8)
    buffer_load_dwordx4 v2, s[16:19], s82 offen offset:0 lds
    v_mfma_f32_16x16x32_bf16 v[192:195], v[96:99], a[64:67], v[192:195]
    s_waitcnt lgkmcnt(6)
    s_lshl_b32 s76, s97, 13
    v_permlane16_swap_b32 v40, v42
    v_mfma_f32_16x16x32_bf16 v[192:195], v[100:103], a[80:83], v[192:195]
    s_add_u32 s83, s60, 2621568
    ds_read_b64_tr_b16 v[116:117], v12 offset:16640
    v_mfma_f32_16x16x32_bf16 v[208:211], v[96:99], a[68:71], v[208:211]
    s_lshl_b32 s58, s53, 19
    ds_read_b64_tr_b16 v[118:119], v12 offset:18688
    v_mfma_f32_16x16x32_bf16 v[208:211], v[100:103], a[84:87], v[208:211]
    buffer_load_dwordx4 v3, s[16:19], s82 offen offset:1024 lds
    v_mfma_f32_16x16x32_bf16 v[224:227], v[96:99], a[72:75], v[224:227]
    s_add_u32 s76, s76, s58
    v_permlane16_swap_b32 v41, v43
    v_mfma_f32_16x16x32_bf16 v[224:227], v[100:103], a[88:91], v[224:227]
    s_lshl2_add_u32 s77, s2, s52
    ds_read_b64_tr_b16 v[120:121], v13 offset:256
    v_mfma_f32_16x16x32_bf16 v[240:243], v[96:99], a[76:79], v[240:243]
    s_mul_i32 s77, s77, 1792
    ds_read_b64_tr_b16 v[122:123], v13 offset:2304
    v_mfma_f32_16x16x32_bf16 v[240:243], v[100:103], a[92:95], v[240:243]
    s_waitcnt lgkmcnt(8)
    buffer_load_dwordx4 v4, s[16:19], s82 offen offset:2048 lds
    v_mfma_f32_16x16x32_bf16 v[196:199], v[104:107], a[64:67], v[196:199]
    s_waitcnt lgkmcnt(6)
    s_lshr_b32 s78, s99, 5
    v_permlane16_swap_b32 v56, v58
    v_mfma_f32_16x16x32_bf16 v[196:199], v[108:111], a[80:83], v[196:199]
    s_mul_i32 s78, s78, 458752
    ds_read_b64_tr_b16 v[124:125], v13 offset:16640
    v_mfma_f32_16x16x32_bf16 v[212:215], v[104:107], a[68:71], v[212:215]
    s_and_b32 s58, s99, 31
    ds_read_b64_tr_b16 v[126:127], v13 offset:18688
    v_mfma_f32_16x16x32_bf16 v[212:215], v[108:111], a[84:87], v[212:215]
    buffer_load_dwordx4 v5, s[16:19], s82 offen offset:3072 lds
    v_mfma_f32_16x16x32_bf16 v[228:231], v[104:107], a[72:75], v[228:231]
    s_add_u32 s82, s60, 2883712
    v_permlane16_swap_b32 v57, v59
    v_mfma_f32_16x16x32_bf16 v[228:231], v[108:111], a[88:91], v[228:231]
    s_waitcnt vmcnt(12)
    ds_read_b64_tr_b16 v[96:97], v12 offset:32768
    v_cvt_pk_bf16_f32 v44, v176, v177
    v_mfma_f32_16x16x32_bf16 v[244:247], v[104:107], a[76:79], v[244:247]
    s_waitcnt lgkmcnt(3)
    ds_read_b64_tr_b16 v[98:99], v12 offset:34816
    v_cvt_pk_bf16_f32 v45, v178, v179
    v_mfma_f32_16x16x32_bf16 v[244:247], v[108:111], a[92:95], v[244:247]
    s_add_u32 m0, s62, 65536
    v_cvt_pk_bf16_f32 v46, v180, v181
    v_cvt_pk_bf16_f32 v47, v182, v183
    v_mfma_f32_16x16x32_bf16 v[200:203], v[112:115], a[64:67], v[200:203]
    buffer_load_dwordx4 v2, s[16:19], s83 offen offset:0 lds
    v_mfma_f32_16x16x32_bf16 v[200:203], v[116:119], a[80:83], v[200:203]
    s_waitcnt vmcnt(9)
    ds_read_b64_tr_b16 v[100:101], v12 offset:49152
    v_cvt_pk_bf16_f32 v60, v184, v185
    v_mfma_f32_16x16x32_bf16 v[216:219], v[112:115], a[68:71], v[216:219]
    s_lshl_b32 s58, s58, 12
    ds_read_b64_tr_b16 v[102:103], v12 offset:51200
    v_cvt_pk_bf16_f32 v61, v186, v187
L_hop1_2:
    s_cbranch_execz L_hop1_6
    v_mfma_f32_16x16x32_bf16 v[216:219], v[116:119], a[84:87], v[216:219]
    buffer_load_dwordx4 v3, s[16:19], s83 offen offset:1024 lds
    v_mfma_f32_16x16x32_bf16 v[232:235], v[112:115], a[72:75], v[232:235]
    s_add_u32 s78, s78, s58
    v_cvt_pk_bf16_f32 v62, v188, v189
    v_cvt_pk_bf16_f32 v63, v190, v191
    v_mfma_f32_16x16x32_bf16 v[232:235], v[116:119], a[88:91], v[232:235]
    s_mul_i32 s79, s99, 14336
    ds_read_b64_tr_b16 v[104:105], v13 offset:32768
    v_mfma_f32_16x16x32_bf16 v[248:251], v[112:115], a[76:79], v[248:251]
    s_and_b32 s58, s2, 1
    ds_read_b64_tr_b16 v[106:107], v13 offset:34816
    v_mfma_f32_16x16x32_bf16 v[248:251], v[116:119], a[92:95], v[248:251]
    buffer_load_dwordx4 v4, s[16:19], s83 offen offset:2048 lds
    v_mfma_f32_16x16x32_bf16 v[204:207], v[120:123], a[64:67], v[204:207]
    s_waitcnt lgkmcnt(6)
    s_mul_i32 s58, s58, 1792
    v_permlane16_swap_b32 v44, v46
    v_mfma_f32_16x16x32_bf16 v[204:207], v[124:127], a[80:83], v[204:207]
    s_add_u32 s79, s79, s58
    ds_read_b64_tr_b16 v[108:109], v13 offset:49152
    v_mfma_f32_16x16x32_bf16 v[220:223], v[120:123], a[68:71], v[220:223]
    s_lshl_b32 s80, s99, 8
    ds_read_b64_tr_b16 v[110:111], v13 offset:51200
    v_mfma_f32_16x16x32_bf16 v[220:223], v[124:127], a[84:87], v[220:223]
    buffer_load_dwordx4 v5, s[16:19], s83 offen offset:3072 lds
    v_mfma_f32_16x16x32_bf16 v[236:239], v[120:123], a[72:75], v[236:239]
    s_mul_i32 s81, s97, 1536
    v_permlane16_swap_b32 v45, v47
    v_mfma_f32_16x16x32_bf16 v[236:239], v[124:127], a[88:91], v[236:239]
    ds_read_b64_tr_b16 v[112:113], v12 offset:33024
    v_mfma_f32_16x16x32_bf16 v[252:255], v[120:123], a[76:79], v[252:255]
    s_add_u32 m0, s62, 81920
    ds_read_b64_tr_b16 v[114:115], v12 offset:35072
    v_mfma_f32_16x16x32_bf16 v[252:255], v[124:127], a[92:95], v[252:255]
    s_waitcnt lgkmcnt(8)
    buffer_load_dwordx4 v2, s[16:19], s82 offen offset:0 lds
    v_mfma_f32_16x16x32_bf16 v[192:195], v[96:99], a[96:99], v[192:195]
    s_waitcnt lgkmcnt(6)
    s_lshl_b32 s58, s53, 19
    v_permlane16_swap_b32 v60, v62
    v_mfma_f32_16x16x32_bf16 v[192:195], v[100:103], a[112:115], v[192:195]
    s_add_u32 s83, s60, 3145856
    ds_read_b64_tr_b16 v[116:117], v12 offset:49408
    v_lshlrev_b32 v23, 4, v0
    v_mfma_f32_16x16x32_bf16 v[208:211], v[96:99], a[100:103], v[208:211]
    s_add_u32 s81, s81, s58
    ds_read_b64_tr_b16 v[118:119], v12 offset:51456
    v_add_u32 v22, s62, v23
    v_mfma_f32_16x16x32_bf16 v[208:211], v[100:103], a[116:119], v[208:211]
    buffer_load_dwordx4 v3, s[16:19], s82 offen offset:1024 lds
    v_mfma_f32_16x16x32_bf16 v[224:227], v[96:99], a[104:107], v[224:227]
    s_add_u32 s81, s81, 425984
    v_permlane16_swap_b32 v61, v63
    v_mfma_f32_16x16x32_bf16 v[224:227], v[100:103], a[120:123], v[224:227]
    ds_read_b64_tr_b16 v[120:121], v13 offset:33024
    v_lshlrev_b32 v27, 7, v0
    v_mfma_f32_16x16x32_bf16 v[240:243], v[96:99], a[108:111], v[240:243]
    s_waitcnt lgkmcnt(7)
    ds_read_b64_tr_b16 v[122:123], v13 offset:35072
    v_min_u32 v29, 1408, v27
    v_mfma_f32_16x16x32_bf16 v[240:243], v[100:103], a[124:127], v[240:243]
    buffer_load_dwordx4 v4, s[16:19], s82 offen offset:2048 lds
    v_mfma_f32_16x16x32_bf16 v[196:199], v[104:107], a[96:99], v[196:199]
    s_waitcnt lgkmcnt(6)
    v_mfma_f32_16x16x32_bf16 v[196:199], v[108:111], a[112:115], v[196:199]
    ds_read_b64_tr_b16 v[124:125], v13 offset:49408
    v_mfma_f32_16x16x32_bf16 v[212:215], v[104:107], a[100:103], v[212:215]
    ds_read_b64_tr_b16 v[126:127], v13 offset:51456
    v_mfma_f32_16x16x32_bf16 v[212:215], v[108:111], a[116:119], v[212:215]
    buffer_load_dwordx4 v5, s[16:19], s82 offen offset:3072 lds
    v_mfma_f32_16x16x32_bf16 v[228:231], v[104:107], a[104:107], v[228:231]
    s_add_u32 s82, s60, 3408000
    v_mfma_f32_16x16x32_bf16 v[228:231], v[108:111], a[120:123], v[228:231]
    s_waitcnt vmcnt(12)
    ds_read_b64_tr_b16 v[96:97], v14 offset:0
    v_mfma_f32_16x16x32_bf16 v[244:247], v[104:107], a[108:111], v[244:247]
    s_waitcnt lgkmcnt(3)
    ds_read_b64_tr_b16 v[98:99], v14 offset:2048
    v_mfma_f32_16x16x32_bf16 v[244:247], v[108:111], a[124:127], v[244:247]
    s_add_u32 m0, s62, 98304
    v_mfma_f32_16x16x32_bf16 v[200:203], v[112:115], a[96:99], v[200:203]
    buffer_load_dwordx4 v2, s[16:19], s83 offen offset:0 lds
    v_mfma_f32_16x16x32_bf16 v[200:203], v[116:119], a[112:115], v[200:203]
    s_waitcnt vmcnt(9)
    ds_read_b64_tr_b16 v[100:101], v14 offset:16384
    v_mfma_f32_16x16x32_bf16 v[216:219], v[112:115], a[100:103], v[216:219]
    ds_read_b64_tr_b16 v[102:103], v14 offset:18432
    v_mfma_f32_16x16x32_bf16 v[216:219], v[116:119], a[116:119], v[216:219]
    buffer_load_dwordx4 v3, s[16:19], s83 offen offset:1024 lds
    v_mfma_f32_16x16x32_bf16 v[232:235], v[112:115], a[104:107], v[232:235]
    v_mfma_f32_16x16x32_bf16 v[232:235], v[116:119], a[120:123], v[232:235]
    ds_read_b64_tr_b16 v[104:105], v15 offset:0
    v_mfma_f32_16x16x32_bf16 v[248:251], v[112:115], a[108:111], v[248:251]
    ds_read_b64_tr_b16 v[106:107], v15 offset:2048
    v_mfma_f32_16x16x32_bf16 v[248:251], v[116:119], a[124:127], v[248:251]
    buffer_load_dwordx4 v4, s[16:19], s83 offen offset:2048 lds
    v_mfma_f32_16x16x32_bf16 v[204:207], v[120:123], a[96:99], v[204:207]
    s_waitcnt lgkmcnt(6)
    v_mfma_f32_16x16x32_bf16 v[204:207], v[124:127], a[112:115], v[204:207]
    ds_read_b64_tr_b16 v[108:109], v15 offset:16384
    v_mfma_f32_16x16x32_bf16 v[220:223], v[120:123], a[100:103], v[220:223]
    ds_read_b64_tr_b16 v[110:111], v15 offset:18432
    v_mfma_f32_16x16x32_bf16 v[220:223], v[124:127], a[116:119], v[220:223]
    buffer_load_dwordx4 v5, s[16:19], s83 offen offset:3072 lds
    v_mfma_f32_16x16x32_bf16 v[236:239], v[120:123], a[104:107], v[236:239]
    s_waitcnt lgkmcnt(6)
    v_mfma_f32_16x16x32_bf16 v[236:239], v[124:127], a[120:123], v[236:239]
    ds_read_b64_tr_b16 v[112:113], v14 offset:256
    v_mfma_f32_16x16x32_bf16 v[252:255], v[120:123], a[108:111], v[252:255]
    s_add_u32 m0, s62, 114688
    ds_read_b64_tr_b16 v[114:115], v14 offset:2304
    v_mfma_f32_16x16x32_bf16 v[252:255], v[124:127], a[124:127], v[252:255]
    buffer_load_dwordx4 v2, s[16:19], s82 offen offset:0 lds
    v_mfma_f32_16x16x32_bf16 v[192:195], v[96:99], a[128:131], v[192:195]
    s_waitcnt lgkmcnt(6)
    v_mfma_f32_16x16x32_bf16 v[192:195], v[100:103], a[144:147], v[192:195]
    s_add_u32 s83, s60, 3670144
    ds_read_b64_tr_b16 v[116:117], v14 offset:16640
    v_mfma_f32_16x16x32_bf16 v[208:211], v[96:99], a[132:135], v[208:211]
    ds_read_b64_tr_b16 v[118:119], v14 offset:18688
    v_mfma_f32_16x16x32_bf16 v[208:211], v[100:103], a[148:151], v[208:211]
    buffer_load_dwordx4 v3, s[16:19], s82 offen offset:1024 lds
    v_mfma_f32_16x16x32_bf16 v[224:227], v[96:99], a[136:139], v[224:227]
    v_mfma_f32_16x16x32_bf16 v[224:227], v[100:103], a[152:155], v[224:227]
    ds_read_b64_tr_b16 v[120:121], v15 offset:256
    v_mfma_f32_16x16x32_bf16 v[240:243], v[96:99], a[140:143], v[240:243]
    s_waitcnt lgkmcnt(7)
    ds_read_b64_tr_b16 v[122:123], v15 offset:2304
    v_mfma_f32_16x16x32_bf16 v[240:243], v[100:103], a[156:159], v[240:243]
    buffer_load_dwordx4 v4, s[16:19], s82 offen offset:2048 lds
    v_mfma_f32_16x16x32_bf16 v[196:199], v[104:107], a[128:131], v[196:199]
    s_waitcnt lgkmcnt(6)
    v_mfma_f32_16x16x32_bf16 v[196:199], v[108:111], a[144:147], v[196:199]
    ds_read_b64_tr_b16 v[124:125], v15 offset:16640
    v_mfma_f32_16x16x32_bf16 v[212:215], v[104:107], a[132:135], v[212:215]
    ds_read_b64_tr_b16 v[126:127], v15 offset:18688
    v_mfma_f32_16x16x32_bf16 v[212:215], v[108:111], a[148:151], v[212:215]
    buffer_load_dwordx4 v5, s[16:19], s82 offen offset:3072 lds
    v_mfma_f32_16x16x32_bf16 v[228:231], v[104:107], a[136:139], v[228:231]
    s_add_u32 s82, s60, 3932288
    v_mfma_f32_16x16x32_bf16 v[228:231], v[108:111], a[152:155], v[228:231]
    s_waitcnt vmcnt(12)
    ds_read_b64_tr_b16 v[96:97], v12 offset:0
    v_mfma_f32_16x16x32_bf16 v[244:247], v[104:107], a[140:143], v[244:247]
    s_waitcnt lgkmcnt(3)
    ds_read_b64_tr_b16 v[98:99], v12 offset:2048
    v_mfma_f32_16x16x32_bf16 v[244:247], v[108:111], a[156:159], v[244:247]
    s_add_u32 m0, s62, 131072
    v_mfma_f32_16x16x32_bf16 v[200:203], v[112:115], a[128:131], v[200:203]
    buffer_load_dwordx4 v2, s[16:19], s83 offen offset:0 lds
    v_mfma_f32_16x16x32_bf16 v[200:203], v[116:119], a[144:147], v[200:203]
    s_waitcnt vmcnt(9)
    ds_read_b64_tr_b16 v[100:101], v12 offset:16384
    v_mfma_f32_16x16x32_bf16 v[216:219], v[112:115], a[132:135], v[216:219]
    ds_read_b64_tr_b16 v[102:103], v12 offset:18432
    v_mfma_f32_16x16x32_bf16 v[216:219], v[116:119], a[148:151], v[216:219]
    buffer_load_dwordx4 v3, s[16:19], s83 offen offset:1024 lds
    v_mfma_f32_16x16x32_bf16 v[232:235], v[112:115], a[136:139], v[232:235]
    v_mfma_f32_16x16x32_bf16 v[232:235], v[116:119], a[152:155], v[232:235]
    ds_read_b64_tr_b16 v[104:105], v13 offset:0
    v_mfma_f32_16x16x32_bf16 v[248:251], v[112:115], a[140:143], v[248:251]
    ds_read_b64_tr_b16 v[106:107], v13 offset:2048
    v_mfma_f32_16x16x32_bf16 v[248:251], v[116:119], a[156:159], v[248:251]
    buffer_load_dwordx4 v4, s[16:19], s83 offen offset:2048 lds
    v_mfma_f32_16x16x32_bf16 v[204:207], v[120:123], a[128:131], v[204:207]
    s_waitcnt lgkmcnt(6)
    v_mfma_f32_16x16x32_bf16 v[204:207], v[124:127], a[144:147], v[204:207]
    ds_read_b64_tr_b16 v[108:109], v13 offset:16384
    v_mfma_f32_16x16x32_bf16 v[220:223], v[120:123], a[132:135], v[220:223]
    ds_read_b64_tr_b16 v[110:111], v13 offset:18432
    v_mfma_f32_16x16x32_bf16 v[220:223], v[124:127], a[148:151], v[220:223]
    buffer_load_dwordx4 v5, s[16:19], s83 offen offset:3072 lds
    v_mfma_f32_16x16x32_bf16 v[236:239], v[120:123], a[136:139], v[236:239]
    s_add_u32 s83, s63, 0
    v_mfma_f32_16x16x32_bf16 v[236:239], v[124:127], a[152:155], v[236:239]
    ds_read_b64_tr_b16 v[112:113], v12 offset:256
    v_mfma_f32_16x16x32_bf16 v[252:255], v[120:123], a[140:143], v[252:255]
    s_add_u32 m0, s62, 147456
    ds_read_b64_tr_b16 v[114:115], v12 offset:2304
    v_mfma_f32_16x16x32_bf16 v[252:255], v[124:127], a[156:159], v[252:255]
    s_waitcnt lgkmcnt(8)
    buffer_load_dwordx4 v2, s[16:19], s82 offen offset:0 lds
    v_mfma_f32_16x16x32_bf16 v[192:195], v[96:99], a[160:163], v[192:195]
    s_waitcnt lgkmcnt(6)
    v_mfma_f32_16x16x32_bf16 v[192:195], v[100:103], a[176:179], v[192:195]
    ds_read_b64_tr_b16 v[116:117], v12 offset:16640
    v_mov_b32 v26, 0x3f803f80
    v_mfma_f32_16x16x32_bf16 v[208:211], v[96:99], a[164:167], v[208:211]
    ds_read_b64_tr_b16 v[118:119], v12 offset:18688
    v_accvgpr_write_b32 a144, v26
    v_mfma_f32_16x16x32_bf16 v[208:211], v[100:103], a[180:183], v[208:211]
    buffer_load_dwordx4 v3, s[16:19], s82 offen offset:1024 lds
    v_mfma_f32_16x16x32_bf16 v[224:227], v[96:99], a[168:171], v[224:227]
    v_accvgpr_write_b32 a145, v26
    v_accvgpr_write_b32 a146, v26
    v_mfma_f32_16x16x32_bf16 v[224:227], v[100:103], a[184:187], v[224:227]
    ds_read_b64_tr_b16 v[120:121], v13 offset:256
    v_accvgpr_write_b32 a147, v26
    v_mfma_f32_16x16x32_bf16 v[240:243], v[96:99], a[172:175], v[240:243]
    s_waitcnt lgkmcnt(7)
    ds_read_b64_tr_b16 v[122:123], v13 offset:2304
    v_mfma_f32_16x16x32_bf16 v[240:243], v[100:103], a[188:191], v[240:243]
    buffer_load_dwordx4 v4, s[16:19], s82 offen offset:2048 lds
    v_mfma_f32_16x16x32_bf16 v[196:199], v[104:107], a[160:163], v[196:199]
    s_waitcnt lgkmcnt(6)
    v_mfma_f32_16x16x32_bf16 v[196:199], v[108:111], a[176:179], v[196:199]
    ds_read_b64_tr_b16 v[124:125], v13 offset:16640
    v_mfma_f32_16x16x32_bf16 v[212:215], v[104:107], a[164:167], v[212:215]
    ds_read_b64_tr_b16 v[126:127], v13 offset:18688
    v_mfma_f32_16x16x32_bf16 v[212:215], v[108:111], a[180:183], v[212:215]
    buffer_load_dwordx4 v5, s[16:19], s82 offen offset:3072 lds
    v_mfma_f32_16x16x32_bf16 v[228:231], v[104:107], a[168:171], v[228:231]
    s_add_u32 s82, s63, 0
    v_mfma_f32_16x16x32_bf16 v[228:231], v[108:111], a[184:187], v[228:231]
    s_waitcnt vmcnt(12)
    ds_read_b64_tr_b16 v[96:97], v12 offset:32768
    v_mfma_f32_16x16x32_bf16 v[244:247], v[104:107], a[172:175], v[244:247]
    s_add_u32 m0, s62, 32768
    ds_read_b64_tr_b16 v[98:99], v12 offset:34816
    v_mfma_f32_16x16x32_bf16 v[244:247], v[108:111], a[188:191], v[244:247]
    s_waitcnt lgkmcnt(8)
    buffer_load_dwordx4 v6, s[8:11], s83 offen offset:0 lds
    v_mfma_f32_16x16x32_bf16 v[200:203], v[112:115], a[160:163], v[200:203]
    s_waitcnt lgkmcnt(6)
    v_mfma_f32_16x16x32_bf16 v[200:203], v[116:119], a[176:179], v[200:203]
    s_waitcnt vmcnt(9)
    ds_read_b64_tr_b16 v[100:101], v12 offset:49152
    v_mfma_f32_16x16x32_bf16 v[216:219], v[112:115], a[164:167], v[216:219]
    ds_read_b64_tr_b16 v[102:103], v12 offset:51200
    v_mfma_f32_16x16x32_bf16 v[216:219], v[116:119], a[180:183], v[216:219]
    buffer_load_dwordx4 v7, s[8:11], s83 offen offset:1024 lds
    v_mfma_f32_16x16x32_bf16 v[232:235], v[112:115], a[168:171], v[232:235]
    v_mfma_f32_16x16x32_bf16 v[232:235], v[116:119], a[184:187], v[232:235]
    ds_read_b64_tr_b16 v[104:105], v13 offset:32768
    v_mfma_f32_16x16x32_bf16 v[248:251], v[112:115], a[172:175], v[248:251]
    s_waitcnt lgkmcnt(7)
    ds_read_b64_tr_b16 v[106:107], v13 offset:34816
    v_mfma_f32_16x16x32_bf16 v[248:251], v[116:119], a[188:191], v[248:251]
    buffer_load_dwordx4 v8, s[8:11], s83 offen offset:2048 lds
    v_mfma_f32_16x16x32_bf16 v[204:207], v[120:123], a[160:163], v[204:207]
    s_waitcnt lgkmcnt(6)
    v_mfma_f32_16x16x32_bf16 v[204:207], v[124:127], a[176:179], v[204:207]
    ds_read_b64_tr_b16 v[108:109], v13 offset:49152
    v_mfma_f32_16x16x32_bf16 v[220:223], v[120:123], a[164:167], v[220:223]
    ds_read_b64_tr_b16 v[110:111], v13 offset:51200
    v_mfma_f32_16x16x32_bf16 v[220:223], v[124:127], a[180:183], v[220:223]
    buffer_load_dwordx4 v9, s[8:11], s83 offen offset:3072 lds
    v_mfma_f32_16x16x32_bf16 v[236:239], v[120:123], a[168:171], v[236:239]
    v_mfma_f32_16x16x32_bf16 v[236:239], v[124:127], a[184:187], v[236:239]
    s_add_u32 m0, s62, 49152
    ds_read_b64_tr_b16 v[112:113], v12 offset:33024
    v_mfma_f32_16x16x32_bf16 v[252:255], v[120:123], a[172:175], v[252:255]
    s_waitcnt lgkmcnt(7)
    ds_read_b64_tr_b16 v[114:115], v12 offset:35072
    v_mfma_f32_16x16x32_bf16 v[252:255], v[124:127], a[188:191], v[252:255]
    buffer_load_dwordx4 v10, s[12:15], s82 offen offset:0 lds
    v_mfma_f32_16x16x32_bf16 v[192:195], v[96:99], a[192:195], v[192:195]
    s_waitcnt lgkmcnt(6)
    v_mfma_f32_16x16x32_bf16 v[192:195], v[100:103], a[208:211], v[192:195]
    ds_read_b64_tr_b16 v[116:117], v12 offset:49408
    v_mfma_f32_16x16x32_bf16 v[208:211], v[96:99], a[196:199], v[208:211]
    ds_read_b64_tr_b16 v[118:119], v12 offset:51456
    v_mfma_f32_16x16x32_bf16 v[208:211], v[100:103], a[212:215], v[208:211]
    buffer_load_dwordx4 v11, s[12:15], s82 offen offset:1024 lds
    v_mfma_f32_16x16x32_bf16 v[224:227], v[96:99], a[200:203], v[224:227]
    v_mfma_f32_16x16x32_bf16 v[224:227], v[100:103], a[216:219], v[224:227]
    ds_read_b64_tr_b16 v[120:121], v13 offset:33024
    v_mfma_f32_16x16x32_bf16 v[240:243], v[96:99], a[204:207], v[240:243]
    s_waitcnt lgkmcnt(7)
    ds_read_b64_tr_b16 v[122:123], v13 offset:35072
    v_mfma_f32_16x16x32_bf16 v[240:243], v[100:103], a[220:223], v[240:243]
    buffer_load_dwordx4 v10, s[12:15], s82 offen offset:2048 lds
    v_mfma_f32_16x16x32_bf16 v[196:199], v[104:107], a[192:195], v[196:199]
    s_waitcnt lgkmcnt(6)
    v_mfma_f32_16x16x32_bf16 v[196:199], v[108:111], a[208:211], v[196:199]
    ds_read_b64_tr_b16 v[124:125], v13 offset:49408
    v_mfma_f32_16x16x32_bf16 v[212:215], v[104:107], a[196:199], v[212:215]
    ds_read_b64_tr_b16 v[126:127], v13 offset:51456
    v_mfma_f32_16x16x32_bf16 v[212:215], v[108:111], a[212:215], v[212:215]
    buffer_load_dwordx4 v11, s[12:15], s82 offen offset:3072 lds
    v_mfma_f32_16x16x32_bf16 v[228:231], v[104:107], a[200:203], v[228:231]
    v_bfe_u32 v2, v0, 2, 2
    v_lshlrev_b32 v2, 10, v2
    v_mfma_f32_16x16x32_bf16 v[228:231], v[108:111], a[216:219], v[228:231]
    v_bfe_u32 v24, v0, 4, 1
    v_lshl_add_u32 v2, v24, 6, v2
    v_mfma_f32_16x16x32_bf16 v[244:247], v[104:107], a[204:207], v[244:247]
    s_waitcnt lgkmcnt(6)
    v_lshrrev_b32 v24, 5, v0
    v_lshl_add_u32 v2, v24, 12, v2
    v_mfma_f32_16x16x32_bf16 v[244:247], v[108:111], a[220:223], v[244:247]
    s_waitcnt vmcnt(12)
    ds_read_b64_tr_b16 a[160:161], v14 offset:0
    v_lshrrev_b32 v24, 4, v0
    v_mfma_f32_16x16x32_bf16 v[200:203], v[112:115], a[192:195], v[200:203]
    s_waitcnt lgkmcnt(5)
    ds_read_b64_tr_b16 a[162:163], v14 offset:2048
    v_and_b32 v24, 2, v24
    v_mfma_f32_16x16x32_bf16 v[200:203], v[116:119], a[208:211], v[200:203]
    s_waitcnt vmcnt(8)
    ds_read_b64_tr_b16 a[176:177], v14 offset:16384
    v_xor_b32 v24, v24, v0
    v_mfma_f32_16x16x32_bf16 v[216:219], v[112:115], a[196:199], v[216:219]
    ds_read_b64_tr_b16 a[178:179], v14 offset:18432
    v_and_b32 v24, 3, v24
    v_mfma_f32_16x16x32_bf16 v[216:219], v[116:119], a[212:215], v[216:219]
    ds_read_b64_tr_b16 a[164:165], v15 offset:0
    v_lshl_add_u32 v2, v24, 4, v2
    v_mfma_f32_16x16x32_bf16 v[232:235], v[112:115], a[200:203], v[232:235]
    ds_read_b64_tr_b16 a[166:167], v15 offset:2048
    v_add_u32 v3, 7168, v2
    v_mfma_f32_16x16x32_bf16 v[232:235], v[116:119], a[216:219], v[232:235]
    ds_read_b64_tr_b16 a[180:181], v15 offset:16384
    v_add_u32 v4, 14336, v2
    v_mfma_f32_16x16x32_bf16 v[248:251], v[112:115], a[204:207], v[248:251]
    ds_read_b64_tr_b16 a[182:183], v15 offset:18432
    v_add_u32 v5, 21504, v2
    v_mfma_f32_16x16x32_bf16 v[248:251], v[116:119], a[220:223], v[248:251]
    s_waitcnt lgkmcnt(10)
    ds_read_b64_tr_b16 a[168:169], v14 offset:256
    v_mfma_f32_16x16x32_bf16 v[204:207], v[120:123], a[192:195], v[204:207]
    s_waitcnt lgkmcnt(9)
    ds_read_b64_tr_b16 a[170:171], v14 offset:2304
    v_mfma_f32_16x16x32_bf16 v[204:207], v[124:127], a[208:211], v[204:207]
    ds_read_b64_tr_b16 a[184:185], v14 offset:16640
    v_mfma_f32_16x16x32_bf16 v[220:223], v[120:123], a[196:199], v[220:223]
    ds_read_b64_tr_b16 a[186:187], v14 offset:18688
    v_mfma_f32_16x16x32_bf16 v[220:223], v[124:127], a[212:215], v[220:223]
    ds_read_b64_tr_b16 a[172:173], v15 offset:256
    v_mfma_f32_16x16x32_bf16 v[236:239], v[120:123], a[200:203], v[236:239]
    ds_read_b64_tr_b16 a[174:175], v15 offset:2304
    v_mfma_f32_16x16x32_bf16 v[236:239], v[124:127], a[216:219], v[236:239]
    s_waitcnt vmcnt(4)
    s_waitcnt lgkmcnt(0)
    s_barrier
    ds_read_b64_tr_b16 a[188:189], v15 offset:16640
    v_mfma_f32_16x16x32_bf16 v[252:255], v[120:123], a[204:207], v[252:255]
    ds_read_b64_tr_b16 a[190:191], v15 offset:18688
    v_mfma_f32_16x16x32_bf16 v[252:255], v[124:127], a[220:223], v[252:255]
    ds_read_b128 a[0:3], v18 offset:0
    v_mfma_f32_16x16x32_bf16 v[192:195], a[160:163], a[224:227], v[192:195]
    ds_read_b128 a[4:7], v19 offset:0
    v_mfma_f32_16x16x32_bf16 v[192:195], a[176:179], a[240:243], v[192:195]
    ds_read_b128 a[8:11], v20 offset:0
    v_mfma_f32_16x16x32_bf16 v[196:199], a[164:167], a[224:227], v[196:199]
    v_mfma_f32_16x16x32_bf16 v[196:199], a[180:183], a[240:243], v[196:199]
    ds_read_b128 a[12:15], v21 offset:0
    v_mfma_f32_16x16x32_bf16 v[200:203], a[168:171], a[224:227], v[200:203]
    v_mfma_f32_16x16x32_bf16 v[200:203], a[184:187], a[240:243], v[200:203]
    ds_read_b128 a[16:19], v18 offset:4096
    v_mfma_f32_16x16x32_bf16 v[204:207], a[172:175], a[224:227], v[204:207]
    s_waitcnt lgkmcnt(5)
    v_mfma_f32_16x16x32_bf16 v[204:207], a[188:191], a[240:243], v[204:207]
    ds_read_b128 a[20:23], v19 offset:4096
    v_mfma_f32_16x16x32_bf16 v[208:211], a[160:163], a[228:231], v[208:211]
    v_mfma_f32_16x16x32_bf16 v[208:211], a[176:179], a[244:247], v[208:211]
    ds_read_b128 a[24:27], v20 offset:4096
    v_mfma_f32_16x16x32_bf16 v[212:215], a[164:167], a[228:231], v[212:215]
    v_cvt_pk_bf16_f32 v64, v192, v193
    v_cvt_pk_bf16_f32 v65, v194, v195
    v_mfma_f32_16x16x32_bf16 v[212:215], a[180:183], a[244:247], v[212:215]
    ds_read_b128 a[28:31], v21 offset:4096
    v_cvt_pk_bf16_f32 v66, v196, v197
    v_mfma_f32_16x16x32_bf16 v[216:219], a[168:171], a[228:231], v[216:219]
    v_cvt_pk_bf16_f32 v67, v198, v199
    v_cvt_pk_bf16_f32 v80, v200, v201
    v_mfma_f32_16x16x32_bf16 v[216:219], a[184:187], a[244:247], v[216:219]
    v_cvt_pk_bf16_f32 v81, v202, v203
    v_cvt_pk_bf16_f32 v82, v204, v205
    v_mfma_f32_16x16x32_bf16 v[220:223], a[172:175], a[228:231], v[220:223]
    v_cvt_pk_bf16_f32 v83, v206, v207
    v_mfma_f32_16x16x32_bf16 v[220:223], a[188:191], a[244:247], v[220:223]
    v_permlane16_swap_b32 v64, v66
    v_mfma_f32_16x16x32_bf16 v[224:227], a[160:163], a[232:235], v[224:227]
    v_permlane16_swap_b32 v65, v67
    v_mfma_f32_16x16x32_bf16 v[224:227], a[176:179], a[248:251], v[224:227]
    s_waitcnt vmcnt(0)
    s_waitcnt lgkmcnt(0)
    s_barrier
    ds_read_b64_tr_b16 a[64:65], v16 offset:16384
    v_permlane16_swap_b32 v80, v82
    v_mfma_f32_16x16x32_bf16 v[228:231], a[164:167], a[232:235], v[228:231]
    ds_read_b64_tr_b16 a[66:67], v16 offset:20480
    v_permlane16_swap_b32 v81, v83
    v_mfma_f32_16x16x32_bf16 v[228:231], a[180:183], a[248:251], v[228:231]
    ds_read_b64_tr_b16 a[68:69], v17 offset:16384
    v_cvt_pk_bf16_f32 v68, v208, v209
    v_mfma_f32_16x16x32_bf16 v[232:235], a[168:171], a[232:235], v[232:235]
    ds_read_b64_tr_b16 a[70:71], v17 offset:20480
    v_cvt_pk_bf16_f32 v69, v210, v211
    v_mfma_f32_16x16x32_bf16 v[232:235], a[184:187], a[248:251], v[232:235]
    v_cvt_pk_bf16_f32 v70, v212, v213
    v_cvt_pk_bf16_f32 v71, v214, v215
    v_mfma_f32_16x16x32_bf16 v[236:239], a[172:175], a[232:235], v[236:239]
    ds_read_b64_tr_b16 a[72:73], v16 offset:16640
    v_cvt_pk_bf16_f32 v84, v216, v217
    v_mfma_f32_16x16x32_bf16 v[236:239], a[188:191], a[248:251], v[236:239]
    ds_read_b64_tr_b16 a[74:75], v16 offset:20736
    v_cvt_pk_bf16_f32 v85, v218, v219
    v_mfma_f32_16x16x32_bf16 v[240:243], a[160:163], a[236:239], v[240:243]
    ds_read_b64_tr_b16 a[76:77], v17 offset:16640
    v_cvt_pk_bf16_f32 v86, v220, v221
    v_mfma_f32_16x16x32_bf16 v[240:243], a[176:179], a[252:255], v[240:243]
    ds_read_b64_tr_b16 a[78:79], v17 offset:20736
    v_cvt_pk_bf16_f32 v87, v222, v223
    v_mfma_f32_16x16x32_bf16 v[244:247], a[164:167], a[236:239], v[244:247]
    v_permlane16_swap_b32 v68, v70
    v_cvt_pk_bf16_f32 v72, v224, v225
    v_cvt_pk_bf16_f32 v73, v226, v227
    v_cvt_pk_bf16_f32 v74, v228, v229
    v_cvt_pk_bf16_f32 v75, v230, v231
    v_cvt_pk_bf16_f32 v88, v232, v233
    v_cvt_pk_bf16_f32 v89, v234, v235
    v_cvt_pk_bf16_f32 v90, v236, v237
    v_cvt_pk_bf16_f32 v91, v238, v239
    v_mfma_f32_16x16x32_bf16 v[244:247], a[180:183], a[252:255], v[244:247]
    ds_read_b64_tr_b16 a[80:81], v16 offset:16896
    v_permlane16_swap_b32 v69, v71
    v_permlane16_swap_b32 v72, v74
    v_mfma_f32_16x16x32_bf16 v[248:251], a[168:171], a[236:239], v[248:251]
    ds_read_b64_tr_b16 a[82:83], v16 offset:20992
    v_permlane16_swap_b32 v84, v86
    v_permlane16_swap_b32 v73, v75
    v_mfma_f32_16x16x32_bf16 v[248:251], a[184:187], a[252:255], v[248:251]
    ds_read_b64_tr_b16 a[84:85], v17 offset:16896
    v_permlane16_swap_b32 v85, v87
    v_permlane16_swap_b32 v88, v90
    v_mfma_f32_16x16x32_bf16 v[252:255], a[172:175], a[236:239], v[252:255]
    ds_read_b64_tr_b16 a[86:87], v17 offset:20992
    v_permlane16_swap_b32 v89, v91
    v_mfma_f32_16x16x32_bf16 v[252:255], a[188:191], a[252:255], v[252:255]
    v_mfma_f32_16x16x32_bf16 v[96:99], a[0:3], v[32:35], 0
    s_add_u32 s83, s63, 16384
    ds_read_b64_tr_b16 a[88:89], v16 offset:17152
    v_mfma_f32_16x16x32_bf16 v[96:99], a[4:7], v[48:51], v[96:99]
    ds_read_b64_tr_b16 a[90:91], v16 offset:21248
    v_mfma_f32_16x16x32_bf16 v[96:99], a[8:11], v[64:67], v[96:99]
    ds_read_b64_tr_b16 a[92:93], v17 offset:17152
    v_cvt_pk_bf16_f32 v76, v240, v241
    v_mfma_f32_16x16x32_bf16 v[96:99], a[12:15], v[80:83], v[96:99]
    ds_read_b64_tr_b16 a[94:95], v17 offset:21248
    v_cvt_pk_bf16_f32 v77, v242, v243
    v_mfma_f32_16x16x32_bf16 v[100:103], a[16:19], v[32:35], 0
    v_cvt_pk_bf16_f32 v78, v244, v245
    v_cvt_pk_bf16_f32 v79, v246, v247
    v_mfma_f32_16x16x32_bf16 v[100:103], a[20:23], v[48:51], v[100:103]
    v_cvt_pk_bf16_f32 v92, v248, v249
    v_cvt_pk_bf16_f32 v93, v250, v251
    v_mfma_f32_16x16x32_bf16 v[100:103], a[24:27], v[64:67], v[100:103]
    v_cvt_pk_bf16_f32 v94, v252, v253
    v_cvt_pk_bf16_f32 v95, v254, v255
    v_mfma_f32_16x16x32_bf16 v[100:103], a[28:31], v[80:83], v[100:103]
    v_permlane16_swap_b32 v76, v78
    v_mfma_f32_16x16x32_bf16 v[104:107], a[0:3], v[36:39], 0
    v_exp_f32 v96, v96
    v_exp_f32 v97, v97
    v_permlane16_swap_b32 v77, v79
    v_mfma_f32_16x16x32_bf16 v[104:107], a[4:7], v[52:55], v[104:107]
    v_cvt_pk_bf16_f32 v112, v96, v97
    v_exp_f32 v98, v98
    v_permlane16_swap_b32 v92, v94
    v_mfma_f32_16x16x32_bf16 v[104:107], a[8:11], v[68:71], v[104:107]
    v_exp_f32 v99, v99
    v_permlane16_swap_b32 v93, v95
    v_mfma_f32_16x16x32_bf16 v[104:107], a[12:15], v[84:87], v[104:107]
    s_add_u32 m0, s62, 65536
    v_cvt_pk_bf16_f32 v113, v98, v99
    v_exp_f32 v100, v100
    v_mfma_f32_16x16x32_bf16 v[108:111], a[16:19], v[36:39], 0
    v_exp_f32 v101, v101
    v_mfma_f32_16x16x32_bf16 v[108:111], a[20:23], v[52:55], v[108:111]
    v_cvt_pk_bf16_f32 v114, v100, v101
    v_exp_f32 v102, v102
    v_mfma_f32_16x16x32_bf16 v[108:111], a[24:27], v[68:71], v[108:111]
    v_exp_f32 v103, v103
    v_mfma_f32_16x16x32_bf16 v[108:111], a[28:31], v[84:87], v[108:111]
    v_cvt_pk_bf16_f32 v115, v102, v103
    v_exp_f32 v104, v104
    v_mfma_f32_16x16x32_bf16 v[96:99], a[0:3], v[40:43], 0
    buffer_load_dwordx4 v6, s[8:11], s83 offen offset:0 lds
    v_mfma_f32_16x16x32_bf16 v[96:99], a[4:7], v[56:59], v[96:99]
    v_exp_f32 v105, v105
    v_mfma_f32_16x16x32_bf16 v[96:99], a[8:11], v[72:75], v[96:99]
    v_cvt_pk_bf16_f32 v116, v104, v105
    v_mfma_f32_16x16x32_bf16 v[96:99], a[12:15], v[88:91], v[96:99]
    v_exp_f32 v106, v106
    v_mfma_f32_16x16x32_bf16 v[100:103], a[16:19], v[40:43], 0
    buffer_load_dwordx4 v7, s[8:11], s83 offen offset:1024 lds
    v_mfma_f32_16x16x32_bf16 v[100:103], a[20:23], v[56:59], v[100:103]
    v_exp_f32 v107, v107
    v_mfma_f32_16x16x32_bf16 v[100:103], a[24:27], v[72:75], v[100:103]
    ds_read_b128 a[32:35], v18 offset:8192
    v_cvt_pk_bf16_f32 v117, v106, v107
    v_mfma_f32_16x16x32_bf16 v[100:103], a[28:31], v[88:91], v[100:103]
    v_exp_f32 v108, v108
    v_mfma_f32_16x16x32_bf16 a[128:131], a[144:147], v[112:115], 0
    s_waitcnt lgkmcnt(15)
    ds_read_b128 a[36:39], v19 offset:8192
    v_mfma_f32_16x16x32_bf16 v[128:131], a[64:67], v[112:115], 0
    s_waitcnt lgkmcnt(14)
    v_exp_f32 v109, v109
    v_mfma_f32_16x16x32_bf16 v[132:135], a[68:71], v[112:115], 0
    s_waitcnt lgkmcnt(12)
    ds_read_b128 a[40:43], v20 offset:8192
    v_cvt_pk_bf16_f32 v118, v108, v109
    v_mfma_f32_16x16x32_bf16 v[136:139], a[72:75], v[112:115], 0
    s_waitcnt lgkmcnt(9)
    v_exp_f32 v110, v110
    v_mfma_f32_16x16x32_bf16 v[140:143], a[76:79], v[112:115], 0
    buffer_load_dwordx4 v8, s[8:11], s83 offen offset:2048 lds
    v_mfma_f32_16x16x32_bf16 v[144:147], a[80:83], v[112:115], 0
    s_waitcnt lgkmcnt(7)
    v_exp_f32 v111, v111
    v_mfma_f32_16x16x32_bf16 v[148:151], a[84:87], v[112:115], 0
    s_waitcnt lgkmcnt(3)
    ds_read_b128 a[44:47], v21 offset:8192
    v_cvt_pk_bf16_f32 v119, v110, v111
    v_mfma_f32_16x16x32_bf16 v[152:155], a[88:91], v[112:115], 0
    buffer_load_dwordx4 v9, s[8:11], s83 offen offset:3072 lds
    v_mfma_f32_16x16x32_bf16 v[156:159], a[92:95], v[112:115], 0
    v_exp_f32 v96, v96
    v_mfma_f32_16x16x32_bf16 v[104:107], a[0:3], v[44:47], 0
    ds_read_b128 a[48:51], v18 offset:12288
    v_mfma_f32_16x16x32_bf16 v[104:107], a[4:7], v[60:63], v[104:107]
    s_add_u32 m0, s62, 81920
    v_exp_f32 v97, v97
    v_mfma_f32_16x16x32_bf16 v[104:107], a[8:11], v[76:79], v[104:107]
    ds_read_b128 a[52:55], v19 offset:12288
    v_cvt_pk_bf16_f32 v112, v96, v97
    v_mfma_f32_16x16x32_bf16 v[104:107], a[12:15], v[92:95], v[104:107]
    v_exp_f32 v98, v98
    v_mfma_f32_16x16x32_bf16 v[108:111], a[16:19], v[44:47], 0
    buffer_load_dwordx4 v10, s[12:15], s83 offen offset:0 lds
    v_mfma_f32_16x16x32_bf16 v[108:111], a[20:23], v[60:63], v[108:111]
    v_exp_f32 v99, v99
    v_mfma_f32_16x16x32_bf16 v[108:111], a[24:27], v[76:79], v[108:111]
    ds_read_b128 a[56:59], v20 offset:12288
    v_cvt_pk_bf16_f32 v113, v98, v99
    v_mfma_f32_16x16x32_bf16 v[108:111], a[28:31], v[92:95], v[108:111]
    v_exp_f32 v100, v100
    v_mfma_f32_16x16x32_bf16 a[132:135], a[144:147], v[116:119], 0
    ds_read_b128 a[60:63], v21 offset:12288
    v_mfma_f32_16x16x32_bf16 v[160:163], a[64:67], v[116:119], 0
    v_exp_f32 v101, v101
    v_mfma_f32_16x16x32_bf16 v[164:167], a[68:71], v[116:119], 0
    ds_read_b64_tr_b16 a[96:97], v16 offset:24576
    v_cvt_pk_bf16_f32 v114, v100, v101
    v_mfma_f32_16x16x32_bf16 v[168:171], a[72:75], v[116:119], 0
    v_exp_f32 v102, v102
    v_mfma_f32_16x16x32_bf16 v[172:175], a[76:79], v[116:119], 0
    buffer_load_dwordx4 v11, s[12:15], s83 offen offset:1024 lds
    v_mfma_f32_16x16x32_bf16 v[176:179], a[80:83], v[116:119], 0
    v_exp_f32 v103, v103
    v_mfma_f32_16x16x32_bf16 v[180:183], a[84:87], v[116:119], 0
    ds_read_b64_tr_b16 a[98:99], v16 offset:28672
    v_cvt_pk_bf16_f32 v115, v102, v103
    v_mfma_f32_16x16x32_bf16 v[184:187], a[88:91], v[116:119], 0
    buffer_load_dwordx4 v10, s[12:15], s83 offen offset:2048 lds
    v_mfma_f32_16x16x32_bf16 v[188:191], a[92:95], v[116:119], 0
    s_waitcnt lgkmcnt(9)
    v_exp_f32 v104, v104
    v_mfma_f32_16x16x32_bf16 v[96:99], a[32:35], v[32:35], 0
    s_waitcnt lgkmcnt(8)
    ds_read_b64_tr_b16 a[100:101], v17 offset:24576
    v_mov_b32 v124, 0
    v_mfma_f32_16x16x32_bf16 v[96:99], a[36:39], v[48:51], v[96:99]
    s_waitcnt lgkmcnt(8)
    v_exp_f32 v105, v105
    v_mfma_f32_16x16x32_bf16 v[96:99], a[40:43], v[64:67], v[96:99]
L_hop1_3:
    s_cbranch_execz L_hop1_7
    s_waitcnt lgkmcnt(7)
    ds_read_b64_tr_b16 a[102:103], v17 offset:28672
    v_cvt_pk_bf16_f32 v116, v104, v105
    v_mfma_f32_16x16x32_bf16 v[96:99], a[44:47], v[80:83], v[96:99]
    s_waitcnt lgkmcnt(6)
    v_exp_f32 v106, v106
    v_mfma_f32_16x16x32_bf16 v[100:103], a[48:51], v[32:35], 0
    buffer_load_dwordx4 v11, s[12:15], s83 offen offset:3072 lds
    v_mfma_f32_16x16x32_bf16 v[100:103], a[52:55], v[48:51], v[100:103]
    s_waitcnt lgkmcnt(5)
    v_exp_f32 v107, v107
    v_mfma_f32_16x16x32_bf16 v[100:103], a[56:59], v[64:67], v[100:103]
    s_waitcnt lgkmcnt(4)
    ds_read_b64_tr_b16 a[104:105], v16 offset:24832
    v_cvt_pk_bf16_f32 v117, v106, v107
    v_mfma_f32_16x16x32_bf16 v[100:103], a[60:63], v[80:83], v[100:103]
    v_exp_f32 v108, v108
    v_mfma_f32_16x16x32_bf16 a[136:139], a[144:147], v[112:115], 0
    ds_read_b64_tr_b16 a[106:107], v16 offset:28928
    v_mov_b32 v125, 0
    v_mfma_f32_16x16x32_bf16 v[192:195], a[64:67], v[112:115], 0
    v_exp_f32 v109, v109
    v_mfma_f32_16x16x32_bf16 v[196:199], a[68:71], v[112:115], 0
    ds_read_b64_tr_b16 a[108:109], v17 offset:24832
    v_cvt_pk_bf16_f32 v118, v108, v109
    v_mfma_f32_16x16x32_bf16 v[200:203], a[72:75], v[112:115], 0
    v_exp_f32 v110, v110
    v_mfma_f32_16x16x32_bf16 v[204:207], a[76:79], v[112:115], 0
    buffer_load_dword v28, v29, s[8:11], s81 offen
    v_mfma_f32_16x16x32_bf16 v[208:211], a[80:83], v[112:115], 0
    v_exp_f32 v111, v111
    v_mfma_f32_16x16x32_bf16 v[212:215], a[84:87], v[112:115], 0
    ds_read_b64_tr_b16 a[110:111], v17 offset:28928
    v_cvt_pk_bf16_f32 v119, v110, v111
    v_mfma_f32_16x16x32_bf16 v[216:219], a[88:91], v[112:115], 0
    buffer_load_dword v25, v29, s[12:15], s81 offen
    v_mfma_f32_16x16x32_bf16 v[220:223], a[92:95], v[112:115], 0
    v_exp_f32 v96, v96
    v_mfma_f32_16x16x32_bf16 v[104:107], a[32:35], v[36:39], 0
    ds_read_b64_tr_b16 a[112:113], v16 offset:25088
    v_mov_b32 v126, 0
    v_mfma_f32_16x16x32_bf16 v[104:107], a[36:39], v[52:55], v[104:107]
    v_exp_f32 v97, v97
    v_mfma_f32_16x16x32_bf16 v[104:107], a[40:43], v[68:71], v[104:107]
    ds_read_b64_tr_b16 a[114:115], v16 offset:29184
    v_cvt_pk_bf16_f32 v112, v96, v97
    v_mfma_f32_16x16x32_bf16 v[104:107], a[44:47], v[84:87], v[104:107]
    v_exp_f32 v98, v98
    v_mfma_f32_16x16x32_bf16 v[108:111], a[48:51], v[36:39], 0
    v_mfma_f32_16x16x32_bf16 v[108:111], a[52:55], v[52:55], v[108:111]
    v_exp_f32 v99, v99
    v_mfma_f32_16x16x32_bf16 v[108:111], a[56:59], v[68:71], v[108:111]
    ds_read_b64_tr_b16 a[116:117], v17 offset:25088
    v_cvt_pk_bf16_f32 v113, v98, v99
    v_mfma_f32_16x16x32_bf16 v[108:111], a[60:63], v[84:87], v[108:111]
    v_exp_f32 v100, v100
    v_mfma_f32_16x16x32_bf16 a[140:143], a[144:147], v[116:119], 0
    ds_read_b64_tr_b16 a[118:119], v17 offset:29184
    v_mov_b32 v127, 0
    v_mfma_f32_16x16x32_bf16 v[224:227], a[64:67], v[116:119], 0
    v_exp_f32 v101, v101
    v_mfma_f32_16x16x32_bf16 v[228:231], a[68:71], v[116:119], 0
    ds_read_b64_tr_b16 a[120:121], v16 offset:25344
    v_cvt_pk_bf16_f32 v114, v100, v101
    v_mfma_f32_16x16x32_bf16 v[232:235], a[72:75], v[116:119], 0
    v_exp_f32 v102, v102
    v_mfma_f32_16x16x32_bf16 v[236:239], a[76:79], v[116:119], 0
    v_mfma_f32_16x16x32_bf16 v[240:243], a[80:83], v[116:119], 0
    v_exp_f32 v103, v103
    v_mfma_f32_16x16x32_bf16 v[244:247], a[84:87], v[116:119], 0
    s_add_u32 s82, s63, 32768
    ds_read_b64_tr_b16 a[122:123], v16 offset:29440
    v_cvt_pk_bf16_f32 v115, v102, v103
    v_mfma_f32_16x16x32_bf16 v[248:251], a[88:91], v[116:119], 0
    v_mfma_f32_16x16x32_bf16 v[252:255], a[92:95], v[116:119], 0
    v_exp_f32 v104, v104
    v_mfma_f32_16x16x32_bf16 v[96:99], a[32:35], v[40:43], 0
    ds_read_b64_tr_b16 a[124:125], v17 offset:25344
    v_min_u32 v120, 1664, v27
    v_mfma_f32_16x16x32_bf16 v[96:99], a[36:39], v[56:59], v[96:99]
    v_exp_f32 v105, v105
    v_mfma_f32_16x16x32_bf16 v[96:99], a[40:43], v[72:75], v[96:99]
    ds_read_b64_tr_b16 a[126:127], v17 offset:29440
    v_cvt_pk_bf16_f32 v116, v104, v105
    v_mfma_f32_16x16x32_bf16 v[96:99], a[44:47], v[88:91], v[96:99]
    v_exp_f32 v106, v106
    v_mfma_f32_16x16x32_bf16 v[100:103], a[48:51], v[40:43], 0
    v_mfma_f32_16x16x32_bf16 v[100:103], a[52:55], v[56:59], v[100:103]
    v_exp_f32 v107, v107
    v_mfma_f32_16x16x32_bf16 v[100:103], a[56:59], v[72:75], v[100:103]
    s_waitcnt lgkmcnt(12)
    v_cvt_pk_bf16_f32 v117, v106, v107
    v_and_b32 v121, 0xfff, v27
    v_mfma_f32_16x16x32_bf16 v[100:103], a[60:63], v[88:91], v[100:103]
    s_waitcnt vmcnt(2) lgkmcnt(0)
    v_exp_f32 v108, v108
    v_mfma_f32_16x16x32_bf16 a[128:131], a[144:147], v[112:115], a[128:131]
    s_barrier
    ds_read_b128 a[0:3], v18 offset:32768
    v_and_b32 v122, 0x7ff, v27
    v_mfma_f32_16x16x32_bf16 v[128:131], a[96:99], v[112:115], v[128:131]
    s_add_u32 m0, s62, 32768
    v_exp_f32 v109, v109
    v_mfma_f32_16x16x32_bf16 v[132:135], a[100:103], v[112:115], v[132:135]
    ds_read_b128 a[4:7], v19 offset:32768
    v_cvt_pk_bf16_f32 v118, v108, v109
    v_mfma_f32_16x16x32_bf16 v[136:139], a[104:107], v[112:115], v[136:139]
    v_exp_f32 v110, v110
    v_mfma_f32_16x16x32_bf16 v[140:143], a[108:111], v[112:115], v[140:143]
    ds_read_b128 a[8:11], v20 offset:32768
    v_min_u32 v122, 1664, v122
    v_mfma_f32_16x16x32_bf16 v[144:147], a[112:115], v[112:115], v[144:147]
    v_exp_f32 v111, v111
    v_mfma_f32_16x16x32_bf16 v[148:151], a[116:119], v[112:115], v[148:151]
    ds_read_b128 a[12:15], v21 offset:32768
    v_cvt_pk_bf16_f32 v119, v110, v111
    v_mfma_f32_16x16x32_bf16 v[152:155], a[120:123], v[112:115], v[152:155]
    buffer_load_dwordx4 v6, s[8:11], s82 offen offset:0 lds
    v_mfma_f32_16x16x32_bf16 v[156:159], a[124:127], v[112:115], v[156:159]
    v_exp_f32 v96, v96
    v_mfma_f32_16x16x32_bf16 v[104:107], a[32:35], v[44:47], 0
    ds_read_b128 a[16:19], v18 offset:36864
    v_lshrrev_b32 v123, 4, v0
    v_mfma_f32_16x16x32_bf16 v[104:107], a[36:39], v[60:63], v[104:107]
    v_exp_f32 v97, v97
    v_mfma_f32_16x16x32_bf16 v[104:107], a[40:43], v[76:79], v[104:107]
    ds_read_b128 a[20:23], v19 offset:36864
    v_cvt_pk_bf16_f32 v112, v96, v97
    v_mfma_f32_16x16x32_bf16 v[104:107], a[44:47], v[92:95], v[104:107]
    v_exp_f32 v98, v98
    v_mfma_f32_16x16x32_bf16 v[108:111], a[48:51], v[44:47], 0
    buffer_load_dwordx4 v7, s[8:11], s82 offen offset:1024 lds
    v_mfma_f32_16x16x32_bf16 v[108:111], a[52:55], v[60:63], v[108:111]
    v_exp_f32 v99, v99
    v_mfma_f32_16x16x32_bf16 v[108:111], a[56:59], v[76:79], v[108:111]
    ds_read_b128 a[24:27], v20 offset:36864
    v_cvt_pk_bf16_f32 v113, v98, v99
    v_mfma_f32_16x16x32_bf16 v[108:111], a[60:63], v[92:95], v[108:111]
    v_exp_f32 v100, v100
    v_mfma_f32_16x16x32_bf16 a[132:135], a[144:147], v[116:119], a[132:135]
    ds_read_b128 a[28:31], v21 offset:36864
    v_mul_u32_u24 v123, 3584, v123
    v_mfma_f32_16x16x32_bf16 v[160:163], a[96:99], v[116:119], v[160:163]
    v_exp_f32 v101, v101
    v_mfma_f32_16x16x32_bf16 v[164:167], a[100:103], v[116:119], v[164:167]
    ds_read_b64_tr_b16 a[64:65], v16 offset:49152
    v_cvt_pk_bf16_f32 v114, v100, v101
    v_mfma_f32_16x16x32_bf16 v[168:171], a[104:107], v[116:119], v[168:171]
    v_exp_f32 v102, v102
    v_mfma_f32_16x16x32_bf16 v[172:175], a[108:111], v[116:119], v[172:175]
    buffer_load_dwordx4 v8, s[8:11], s82 offen offset:2048 lds
    v_mfma_f32_16x16x32_bf16 v[176:179], a[112:115], v[116:119], v[176:179]
    v_exp_f32 v103, v103
    v_mfma_f32_16x16x32_bf16 v[180:183], a[116:119], v[116:119], v[180:183]
    ds_read_b64_tr_b16 a[66:67], v16 offset:53248
    v_cvt_pk_bf16_f32 v115, v102, v103
    v_mfma_f32_16x16x32_bf16 v[184:187], a[120:123], v[116:119], v[184:187]
    buffer_load_dwordx4 v9, s[8:11], s82 offen offset:3072 lds
    v_mfma_f32_16x16x32_bf16 v[188:191], a[124:127], v[116:119], v[188:191]
    s_waitcnt lgkmcnt(9)
    v_exp_f32 v104, v104
    v_mfma_f32_16x16x32_bf16 v[96:99], a[0:3], v[32:35], 0
    s_waitcnt lgkmcnt(7)
    ds_read_b64_tr_b16 a[68:69], v17 offset:49152
    v_add_u32 v122, v122, v123
    v_mfma_f32_16x16x32_bf16 v[96:99], a[4:7], v[48:51], v[96:99]
    s_add_u32 m0, s62, 49152
    v_exp_f32 v105, v105
    v_mfma_f32_16x16x32_bf16 v[96:99], a[8:11], v[64:67], v[96:99]
    s_waitcnt lgkmcnt(7)
    ds_read_b64_tr_b16 a[70:71], v17 offset:53248
    v_cvt_pk_bf16_f32 v116, v104, v105
    v_mfma_f32_16x16x32_bf16 v[96:99], a[12:15], v[80:83], v[96:99]
    s_waitcnt lgkmcnt(6)
    v_exp_f32 v106, v106
    v_mfma_f32_16x16x32_bf16 v[100:103], a[16:19], v[32:35], 0
    buffer_load_dwordx4 v10, s[12:15], s82 offen offset:0 lds
    v_mfma_f32_16x16x32_bf16 v[100:103], a[20:23], v[48:51], v[100:103]
    s_waitcnt lgkmcnt(5)
    v_exp_f32 v107, v107
    v_mfma_f32_16x16x32_bf16 v[100:103], a[24:27], v[64:67], v[100:103]
    s_waitcnt lgkmcnt(4)
    ds_read_b64_tr_b16 a[72:73], v16 offset:49408
    v_cvt_pk_bf16_f32 v117, v106, v107
    v_mfma_f32_16x16x32_bf16 v[100:103], a[28:31], v[80:83], v[100:103]
    v_exp_f32 v108, v108
    v_mfma_f32_16x16x32_bf16 a[136:139], a[144:147], v[112:115], a[136:139]
    ds_read_b64_tr_b16 a[74:75], v16 offset:53504
    v_and_b32 v26, 4, v31
    v_mfma_f32_16x16x32_bf16 v[192:195], a[96:99], v[112:115], v[192:195]
    v_exp_f32 v109, v109
    v_mfma_f32_16x16x32_bf16 v[196:199], a[100:103], v[112:115], v[196:199]
    ds_read_b64_tr_b16 a[76:77], v17 offset:49408
    v_cvt_pk_bf16_f32 v118, v108, v109
    v_mfma_f32_16x16x32_bf16 v[200:203], a[104:107], v[112:115], v[200:203]
    v_exp_f32 v110, v110
    v_mfma_f32_16x16x32_bf16 v[204:207], a[108:111], v[112:115], v[204:207]
    buffer_load_dwordx4 v11, s[12:15], s82 offen offset:1024 lds
    v_mfma_f32_16x16x32_bf16 v[208:211], a[112:115], v[112:115], v[208:211]
    v_exp_f32 v111, v111
    v_mfma_f32_16x16x32_bf16 v[212:215], a[116:119], v[112:115], v[212:215]
    ds_read_b64_tr_b16 a[78:79], v17 offset:53504
    v_cvt_pk_bf16_f32 v119, v110, v111
    v_mfma_f32_16x16x32_bf16 v[216:219], a[120:123], v[112:115], v[216:219]
    buffer_load_dwordx4 v10, s[12:15], s82 offen offset:2048 lds
    v_mfma_f32_16x16x32_bf16 v[220:223], a[124:127], v[112:115], v[220:223]
    v_exp_f32 v96, v96
    v_mfma_f32_16x16x32_bf16 v[104:107], a[0:3], v[36:39], 0
    ds_read_b64_tr_b16 a[80:81], v16 offset:49664
    v_lshl_add_u32 v123, v26, 3, 32
    v_mfma_f32_16x16x32_bf16 v[104:107], a[4:7], v[52:55], v[104:107]
    v_exp_f32 v97, v97
    v_mfma_f32_16x16x32_bf16 v[104:107], a[8:11], v[68:71], v[104:107]
    ds_read_b64_tr_b16 a[82:83], v16 offset:53760
    v_cvt_pk_bf16_f32 v112, v96, v97
    v_mfma_f32_16x16x32_bf16 v[104:107], a[12:15], v[84:87], v[104:107]
    v_exp_f32 v98, v98
    v_mfma_f32_16x16x32_bf16 v[108:111], a[16:19], v[36:39], 0
    buffer_load_dwordx4 v11, s[12:15], s82 offen offset:3072 lds
    v_mfma_f32_16x16x32_bf16 v[108:111], a[20:23], v[52:55], v[108:111]
    v_exp_f32 v99, v99
    v_mfma_f32_16x16x32_bf16 v[108:111], a[24:27], v[68:71], v[108:111]
    ds_read_b64_tr_b16 a[84:85], v17 offset:49664
    v_cvt_pk_bf16_f32 v113, v98, v99
    v_mfma_f32_16x16x32_bf16 v[108:111], a[28:31], v[84:87], v[108:111]
    v_exp_f32 v100, v100
    v_mfma_f32_16x16x32_bf16 a[140:143], a[144:147], v[116:119], a[140:143]
    ds_read_b64_tr_b16 a[86:87], v17 offset:53760
    v_and_b32 v24, 0xff, v27
    v_mfma_f32_16x16x32_bf16 v[224:227], a[96:99], v[116:119], v[224:227]
    s_getpc_b64 s[66:67]
L_pc2:
    v_exp_f32 v101, v101
    v_mfma_f32_16x16x32_bf16 v[228:231], a[100:103], v[116:119], v[228:231]
    s_add_u32 s80, s80, L_join - L_pc2
    ds_read_b64_tr_b16 a[88:89], v16 offset:49920
    v_cvt_pk_bf16_f32 v114, v100, v101
    v_mfma_f32_16x16x32_bf16 v[232:235], a[104:107], v[116:119], v[232:235]
    v_exp_f32 v102, v102
    v_mfma_f32_16x16x32_bf16 v[236:239], a[108:111], v[116:119], v[236:239]
    s_waitcnt vmcnt(9)
    buffer_load_dword v28, v27, s[20:23], s76 offen
    v_mfma_f32_16x16x32_bf16 v[240:243], a[112:115], v[116:119], v[240:243]
    v_exp_f32 v103, v103
    v_mfma_f32_16x16x32_bf16 v[244:247], a[116:119], v[116:119], v[244:247]
    ds_read_b64_tr_b16 a[90:91], v16 offset:54016
    v_cvt_pk_bf16_f32 v115, v102, v103
    v_mfma_f32_16x16x32_bf16 v[248:251], a[120:123], v[116:119], v[248:251]
    v_mfma_f32_16x16x32_bf16 v[252:255], a[124:127], v[116:119], v[252:255]
    v_exp_f32 v104, v104
    v_mfma_f32_16x16x32_bf16 v[96:99], a[0:3], v[40:43], 0
    ds_read_b64_tr_b16 a[92:93], v17 offset:49920
    v_add_u32 v24, s80, v24
    v_mfma_f32_16x16x32_bf16 v[96:99], a[4:7], v[56:59], v[96:99]
    v_exp_f32 v105, v105
    v_mfma_f32_16x16x32_bf16 v[96:99], a[8:11], v[72:75], v[96:99]
    ds_read_b64_tr_b16 a[94:95], v17 offset:54016
    v_cvt_pk_bf16_f32 v116, v104, v105
    v_mfma_f32_16x16x32_bf16 v[96:99], a[12:15], v[88:91], v[96:99]
    v_exp_f32 v106, v106
    v_mfma_f32_16x16x32_bf16 v[100:103], a[16:19], v[40:43], 0
    v_mfma_f32_16x16x32_bf16 v[100:103], a[20:23], v[56:59], v[100:103]
    v_exp_f32 v107, v107
    v_mfma_f32_16x16x32_bf16 v[100:103], a[24:27], v[72:75], v[100:103]
    ds_read_b128 a[32:35], v18 offset:40960
    v_cvt_pk_bf16_f32 v117, v106, v107
    v_mfma_f32_16x16x32_bf16 v[100:103], a[28:31], v[88:91], v[100:103]
    v_exp_f32 v108, v108
    v_mfma_f32_16x16x32_bf16 a[128:131], a[144:147], v[112:115], a[128:131]
    s_waitcnt lgkmcnt(15)
    ds_read_b128 a[36:39], v19 offset:40960
    v_min_u32 v24, L_code_end - L_pc2 - 4, v24
    v_mfma_f32_16x16x32_bf16 v[128:131], a[64:67], v[112:115], v[128:131]
    s_waitcnt lgkmcnt(14)
    v_exp_f32 v109, v109
    v_mfma_f32_16x16x32_bf16 v[132:135], a[68:71], v[112:115], v[132:135]
    s_waitcnt lgkmcnt(12)
    ds_read_b128 a[40:43], v20 offset:40960
    v_cvt_pk_bf16_f32 v118, v108, v109
    v_mfma_f32_16x16x32_bf16 v[136:139], a[72:75], v[112:115], v[136:139]
    s_waitcnt lgkmcnt(11)
    v_exp_f32 v110, v110
    s_sub_u32 s55, s96, 16
    s_cmp_ge_u32 s55, 48
    s_cbranch_scc1 L_nz_17
    s_cmp_ge_u32 s55, 32
    s_cselect_b32 s55, 4, 0
    s_cselect_b32 s57, 0, s52
    s_cmp_lg_u32 s57, 0
    s_cbranch_scc1 L_nz_17
    s_mov_b64 exec, 1
    buffer_atomic_add v30, v0, s[44:47], s55 offen offset:132 sc1
    s_mov_b64 exec, -1
L_nz_17:
    v_mfma_f32_16x16x32_bf16 v[140:143], a[76:79], v[112:115], v[140:143]
    s_waitcnt lgkmcnt(9)
    v_mfma_f32_16x16x32_bf16 v[144:147], a[80:83], v[112:115], v[144:147]
    s_waitcnt lgkmcnt(7)
    v_exp_f32 v111, v111
    v_mfma_f32_16x16x32_bf16 v[148:151], a[84:87], v[112:115], v[148:151]
    s_waitcnt lgkmcnt(5)
    ds_read_b128 a[44:47], v21 offset:40960
    v_cvt_pk_bf16_f32 v119, v110, v111
    v_mfma_f32_16x16x32_bf16 v[152:155], a[88:91], v[112:115], v[152:155]
    s_waitcnt lgkmcnt(4)
    v_mfma_f32_16x16x32_bf16 v[156:159], a[92:95], v[112:115], v[156:159]
    s_add_u32 s83, s61, 131072
    v_exp_f32 v96, v96
    v_mfma_f32_16x16x32_bf16 v[104:107], a[0:3], v[44:47], 0
    ds_read_b128 a[48:51], v18 offset:45056
    s_waitcnt vmcnt(9)
    v_mov_b32 v25, s67
    v_mfma_f32_16x16x32_bf16 v[104:107], a[4:7], v[60:63], v[104:107]
    v_exp_f32 v97, v97
    v_mfma_f32_16x16x32_bf16 v[104:107], a[8:11], v[76:79], v[104:107]
    ds_read_b128 a[52:55], v19 offset:45056
    v_cvt_pk_bf16_f32 v112, v96, v97
    v_mfma_f32_16x16x32_bf16 v[104:107], a[12:15], v[92:95], v[104:107]
    v_exp_f32 v98, v98
    v_mfma_f32_16x16x32_bf16 v[108:111], a[16:19], v[44:47], 0
    v_mfma_f32_16x16x32_bf16 v[108:111], a[20:23], v[60:63], v[108:111]
    v_exp_f32 v99, v99
    v_mfma_f32_16x16x32_bf16 v[108:111], a[24:27], v[76:79], v[108:111]
    ds_read_b128 a[56:59], v20 offset:45056
    v_cvt_pk_bf16_f32 v113, v98, v99
    v_mfma_f32_16x16x32_bf16 v[108:111], a[28:31], v[92:95], v[108:111]
    v_exp_f32 v100, v100
    v_mfma_f32_16x16x32_bf16 a[132:135], a[144:147], v[116:119], a[132:135]
    ds_read_b128 a[60:63], v21 offset:45056
    v_add_co_u32 v24, vcc, s66, v24
    v_mfma_f32_16x16x32_bf16 v[160:163], a[64:67], v[116:119], v[160:163]
    v_exp_f32 v101, v101
    v_mfma_f32_16x16x32_bf16 v[164:167], a[68:71], v[116:119], v[164:167]
    ds_read_b64_tr_b16 a[96:97], v16 offset:57344
    v_cvt_pk_bf16_f32 v114, v100, v101
    v_mfma_f32_16x16x32_bf16 v[168:171], a[72:75], v[116:119], v[168:171]
    s_add_u32 m0, s62, 98304
    v_exp_f32 v102, v102
    v_mfma_f32_16x16x32_bf16 v[172:175], a[76:79], v[116:119], v[172:175]
    buffer_load_dwordx4 v2, s[20:23], s83 offen offset:0 lds
    v_mfma_f32_16x16x32_bf16 v[176:179], a[80:83], v[116:119], v[176:179]
    v_exp_f32 v103, v103
    v_mfma_f32_16x16x32_bf16 v[180:183], a[84:87], v[116:119], v[180:183]
    ds_read_b64_tr_b16 a[98:99], v16 offset:61440
    v_cvt_pk_bf16_f32 v115, v102, v103
    v_mfma_f32_16x16x32_bf16 v[184:187], a[88:91], v[116:119], v[184:187]
    buffer_load_dwordx4 v3, s[20:23], s83 offen offset:1024 lds
    v_mfma_f32_16x16x32_bf16 v[188:191], a[92:95], v[116:119], v[188:191]
    s_waitcnt lgkmcnt(9)
    v_exp_f32 v104, v104
    v_mfma_f32_16x16x32_bf16 v[96:99], a[32:35], v[32:35], 0
    s_waitcnt lgkmcnt(7)
    ds_read_b64_tr_b16 a[100:101], v17 offset:57344
    v_addc_co_u32 v25, vcc, 0, v25, vcc
    v_mfma_f32_16x16x32_bf16 v[96:99], a[36:39], v[48:51], v[96:99]
    s_add_u32 s82, s61, 163840
    v_exp_f32 v105, v105
    v_mfma_f32_16x16x32_bf16 v[96:99], a[40:43], v[64:67], v[96:99]
    s_waitcnt lgkmcnt(7)
    ds_read_b64_tr_b16 a[102:103], v17 offset:61440
    v_cvt_pk_bf16_f32 v116, v104, v105
    v_mfma_f32_16x16x32_bf16 v[96:99], a[44:47], v[80:83], v[96:99]
    s_waitcnt lgkmcnt(6)
    v_exp_f32 v106, v106
    v_mfma_f32_16x16x32_bf16 v[100:103], a[48:51], v[32:35], 0
    buffer_load_dwordx4 v4, s[20:23], s83 offen offset:2048 lds
    v_mfma_f32_16x16x32_bf16 v[100:103], a[52:55], v[48:51], v[100:103]
    s_waitcnt lgkmcnt(5)
    v_exp_f32 v107, v107
    v_mfma_f32_16x16x32_bf16 v[100:103], a[56:59], v[64:67], v[100:103]
    s_waitcnt lgkmcnt(4)
    ds_read_b64_tr_b16 a[104:105], v16 offset:57600
    v_cvt_pk_bf16_f32 v117, v106, v107
    v_mfma_f32_16x16x32_bf16 v[100:103], a[60:63], v[80:83], v[100:103]
    v_exp_f32 v108, v108
    v_mfma_f32_16x16x32_bf16 a[136:139], a[144:147], v[112:115], a[136:139]
    ds_read_b64_tr_b16 a[106:107], v16 offset:61696
    v_mfma_f32_16x16x32_bf16 v[192:195], a[64:67], v[112:115], v[192:195]
    v_exp_f32 v109, v109
    v_mfma_f32_16x16x32_bf16 v[196:199], a[68:71], v[112:115], v[196:199]
    ds_read_b64_tr_b16 a[108:109], v17 offset:57600
    v_cvt_pk_bf16_f32 v118, v108, v109
    v_mfma_f32_16x16x32_bf16 v[200:203], a[72:75], v[112:115], v[200:203]
    v_exp_f32 v110, v110
    v_mfma_f32_16x16x32_bf16 v[204:207], a[76:79], v[112:115], v[204:207]
    buffer_load_dwordx4 v5, s[20:23], s83 offen offset:3072 lds
    v_mfma_f32_16x16x32_bf16 v[208:211], a[80:83], v[112:115], v[208:211]
    s_add_u32 m0, s62, 114688
    v_exp_f32 v111, v111
    v_mfma_f32_16x16x32_bf16 v[212:215], a[84:87], v[112:115], v[212:215]
    ds_read_b64_tr_b16 a[110:111], v17 offset:61696
    v_cvt_pk_bf16_f32 v119, v110, v111
    v_mfma_f32_16x16x32_bf16 v[216:219], a[88:91], v[112:115], v[216:219]
    buffer_load_dwordx4 v2, s[20:23], s82 offen offset:0 lds
    v_mfma_f32_16x16x32_bf16 v[220:223], a[92:95], v[112:115], v[220:223]
    v_exp_f32 v96, v96
    v_mfma_f32_16x16x32_bf16 v[104:107], a[32:35], v[36:39], 0
    ds_read_b64_tr_b16 a[112:113], v16 offset:57856
    v_mfma_f32_16x16x32_bf16 v[104:107], a[36:39], v[52:55], v[104:107]
    v_exp_f32 v97, v97
    v_mfma_f32_16x16x32_bf16 v[104:107], a[40:43], v[68:71], v[104:107]
    ds_read_b64_tr_b16 a[114:115], v16 offset:61952
    v_cvt_pk_bf16_f32 v112, v96, v97
    v_mfma_f32_16x16x32_bf16 v[104:107], a[44:47], v[84:87], v[104:107]
    v_exp_f32 v98, v98
    v_mfma_f32_16x16x32_bf16 v[108:111], a[48:51], v[36:39], 0
    buffer_load_dwordx4 v3, s[20:23], s82 offen offset:1024 lds
    v_mfma_f32_16x16x32_bf16 v[108:111], a[52:55], v[52:55], v[108:111]
    v_exp_f32 v99, v99
    v_mfma_f32_16x16x32_bf16 v[108:111], a[56:59], v[68:71], v[108:111]
    ds_read_b64_tr_b16 a[116:117], v17 offset:57856
    v_cvt_pk_bf16_f32 v113, v98, v99
    v_mfma_f32_16x16x32_bf16 v[108:111], a[60:63], v[84:87], v[108:111]
    v_exp_f32 v100, v100
    v_mfma_f32_16x16x32_bf16 a[140:143], a[144:147], v[116:119], a[140:143]
    ds_read_b64_tr_b16 a[118:119], v17 offset:61952
    v_mfma_f32_16x16x32_bf16 v[224:227], a[64:67], v[116:119], v[224:227]
    v_exp_f32 v101, v101
    v_mfma_f32_16x16x32_bf16 v[228:231], a[68:71], v[116:119], v[228:231]
    ds_read_b64_tr_b16 a[120:121], v16 offset:58112
    v_cvt_pk_bf16_f32 v114, v100, v101
    v_mfma_f32_16x16x32_bf16 v[232:235], a[72:75], v[116:119], v[232:235]
    v_exp_f32 v102, v102
    v_mfma_f32_16x16x32_bf16 v[236:239], a[76:79], v[116:119], v[236:239]
    buffer_load_dwordx4 v4, s[20:23], s82 offen offset:2048 lds
    v_mfma_f32_16x16x32_bf16 v[240:243], a[80:83], v[116:119], v[240:243]
    v_exp_f32 v103, v103
    v_mfma_f32_16x16x32_bf16 v[244:247], a[84:87], v[116:119], v[244:247]
    s_add_u32 s83, s63, 49152
    ds_read_b64_tr_b16 a[122:123], v16 offset:62208
    v_cvt_pk_bf16_f32 v115, v102, v103
    v_mfma_f32_16x16x32_bf16 v[248:251], a[88:91], v[116:119], v[248:251]
    buffer_load_dwordx4 v5, s[20:23], s82 offen offset:3072 lds
    v_mfma_f32_16x16x32_bf16 v[252:255], a[92:95], v[116:119], v[252:255]
    v_exp_f32 v104, v104
    v_mfma_f32_16x16x32_bf16 v[96:99], a[32:35], v[40:43], 0
    ds_read_b64_tr_b16 a[124:125], v17 offset:58112
    v_mfma_f32_16x16x32_bf16 v[96:99], a[36:39], v[56:59], v[96:99]
    v_exp_f32 v105, v105
    v_mfma_f32_16x16x32_bf16 v[96:99], a[40:43], v[72:75], v[96:99]
    ds_read_b64_tr_b16 a[126:127], v17 offset:62208
    v_cvt_pk_bf16_f32 v116, v104, v105
    v_mfma_f32_16x16x32_bf16 v[96:99], a[44:47], v[88:91], v[96:99]
    v_exp_f32 v106, v106
    v_mfma_f32_16x16x32_bf16 v[100:103], a[48:51], v[40:43], 0
    v_mfma_f32_16x16x32_bf16 v[100:103], a[52:55], v[56:59], v[100:103]
    v_exp_f32 v107, v107
    v_mfma_f32_16x16x32_bf16 v[100:103], a[56:59], v[72:75], v[100:103]
    s_waitcnt lgkmcnt(12)
    v_cvt_pk_bf16_f32 v117, v106, v107
    v_mfma_f32_16x16x32_bf16 v[100:103], a[60:63], v[88:91], v[100:103]
    s_waitcnt vmcnt(9) lgkmcnt(0)
    v_exp_f32 v108, v108
    v_mfma_f32_16x16x32_bf16 a[128:131], a[144:147], v[112:115], a[128:131]
    s_barrier
    ds_read_b128 a[0:3], v18 offset:0
    v_mfma_f32_16x16x32_bf16 v[128:131], a[96:99], v[112:115], v[128:131]
    s_add_u32 m0, s62, 65536
    v_exp_f32 v109, v109
    v_mfma_f32_16x16x32_bf16 v[132:135], a[100:103], v[112:115], v[132:135]
    ds_read_b128 a[4:7], v19 offset:0
    v_cvt_pk_bf16_f32 v118, v108, v109
    v_mfma_f32_16x16x32_bf16 v[136:139], a[104:107], v[112:115], v[136:139]
    v_exp_f32 v110, v110
    v_mfma_f32_16x16x32_bf16 v[140:143], a[108:111], v[112:115], v[140:143]
    ds_read_b128 a[8:11], v20 offset:0
    v_mfma_f32_16x16x32_bf16 v[144:147], a[112:115], v[112:115], v[144:147]
    v_exp_f32 v111, v111
    v_mfma_f32_16x16x32_bf16 v[148:151], a[116:119], v[112:115], v[148:151]
    ds_read_b128 a[12:15], v21 offset:0
    v_cvt_pk_bf16_f32 v119, v110, v111
    v_mfma_f32_16x16x32_bf16 v[152:155], a[120:123], v[112:115], v[152:155]
    buffer_load_dwordx4 v6, s[8:11], s83 offen offset:0 lds
    v_mfma_f32_16x16x32_bf16 v[156:159], a[124:127], v[112:115], v[156:159]
    v_exp_f32 v96, v96
    v_mfma_f32_16x16x32_bf16 v[104:107], a[32:35], v[44:47], 0
    ds_read_b128 a[16:19], v18 offset:4096
    v_mfma_f32_16x16x32_bf16 v[104:107], a[36:39], v[60:63], v[104:107]
    v_exp_f32 v97, v97
    v_mfma_f32_16x16x32_bf16 v[104:107], a[40:43], v[76:79], v[104:107]
    ds_read_b128 a[20:23], v19 offset:4096
    v_cvt_pk_bf16_f32 v112, v96, v97
    v_mfma_f32_16x16x32_bf16 v[104:107], a[44:47], v[92:95], v[104:107]
    v_exp_f32 v98, v98
    v_mfma_f32_16x16x32_bf16 v[108:111], a[48:51], v[44:47], 0
    buffer_load_dwordx4 v7, s[8:11], s83 offen offset:1024 lds
    v_mfma_f32_16x16x32_bf16 v[108:111], a[52:55], v[60:63], v[108:111]
    v_exp_f32 v99, v99
    v_mfma_f32_16x16x32_bf16 v[108:111], a[56:59], v[76:79], v[108:111]
    ds_read_b128 a[24:27], v20 offset:4096
    v_cvt_pk_bf16_f32 v113, v98, v99
    v_mfma_f32_16x16x32_bf16 v[108:111], a[60:63], v[92:95], v[108:111]
    v_exp_f32 v100, v100
    v_mfma_f32_16x16x32_bf16 a[132:135], a[144:147], v[116:119], a[132:135]
    ds_read_b128 a[28:31], v21 offset:4096
    v_mfma_f32_16x16x32_bf16 v[160:163], a[96:99], v[116:119], v[160:163]
    v_exp_f32 v101, v101
    v_mfma_f32_16x16x32_bf16 v[164:167], a[100:103], v[116:119], v[164:167]
    ds_read_b64_tr_b16 a[64:65], v16 offset:16384
    v_cvt_pk_bf16_f32 v114, v100, v101
    v_mfma_f32_16x16x32_bf16 v[168:171], a[104:107], v[116:119], v[168:171]
    v_exp_f32 v102, v102
    v_mfma_f32_16x16x32_bf16 v[172:175], a[108:111], v[116:119], v[172:175]
    buffer_load_dwordx4 v8, s[8:11], s83 offen offset:2048 lds
    v_mfma_f32_16x16x32_bf16 v[176:179], a[112:115], v[116:119], v[176:179]
    v_exp_f32 v103, v103
    v_mfma_f32_16x16x32_bf16 v[180:183], a[116:119], v[116:119], v[180:183]
    ds_read_b64_tr_b16 a[66:67], v16 offset:20480
    v_cvt_pk_bf16_f32 v115, v102, v103
    v_mfma_f32_16x16x32_bf16 v[184:187], a[120:123], v[116:119], v[184:187]
    buffer_load_dwordx4 v9, s[8:11], s83 offen offset:3072 lds
    v_mfma_f32_16x16x32_bf16 v[188:191], a[124:127], v[116:119], v[188:191]
    s_waitcnt lgkmcnt(9)
    v_exp_f32 v104, v104
    v_mfma_f32_16x16x32_bf16 v[96:99], a[0:3], v[32:35], 0
    s_waitcnt lgkmcnt(7)
    ds_read_b64_tr_b16 a[68:69], v17 offset:16384
    v_mfma_f32_16x16x32_bf16 v[96:99], a[4:7], v[48:51], v[96:99]
    s_add_u32 m0, s62, 81920
    v_exp_f32 v105, v105
    v_mfma_f32_16x16x32_bf16 v[96:99], a[8:11], v[64:67], v[96:99]
    s_waitcnt lgkmcnt(7)
    ds_read_b64_tr_b16 a[70:71], v17 offset:20480
    v_cvt_pk_bf16_f32 v116, v104, v105
    v_mfma_f32_16x16x32_bf16 v[96:99], a[12:15], v[80:83], v[96:99]
    s_waitcnt lgkmcnt(6)
    v_exp_f32 v106, v106
    v_mfma_f32_16x16x32_bf16 v[100:103], a[16:19], v[32:35], 0
    buffer_load_dwordx4 v10, s[12:15], s83 offen offset:0 lds
    v_mfma_f32_16x16x32_bf16 v[100:103], a[20:23], v[48:51], v[100:103]
    s_waitcnt lgkmcnt(5)
    v_exp_f32 v107, v107
    v_mfma_f32_16x16x32_bf16 v[100:103], a[24:27], v[64:67], v[100:103]
    s_waitcnt lgkmcnt(4)
    ds_read_b64_tr_b16 a[72:73], v16 offset:16640
    v_cvt_pk_bf16_f32 v117, v106, v107
    v_mfma_f32_16x16x32_bf16 v[100:103], a[28:31], v[80:83], v[100:103]
    v_exp_f32 v108, v108
    v_mfma_f32_16x16x32_bf16 a[136:139], a[144:147], v[112:115], a[136:139]
    ds_read_b64_tr_b16 a[74:75], v16 offset:20736
    v_mfma_f32_16x16x32_bf16 v[192:195], a[96:99], v[112:115], v[192:195]
    v_exp_f32 v109, v109
    v_mfma_f32_16x16x32_bf16 v[196:199], a[100:103], v[112:115], v[196:199]
    s_add_u32 s82, s61, 196608
    ds_read_b64_tr_b16 a[76:77], v17 offset:16640
    v_cvt_pk_bf16_f32 v118, v108, v109
    v_mfma_f32_16x16x32_bf16 v[200:203], a[104:107], v[112:115], v[200:203]
    v_exp_f32 v110, v110
    v_mfma_f32_16x16x32_bf16 v[204:207], a[108:111], v[112:115], v[204:207]
    buffer_load_dwordx4 v11, s[12:15], s83 offen offset:1024 lds
    v_mfma_f32_16x16x32_bf16 v[208:211], a[112:115], v[112:115], v[208:211]
    v_exp_f32 v111, v111
    v_mfma_f32_16x16x32_bf16 v[212:215], a[116:119], v[112:115], v[212:215]
    ds_read_b64_tr_b16 a[78:79], v17 offset:20736
    v_cvt_pk_bf16_f32 v119, v110, v111
    v_mfma_f32_16x16x32_bf16 v[216:219], a[120:123], v[112:115], v[216:219]
    buffer_load_dwordx4 v10, s[12:15], s83 offen offset:2048 lds
    v_mfma_f32_16x16x32_bf16 v[220:223], a[124:127], v[112:115], v[220:223]
    v_exp_f32 v96, v96
    v_mfma_f32_16x16x32_bf16 v[104:107], a[0:3], v[36:39], 0
    ds_read_b64_tr_b16 a[80:81], v16 offset:16896
    v_mfma_f32_16x16x32_bf16 v[104:107], a[4:7], v[52:55], v[104:107]
    v_exp_f32 v97, v97
    v_mfma_f32_16x16x32_bf16 v[104:107], a[8:11], v[68:71], v[104:107]
    ds_read_b64_tr_b16 a[82:83], v16 offset:20992
    v_cvt_pk_bf16_f32 v112, v96, v97
    v_mfma_f32_16x16x32_bf16 v[104:107], a[12:15], v[84:87], v[104:107]
    v_exp_f32 v98, v98
    v_mfma_f32_16x16x32_bf16 v[108:111], a[16:19], v[36:39], 0
    buffer_load_dwordx4 v11, s[12:15], s83 offen offset:3072 lds
    v_mfma_f32_16x16x32_bf16 v[108:111], a[20:23], v[52:55], v[108:111]
    s_add_u32 m0, s62, 131072
    v_exp_f32 v99, v99
    v_mfma_f32_16x16x32_bf16 v[108:111], a[24:27], v[68:71], v[108:111]
    ds_read_b64_tr_b16 a[84:85], v17 offset:16896
    v_cvt_pk_bf16_f32 v113, v98, v99
    v_mfma_f32_16x16x32_bf16 v[108:111], a[28:31], v[84:87], v[108:111]
    v_exp_f32 v100, v100
    v_mfma_f32_16x16x32_bf16 a[140:143], a[144:147], v[116:119], a[140:143]
    ds_read_b64_tr_b16 a[86:87], v17 offset:20992
    v_mfma_f32_16x16x32_bf16 v[224:227], a[96:99], v[116:119], v[224:227]
    v_exp_f32 v101, v101
    v_mfma_f32_16x16x32_bf16 v[228:231], a[100:103], v[116:119], v[228:231]
    ds_read_b64_tr_b16 a[88:89], v16 offset:17152
    v_cvt_pk_bf16_f32 v114, v100, v101
    v_mfma_f32_16x16x32_bf16 v[232:235], a[104:107], v[116:119], v[232:235]
    v_exp_f32 v102, v102
    v_mfma_f32_16x16x32_bf16 v[236:239], a[108:111], v[116:119], v[236:239]
    buffer_load_dwordx4 v2, s[20:23], s82 offen offset:0 lds
    v_mfma_f32_16x16x32_bf16 v[240:243], a[112:115], v[116:119], v[240:243]
    v_exp_f32 v103, v103
    v_mfma_f32_16x16x32_bf16 v[244:247], a[116:119], v[116:119], v[244:247]
    ds_read_b64_tr_b16 a[90:91], v16 offset:21248
    v_cvt_pk_bf16_f32 v115, v102, v103
    v_mfma_f32_16x16x32_bf16 v[248:251], a[120:123], v[116:119], v[248:251]
    buffer_load_dwordx4 v3, s[20:23], s82 offen offset:1024 lds
    v_mfma_f32_16x16x32_bf16 v[252:255], a[124:127], v[116:119], v[252:255]
L_hop1_4:
    s_cbranch_execz L_hop1_8
    v_exp_f32 v104, v104
    v_mfma_f32_16x16x32_bf16 v[96:99], a[0:3], v[40:43], 0
    ds_read_b64_tr_b16 a[92:93], v17 offset:17152
    v_mfma_f32_16x16x32_bf16 v[96:99], a[4:7], v[56:59], v[96:99]
    s_add_u32 s83, s61, 229376
    v_exp_f32 v105, v105
    v_mfma_f32_16x16x32_bf16 v[96:99], a[8:11], v[72:75], v[96:99]
    ds_read_b64_tr_b16 a[94:95], v17 offset:21248
    v_cvt_pk_bf16_f32 v116, v104, v105
    v_mfma_f32_16x16x32_bf16 v[96:99], a[12:15], v[88:91], v[96:99]
    v_exp_f32 v106, v106
    v_mfma_f32_16x16x32_bf16 v[100:103], a[16:19], v[40:43], 0
    buffer_load_dwordx4 v4, s[20:23], s82 offen offset:2048 lds
    v_mfma_f32_16x16x32_bf16 v[100:103], a[20:23], v[56:59], v[100:103]
    v_exp_f32 v107, v107
    v_mfma_f32_16x16x32_bf16 v[100:103], a[24:27], v[72:75], v[100:103]
    ds_read_b128 a[32:35], v18 offset:8192
    v_cvt_pk_bf16_f32 v117, v106, v107
    v_mfma_f32_16x16x32_bf16 v[100:103], a[28:31], v[88:91], v[100:103]
    v_exp_f32 v108, v108
    v_mfma_f32_16x16x32_bf16 a[128:131], a[144:147], v[112:115], a[128:131]
    s_waitcnt lgkmcnt(15)
    ds_read_b128 a[36:39], v19 offset:8192
    v_mfma_f32_16x16x32_bf16 v[128:131], a[64:67], v[112:115], v[128:131]
    s_waitcnt lgkmcnt(14)
    v_exp_f32 v109, v109
    v_mfma_f32_16x16x32_bf16 v[132:135], a[68:71], v[112:115], v[132:135]
    s_waitcnt lgkmcnt(12)
    ds_read_b128 a[40:43], v20 offset:8192
    v_cvt_pk_bf16_f32 v118, v108, v109
    v_mfma_f32_16x16x32_bf16 v[136:139], a[72:75], v[112:115], v[136:139]
    s_waitcnt lgkmcnt(7)
    v_exp_f32 v110, v110
    v_mfma_f32_16x16x32_bf16 v[140:143], a[76:79], v[112:115], v[140:143]
    buffer_load_dwordx4 v5, s[20:23], s82 offen offset:3072 lds
    v_mfma_f32_16x16x32_bf16 v[144:147], a[80:83], v[112:115], v[144:147]
    s_add_u32 m0, s62, 147456
    v_exp_f32 v111, v111
    v_mfma_f32_16x16x32_bf16 v[148:151], a[84:87], v[112:115], v[148:151]
    s_waitcnt lgkmcnt(3)
    ds_read_b128 a[44:47], v21 offset:8192
    v_cvt_pk_bf16_f32 v119, v110, v111
    v_mfma_f32_16x16x32_bf16 v[152:155], a[88:91], v[112:115], v[152:155]
    buffer_load_dwordx4 v2, s[20:23], s83 offen offset:0 lds
    v_mfma_f32_16x16x32_bf16 v[156:159], a[92:95], v[112:115], v[156:159]
    v_exp_f32 v96, v96
    v_mfma_f32_16x16x32_bf16 v[104:107], a[0:3], v[44:47], 0
    ds_read_b128 a[48:51], v18 offset:12288
    v_mfma_f32_16x16x32_bf16 v[104:107], a[4:7], v[60:63], v[104:107]
    v_exp_f32 v97, v97
    v_mfma_f32_16x16x32_bf16 v[104:107], a[8:11], v[76:79], v[104:107]
    ds_read_b128 a[52:55], v19 offset:12288
    v_cvt_pk_bf16_f32 v112, v96, v97
    v_mfma_f32_16x16x32_bf16 v[104:107], a[12:15], v[92:95], v[104:107]
    v_exp_f32 v98, v98
    v_mfma_f32_16x16x32_bf16 v[108:111], a[16:19], v[44:47], 0
    buffer_load_dwordx4 v3, s[20:23], s83 offen offset:1024 lds
    v_mfma_f32_16x16x32_bf16 v[108:111], a[20:23], v[60:63], v[108:111]
    v_exp_f32 v99, v99
    v_mfma_f32_16x16x32_bf16 v[108:111], a[24:27], v[76:79], v[108:111]
    ds_read_b128 a[56:59], v20 offset:12288
    v_cvt_pk_bf16_f32 v113, v98, v99
    v_mfma_f32_16x16x32_bf16 v[108:111], a[28:31], v[92:95], v[108:111]
    v_exp_f32 v100, v100
    v_mfma_f32_16x16x32_bf16 a[132:135], a[144:147], v[116:119], a[132:135]
    ds_read_b128 a[60:63], v21 offset:12288
    v_mfma_f32_16x16x32_bf16 v[160:163], a[64:67], v[116:119], v[160:163]
    v_exp_f32 v101, v101
    v_mfma_f32_16x16x32_bf16 v[164:167], a[68:71], v[116:119], v[164:167]
    ds_read_b64_tr_b16 a[96:97], v16 offset:24576
    v_cvt_pk_bf16_f32 v114, v100, v101
    v_mfma_f32_16x16x32_bf16 v[168:171], a[72:75], v[116:119], v[168:171]
    v_exp_f32 v102, v102
    v_mfma_f32_16x16x32_bf16 v[172:175], a[76:79], v[116:119], v[172:175]
    buffer_load_dwordx4 v4, s[20:23], s83 offen offset:2048 lds
    v_mfma_f32_16x16x32_bf16 v[176:179], a[80:83], v[116:119], v[176:179]
    v_exp_f32 v103, v103
    v_mfma_f32_16x16x32_bf16 v[180:183], a[84:87], v[116:119], v[180:183]
    s_waitcnt lgkmcnt(8)
    ds_read_b64_tr_b16 a[98:99], v16 offset:28672
    v_cvt_pk_bf16_f32 v115, v102, v103
    v_mfma_f32_16x16x32_bf16 v[184:187], a[88:91], v[116:119], v[184:187]
    buffer_load_dwordx4 v5, s[20:23], s83 offen offset:3072 lds
    v_mfma_f32_16x16x32_bf16 v[188:191], a[92:95], v[116:119], v[188:191]
    s_waitcnt vmcnt(20)
    v_exp_f32 v104, v104
    v_mfma_f32_16x16x32_bf16 v[96:99], a[32:35], v[32:35], 0
    s_waitcnt lgkmcnt(8)
    ds_read_b64_tr_b16 a[100:101], v17 offset:24576
    v_mfma_f32_16x16x32_bf16 v[96:99], a[36:39], v[48:51], v[96:99]
    s_waitcnt lgkmcnt(8)
    v_exp_f32 v105, v105
    v_mfma_f32_16x16x32_bf16 v[96:99], a[40:43], v[64:67], v[96:99]
    s_waitcnt lgkmcnt(7)
    ds_read_b64_tr_b16 a[102:103], v17 offset:28672
    v_cvt_pk_bf16_f32 v116, v104, v105
    v_mfma_f32_16x16x32_bf16 v[96:99], a[44:47], v[80:83], v[96:99]
    s_waitcnt lgkmcnt(7)
    v_exp_f32 v106, v106
    v_mfma_f32_16x16x32_bf16 v[100:103], a[48:51], v[32:35], 0
    s_waitcnt lgkmcnt(6)
    ds_read_b64_tr_b16 a[160:161], v12 offset:32768
    v_mfma_f32_16x16x32_bf16 v[100:103], a[52:55], v[48:51], v[100:103]
    s_waitcnt lgkmcnt(6)
    v_exp_f32 v107, v107
    v_mfma_f32_16x16x32_bf16 v[100:103], a[56:59], v[64:67], v[100:103]
    s_waitcnt lgkmcnt(5)
    ds_read_b64_tr_b16 a[104:105], v16 offset:24832
    v_cvt_pk_bf16_f32 v117, v106, v107
    v_mfma_f32_16x16x32_bf16 v[100:103], a[60:63], v[80:83], v[100:103]
    v_exp_f32 v108, v108
    v_mfma_f32_16x16x32_bf16 a[136:139], a[144:147], v[112:115], a[136:139]
    ds_read_b64_tr_b16 a[106:107], v16 offset:28928
    v_mfma_f32_16x16x32_bf16 v[192:195], a[64:67], v[112:115], v[192:195]
    v_exp_f32 v109, v109
    v_mfma_f32_16x16x32_bf16 v[196:199], a[68:71], v[112:115], v[196:199]
    ds_read_b64_tr_b16 a[108:109], v17 offset:24832
    v_cvt_pk_bf16_f32 v118, v108, v109
    v_mfma_f32_16x16x32_bf16 v[200:203], a[72:75], v[112:115], v[200:203]
    v_exp_f32 v110, v110
    v_mfma_f32_16x16x32_bf16 v[204:207], a[76:79], v[112:115], v[204:207]
    ds_read_b64_tr_b16 a[162:163], v12 offset:34816
    v_mfma_f32_16x16x32_bf16 v[208:211], a[80:83], v[112:115], v[208:211]
    v_exp_f32 v111, v111
    v_mfma_f32_16x16x32_bf16 v[212:215], a[84:87], v[112:115], v[212:215]
    ds_read_b64_tr_b16 a[110:111], v17 offset:28928
    v_cvt_pk_bf16_f32 v119, v110, v111
    v_mfma_f32_16x16x32_bf16 v[216:219], a[88:91], v[112:115], v[216:219]
    ds_read_b64_tr_b16 a[164:165], v13 offset:32768
    v_mfma_f32_16x16x32_bf16 v[220:223], a[92:95], v[112:115], v[220:223]
    v_exp_f32 v96, v96
    v_mfma_f32_16x16x32_bf16 v[104:107], a[32:35], v[36:39], 0
    ds_read_b64_tr_b16 a[112:113], v16 offset:25088
    v_mfma_f32_16x16x32_bf16 v[104:107], a[36:39], v[52:55], v[104:107]
    v_exp_f32 v97, v97
    v_mfma_f32_16x16x32_bf16 v[104:107], a[40:43], v[68:71], v[104:107]
    ds_read_b64_tr_b16 a[114:115], v16 offset:29184
    v_cvt_pk_bf16_f32 v112, v96, v97
    v_mfma_f32_16x16x32_bf16 v[104:107], a[44:47], v[84:87], v[104:107]
    v_exp_f32 v98, v98
    v_mfma_f32_16x16x32_bf16 v[108:111], a[48:51], v[36:39], 0
    ds_read_b64_tr_b16 a[166:167], v13 offset:34816
    v_mfma_f32_16x16x32_bf16 v[108:111], a[52:55], v[52:55], v[108:111]
    v_exp_f32 v99, v99
    v_mfma_f32_16x16x32_bf16 v[108:111], a[56:59], v[68:71], v[108:111]
    ds_read_b64_tr_b16 a[116:117], v17 offset:25088
    v_cvt_pk_bf16_f32 v113, v98, v99
    v_mfma_f32_16x16x32_bf16 v[108:111], a[60:63], v[84:87], v[108:111]
    v_exp_f32 v100, v100
    v_mfma_f32_16x16x32_bf16 a[140:143], a[144:147], v[116:119], a[140:143]
    ds_read_b64_tr_b16 a[118:119], v17 offset:29184
    v_mfma_f32_16x16x32_bf16 v[224:227], a[64:67], v[116:119], v[224:227]
    v_exp_f32 v101, v101
    v_mfma_f32_16x16x32_bf16 v[228:231], a[68:71], v[116:119], v[228:231]
    ds_read_b64_tr_b16 a[120:121], v16 offset:25344
    v_cvt_pk_bf16_f32 v114, v100, v101
    v_mfma_f32_16x16x32_bf16 v[232:235], a[72:75], v[116:119], v[232:235]
    v_exp_f32 v102, v102
    v_mfma_f32_16x16x32_bf16 v[236:239], a[76:79], v[116:119], v[236:239]
    ds_read_b64_tr_b16 a[168:169], v12 offset:33024
    v_mfma_f32_16x16x32_bf16 v[240:243], a[80:83], v[116:119], v[240:243]
    v_exp_f32 v103, v103
    v_mfma_f32_16x16x32_bf16 v[244:247], a[84:87], v[116:119], v[244:247]
    s_add_u32 s82, s63, 65536
    ds_read_b64_tr_b16 a[122:123], v16 offset:29440
    v_cvt_pk_bf16_f32 v115, v102, v103
    v_mfma_f32_16x16x32_bf16 v[248:251], a[88:91], v[116:119], v[248:251]
    ds_read_b64_tr_b16 a[170:171], v12 offset:35072
    v_mfma_f32_16x16x32_bf16 v[252:255], a[92:95], v[116:119], v[252:255]
    v_exp_f32 v104, v104
    v_mfma_f32_16x16x32_bf16 v[96:99], a[32:35], v[40:43], 0
    ds_read_b64_tr_b16 a[124:125], v17 offset:25344
    v_mfma_f32_16x16x32_bf16 v[96:99], a[36:39], v[56:59], v[96:99]
    v_exp_f32 v105, v105
    v_mfma_f32_16x16x32_bf16 v[96:99], a[40:43], v[72:75], v[96:99]
    ds_read_b64_tr_b16 a[126:127], v17 offset:29440
    v_cvt_pk_bf16_f32 v116, v104, v105
    v_mfma_f32_16x16x32_bf16 v[96:99], a[44:47], v[88:91], v[96:99]
    v_exp_f32 v106, v106
    v_mfma_f32_16x16x32_bf16 v[100:103], a[48:51], v[40:43], 0
    ds_read_b64_tr_b16 a[172:173], v13 offset:33024
    v_mfma_f32_16x16x32_bf16 v[100:103], a[52:55], v[56:59], v[100:103]
    v_exp_f32 v107, v107
    v_mfma_f32_16x16x32_bf16 v[100:103], a[56:59], v[72:75], v[100:103]
    s_waitcnt lgkmcnt(15)
    ds_read_b64_tr_b16 a[174:175], v13 offset:35072
    v_cvt_pk_bf16_f32 v117, v106, v107
    v_mfma_f32_16x16x32_bf16 v[100:103], a[60:63], v[88:91], v[100:103]
    s_waitcnt vmcnt(8) lgkmcnt(0)
    v_exp_f32 v108, v108
    v_mfma_f32_16x16x32_bf16 a[128:131], a[144:147], v[112:115], a[128:131]
    s_barrier
    ds_read_b128 a[0:3], v18 offset:32768
    v_mfma_f32_16x16x32_bf16 v[128:131], a[96:99], v[112:115], v[128:131]
    s_add_u32 m0, s62, 32768
    v_exp_f32 v109, v109
    v_mfma_f32_16x16x32_bf16 v[132:135], a[100:103], v[112:115], v[132:135]
    ds_read_b128 a[4:7], v19 offset:32768
    v_cvt_pk_bf16_f32 v118, v108, v109
    v_mfma_f32_16x16x32_bf16 v[136:139], a[104:107], v[112:115], v[136:139]
    v_exp_f32 v110, v110
    v_mfma_f32_16x16x32_bf16 v[140:143], a[108:111], v[112:115], v[140:143]
    ds_read_b128 a[8:11], v20 offset:32768
    v_mfma_f32_16x16x32_bf16 v[144:147], a[112:115], v[112:115], v[144:147]
    v_exp_f32 v111, v111
    v_mfma_f32_16x16x32_bf16 v[148:151], a[116:119], v[112:115], v[148:151]
    ds_read_b128 a[12:15], v21 offset:32768
    v_cvt_pk_bf16_f32 v119, v110, v111
    v_mfma_f32_16x16x32_bf16 v[152:155], a[120:123], v[112:115], v[152:155]
    buffer_load_dwordx4 v6, s[8:11], s82 offen offset:0 lds
    v_mfma_f32_16x16x32_bf16 v[156:159], a[124:127], v[112:115], v[156:159]
    v_exp_f32 v96, v96
    v_mfma_f32_16x16x32_bf16 v[104:107], a[32:35], v[44:47], 0
    ds_read_b128 a[16:19], v18 offset:36864
    v_mfma_f32_16x16x32_bf16 v[104:107], a[36:39], v[60:63], v[104:107]
    v_exp_f32 v97, v97
    v_mfma_f32_16x16x32_bf16 v[104:107], a[40:43], v[76:79], v[104:107]
    ds_read_b128 a[20:23], v19 offset:36864
    v_cvt_pk_bf16_f32 v112, v96, v97
    v_mfma_f32_16x16x32_bf16 v[104:107], a[44:47], v[92:95], v[104:107]
    v_exp_f32 v98, v98
    v_mfma_f32_16x16x32_bf16 v[108:111], a[48:51], v[44:47], 0
    buffer_load_dwordx4 v7, s[8:11], s82 offen offset:1024 lds
    v_mfma_f32_16x16x32_bf16 v[108:111], a[52:55], v[60:63], v[108:111]
    v_exp_f32 v99, v99
    v_mfma_f32_16x16x32_bf16 v[108:111], a[56:59], v[76:79], v[108:111]
    ds_read_b128 a[24:27], v20 offset:36864
    v_cvt_pk_bf16_f32 v113, v98, v99
    v_mfma_f32_16x16x32_bf16 v[108:111], a[60:63], v[92:95], v[108:111]
    v_exp_f32 v100, v100
    v_mfma_f32_16x16x32_bf16 a[132:135], a[144:147], v[116:119], a[132:135]
    ds_read_b128 a[28:31], v21 offset:36864
    v_mfma_f32_16x16x32_bf16 v[160:163], a[96:99], v[116:119], v[160:163]
    v_exp_f32 v101, v101
    v_mfma_f32_16x16x32_bf16 v[164:167], a[100:103], v[116:119], v[164:167]
    ds_read_b64_tr_b16 a[64:65], v16 offset:49152
    v_cvt_pk_bf16_f32 v114, v100, v101
    v_mfma_f32_16x16x32_bf16 v[168:171], a[104:107], v[116:119], v[168:171]
    v_exp_f32 v102, v102
    v_mfma_f32_16x16x32_bf16 v[172:175], a[108:111], v[116:119], v[172:175]
    buffer_load_dwordx4 v8, s[8:11], s82 offen offset:2048 lds
    v_mfma_f32_16x16x32_bf16 v[176:179], a[112:115], v[116:119], v[176:179]
    v_exp_f32 v103, v103
    v_mfma_f32_16x16x32_bf16 v[180:183], a[116:119], v[116:119], v[180:183]
    ds_read_b64_tr_b16 a[66:67], v16 offset:53248
    v_cvt_pk_bf16_f32 v115, v102, v103
    v_mfma_f32_16x16x32_bf16 v[184:187], a[120:123], v[116:119], v[184:187]
    buffer_load_dwordx4 v9, s[8:11], s82 offen offset:3072 lds
    v_mfma_f32_16x16x32_bf16 v[188:191], a[124:127], v[116:119], v[188:191]
    s_waitcnt lgkmcnt(9)
    v_exp_f32 v104, v104
    v_mfma_f32_16x16x32_bf16 v[96:99], a[0:3], v[32:35], 0
    s_waitcnt lgkmcnt(7)
    ds_read_b64_tr_b16 a[68:69], v17 offset:49152
    v_mfma_f32_16x16x32_bf16 v[96:99], a[4:7], v[48:51], v[96:99]
    s_add_u32 m0, s62, 49152
    v_exp_f32 v105, v105
    v_mfma_f32_16x16x32_bf16 v[96:99], a[8:11], v[64:67], v[96:99]
    s_waitcnt lgkmcnt(7)
    ds_read_b64_tr_b16 a[70:71], v17 offset:53248
    v_cvt_pk_bf16_f32 v116, v104, v105
    v_mfma_f32_16x16x32_bf16 v[96:99], a[12:15], v[80:83], v[96:99]
    s_waitcnt lgkmcnt(6)
    v_exp_f32 v106, v106
    v_mfma_f32_16x16x32_bf16 v[100:103], a[16:19], v[32:35], 0
    buffer_load_dwordx4 v10, s[12:15], s82 offen offset:0 lds
    v_mfma_f32_16x16x32_bf16 v[100:103], a[20:23], v[48:51], v[100:103]
    s_waitcnt lgkmcnt(5)
    v_exp_f32 v107, v107
    v_mfma_f32_16x16x32_bf16 v[100:103], a[24:27], v[64:67], v[100:103]
    s_waitcnt lgkmcnt(4)
    ds_read_b64_tr_b16 a[72:73], v16 offset:49408
    v_cvt_pk_bf16_f32 v117, v106, v107
    v_mfma_f32_16x16x32_bf16 v[100:103], a[28:31], v[80:83], v[100:103]
    v_exp_f32 v108, v108
    v_mfma_f32_16x16x32_bf16 a[136:139], a[144:147], v[112:115], a[136:139]
    ds_read_b64_tr_b16 a[74:75], v16 offset:53504
    v_mfma_f32_16x16x32_bf16 v[192:195], a[96:99], v[112:115], v[192:195]
    v_exp_f32 v109, v109
    v_mfma_f32_16x16x32_bf16 v[196:199], a[100:103], v[112:115], v[196:199]
    ds_read_b64_tr_b16 a[76:77], v17 offset:49408
    v_cvt_pk_bf16_f32 v118, v108, v109
    v_mfma_f32_16x16x32_bf16 v[200:203], a[104:107], v[112:115], v[200:203]
    v_exp_f32 v110, v110
    v_mfma_f32_16x16x32_bf16 v[204:207], a[108:111], v[112:115], v[204:207]
    buffer_load_dwordx4 v11, s[12:15], s82 offen offset:1024 lds
    v_mfma_f32_16x16x32_bf16 v[208:211], a[112:115], v[112:115], v[208:211]
    v_exp_f32 v111, v111
    v_mfma_f32_16x16x32_bf16 v[212:215], a[116:119], v[112:115], v[212:215]
    ds_read_b64_tr_b16 a[78:79], v17 offset:53504
    v_cvt_pk_bf16_f32 v119, v110, v111
    v_mfma_f32_16x16x32_bf16 v[216:219], a[120:123], v[112:115], v[216:219]
    buffer_load_dwordx4 v10, s[12:15], s82 offen offset:2048 lds
    v_mfma_f32_16x16x32_bf16 v[220:223], a[124:127], v[112:115], v[220:223]
    v_exp_f32 v96, v96
    v_mfma_f32_16x16x32_bf16 v[104:107], a[0:3], v[36:39], 0
    ds_read_b64_tr_b16 a[80:81], v16 offset:49664
    v_mfma_f32_16x16x32_bf16 v[104:107], a[4:7], v[52:55], v[104:107]
    v_exp_f32 v97, v97
    v_mfma_f32_16x16x32_bf16 v[104:107], a[8:11], v[68:71], v[104:107]
    ds_read_b64_tr_b16 a[82:83], v16 offset:53760
    v_cvt_pk_bf16_f32 v112, v96, v97
    v_mfma_f32_16x16x32_bf16 v[104:107], a[12:15], v[84:87], v[104:107]
    v_exp_f32 v98, v98
    v_mfma_f32_16x16x32_bf16 v[108:111], a[16:19], v[36:39], 0
    buffer_load_dwordx4 v11, s[12:15], s82 offen offset:3072 lds
    v_mfma_f32_16x16x32_bf16 v[108:111], a[20:23], v[52:55], v[108:111]
    s_add_u32 s55, s92, 0
    v_exp_f32 v99, v99
    v_mfma_f32_16x16x32_bf16 v[108:111], a[24:27], v[68:71], v[108:111]
    ds_read_b64_tr_b16 a[84:85], v17 offset:49664
    v_cvt_pk_bf16_f32 v113, v98, v99
    v_mfma_f32_16x16x32_bf16 v[108:111], a[28:31], v[84:87], v[108:111]
    v_exp_f32 v100, v100
    v_mfma_f32_16x16x32_bf16 a[140:143], a[144:147], v[116:119], a[140:143]
    ds_read_b64_tr_b16 a[86:87], v17 offset:53760
    v_mfma_f32_16x16x32_bf16 v[224:227], a[96:99], v[116:119], v[224:227]
    v_exp_f32 v101, v101
    v_mfma_f32_16x16x32_bf16 v[228:231], a[100:103], v[116:119], v[228:231]
    s_add_u32 s83, s61, 262144
    ds_read_b64_tr_b16 a[88:89], v16 offset:49920
    v_cvt_pk_bf16_f32 v114, v100, v101
    v_mfma_f32_16x16x32_bf16 v[232:235], a[104:107], v[116:119], v[232:235]
    v_exp_f32 v102, v102
    v_mfma_f32_16x16x32_bf16 v[236:239], a[108:111], v[116:119], v[236:239]
    buffer_load_dword v28, v120, s[28:31], s77 offen
    v_mfma_f32_16x16x32_bf16 v[240:243], a[112:115], v[116:119], v[240:243]
    v_exp_f32 v103, v103
    v_mfma_f32_16x16x32_bf16 v[244:247], a[116:119], v[116:119], v[244:247]
    ds_read_b64_tr_b16 a[90:91], v16 offset:54016
    v_cvt_pk_bf16_f32 v115, v102, v103
    v_mfma_f32_16x16x32_bf16 v[248:251], a[120:123], v[116:119], v[248:251]
    buffer_store_dwordx4 v[124:127], v23, s[48:51], s55 offen offset:0 sc1
    v_mfma_f32_16x16x32_bf16 v[252:255], a[124:127], v[116:119], v[252:255]
    v_exp_f32 v104, v104
    v_mfma_f32_16x16x32_bf16 v[96:99], a[0:3], v[40:43], 0
    ds_read_b64_tr_b16 a[92:93], v17 offset:49920
    v_mfma_f32_16x16x32_bf16 v[96:99], a[4:7], v[56:59], v[96:99]
    v_exp_f32 v105, v105
    v_mfma_f32_16x16x32_bf16 v[96:99], a[8:11], v[72:75], v[96:99]
    ds_read_b64_tr_b16 a[94:95], v17 offset:54016
    v_cvt_pk_bf16_f32 v116, v104, v105
    v_mfma_f32_16x16x32_bf16 v[96:99], a[12:15], v[88:91], v[96:99]
    v_exp_f32 v106, v106
    v_mfma_f32_16x16x32_bf16 v[100:103], a[16:19], v[40:43], 0
    buffer_store_dwordx4 v[124:127], v23, s[48:51], s55 offen offset:1024 sc1
    v_mfma_f32_16x16x32_bf16 v[100:103], a[20:23], v[56:59], v[100:103]
    v_exp_f32 v107, v107
    v_mfma_f32_16x16x32_bf16 v[100:103], a[24:27], v[72:75], v[100:103]
    s_add_u32 m0, s62, 98304
    ds_read_b128 a[32:35], v18 offset:40960
    v_cvt_pk_bf16_f32 v117, v106, v107
    v_mfma_f32_16x16x32_bf16 v[100:103], a[28:31], v[88:91], v[100:103]
    v_exp_f32 v108, v108
    v_mfma_f32_16x16x32_bf16 a[128:131], a[144:147], v[112:115], a[128:131]
    s_waitcnt lgkmcnt(15)
    ds_read_b128 a[36:39], v19 offset:40960
    v_mfma_f32_16x16x32_bf16 v[128:131], a[64:67], v[112:115], v[128:131]
    s_waitcnt lgkmcnt(14)
    v_exp_f32 v109, v109
    v_mfma_f32_16x16x32_bf16 v[132:135], a[68:71], v[112:115], v[132:135]
    s_waitcnt lgkmcnt(12)
    ds_read_b128 a[40:43], v20 offset:40960
    v_cvt_pk_bf16_f32 v118, v108, v109
    v_mfma_f32_16x16x32_bf16 v[136:139], a[72:75], v[112:115], v[136:139]
    s_waitcnt lgkmcnt(9)
    v_exp_f32 v110, v110
    v_mfma_f32_16x16x32_bf16 v[140:143], a[76:79], v[112:115], v[140:143]
    buffer_load_dwordx4 v2, s[20:23], s83 offen offset:0 lds
    v_mfma_f32_16x16x32_bf16 v[144:147], a[80:83], v[112:115], v[144:147]
    s_waitcnt lgkmcnt(7)
    v_exp_f32 v111, v111
    v_mfma_f32_16x16x32_bf16 v[148:151], a[84:87], v[112:115], v[148:151]
    s_waitcnt lgkmcnt(3)
    ds_read_b128 a[44:47], v21 offset:40960
    v_cvt_pk_bf16_f32 v119, v110, v111
    v_mfma_f32_16x16x32_bf16 v[152:155], a[88:91], v[112:115], v[152:155]
    buffer_load_dwordx4 v3, s[20:23], s83 offen offset:1024 lds
    v_mfma_f32_16x16x32_bf16 v[156:159], a[92:95], v[112:115], v[156:159]
    v_exp_f32 v96, v96
    v_mfma_f32_16x16x32_bf16 v[104:107], a[0:3], v[44:47], 0
    ds_read_b128 a[48:51], v18 offset:45056
    v_mfma_f32_16x16x32_bf16 v[104:107], a[4:7], v[60:63], v[104:107]
    v_exp_f32 v97, v97
    v_mfma_f32_16x16x32_bf16 v[104:107], a[8:11], v[76:79], v[104:107]
    ds_read_b128 a[52:55], v19 offset:45056
    v_cvt_pk_bf16_f32 v112, v96, v97
    v_mfma_f32_16x16x32_bf16 v[104:107], a[12:15], v[92:95], v[104:107]
    v_exp_f32 v98, v98
    v_mfma_f32_16x16x32_bf16 v[108:111], a[16:19], v[44:47], 0
    buffer_load_dwordx4 v4, s[20:23], s83 offen offset:2048 lds
    v_mfma_f32_16x16x32_bf16 v[108:111], a[20:23], v[60:63], v[108:111]
    v_exp_f32 v99, v99
    v_mfma_f32_16x16x32_bf16 v[108:111], a[24:27], v[76:79], v[108:111]
    ds_read_b128 a[56:59], v20 offset:45056
    v_cvt_pk_bf16_f32 v113, v98, v99
    v_mfma_f32_16x16x32_bf16 v[108:111], a[28:31], v[92:95], v[108:111]
    v_exp_f32 v100, v100
    v_mfma_f32_16x16x32_bf16 a[132:135], a[144:147], v[116:119], a[132:135]
    ds_read_b128 a[60:63], v21 offset:45056
    v_mfma_f32_16x16x32_bf16 v[160:163], a[64:67], v[116:119], v[160:163]
    v_exp_f32 v101, v101
    v_mfma_f32_16x16x32_bf16 v[164:167], a[68:71], v[116:119], v[164:167]
    ds_read_b64_tr_b16 a[96:97], v16 offset:57344
    v_cvt_pk_bf16_f32 v114, v100, v101
    v_mfma_f32_16x16x32_bf16 v[168:171], a[72:75], v[116:119], v[168:171]
    v_exp_f32 v102, v102
    v_mfma_f32_16x16x32_bf16 v[172:175], a[76:79], v[116:119], v[172:175]
    buffer_load_dwordx4 v5, s[20:23], s83 offen offset:3072 lds
    v_mfma_f32_16x16x32_bf16 v[176:179], a[80:83], v[116:119], v[176:179]
    v_exp_f32 v103, v103
    v_mfma_f32_16x16x32_bf16 v[180:183], a[84:87], v[116:119], v[180:183]
    ds_read_b64_tr_b16 a[98:99], v16 offset:61440
    v_cvt_pk_bf16_f32 v115, v102, v103
    v_mfma_f32_16x16x32_bf16 v[184:187], a[88:91], v[116:119], v[184:187]
    ds_read_b64_tr_b16 a[176:177], v12 offset:49152
    v_mfma_f32_16x16x32_bf16 v[188:191], a[92:95], v[116:119], v[188:191]
    s_waitcnt lgkmcnt(10)
    v_exp_f32 v104, v104
    v_mfma_f32_16x16x32_bf16 v[96:99], a[32:35], v[32:35], 0
    s_waitcnt lgkmcnt(9)
    ds_read_b64_tr_b16 a[100:101], v17 offset:57344
    v_mfma_f32_16x16x32_bf16 v[96:99], a[36:39], v[48:51], v[96:99]
    s_waitcnt lgkmcnt(9)
    v_exp_f32 v105, v105
    v_mfma_f32_16x16x32_bf16 v[96:99], a[40:43], v[64:67], v[96:99]
    s_waitcnt lgkmcnt(8)
    ds_read_b64_tr_b16 a[102:103], v17 offset:61440
    v_cvt_pk_bf16_f32 v116, v104, v105
    v_mfma_f32_16x16x32_bf16 v[96:99], a[44:47], v[80:83], v[96:99]
    s_waitcnt lgkmcnt(8)
    v_exp_f32 v106, v106
    v_mfma_f32_16x16x32_bf16 v[100:103], a[48:51], v[32:35], 0
    s_waitcnt lgkmcnt(7)
    ds_read_b64_tr_b16 a[178:179], v12 offset:51200
    v_mfma_f32_16x16x32_bf16 v[100:103], a[52:55], v[48:51], v[100:103]
    s_waitcnt lgkmcnt(7)
    v_exp_f32 v107, v107
    v_mfma_f32_16x16x32_bf16 v[100:103], a[56:59], v[64:67], v[100:103]
    s_waitcnt lgkmcnt(6)
    ds_read_b64_tr_b16 a[104:105], v16 offset:57600
    v_cvt_pk_bf16_f32 v117, v106, v107
    v_mfma_f32_16x16x32_bf16 v[100:103], a[60:63], v[80:83], v[100:103]
    v_exp_f32 v108, v108
    v_mfma_f32_16x16x32_bf16 a[136:139], a[144:147], v[112:115], a[136:139]
    ds_read_b64_tr_b16 a[106:107], v16 offset:61696
    v_mfma_f32_16x16x32_bf16 v[192:195], a[64:67], v[112:115], v[192:195]
    v_exp_f32 v109, v109
    v_mfma_f32_16x16x32_bf16 v[196:199], a[68:71], v[112:115], v[196:199]
    ds_read_b64_tr_b16 a[108:109], v17 offset:57600
    v_cvt_pk_bf16_f32 v118, v108, v109
    v_mfma_f32_16x16x32_bf16 v[200:203], a[72:75], v[112:115], v[200:203]
    v_exp_f32 v110, v110
    v_mfma_f32_16x16x32_bf16 v[204:207], a[76:79], v[112:115], v[204:207]
    ds_read_b64_tr_b16 a[180:181], v13 offset:49152
    v_mfma_f32_16x16x32_bf16 v[208:211], a[80:83], v[112:115], v[208:211]
    v_exp_f32 v111, v111
    v_mfma_f32_16x16x32_bf16 v[212:215], a[84:87], v[112:115], v[212:215]
    ds_read_b64_tr_b16 a[110:111], v17 offset:61696
    v_cvt_pk_bf16_f32 v119, v110, v111
    v_mfma_f32_16x16x32_bf16 v[216:219], a[88:91], v[112:115], v[216:219]
    ds_read_b64_tr_b16 a[182:183], v13 offset:51200
    v_mfma_f32_16x16x32_bf16 v[220:223], a[92:95], v[112:115], v[220:223]
    v_exp_f32 v96, v96
    v_mfma_f32_16x16x32_bf16 v[104:107], a[32:35], v[36:39], 0
    ds_read_b64_tr_b16 a[112:113], v16 offset:57856
    v_mfma_f32_16x16x32_bf16 v[104:107], a[36:39], v[52:55], v[104:107]
    v_exp_f32 v97, v97
    v_mfma_f32_16x16x32_bf16 v[104:107], a[40:43], v[68:71], v[104:107]
    ds_read_b64_tr_b16 a[114:115], v16 offset:61952
    v_cvt_pk_bf16_f32 v112, v96, v97
    v_mfma_f32_16x16x32_bf16 v[104:107], a[44:47], v[84:87], v[104:107]
    v_exp_f32 v98, v98
    v_mfma_f32_16x16x32_bf16 v[108:111], a[48:51], v[36:39], 0
    ds_read_b64_tr_b16 a[184:185], v12 offset:49408
    v_mfma_f32_16x16x32_bf16 v[108:111], a[52:55], v[52:55], v[108:111]
    v_exp_f32 v99, v99
    v_mfma_f32_16x16x32_bf16 v[108:111], a[56:59], v[68:71], v[108:111]
    ds_read_b64_tr_b16 a[116:117], v17 offset:57856
    v_cvt_pk_bf16_f32 v113, v98, v99
    v_mfma_f32_16x16x32_bf16 v[108:111], a[60:63], v[84:87], v[108:111]
    v_exp_f32 v100, v100
    v_mfma_f32_16x16x32_bf16 a[140:143], a[144:147], v[116:119], a[140:143]
    ds_read_b64_tr_b16 a[118:119], v17 offset:61952
    v_mfma_f32_16x16x32_bf16 v[224:227], a[64:67], v[116:119], v[224:227]
    v_exp_f32 v101, v101
    v_mfma_f32_16x16x32_bf16 v[228:231], a[68:71], v[116:119], v[228:231]
    ds_read_b64_tr_b16 a[120:121], v16 offset:58112
    v_cvt_pk_bf16_f32 v114, v100, v101
    v_mfma_f32_16x16x32_bf16 v[232:235], a[72:75], v[116:119], v[232:235]
    v_exp_f32 v102, v102
    v_mfma_f32_16x16x32_bf16 v[236:239], a[76:79], v[116:119], v[236:239]
    ds_read_b64_tr_b16 a[186:187], v12 offset:51456
    v_mfma_f32_16x16x32_bf16 v[240:243], a[80:83], v[116:119], v[240:243]
    v_exp_f32 v103, v103
    v_mfma_f32_16x16x32_bf16 v[244:247], a[84:87], v[116:119], v[244:247]
    s_add_u32 s82, s63, 81920
    ds_read_b64_tr_b16 a[122:123], v16 offset:62208
    v_cvt_pk_bf16_f32 v115, v102, v103
    v_mfma_f32_16x16x32_bf16 v[248:251], a[88:91], v[116:119], v[248:251]
    ds_read_b64_tr_b16 a[188:189], v13 offset:49408
    v_mfma_f32_16x16x32_bf16 v[252:255], a[92:95], v[116:119], v[252:255]
    v_exp_f32 v104, v104
    v_mfma_f32_16x16x32_bf16 v[96:99], a[32:35], v[40:43], 0
    ds_read_b64_tr_b16 a[124:125], v17 offset:58112
    v_mfma_f32_16x16x32_bf16 v[96:99], a[36:39], v[56:59], v[96:99]
    v_exp_f32 v105, v105
    v_mfma_f32_16x16x32_bf16 v[96:99], a[40:43], v[72:75], v[96:99]
    ds_read_b64_tr_b16 a[126:127], v17 offset:62208
    v_cvt_pk_bf16_f32 v116, v104, v105
    v_mfma_f32_16x16x32_bf16 v[96:99], a[44:47], v[88:91], v[96:99]
    v_exp_f32 v106, v106
    v_mfma_f32_16x16x32_bf16 v[100:103], a[48:51], v[40:43], 0
    ds_read_b64_tr_b16 a[190:191], v13 offset:51456
    v_mfma_f32_16x16x32_bf16 v[100:103], a[52:55], v[56:59], v[100:103]
    v_exp_f32 v107, v107
    v_mfma_f32_16x16x32_bf16 v[100:103], a[56:59], v[72:75], v[100:103]
    s_waitcnt lgkmcnt(15)
    v_cvt_pk_bf16_f32 v117, v106, v107
    v_mfma_f32_16x16x32_bf16 v[100:103], a[60:63], v[88:91], v[100:103]
    s_waitcnt vmcnt(7) lgkmcnt(0)
    v_exp_f32 v108, v108
    v_mfma_f32_16x16x32_bf16 a[128:131], a[144:147], v[112:115], a[128:131]
    s_barrier
    ds_read_b128 a[0:3], v18 offset:0
    v_mfma_f32_16x16x32_bf16 v[128:131], a[96:99], v[112:115], v[128:131]
    s_add_u32 m0, s62, 65536
    v_exp_f32 v109, v109
    v_mfma_f32_16x16x32_bf16 v[132:135], a[100:103], v[112:115], v[132:135]
    ds_read_b128 a[4:7], v19 offset:0
    v_cvt_pk_bf16_f32 v118, v108, v109
    v_mfma_f32_16x16x32_bf16 v[136:139], a[104:107], v[112:115], v[136:139]
    v_exp_f32 v110, v110
    v_mfma_f32_16x16x32_bf16 v[140:143], a[108:111], v[112:115], v[140:143]
    ds_read_b128 a[8:11], v20 offset:0
    v_mfma_f32_16x16x32_bf16 v[144:147], a[112:115], v[112:115], v[144:147]
    v_exp_f32 v111, v111
    v_mfma_f32_16x16x32_bf16 v[148:151], a[116:119], v[112:115], v[148:151]
    ds_read_b128 a[12:15], v21 offset:0
    v_cvt_pk_bf16_f32 v119, v110, v111
    v_mfma_f32_16x16x32_bf16 v[152:155], a[120:123], v[112:115], v[152:155]
    buffer_load_dwordx4 v6, s[8:11], s82 offen offset:0 lds
    v_mfma_f32_16x16x32_bf16 v[156:159], a[124:127], v[112:115], v[156:159]
    v_exp_f32 v96, v96
    v_mfma_f32_16x16x32_bf16 v[104:107], a[32:35], v[44:47], 0
    ds_read_b128 a[16:19], v18 offset:4096
    v_mfma_f32_16x16x32_bf16 v[104:107], a[36:39], v[60:63], v[104:107]
    v_exp_f32 v97, v97
    v_mfma_f32_16x16x32_bf16 v[104:107], a[40:43], v[76:79], v[104:107]
    ds_read_b128 a[20:23], v19 offset:4096
    v_cvt_pk_bf16_f32 v112, v96, v97
    v_mfma_f32_16x16x32_bf16 v[104:107], a[44:47], v[92:95], v[104:107]
    v_exp_f32 v98, v98
    v_mfma_f32_16x16x32_bf16 v[108:111], a[48:51], v[44:47], 0
    buffer_load_dwordx4 v7, s[8:11], s82 offen offset:1024 lds
    v_mfma_f32_16x16x32_bf16 v[108:111], a[52:55], v[60:63], v[108:111]
    v_exp_f32 v99, v99
    v_mfma_f32_16x16x32_bf16 v[108:111], a[56:59], v[76:79], v[108:111]
    ds_read_b128 a[24:27], v20 offset:4096
    v_cvt_pk_bf16_f32 v113, v98, v99
    v_mfma_f32_16x16x32_bf16 v[108:111], a[60:63], v[92:95], v[108:111]
    v_exp_f32 v100, v100
    v_mfma_f32_16x16x32_bf16 a[132:135], a[144:147], v[116:119], a[132:135]
    ds_read_b128 a[28:31], v21 offset:4096
    v_mfma_f32_16x16x32_bf16 v[160:163], a[96:99], v[116:119], v[160:163]
    v_exp_f32 v101, v101
    v_mfma_f32_16x16x32_bf16 v[164:167], a[100:103], v[116:119], v[164:167]
    ds_read_b64_tr_b16 a[64:65], v16 offset:16384
    v_cvt_pk_bf16_f32 v114, v100, v101
    v_mfma_f32_16x16x32_bf16 v[168:171], a[104:107], v[116:119], v[168:171]
    v_exp_f32 v102, v102
    v_mfma_f32_16x16x32_bf16 v[172:175], a[108:111], v[116:119], v[172:175]
    buffer_load_dwordx4 v8, s[8:11], s82 offen offset:2048 lds
    v_mfma_f32_16x16x32_bf16 v[176:179], a[112:115], v[116:119], v[176:179]
    v_exp_f32 v103, v103
    v_mfma_f32_16x16x32_bf16 v[180:183], a[116:119], v[116:119], v[180:183]
    ds_read_b64_tr_b16 a[66:67], v16 offset:20480
    v_cvt_pk_bf16_f32 v115, v102, v103
    v_mfma_f32_16x16x32_bf16 v[184:187], a[120:123], v[116:119], v[184:187]
    buffer_load_dwordx4 v9, s[8:11], s82 offen offset:3072 lds
    v_mfma_f32_16x16x32_bf16 v[188:191], a[124:127], v[116:119], v[188:191]
    s_waitcnt lgkmcnt(9)
    v_exp_f32 v104, v104
    v_mfma_f32_16x16x32_bf16 v[96:99], a[0:3], v[32:35], 0
    s_waitcnt lgkmcnt(7)
    ds_read_b64_tr_b16 a[68:69], v17 offset:16384
    v_mfma_f32_16x16x32_bf16 v[96:99], a[4:7], v[48:51], v[96:99]
    s_add_u32 m0, s62, 81920
    v_exp_f32 v105, v105
    v_mfma_f32_16x16x32_bf16 v[96:99], a[8:11], v[64:67], v[96:99]
    s_waitcnt lgkmcnt(7)
L_hop1_5:
    s_cbranch_execz L_hop1_9
    ds_read_b64_tr_b16 a[70:71], v17 offset:20480
    v_cvt_pk_bf16_f32 v116, v104, v105
    v_mfma_f32_16x16x32_bf16 v[96:99], a[12:15], v[80:83], v[96:99]
    s_waitcnt lgkmcnt(6)
    v_exp_f32 v106, v106
    v_mfma_f32_16x16x32_bf16 v[100:103], a[16:19], v[32:35], 0
    buffer_load_dwordx4 v10, s[12:15], s82 offen offset:0 lds
    v_mfma_f32_16x16x32_bf16 v[100:103], a[20:23], v[48:51], v[100:103]
    s_waitcnt lgkmcnt(5)
    v_exp_f32 v107, v107
    v_mfma_f32_16x16x32_bf16 v[100:103], a[24:27], v[64:67], v[100:103]
    s_waitcnt lgkmcnt(4)
    ds_read_b64_tr_b16 a[72:73], v16 offset:16640
    v_cvt_pk_bf16_f32 v117, v106, v107
    v_mfma_f32_16x16x32_bf16 v[100:103], a[28:31], v[80:83], v[100:103]
    v_exp_f32 v108, v108
    v_mfma_f32_16x16x32_bf16 a[136:139], a[144:147], v[112:115], a[136:139]
    ds_read_b64_tr_b16 a[74:75], v16 offset:20736
    v_mfma_f32_16x16x32_bf16 v[192:195], a[96:99], v[112:115], v[192:195]
    v_exp_f32 v109, v109
    v_mfma_f32_16x16x32_bf16 v[196:199], a[100:103], v[112:115], v[196:199]
    ds_read_b64_tr_b16 a[76:77], v17 offset:16640
    v_cvt_pk_bf16_f32 v118, v108, v109
    v_mfma_f32_16x16x32_bf16 v[200:203], a[104:107], v[112:115], v[200:203]
    v_exp_f32 v110, v110
    v_mfma_f32_16x16x32_bf16 v[204:207], a[108:111], v[112:115], v[204:207]
    buffer_load_dwordx4 v11, s[12:15], s82 offen offset:1024 lds
    v_mfma_f32_16x16x32_bf16 v[208:211], a[112:115], v[112:115], v[208:211]
    v_exp_f32 v111, v111
    v_mfma_f32_16x16x32_bf16 v[212:215], a[116:119], v[112:115], v[212:215]
    ds_read_b64_tr_b16 a[78:79], v17 offset:20736
    v_cvt_pk_bf16_f32 v119, v110, v111
    v_mfma_f32_16x16x32_bf16 v[216:219], a[120:123], v[112:115], v[216:219]
    buffer_load_dwordx4 v10, s[12:15], s82 offen offset:2048 lds
    v_mfma_f32_16x16x32_bf16 v[220:223], a[124:127], v[112:115], v[220:223]
    v_exp_f32 v96, v96
    v_mfma_f32_16x16x32_bf16 v[104:107], a[0:3], v[36:39], 0
    ds_read_b64_tr_b16 a[80:81], v16 offset:16896
    v_mfma_f32_16x16x32_bf16 v[104:107], a[4:7], v[52:55], v[104:107]
    v_exp_f32 v97, v97
    v_mfma_f32_16x16x32_bf16 v[104:107], a[8:11], v[68:71], v[104:107]
    ds_read_b64_tr_b16 a[82:83], v16 offset:20992
    v_cvt_pk_bf16_f32 v112, v96, v97
    v_mfma_f32_16x16x32_bf16 v[104:107], a[12:15], v[84:87], v[104:107]
    v_exp_f32 v98, v98
    v_mfma_f32_16x16x32_bf16 v[108:111], a[16:19], v[36:39], 0
    buffer_load_dwordx4 v11, s[12:15], s82 offen offset:3072 lds
    v_mfma_f32_16x16x32_bf16 v[108:111], a[20:23], v[52:55], v[108:111]
    s_add_u32 s55, s92, 57344
    v_exp_f32 v99, v99
    v_mfma_f32_16x16x32_bf16 v[108:111], a[24:27], v[68:71], v[108:111]
    ds_read_b64_tr_b16 a[84:85], v17 offset:16896
    v_cvt_pk_bf16_f32 v113, v98, v99
    v_mfma_f32_16x16x32_bf16 v[108:111], a[28:31], v[84:87], v[108:111]
    v_exp_f32 v100, v100
    v_mfma_f32_16x16x32_bf16 a[140:143], a[144:147], v[116:119], a[140:143]
    ds_read_b64_tr_b16 a[86:87], v17 offset:20992
    v_mfma_f32_16x16x32_bf16 v[224:227], a[96:99], v[116:119], v[224:227]
    v_exp_f32 v101, v101
    v_mfma_f32_16x16x32_bf16 v[228:231], a[100:103], v[116:119], v[228:231]
    s_add_u32 s83, s61, 294912
    ds_read_b64_tr_b16 a[88:89], v16 offset:17152
    v_cvt_pk_bf16_f32 v114, v100, v101
    v_mfma_f32_16x16x32_bf16 v[232:235], a[104:107], v[116:119], v[232:235]
    v_exp_f32 v102, v102
    v_mfma_f32_16x16x32_bf16 v[236:239], a[108:111], v[116:119], v[236:239]
    buffer_load_dword v29, v26, s[44:47], 0 offen offset:132 sc1
    v_mfma_f32_16x16x32_bf16 v[240:243], a[112:115], v[116:119], v[240:243]
    v_exp_f32 v103, v103
    v_mfma_f32_16x16x32_bf16 v[244:247], a[116:119], v[116:119], v[244:247]
    ds_read_b64_tr_b16 a[90:91], v16 offset:21248
    v_cvt_pk_bf16_f32 v115, v102, v103
    v_mfma_f32_16x16x32_bf16 v[248:251], a[120:123], v[116:119], v[248:251]
    buffer_store_dwordx4 v[124:127], v23, s[48:51], s55 offen offset:0 sc1
    v_mfma_f32_16x16x32_bf16 v[252:255], a[124:127], v[116:119], v[252:255]
    v_exp_f32 v104, v104
    v_mfma_f32_16x16x32_bf16 v[96:99], a[0:3], v[40:43], 0
    ds_read_b64_tr_b16 a[92:93], v17 offset:17152
    v_mfma_f32_16x16x32_bf16 v[96:99], a[4:7], v[56:59], v[96:99]
    v_exp_f32 v105, v105
    v_mfma_f32_16x16x32_bf16 v[96:99], a[8:11], v[72:75], v[96:99]
    ds_read_b64_tr_b16 a[94:95], v17 offset:21248
    v_cvt_pk_bf16_f32 v116, v104, v105
    v_mfma_f32_16x16x32_bf16 v[96:99], a[12:15], v[88:91], v[96:99]
    v_exp_f32 v106, v106
    v_mfma_f32_16x16x32_bf16 v[100:103], a[16:19], v[40:43], 0
    buffer_store_dwordx4 v[124:127], v23, s[48:51], s55 offen offset:1024 sc1
    v_mfma_f32_16x16x32_bf16 v[100:103], a[20:23], v[56:59], v[100:103]
    v_exp_f32 v107, v107
    v_mfma_f32_16x16x32_bf16 v[100:103], a[24:27], v[72:75], v[100:103]
    s_add_u32 m0, s62, 114688
    ds_read_b128 a[32:35], v18 offset:8192
    v_cvt_pk_bf16_f32 v117, v106, v107
    v_mfma_f32_16x16x32_bf16 v[100:103], a[28:31], v[88:91], v[100:103]
    v_exp_f32 v108, v108
    v_mfma_f32_16x16x32_bf16 a[128:131], a[144:147], v[112:115], a[128:131]
    s_waitcnt lgkmcnt(15)
    ds_read_b128 a[36:39], v19 offset:8192
    v_mfma_f32_16x16x32_bf16 v[128:131], a[64:67], v[112:115], v[128:131]
    s_waitcnt lgkmcnt(14)
    v_exp_f32 v109, v109
    v_mfma_f32_16x16x32_bf16 v[132:135], a[68:71], v[112:115], v[132:135]
    s_waitcnt lgkmcnt(12)
    ds_read_b128 a[40:43], v20 offset:8192
    v_cvt_pk_bf16_f32 v118, v108, v109
    v_mfma_f32_16x16x32_bf16 v[136:139], a[72:75], v[112:115], v[136:139]
    s_waitcnt lgkmcnt(9)
    v_exp_f32 v110, v110
    v_mfma_f32_16x16x32_bf16 v[140:143], a[76:79], v[112:115], v[140:143]
    buffer_load_dwordx4 v2, s[20:23], s83 offen offset:0 lds
    v_mfma_f32_16x16x32_bf16 v[144:147], a[80:83], v[112:115], v[144:147]
    s_waitcnt lgkmcnt(7)
    v_exp_f32 v111, v111
    v_mfma_f32_16x16x32_bf16 v[148:151], a[84:87], v[112:115], v[148:151]
    s_waitcnt lgkmcnt(3)
    ds_read_b128 a[44:47], v21 offset:8192
    v_cvt_pk_bf16_f32 v119, v110, v111
    v_mfma_f32_16x16x32_bf16 v[152:155], a[88:91], v[112:115], v[152:155]
    buffer_load_dwordx4 v3, s[20:23], s83 offen offset:1024 lds
    v_mfma_f32_16x16x32_bf16 v[156:159], a[92:95], v[112:115], v[156:159]
    v_exp_f32 v96, v96
    v_mfma_f32_16x16x32_bf16 v[104:107], a[0:3], v[44:47], 0
    ds_read_b128 a[48:51], v18 offset:12288
    v_mfma_f32_16x16x32_bf16 v[104:107], a[4:7], v[60:63], v[104:107]
    v_exp_f32 v97, v97
    v_mfma_f32_16x16x32_bf16 v[104:107], a[8:11], v[76:79], v[104:107]
    ds_read_b128 a[52:55], v19 offset:12288
    v_cvt_pk_bf16_f32 v112, v96, v97
    v_mfma_f32_16x16x32_bf16 v[104:107], a[12:15], v[92:95], v[104:107]
    v_exp_f32 v98, v98
    v_mfma_f32_16x16x32_bf16 v[108:111], a[16:19], v[44:47], 0
    buffer_load_dwordx4 v4, s[20:23], s83 offen offset:2048 lds
    v_mfma_f32_16x16x32_bf16 v[108:111], a[20:23], v[60:63], v[108:111]
    v_exp_f32 v99, v99
    v_mfma_f32_16x16x32_bf16 v[108:111], a[24:27], v[76:79], v[108:111]
    ds_read_b128 a[56:59], v20 offset:12288
    v_cvt_pk_bf16_f32 v113, v98, v99
    v_mfma_f32_16x16x32_bf16 v[108:111], a[28:31], v[92:95], v[108:111]
    v_exp_f32 v100, v100
    v_mfma_f32_16x16x32_bf16 a[132:135], a[144:147], v[116:119], a[132:135]
    ds_read_b128 a[60:63], v21 offset:12288
    v_mfma_f32_16x16x32_bf16 v[160:163], a[64:67], v[116:119], v[160:163]
    v_exp_f32 v101, v101
    v_mfma_f32_16x16x32_bf16 v[164:167], a[68:71], v[116:119], v[164:167]
    ds_read_b64_tr_b16 a[96:97], v16 offset:24576
    v_cvt_pk_bf16_f32 v114, v100, v101
    v_mfma_f32_16x16x32_bf16 v[168:171], a[72:75], v[116:119], v[168:171]
    v_exp_f32 v102, v102
    v_mfma_f32_16x16x32_bf16 v[172:175], a[76:79], v[116:119], v[172:175]
    buffer_load_dwordx4 v5, s[20:23], s83 offen offset:3072 lds
    v_mfma_f32_16x16x32_bf16 v[176:179], a[80:83], v[116:119], v[176:179]
    v_exp_f32 v103, v103
    v_mfma_f32_16x16x32_bf16 v[180:183], a[84:87], v[116:119], v[180:183]
    ds_read_b64_tr_b16 a[98:99], v16 offset:28672
    v_cvt_pk_bf16_f32 v115, v102, v103
    v_mfma_f32_16x16x32_bf16 v[184:187], a[88:91], v[116:119], v[184:187]
    ds_read_b64_tr_b16 a[192:193], v14 offset:0
    v_mfma_f32_16x16x32_bf16 v[188:191], a[92:95], v[116:119], v[188:191]
    s_waitcnt lgkmcnt(10)
    v_exp_f32 v104, v104
    v_mfma_f32_16x16x32_bf16 v[96:99], a[32:35], v[32:35], 0
    s_waitcnt lgkmcnt(9)
    ds_read_b64_tr_b16 a[100:101], v17 offset:24576
    v_mfma_f32_16x16x32_bf16 v[96:99], a[36:39], v[48:51], v[96:99]
    s_waitcnt lgkmcnt(9)
    v_exp_f32 v105, v105
    v_mfma_f32_16x16x32_bf16 v[96:99], a[40:43], v[64:67], v[96:99]
    s_waitcnt lgkmcnt(8)
    ds_read_b64_tr_b16 a[102:103], v17 offset:28672
    v_cvt_pk_bf16_f32 v116, v104, v105
    v_mfma_f32_16x16x32_bf16 v[96:99], a[44:47], v[80:83], v[96:99]
    s_waitcnt lgkmcnt(8)
    v_exp_f32 v106, v106
    v_mfma_f32_16x16x32_bf16 v[100:103], a[48:51], v[32:35], 0
    s_waitcnt lgkmcnt(7)
    ds_read_b64_tr_b16 a[194:195], v14 offset:2048
    v_mfma_f32_16x16x32_bf16 v[100:103], a[52:55], v[48:51], v[100:103]
    s_waitcnt lgkmcnt(7)
    v_exp_f32 v107, v107
    v_mfma_f32_16x16x32_bf16 v[100:103], a[56:59], v[64:67], v[100:103]
    s_waitcnt lgkmcnt(6)
    ds_read_b64_tr_b16 a[104:105], v16 offset:24832
    v_cvt_pk_bf16_f32 v117, v106, v107
    v_mfma_f32_16x16x32_bf16 v[100:103], a[60:63], v[80:83], v[100:103]
    v_exp_f32 v108, v108
    v_mfma_f32_16x16x32_bf16 a[136:139], a[144:147], v[112:115], a[136:139]
    ds_read_b64_tr_b16 a[106:107], v16 offset:28928
    v_mfma_f32_16x16x32_bf16 v[192:195], a[64:67], v[112:115], v[192:195]
    v_exp_f32 v109, v109
    v_mfma_f32_16x16x32_bf16 v[196:199], a[68:71], v[112:115], v[196:199]
    ds_read_b64_tr_b16 a[108:109], v17 offset:24832
    v_cvt_pk_bf16_f32 v118, v108, v109
    v_mfma_f32_16x16x32_bf16 v[200:203], a[72:75], v[112:115], v[200:203]
    v_exp_f32 v110, v110
    v_mfma_f32_16x16x32_bf16 v[204:207], a[76:79], v[112:115], v[204:207]
    ds_read_b64_tr_b16 a[196:197], v15 offset:0
    v_mfma_f32_16x16x32_bf16 v[208:211], a[80:83], v[112:115], v[208:211]
    v_exp_f32 v111, v111
    v_mfma_f32_16x16x32_bf16 v[212:215], a[84:87], v[112:115], v[212:215]
    ds_read_b64_tr_b16 a[110:111], v17 offset:28928
    v_cvt_pk_bf16_f32 v119, v110, v111
    v_mfma_f32_16x16x32_bf16 v[216:219], a[88:91], v[112:115], v[216:219]
    ds_read_b64_tr_b16 a[198:199], v15 offset:2048
    v_mfma_f32_16x16x32_bf16 v[220:223], a[92:95], v[112:115], v[220:223]
    v_exp_f32 v96, v96
    v_mfma_f32_16x16x32_bf16 v[104:107], a[32:35], v[36:39], 0
    ds_read_b64_tr_b16 a[112:113], v16 offset:25088
    v_mfma_f32_16x16x32_bf16 v[104:107], a[36:39], v[52:55], v[104:107]
    v_exp_f32 v97, v97
    v_mfma_f32_16x16x32_bf16 v[104:107], a[40:43], v[68:71], v[104:107]
    ds_read_b64_tr_b16 a[114:115], v16 offset:29184
    v_cvt_pk_bf16_f32 v112, v96, v97
    v_mfma_f32_16x16x32_bf16 v[104:107], a[44:47], v[84:87], v[104:107]
    v_exp_f32 v98, v98
    v_mfma_f32_16x16x32_bf16 v[108:111], a[48:51], v[36:39], 0
    ds_read_b64_tr_b16 a[200:201], v14 offset:256
    v_mfma_f32_16x16x32_bf16 v[108:111], a[52:55], v[52:55], v[108:111]
    v_exp_f32 v99, v99
    v_mfma_f32_16x16x32_bf16 v[108:111], a[56:59], v[68:71], v[108:111]
    ds_read_b64_tr_b16 a[116:117], v17 offset:25088
    v_cvt_pk_bf16_f32 v113, v98, v99
    v_mfma_f32_16x16x32_bf16 v[108:111], a[60:63], v[84:87], v[108:111]
    v_exp_f32 v100, v100
    v_mfma_f32_16x16x32_bf16 a[140:143], a[144:147], v[116:119], a[140:143]
    ds_read_b64_tr_b16 a[118:119], v17 offset:29184
    v_mfma_f32_16x16x32_bf16 v[224:227], a[64:67], v[116:119], v[224:227]
    v_exp_f32 v101, v101
    v_mfma_f32_16x16x32_bf16 v[228:231], a[68:71], v[116:119], v[228:231]
    ds_read_b64_tr_b16 a[120:121], v16 offset:25344
    v_cvt_pk_bf16_f32 v114, v100, v101
    v_mfma_f32_16x16x32_bf16 v[232:235], a[72:75], v[116:119], v[232:235]
    v_exp_f32 v102, v102
    v_mfma_f32_16x16x32_bf16 v[236:239], a[76:79], v[116:119], v[236:239]
    ds_read_b64_tr_b16 a[202:203], v14 offset:2304
    v_mfma_f32_16x16x32_bf16 v[240:243], a[80:83], v[116:119], v[240:243]
    v_exp_f32 v103, v103
    v_mfma_f32_16x16x32_bf16 v[244:247], a[84:87], v[116:119], v[244:247]
    s_add_u32 s82, s63, 98304
    ds_read_b64_tr_b16 a[122:123], v16 offset:29440
    v_cvt_pk_bf16_f32 v115, v102, v103
    v_mfma_f32_16x16x32_bf16 v[248:251], a[88:91], v[116:119], v[248:251]
    ds_read_b64_tr_b16 a[204:205], v15 offset:256
    v_mfma_f32_16x16x32_bf16 v[252:255], a[92:95], v[116:119], v[252:255]
    v_exp_f32 v104, v104
    v_mfma_f32_16x16x32_bf16 v[96:99], a[32:35], v[40:43], 0
    ds_read_b64_tr_b16 a[124:125], v17 offset:25344
    v_mfma_f32_16x16x32_bf16 v[96:99], a[36:39], v[56:59], v[96:99]
    v_exp_f32 v105, v105
    v_mfma_f32_16x16x32_bf16 v[96:99], a[40:43], v[72:75], v[96:99]
    ds_read_b64_tr_b16 a[126:127], v17 offset:29440
    v_cvt_pk_bf16_f32 v116, v104, v105
    v_mfma_f32_16x16x32_bf16 v[96:99], a[44:47], v[88:91], v[96:99]
    v_exp_f32 v106, v106
    v_mfma_f32_16x16x32_bf16 v[100:103], a[48:51], v[40:43], 0
    ds_read_b64_tr_b16 a[206:207], v15 offset:2304
    v_mfma_f32_16x16x32_bf16 v[100:103], a[52:55], v[56:59], v[100:103]
    v_exp_f32 v107, v107
    v_mfma_f32_16x16x32_bf16 v[100:103], a[56:59], v[72:75], v[100:103]
    s_waitcnt lgkmcnt(15)
    v_cvt_pk_bf16_f32 v117, v106, v107
    v_mfma_f32_16x16x32_bf16 v[100:103], a[60:63], v[88:91], v[100:103]
    s_waitcnt vmcnt(7) lgkmcnt(0)
    v_exp_f32 v108, v108
    v_mfma_f32_16x16x32_bf16 a[128:131], a[144:147], v[112:115], a[128:131]
    s_barrier
    ds_read_b128 a[0:3], v18 offset:32768
    v_mfma_f32_16x16x32_bf16 v[128:131], a[96:99], v[112:115], v[128:131]
    s_add_u32 m0, s62, 32768
    v_exp_f32 v109, v109
    v_mfma_f32_16x16x32_bf16 v[132:135], a[100:103], v[112:115], v[132:135]
    ds_read_b128 a[4:7], v19 offset:32768
    v_cvt_pk_bf16_f32 v118, v108, v109
    v_mfma_f32_16x16x32_bf16 v[136:139], a[104:107], v[112:115], v[136:139]
    v_exp_f32 v110, v110
    v_mfma_f32_16x16x32_bf16 v[140:143], a[108:111], v[112:115], v[140:143]
    ds_read_b128 a[8:11], v20 offset:32768
    v_mfma_f32_16x16x32_bf16 v[144:147], a[112:115], v[112:115], v[144:147]
    v_exp_f32 v111, v111
    v_mfma_f32_16x16x32_bf16 v[148:151], a[116:119], v[112:115], v[148:151]
    ds_read_b128 a[12:15], v21 offset:32768
    v_cvt_pk_bf16_f32 v119, v110, v111
    v_mfma_f32_16x16x32_bf16 v[152:155], a[120:123], v[112:115], v[152:155]
    buffer_load_dwordx4 v6, s[8:11], s82 offen offset:0 lds
    v_mfma_f32_16x16x32_bf16 v[156:159], a[124:127], v[112:115], v[156:159]
    v_exp_f32 v96, v96
    v_mfma_f32_16x16x32_bf16 v[104:107], a[32:35], v[44:47], 0
    ds_read_b128 a[16:19], v18 offset:36864
    v_mfma_f32_16x16x32_bf16 v[104:107], a[36:39], v[60:63], v[104:107]
    v_exp_f32 v97, v97
    v_mfma_f32_16x16x32_bf16 v[104:107], a[40:43], v[76:79], v[104:107]
    ds_read_b128 a[20:23], v19 offset:36864
    v_cvt_pk_bf16_f32 v112, v96, v97
    v_mfma_f32_16x16x32_bf16 v[104:107], a[44:47], v[92:95], v[104:107]
    v_exp_f32 v98, v98
    v_mfma_f32_16x16x32_bf16 v[108:111], a[48:51], v[44:47], 0
    buffer_load_dwordx4 v7, s[8:11], s82 offen offset:1024 lds
    v_mfma_f32_16x16x32_bf16 v[108:111], a[52:55], v[60:63], v[108:111]
    v_exp_f32 v99, v99
    v_mfma_f32_16x16x32_bf16 v[108:111], a[56:59], v[76:79], v[108:111]
    ds_read_b128 a[24:27], v20 offset:36864
    v_cvt_pk_bf16_f32 v113, v98, v99
    v_mfma_f32_16x16x32_bf16 v[108:111], a[60:63], v[92:95], v[108:111]
    v_exp_f32 v100, v100
    v_mfma_f32_16x16x32_bf16 a[132:135], a[144:147], v[116:119], a[132:135]
    ds_read_b128 a[28:31], v21 offset:36864
    v_mfma_f32_16x16x32_bf16 v[160:163], a[96:99], v[116:119], v[160:163]
    v_exp_f32 v101, v101
    v_mfma_f32_16x16x32_bf16 v[164:167], a[100:103], v[116:119], v[164:167]
    ds_read_b64_tr_b16 a[64:65], v16 offset:49152
    v_cvt_pk_bf16_f32 v114, v100, v101
    v_mfma_f32_16x16x32_bf16 v[168:171], a[104:107], v[116:119], v[168:171]
    v_exp_f32 v102, v102
    v_mfma_f32_16x16x32_bf16 v[172:175], a[108:111], v[116:119], v[172:175]
    buffer_load_dwordx4 v8, s[8:11], s82 offen offset:2048 lds
    v_mfma_f32_16x16x32_bf16 v[176:179], a[112:115], v[116:119], v[176:179]
    v_exp_f32 v103, v103
    v_mfma_f32_16x16x32_bf16 v[180:183], a[116:119], v[116:119], v[180:183]
    ds_read_b64_tr_b16 a[66:67], v16 offset:53248
    v_cvt_pk_bf16_f32 v115, v102, v103
    v_mfma_f32_16x16x32_bf16 v[184:187], a[120:123], v[116:119], v[184:187]
    buffer_load_dwordx4 v9, s[8:11], s82 offen offset:3072 lds
    v_mfma_f32_16x16x32_bf16 v[188:191], a[124:127], v[116:119], v[188:191]
    s_waitcnt lgkmcnt(9)
    v_exp_f32 v104, v104
    v_mfma_f32_16x16x32_bf16 v[96:99], a[0:3], v[32:35], 0
    s_waitcnt lgkmcnt(7)
    ds_read_b64_tr_b16 a[68:69], v17 offset:49152
    v_mfma_f32_16x16x32_bf16 v[96:99], a[4:7], v[48:51], v[96:99]
    s_add_u32 m0, s62, 49152
    v_exp_f32 v105, v105
    v_mfma_f32_16x16x32_bf16 v[96:99], a[8:11], v[64:67], v[96:99]
    s_waitcnt lgkmcnt(7)
    ds_read_b64_tr_b16 a[70:71], v17 offset:53248
    v_cvt_pk_bf16_f32 v116, v104, v105
    v_mfma_f32_16x16x32_bf16 v[96:99], a[12:15], v[80:83], v[96:99]
    s_waitcnt lgkmcnt(6)
    v_exp_f32 v106, v106
    v_mfma_f32_16x16x32_bf16 v[100:103], a[16:19], v[32:35], 0
    buffer_load_dwordx4 v10, s[12:15], s82 offen offset:0 lds
    v_mfma_f32_16x16x32_bf16 v[100:103], a[20:23], v[48:51], v[100:103]
    s_waitcnt lgkmcnt(5)
    v_exp_f32 v107, v107
    v_mfma_f32_16x16x32_bf16 v[100:103], a[24:27], v[64:67], v[100:103]
    s_waitcnt lgkmcnt(4)
    ds_read_b64_tr_b16 a[72:73], v16 offset:49408
    v_cvt_pk_bf16_f32 v117, v106, v107
    v_mfma_f32_16x16x32_bf16 v[100:103], a[28:31], v[80:83], v[100:103]
    v_exp_f32 v108, v108
    v_mfma_f32_16x16x32_bf16 a[136:139], a[144:147], v[112:115], a[136:139]
    ds_read_b64_tr_b16 a[74:75], v16 offset:53504
    v_mfma_f32_16x16x32_bf16 v[192:195], a[96:99], v[112:115], v[192:195]
    v_exp_f32 v109, v109
    v_mfma_f32_16x16x32_bf16 v[196:199], a[100:103], v[112:115], v[196:199]
    ds_read_b64_tr_b16 a[76:77], v17 offset:49408
    v_cvt_pk_bf16_f32 v118, v108, v109
    v_mfma_f32_16x16x32_bf16 v[200:203], a[104:107], v[112:115], v[200:203]
    v_exp_f32 v110, v110
    v_mfma_f32_16x16x32_bf16 v[204:207], a[108:111], v[112:115], v[204:207]
    buffer_load_dwordx4 v11, s[12:15], s82 offen offset:1024 lds
    v_mfma_f32_16x16x32_bf16 v[208:211], a[112:115], v[112:115], v[208:211]
    v_exp_f32 v111, v111
    v_mfma_f32_16x16x32_bf16 v[212:215], a[116:119], v[112:115], v[212:215]
    ds_read_b64_tr_b16 a[78:79], v17 offset:53504
    v_cvt_pk_bf16_f32 v119, v110, v111
    v_mfma_f32_16x16x32_bf16 v[216:219], a[120:123], v[112:115], v[216:219]
    buffer_load_dwordx4 v10, s[12:15], s82 offen offset:2048 lds
    v_mfma_f32_16x16x32_bf16 v[220:223], a[124:127], v[112:115], v[220:223]
    v_exp_f32 v96, v96
    v_mfma_f32_16x16x32_bf16 v[104:107], a[0:3], v[36:39], 0
    ds_read_b64_tr_b16 a[80:81], v16 offset:49664
    v_mfma_f32_16x16x32_bf16 v[104:107], a[4:7], v[52:55], v[104:107]
    v_exp_f32 v97, v97
    v_mfma_f32_16x16x32_bf16 v[104:107], a[8:11], v[68:71], v[104:107]
    ds_read_b64_tr_b16 a[82:83], v16 offset:53760
    v_cvt_pk_bf16_f32 v112, v96, v97
    v_mfma_f32_16x16x32_bf16 v[104:107], a[12:15], v[84:87], v[104:107]
    v_exp_f32 v98, v98
    v_mfma_f32_16x16x32_bf16 v[108:111], a[16:19], v[36:39], 0
    buffer_load_dwordx4 v11, s[12:15], s82 offen offset:3072 lds
    v_mfma_f32_16x16x32_bf16 v[108:111], a[20:23], v[52:55], v[108:111]
    s_add_u32 s55, s92, 114688
    v_exp_f32 v99, v99
    v_mfma_f32_16x16x32_bf16 v[108:111], a[24:27], v[68:71], v[108:111]
    ds_read_b64_tr_b16 a[84:85], v17 offset:49664
    v_cvt_pk_bf16_f32 v113, v98, v99
    v_mfma_f32_16x16x32_bf16 v[108:111], a[28:31], v[84:87], v[108:111]
    v_exp_f32 v100, v100
    v_mfma_f32_16x16x32_bf16 a[140:143], a[144:147], v[116:119], a[140:143]
    ds_read_b64_tr_b16 a[86:87], v17 offset:53760
    v_mfma_f32_16x16x32_bf16 v[224:227], a[96:99], v[116:119], v[224:227]
    v_exp_f32 v101, v101
    v_mfma_f32_16x16x32_bf16 v[228:231], a[100:103], v[116:119], v[228:231]
    s_add_u32 s83, s61, 0
    ds_read_b64_tr_b16 a[88:89], v16 offset:49920
    v_cvt_pk_bf16_f32 v114, v100, v101
    v_mfma_f32_16x16x32_bf16 v[232:235], a[104:107], v[116:119], v[232:235]
    v_exp_f32 v102, v102
    v_mfma_f32_16x16x32_bf16 v[236:239], a[108:111], v[116:119], v[236:239]
    buffer_load_dword v28, v120, s[24:27], s77 offen
    v_mfma_f32_16x16x32_bf16 v[240:243], a[112:115], v[116:119], v[240:243]
    v_exp_f32 v103, v103
    v_mfma_f32_16x16x32_bf16 v[244:247], a[116:119], v[116:119], v[244:247]
    ds_read_b64_tr_b16 a[90:91], v16 offset:54016
    v_cvt_pk_bf16_f32 v115, v102, v103
    v_mfma_f32_16x16x32_bf16 v[248:251], a[120:123], v[116:119], v[248:251]
    buffer_store_dwordx4 v[124:127], v23, s[48:51], s55 offen offset:0 sc1
    v_mfma_f32_16x16x32_bf16 v[252:255], a[124:127], v[116:119], v[252:255]
    v_exp_f32 v104, v104
    v_mfma_f32_16x16x32_bf16 v[96:99], a[0:3], v[40:43], 0
    ds_read_b64_tr_b16 a[92:93], v17 offset:49920
    v_mfma_f32_16x16x32_bf16 v[96:99], a[4:7], v[56:59], v[96:99]
    v_exp_f32 v105, v105
    v_mfma_f32_16x16x32_bf16 v[96:99], a[8:11], v[72:75], v[96:99]
    ds_read_b64_tr_b16 a[94:95], v17 offset:54016
    v_cvt_pk_bf16_f32 v116, v104, v105
    v_mfma_f32_16x16x32_bf16 v[96:99], a[12:15], v[88:91], v[96:99]
    v_exp_f32 v106, v106
    v_mfma_f32_16x16x32_bf16 v[100:103], a[16:19], v[40:43], 0
    buffer_store_dwordx4 v[124:127], v23, s[48:51], s55 offen offset:1024 sc1
    v_mfma_f32_16x16x32_bf16 v[100:103], a[20:23], v[56:59], v[100:103]
    v_exp_f32 v107, v107
    v_mfma_f32_16x16x32_bf16 v[100:103], a[24:27], v[72:75], v[100:103]
    s_add_u32 m0, s62, 131072
    ds_read_b128 a[32:35], v18 offset:40960
    v_cvt_pk_bf16_f32 v117, v106, v107
    v_mfma_f32_16x16x32_bf16 v[100:103], a[28:31], v[88:91], v[100:103]
    v_exp_f32 v108, v108
    v_mfma_f32_16x16x32_bf16 a[128:131], a[144:147], v[112:115], a[128:131]
    s_waitcnt lgkmcnt(15)
    ds_read_b128 a[36:39], v19 offset:40960
    v_mfma_f32_16x16x32_bf16 v[128:131], a[64:67], v[112:115], v[128:131]
    s_waitcnt lgkmcnt(14)
    v_exp_f32 v109, v109
    v_mfma_f32_16x16x32_bf16 v[132:135], a[68:71], v[112:115], v[132:135]
    s_waitcnt lgkmcnt(12)
    ds_read_b128 a[40:43], v20 offset:40960
    v_cvt_pk_bf16_f32 v118, v108, v109
    v_mfma_f32_16x16x32_bf16 v[136:139], a[72:75], v[112:115], v[136:139]
    s_waitcnt lgkmcnt(9)
    v_exp_f32 v110, v110
    v_mfma_f32_16x16x32_bf16 v[140:143], a[76:79], v[112:115], v[140:143]
    buffer_load_dwordx4 v2, s[20:23], s83 offen offset:0 lds
    v_mfma_f32_16x16x32_bf16 v[144:147], a[80:83], v[112:115], v[144:147]
    s_waitcnt lgkmcnt(7)
    v_exp_f32 v111, v111
    v_mfma_f32_16x16x32_bf16 v[148:151], a[84:87], v[112:115], v[148:151]
    s_waitcnt lgkmcnt(3)
    ds_read_b128 a[44:47], v21 offset:40960
    v_cvt_pk_bf16_f32 v119, v110, v111
    v_mfma_f32_16x16x32_bf16 v[152:155], a[88:91], v[112:115], v[152:155]
    buffer_load_dwordx4 v3, s[20:23], s83 offen offset:1024 lds
    v_mfma_f32_16x16x32_bf16 v[156:159], a[92:95], v[112:115], v[156:159]
    v_exp_f32 v96, v96
    v_mfma_f32_16x16x32_bf16 v[104:107], a[0:3], v[44:47], 0
    ds_read_b128 a[48:51], v18 offset:45056
    v_mfma_f32_16x16x32_bf16 v[104:107], a[4:7], v[60:63], v[104:107]
    v_exp_f32 v97, v97
    v_mfma_f32_16x16x32_bf16 v[104:107], a[8:11], v[76:79], v[104:107]
    ds_read_b128 a[52:55], v19 offset:45056
    v_cvt_pk_bf16_f32 v112, v96, v97
    v_mfma_f32_16x16x32_bf16 v[104:107], a[12:15], v[92:95], v[104:107]
    v_exp_f32 v98, v98
    v_mfma_f32_16x16x32_bf16 v[108:111], a[16:19], v[44:47], 0
    buffer_load_dwordx4 v4, s[20:23], s83 offen offset:2048 lds
    v_mfma_f32_16x16x32_bf16 v[108:111], a[20:23], v[60:63], v[108:111]
    v_exp_f32 v99, v99
    v_mfma_f32_16x16x32_bf16 v[108:111], a[24:27], v[76:79], v[108:111]
    ds_read_b128 a[56:59], v20 offset:45056
    v_cvt_pk_bf16_f32 v113, v98, v99
    v_mfma_f32_16x16x32_bf16 v[108:111], a[28:31], v[92:95], v[108:111]
    v_exp_f32 v100, v100
    v_mfma_f32_16x16x32_bf16 a[132:135], a[144:147], v[116:119], a[132:135]
    ds_read_b128 a[60:63], v21 offset:45056
    v_mfma_f32_16x16x32_bf16 v[160:163], a[64:67], v[116:119], v[160:163]
    v_exp_f32 v101, v101
    v_mfma_f32_16x16x32_bf16 v[164:167], a[68:71], v[116:119], v[164:167]
    ds_read_b64_tr_b16 a[96:97], v16 offset:57344
    v_cvt_pk_bf16_f32 v114, v100, v101
    v_mfma_f32_16x16x32_bf16 v[168:171], a[72:75], v[116:119], v[168:171]
    v_exp_f32 v102, v102
    v_mfma_f32_16x16x32_bf16 v[172:175], a[76:79], v[116:119], v[172:175]
    buffer_load_dwordx4 v5, s[20:23], s83 offen offset:3072 lds
    v_mfma_f32_16x16x32_bf16 v[176:179], a[80:83], v[116:119], v[176:179]
    v_exp_f32 v103, v103
    v_mfma_f32_16x16x32_bf16 v[180:183], a[84:87], v[116:119], v[180:183]
    ds_read_b64_tr_b16 a[98:99], v16 offset:61440
    v_cvt_pk_bf16_f32 v115, v102, v103
    v_mfma_f32_16x16x32_bf16 v[184:187], a[88:91], v[116:119], v[184:187]
    ds_read_b64_tr_b16 a[208:209], v14 offset:16384
    v_mfma_f32_16x16x32_bf16 v[188:191], a[92:95], v[116:119], v[188:191]
    s_waitcnt lgkmcnt(10)
    v_exp_f32 v104, v104
    v_mfma_f32_16x16x32_bf16 v[96:99], a[32:35], v[32:35], 0
    s_waitcnt lgkmcnt(9)
    ds_read_b64_tr_b16 a[100:101], v17 offset:57344
    v_mfma_f32_16x16x32_bf16 v[96:99], a[36:39], v[48:51], v[96:99]
    s_waitcnt lgkmcnt(9)
    v_exp_f32 v105, v105
    v_mfma_f32_16x16x32_bf16 v[96:99], a[40:43], v[64:67], v[96:99]
    s_waitcnt lgkmcnt(8)
    ds_read_b64_tr_b16 a[102:103], v17 offset:61440
    v_cvt_pk_bf16_f32 v116, v104, v105
    v_mfma_f32_16x16x32_bf16 v[96:99], a[44:47], v[80:83], v[96:99]
    s_waitcnt lgkmcnt(8)
    v_exp_f32 v106, v106
    v_mfma_f32_16x16x32_bf16 v[100:103], a[48:51], v[32:35], 0
    s_waitcnt lgkmcnt(7)
    ds_read_b64_tr_b16 a[210:211], v14 offset:18432
    v_mfma_f32_16x16x32_bf16 v[100:103], a[52:55], v[48:51], v[100:103]
    s_waitcnt lgkmcnt(7)
    v_exp_f32 v107, v107
    v_mfma_f32_16x16x32_bf16 v[100:103], a[56:59], v[64:67], v[100:103]
    s_waitcnt lgkmcnt(6)
    ds_read_b64_tr_b16 a[104:105], v16 offset:57600
    v_cvt_pk_bf16_f32 v117, v106, v107
    v_mfma_f32_16x16x32_bf16 v[100:103], a[60:63], v[80:83], v[100:103]
    v_exp_f32 v108, v108
    v_mfma_f32_16x16x32_bf16 a[136:139], a[144:147], v[112:115], a[136:139]
    ds_read_b64_tr_b16 a[106:107], v16 offset:61696
    v_mfma_f32_16x16x32_bf16 v[192:195], a[64:67], v[112:115], v[192:195]
    v_exp_f32 v109, v109
    v_mfma_f32_16x16x32_bf16 v[196:199], a[68:71], v[112:115], v[196:199]
    ds_read_b64_tr_b16 a[108:109], v17 offset:57600
    v_cvt_pk_bf16_f32 v118, v108, v109
    v_mfma_f32_16x16x32_bf16 v[200:203], a[72:75], v[112:115], v[200:203]
    v_exp_f32 v110, v110
    v_mfma_f32_16x16x32_bf16 v[204:207], a[76:79], v[112:115], v[204:207]
    ds_read_b64_tr_b16 a[212:213], v15 offset:16384
    v_mfma_f32_16x16x32_bf16 v[208:211], a[80:83], v[112:115], v[208:211]
    v_exp_f32 v111, v111
    v_mfma_f32_16x16x32_bf16 v[212:215], a[84:87], v[112:115], v[212:215]
    ds_read_b64_tr_b16 a[110:111], v17 offset:61696
    v_cvt_pk_bf16_f32 v119, v110, v111
    v_mfma_f32_16x16x32_bf16 v[216:219], a[88:91], v[112:115], v[216:219]
    ds_read_b64_tr_b16 a[214:215], v15 offset:18432
    v_mfma_f32_16x16x32_bf16 v[220:223], a[92:95], v[112:115], v[220:223]
    v_exp_f32 v96, v96
    v_mfma_f32_16x16x32_bf16 v[104:107], a[32:35], v[36:39], 0
    ds_read_b64_tr_b16 a[112:113], v16 offset:57856
    v_mfma_f32_16x16x32_bf16 v[104:107], a[36:39], v[52:55], v[104:107]
    v_exp_f32 v97, v97
    v_mfma_f32_16x16x32_bf16 v[104:107], a[40:43], v[68:71], v[104:107]
    ds_read_b64_tr_b16 a[114:115], v16 offset:61952
    v_cvt_pk_bf16_f32 v112, v96, v97
    v_mfma_f32_16x16x32_bf16 v[104:107], a[44:47], v[84:87], v[104:107]
    v_exp_f32 v98, v98
    v_mfma_f32_16x16x32_bf16 v[108:111], a[48:51], v[36:39], 0
    ds_read_b64_tr_b16 a[216:217], v14 offset:16640
    v_mfma_f32_16x16x32_bf16 v[108:111], a[52:55], v[52:55], v[108:111]
    v_exp_f32 v99, v99
    v_mfma_f32_16x16x32_bf16 v[108:111], a[56:59], v[68:71], v[108:111]
    ds_read_b64_tr_b16 a[116:117], v17 offset:57856
    v_cvt_pk_bf16_f32 v113, v98, v99
    v_mfma_f32_16x16x32_bf16 v[108:111], a[60:63], v[84:87], v[108:111]
    v_exp_f32 v100, v100
    v_mfma_f32_16x16x32_bf16 a[140:143], a[144:147], v[116:119], a[140:143]
    ds_read_b64_tr_b16 a[118:119], v17 offset:61952
    v_mfma_f32_16x16x32_bf16 v[224:227], a[64:67], v[116:119], v[224:227]
    v_exp_f32 v101, v101
    v_mfma_f32_16x16x32_bf16 v[228:231], a[68:71], v[116:119], v[228:231]
    ds_read_b64_tr_b16 a[120:121], v16 offset:58112
    v_cvt_pk_bf16_f32 v114, v100, v101
    v_mfma_f32_16x16x32_bf16 v[232:235], a[72:75], v[116:119], v[232:235]
    v_exp_f32 v102, v102
    v_mfma_f32_16x16x32_bf16 v[236:239], a[76:79], v[116:119], v[236:239]
    ds_read_b64_tr_b16 a[218:219], v14 offset:18688
    v_mfma_f32_16x16x32_bf16 v[240:243], a[80:83], v[116:119], v[240:243]
    v_exp_f32 v103, v103
    v_mfma_f32_16x16x32_bf16 v[244:247], a[84:87], v[116:119], v[244:247]
    s_add_u32 s82, s63, 114688
    ds_read_b64_tr_b16 a[122:123], v16 offset:62208
    v_cvt_pk_bf16_f32 v115, v102, v103
    v_mfma_f32_16x16x32_bf16 v[248:251], a[88:91], v[116:119], v[248:251]
    ds_read_b64_tr_b16 a[220:221], v15 offset:16640
    v_mfma_f32_16x16x32_bf16 v[252:255], a[92:95], v[116:119], v[252:255]
    v_exp_f32 v104, v104
    v_mfma_f32_16x16x32_bf16 v[96:99], a[32:35], v[40:43], 0
    ds_read_b64_tr_b16 a[124:125], v17 offset:58112
    v_mfma_f32_16x16x32_bf16 v[96:99], a[36:39], v[56:59], v[96:99]
    v_exp_f32 v105, v105
    v_mfma_f32_16x16x32_bf16 v[96:99], a[40:43], v[72:75], v[96:99]
    ds_read_b64_tr_b16 a[126:127], v17 offset:62208
    v_cvt_pk_bf16_f32 v116, v104, v105
    v_mfma_f32_16x16x32_bf16 v[96:99], a[44:47], v[88:91], v[96:99]
L_hop1_6:
    s_cbranch_execz L_hop1_10
    v_exp_f32 v106, v106
    v_mfma_f32_16x16x32_bf16 v[100:103], a[48:51], v[40:43], 0
    ds_read_b64_tr_b16 a[222:223], v15 offset:18688
    v_mfma_f32_16x16x32_bf16 v[100:103], a[52:55], v[56:59], v[100:103]
    v_exp_f32 v107, v107
    v_mfma_f32_16x16x32_bf16 v[100:103], a[56:59], v[72:75], v[100:103]
    s_waitcnt lgkmcnt(15)
    v_cvt_pk_bf16_f32 v117, v106, v107
    v_mfma_f32_16x16x32_bf16 v[100:103], a[60:63], v[88:91], v[100:103]
    s_waitcnt vmcnt(7) lgkmcnt(0)
    v_exp_f32 v108, v108
    v_mfma_f32_16x16x32_bf16 a[128:131], a[144:147], v[112:115], a[128:131]
    s_barrier
    ds_read_b128 a[0:3], v18 offset:0
    v_mfma_f32_16x16x32_bf16 v[128:131], a[96:99], v[112:115], v[128:131]
    s_add_u32 m0, s62, 65536
    v_exp_f32 v109, v109
    v_mfma_f32_16x16x32_bf16 v[132:135], a[100:103], v[112:115], v[132:135]
    ds_read_b128 a[4:7], v19 offset:0
    v_cvt_pk_bf16_f32 v118, v108, v109
    v_mfma_f32_16x16x32_bf16 v[136:139], a[104:107], v[112:115], v[136:139]
    v_exp_f32 v110, v110
    v_mfma_f32_16x16x32_bf16 v[140:143], a[108:111], v[112:115], v[140:143]
    ds_read_b128 a[8:11], v20 offset:0
    v_cmp_gt_u32 vcc, v123, v29
    v_mfma_f32_16x16x32_bf16 v[144:147], a[112:115], v[112:115], v[144:147]
    v_exp_f32 v111, v111
    v_mfma_f32_16x16x32_bf16 v[148:151], a[116:119], v[112:115], v[148:151]
    s_cbranch_vccnz L_mod2
L_mod2j:
    ds_read_b128 a[12:15], v21 offset:0
    v_cvt_pk_bf16_f32 v119, v110, v111
    v_mfma_f32_16x16x32_bf16 v[152:155], a[120:123], v[112:115], v[152:155]
    buffer_load_dwordx4 v6, s[8:11], s82 offen offset:0 lds
    v_mfma_f32_16x16x32_bf16 v[156:159], a[124:127], v[112:115], v[156:159]
    v_exp_f32 v96, v96
    v_mfma_f32_16x16x32_bf16 v[104:107], a[32:35], v[44:47], 0
    ds_read_b128 a[16:19], v18 offset:4096
    v_mfma_f32_16x16x32_bf16 v[104:107], a[36:39], v[60:63], v[104:107]
    v_exp_f32 v97, v97
    v_mfma_f32_16x16x32_bf16 v[104:107], a[40:43], v[76:79], v[104:107]
    ds_read_b128 a[20:23], v19 offset:4096
    v_cvt_pk_bf16_f32 v112, v96, v97
    v_mfma_f32_16x16x32_bf16 v[104:107], a[44:47], v[92:95], v[104:107]
    v_exp_f32 v98, v98
    v_mfma_f32_16x16x32_bf16 v[108:111], a[48:51], v[44:47], 0
    buffer_load_dwordx4 v7, s[8:11], s82 offen offset:1024 lds
    v_mfma_f32_16x16x32_bf16 v[108:111], a[52:55], v[60:63], v[108:111]
    v_exp_f32 v99, v99
    v_mfma_f32_16x16x32_bf16 v[108:111], a[56:59], v[76:79], v[108:111]
    ds_read_b128 a[24:27], v20 offset:4096
    v_cvt_pk_bf16_f32 v113, v98, v99
    v_mfma_f32_16x16x32_bf16 v[108:111], a[60:63], v[92:95], v[108:111]
    v_exp_f32 v100, v100
    v_mfma_f32_16x16x32_bf16 a[132:135], a[144:147], v[116:119], a[132:135]
    ds_read_b128 a[28:31], v21 offset:4096
    v_mfma_f32_16x16x32_bf16 v[160:163], a[96:99], v[116:119], v[160:163]
    v_exp_f32 v101, v101
    v_mfma_f32_16x16x32_bf16 v[164:167], a[100:103], v[116:119], v[164:167]
    ds_read_b64_tr_b16 a[64:65], v16 offset:16384
    v_cvt_pk_bf16_f32 v114, v100, v101
    v_mfma_f32_16x16x32_bf16 v[168:171], a[104:107], v[116:119], v[168:171]
    v_exp_f32 v102, v102
    v_mfma_f32_16x16x32_bf16 v[172:175], a[108:111], v[116:119], v[172:175]
    buffer_load_dwordx4 v8, s[8:11], s82 offen offset:2048 lds
    v_mfma_f32_16x16x32_bf16 v[176:179], a[112:115], v[116:119], v[176:179]
    v_exp_f32 v103, v103
    v_mfma_f32_16x16x32_bf16 v[180:183], a[116:119], v[116:119], v[180:183]
    ds_read_b64_tr_b16 a[66:67], v16 offset:20480
    v_cvt_pk_bf16_f32 v115, v102, v103
    v_mfma_f32_16x16x32_bf16 v[184:187], a[120:123], v[116:119], v[184:187]
    buffer_load_dwordx4 v9, s[8:11], s82 offen offset:3072 lds
    v_mfma_f32_16x16x32_bf16 v[188:191], a[124:127], v[116:119], v[188:191]
    s_waitcnt lgkmcnt(9)
    v_exp_f32 v104, v104
    v_mfma_f32_16x16x32_bf16 v[96:99], a[0:3], v[32:35], 0
    s_waitcnt lgkmcnt(7)
    ds_read_b64_tr_b16 a[68:69], v17 offset:16384
    v_mfma_f32_16x16x32_bf16 v[96:99], a[4:7], v[48:51], v[96:99]
    s_add_u32 m0, s62, 81920
    v_exp_f32 v105, v105
    v_mfma_f32_16x16x32_bf16 v[96:99], a[8:11], v[64:67], v[96:99]
    s_waitcnt lgkmcnt(7)
    ds_read_b64_tr_b16 a[70:71], v17 offset:20480
    v_cvt_pk_bf16_f32 v116, v104, v105
    v_mfma_f32_16x16x32_bf16 v[96:99], a[12:15], v[80:83], v[96:99]
    s_waitcnt lgkmcnt(6)
    v_exp_f32 v106, v106
    v_mfma_f32_16x16x32_bf16 v[100:103], a[16:19], v[32:35], 0
    buffer_load_dwordx4 v10, s[12:15], s82 offen offset:0 lds
    v_mfma_f32_16x16x32_bf16 v[100:103], a[20:23], v[48:51], v[100:103]
    s_waitcnt lgkmcnt(5)
    v_exp_f32 v107, v107
    v_mfma_f32_16x16x32_bf16 v[100:103], a[24:27], v[64:67], v[100:103]
    s_waitcnt lgkmcnt(4)
    ds_read_b64_tr_b16 a[72:73], v16 offset:16640
    v_cvt_pk_bf16_f32 v117, v106, v107
    v_mfma_f32_16x16x32_bf16 v[100:103], a[28:31], v[80:83], v[100:103]
    v_exp_f32 v108, v108
    v_mfma_f32_16x16x32_bf16 a[136:139], a[144:147], v[112:115], a[136:139]
    ds_read_b64_tr_b16 a[74:75], v16 offset:20736
    v_mfma_f32_16x16x32_bf16 v[192:195], a[96:99], v[112:115], v[192:195]
    v_exp_f32 v109, v109
    v_mfma_f32_16x16x32_bf16 v[196:199], a[100:103], v[112:115], v[196:199]
    ds_read_b64_tr_b16 a[76:77], v17 offset:16640
    v_cvt_pk_bf16_f32 v118, v108, v109
    v_mfma_f32_16x16x32_bf16 v[200:203], a[104:107], v[112:115], v[200:203]
    v_exp_f32 v110, v110
    v_mfma_f32_16x16x32_bf16 v[204:207], a[108:111], v[112:115], v[204:207]
    buffer_load_dwordx4 v11, s[12:15], s82 offen offset:1024 lds
    v_mfma_f32_16x16x32_bf16 v[208:211], a[112:115], v[112:115], v[208:211]
    v_exp_f32 v111, v111
    v_mfma_f32_16x16x32_bf16 v[212:215], a[116:119], v[112:115], v[212:215]
    ds_read_b64_tr_b16 a[78:79], v17 offset:20736
    v_cvt_pk_bf16_f32 v119, v110, v111
    v_mfma_f32_16x16x32_bf16 v[216:219], a[120:123], v[112:115], v[216:219]
    buffer_load_dwordx4 v10, s[12:15], s82 offen offset:2048 lds
    v_mfma_f32_16x16x32_bf16 v[220:223], a[124:127], v[112:115], v[220:223]
    v_exp_f32 v96, v96
    v_mfma_f32_16x16x32_bf16 v[104:107], a[0:3], v[36:39], 0
    ds_read_b64_tr_b16 a[80:81], v16 offset:16896
    v_mfma_f32_16x16x32_bf16 v[104:107], a[4:7], v[52:55], v[104:107]
    v_exp_f32 v97, v97
    v_mfma_f32_16x16x32_bf16 v[104:107], a[8:11], v[68:71], v[104:107]
    ds_read_b64_tr_b16 a[82:83], v16 offset:20992
    v_cvt_pk_bf16_f32 v112, v96, v97
    v_mfma_f32_16x16x32_bf16 v[104:107], a[12:15], v[84:87], v[104:107]
    v_exp_f32 v98, v98
    v_mfma_f32_16x16x32_bf16 v[108:111], a[16:19], v[36:39], 0
    buffer_load_dwordx4 v11, s[12:15], s82 offen offset:3072 lds
    v_mfma_f32_16x16x32_bf16 v[108:111], a[20:23], v[52:55], v[108:111]
    s_add_u32 s55, s92, 172032
    v_exp_f32 v99, v99
    v_mfma_f32_16x16x32_bf16 v[108:111], a[24:27], v[68:71], v[108:111]
    ds_read_b64_tr_b16 a[84:85], v17 offset:16896
    v_cvt_pk_bf16_f32 v113, v98, v99
    v_mfma_f32_16x16x32_bf16 v[108:111], a[28:31], v[84:87], v[108:111]
    v_exp_f32 v100, v100
    v_mfma_f32_16x16x32_bf16 a[140:143], a[144:147], v[116:119], a[140:143]
    ds_read_b64_tr_b16 a[86:87], v17 offset:20992
    v_mfma_f32_16x16x32_bf16 v[224:227], a[96:99], v[116:119], v[224:227]
    v_exp_f32 v101, v101
    v_mfma_f32_16x16x32_bf16 v[228:231], a[100:103], v[116:119], v[228:231]
    s_add_u32 s83, s61, 32768
    ds_read_b64_tr_b16 a[88:89], v16 offset:17152
    v_cvt_pk_bf16_f32 v114, v100, v101
    v_mfma_f32_16x16x32_bf16 v[232:235], a[104:107], v[116:119], v[232:235]
    v_exp_f32 v102, v102
    v_mfma_f32_16x16x32_bf16 v[236:239], a[108:111], v[116:119], v[236:239]
    s_waitcnt vmcnt(14)
    buffer_load_dword v28, v121, s[28:31], s78 offen
    v_mfma_f32_16x16x32_bf16 v[240:243], a[112:115], v[116:119], v[240:243]
    v_exp_f32 v103, v103
    v_mfma_f32_16x16x32_bf16 v[244:247], a[116:119], v[116:119], v[244:247]
    ds_read_b64_tr_b16 a[90:91], v16 offset:21248
    v_cvt_pk_bf16_f32 v115, v102, v103
    v_mfma_f32_16x16x32_bf16 v[248:251], a[120:123], v[116:119], v[248:251]
    buffer_store_dwordx4 v[124:127], v23, s[48:51], s55 offen offset:0 sc1
    v_mfma_f32_16x16x32_bf16 v[252:255], a[124:127], v[116:119], v[252:255]
    v_exp_f32 v104, v104
    v_mfma_f32_16x16x32_bf16 v[96:99], a[0:3], v[40:43], 0
    ds_read_b64_tr_b16 a[92:93], v17 offset:17152
    v_mfma_f32_16x16x32_bf16 v[96:99], a[4:7], v[56:59], v[96:99]
    v_exp_f32 v105, v105
    v_mfma_f32_16x16x32_bf16 v[96:99], a[8:11], v[72:75], v[96:99]
    ds_read_b64_tr_b16 a[94:95], v17 offset:21248
    v_cvt_pk_bf16_f32 v116, v104, v105
    v_mfma_f32_16x16x32_bf16 v[96:99], a[12:15], v[88:91], v[96:99]
    v_exp_f32 v106, v106
    v_mfma_f32_16x16x32_bf16 v[100:103], a[16:19], v[40:43], 0
    buffer_store_dwordx4 v[124:127], v23, s[48:51], s55 offen offset:1024 sc1
    v_mfma_f32_16x16x32_bf16 v[100:103], a[20:23], v[56:59], v[100:103]
    v_exp_f32 v107, v107
    v_mfma_f32_16x16x32_bf16 v[100:103], a[24:27], v[72:75], v[100:103]
    s_add_u32 m0, s62, 147456
    ds_read_b128 a[32:35], v18 offset:8192
    v_cvt_pk_bf16_f32 v117, v106, v107
    v_mfma_f32_16x16x32_bf16 v[100:103], a[28:31], v[88:91], v[100:103]
    v_exp_f32 v108, v108
    v_mfma_f32_16x16x32_bf16 a[128:131], a[144:147], v[112:115], a[128:131]
    s_waitcnt lgkmcnt(15)
    ds_read_b128 a[36:39], v19 offset:8192
    v_mfma_f32_16x16x32_bf16 v[128:131], a[64:67], v[112:115], v[128:131]
    s_waitcnt lgkmcnt(14)
    v_exp_f32 v109, v109
    v_mfma_f32_16x16x32_bf16 v[132:135], a[68:71], v[112:115], v[132:135]
    s_waitcnt lgkmcnt(12)
    ds_read_b128 a[40:43], v20 offset:8192
    v_cvt_pk_bf16_f32 v118, v108, v109
    v_mfma_f32_16x16x32_bf16 v[136:139], a[72:75], v[112:115], v[136:139]
    s_waitcnt lgkmcnt(9)
    v_exp_f32 v110, v110
    v_mfma_f32_16x16x32_bf16 v[140:143], a[76:79], v[112:115], v[140:143]
    buffer_load_dwordx4 v2, s[20:23], s83 offen offset:0 lds
    v_mfma_f32_16x16x32_bf16 v[144:147], a[80:83], v[112:115], v[144:147]
    s_waitcnt lgkmcnt(7)
    v_exp_f32 v111, v111
    v_mfma_f32_16x16x32_bf16 v[148:151], a[84:87], v[112:115], v[148:151]
    s_waitcnt lgkmcnt(3)
    ds_read_b128 a[44:47], v21 offset:8192
    v_cvt_pk_bf16_f32 v119, v110, v111
    v_mfma_f32_16x16x32_bf16 v[152:155], a[88:91], v[112:115], v[152:155]
    buffer_load_dwordx4 v3, s[20:23], s83 offen offset:1024 lds
    v_mfma_f32_16x16x32_bf16 v[156:159], a[92:95], v[112:115], v[156:159]
    v_exp_f32 v96, v96
    v_mfma_f32_16x16x32_bf16 v[104:107], a[0:3], v[44:47], 0
    ds_read_b128 a[48:51], v18 offset:12288
    v_mfma_f32_16x16x32_bf16 v[104:107], a[4:7], v[60:63], v[104:107]
    v_exp_f32 v97, v97
    v_mfma_f32_16x16x32_bf16 v[104:107], a[8:11], v[76:79], v[104:107]
    ds_read_b128 a[52:55], v19 offset:12288
    v_cvt_pk_bf16_f32 v112, v96, v97
    v_mfma_f32_16x16x32_bf16 v[104:107], a[12:15], v[92:95], v[104:107]
    v_exp_f32 v98, v98
    v_mfma_f32_16x16x32_bf16 v[108:111], a[16:19], v[44:47], 0
    buffer_load_dwordx4 v4, s[20:23], s83 offen offset:2048 lds
    v_mfma_f32_16x16x32_bf16 v[108:111], a[20:23], v[60:63], v[108:111]
    v_exp_f32 v99, v99
    v_mfma_f32_16x16x32_bf16 v[108:111], a[24:27], v[76:79], v[108:111]
    ds_read_b128 a[56:59], v20 offset:12288
    v_cvt_pk_bf16_f32 v113, v98, v99
    v_mfma_f32_16x16x32_bf16 v[108:111], a[28:31], v[92:95], v[108:111]
    v_exp_f32 v100, v100
    v_mfma_f32_16x16x32_bf16 a[132:135], a[144:147], v[116:119], a[132:135]
    ds_read_b128 a[60:63], v21 offset:12288
    v_mfma_f32_16x16x32_bf16 v[160:163], a[64:67], v[116:119], v[160:163]
    v_exp_f32 v101, v101
    v_mfma_f32_16x16x32_bf16 v[164:167], a[68:71], v[116:119], v[164:167]
    ds_read_b64_tr_b16 a[96:97], v16 offset:24576
    v_cvt_pk_bf16_f32 v114, v100, v101
    v_mfma_f32_16x16x32_bf16 v[168:171], a[72:75], v[116:119], v[168:171]
    v_exp_f32 v102, v102
    v_mfma_f32_16x16x32_bf16 v[172:175], a[76:79], v[116:119], v[172:175]
    buffer_load_dwordx4 v5, s[20:23], s83 offen offset:3072 lds
    v_mfma_f32_16x16x32_bf16 v[176:179], a[80:83], v[116:119], v[176:179]
    v_exp_f32 v103, v103
    v_mfma_f32_16x16x32_bf16 v[180:183], a[84:87], v[116:119], v[180:183]
    ds_read_b64_tr_b16 a[98:99], v16 offset:28672
    v_cvt_pk_bf16_f32 v115, v102, v103
    v_mfma_f32_16x16x32_bf16 v[184:187], a[88:91], v[116:119], v[184:187]
    ds_read_b64_tr_b16 a[224:225], v12 offset:32768
    v_mfma_f32_16x16x32_bf16 v[188:191], a[92:95], v[116:119], v[188:191]
    s_waitcnt lgkmcnt(10)
    v_exp_f32 v104, v104
    v_mfma_f32_16x16x32_bf16 v[96:99], a[32:35], v[32:35], 0
    s_waitcnt lgkmcnt(9)
    ds_read_b64_tr_b16 a[100:101], v17 offset:24576
    v_mfma_f32_16x16x32_bf16 v[96:99], a[36:39], v[48:51], v[96:99]
    s_waitcnt lgkmcnt(9)
    v_exp_f32 v105, v105
    v_mfma_f32_16x16x32_bf16 v[96:99], a[40:43], v[64:67], v[96:99]
    s_waitcnt lgkmcnt(8)
    ds_read_b64_tr_b16 a[102:103], v17 offset:28672
    v_cvt_pk_bf16_f32 v116, v104, v105
    v_mfma_f32_16x16x32_bf16 v[96:99], a[44:47], v[80:83], v[96:99]
    s_waitcnt lgkmcnt(8)
    v_exp_f32 v106, v106
    v_mfma_f32_16x16x32_bf16 v[100:103], a[48:51], v[32:35], 0
    s_waitcnt lgkmcnt(7)
    ds_read_b64_tr_b16 a[226:227], v12 offset:34816
    v_mfma_f32_16x16x32_bf16 v[100:103], a[52:55], v[48:51], v[100:103]
    s_waitcnt lgkmcnt(7)
    v_exp_f32 v107, v107
    v_mfma_f32_16x16x32_bf16 v[100:103], a[56:59], v[64:67], v[100:103]
    s_waitcnt lgkmcnt(6)
    ds_read_b64_tr_b16 a[104:105], v16 offset:24832
    v_cvt_pk_bf16_f32 v117, v106, v107
    v_mfma_f32_16x16x32_bf16 v[100:103], a[60:63], v[80:83], v[100:103]
    v_exp_f32 v108, v108
    v_mfma_f32_16x16x32_bf16 a[136:139], a[144:147], v[112:115], a[136:139]
    ds_read_b64_tr_b16 a[106:107], v16 offset:28928
    v_mfma_f32_16x16x32_bf16 v[192:195], a[64:67], v[112:115], v[192:195]
    v_exp_f32 v109, v109
    v_mfma_f32_16x16x32_bf16 v[196:199], a[68:71], v[112:115], v[196:199]
    ds_read_b64_tr_b16 a[108:109], v17 offset:24832
    v_cvt_pk_bf16_f32 v118, v108, v109
    v_mfma_f32_16x16x32_bf16 v[200:203], a[72:75], v[112:115], v[200:203]
    v_exp_f32 v110, v110
    v_mfma_f32_16x16x32_bf16 v[204:207], a[76:79], v[112:115], v[204:207]
    ds_read_b64_tr_b16 a[228:229], v13 offset:32768
    v_mfma_f32_16x16x32_bf16 v[208:211], a[80:83], v[112:115], v[208:211]
    v_exp_f32 v111, v111
    v_mfma_f32_16x16x32_bf16 v[212:215], a[84:87], v[112:115], v[212:215]
    ds_read_b64_tr_b16 a[110:111], v17 offset:28928
    v_cvt_pk_bf16_f32 v119, v110, v111
    v_mfma_f32_16x16x32_bf16 v[216:219], a[88:91], v[112:115], v[216:219]
    ds_read_b64_tr_b16 a[230:231], v13 offset:34816
    v_mfma_f32_16x16x32_bf16 v[220:223], a[92:95], v[112:115], v[220:223]
    s_mov_b64 s[64:65], 0
    v_exp_f32 v96, v96
    v_mfma_f32_16x16x32_bf16 v[104:107], a[32:35], v[36:39], 0
    ds_read_b64_tr_b16 a[112:113], v16 offset:25088
    v_mov_b32 v125, 0x2b800000
    v_mfma_f32_16x16x32_bf16 v[104:107], a[36:39], v[52:55], v[104:107]
    v_exp_f32 v97, v97
    v_mfma_f32_16x16x32_bf16 v[104:107], a[40:43], v[68:71], v[104:107]
    ds_read_b64_tr_b16 a[114:115], v16 offset:29184
    v_cvt_pk_bf16_f32 v112, v96, v97
    v_mfma_f32_16x16x32_bf16 v[104:107], a[44:47], v[84:87], v[104:107]
    v_exp_f32 v98, v98
    v_mfma_f32_16x16x32_bf16 v[108:111], a[48:51], v[36:39], 0
    ds_read_b64_tr_b16 a[232:233], v12 offset:33024
    v_mov_b32 v126, 0x53800000
    v_mfma_f32_16x16x32_bf16 v[108:111], a[52:55], v[52:55], v[108:111]
    v_exp_f32 v99, v99
    v_mfma_f32_16x16x32_bf16 v[108:111], a[56:59], v[68:71], v[108:111]
    ds_read_b64_tr_b16 a[116:117], v17 offset:25088
    v_cvt_pk_bf16_f32 v113, v98, v99
    v_mfma_f32_16x16x32_bf16 v[108:111], a[60:63], v[84:87], v[108:111]
    v_exp_f32 v100, v100
    v_mfma_f32_16x16x32_bf16 a[140:143], a[144:147], v[116:119], a[140:143]
    ds_read_b64_tr_b16 a[118:119], v17 offset:29184
    v_mfma_f32_16x16x32_bf16 v[224:227], a[64:67], v[116:119], v[224:227]
    v_exp_f32 v101, v101
    v_mfma_f32_16x16x32_bf16 v[228:231], a[68:71], v[116:119], v[228:231]
    ds_read_b64_tr_b16 a[120:121], v16 offset:25344
    v_cvt_pk_bf16_f32 v114, v100, v101
    v_mfma_f32_16x16x32_bf16 v[232:235], a[72:75], v[116:119], v[232:235]
    v_exp_f32 v102, v102
    v_mfma_f32_16x16x32_bf16 v[236:239], a[76:79], v[116:119], v[236:239]
    ds_read_b64_tr_b16 a[234:235], v12 offset:35072
    v_mfma_f32_16x16x32_bf16 v[240:243], a[80:83], v[116:119], v[240:243]
    v_exp_f32 v103, v103
    v_mfma_f32_16x16x32_bf16 v[244:247], a[84:87], v[116:119], v[244:247]
    ds_read_b64_tr_b16 a[122:123], v16 offset:29440
    v_cvt_pk_bf16_f32 v115, v102, v103
    v_mfma_f32_16x16x32_bf16 v[248:251], a[88:91], v[116:119], v[248:251]
    ds_read_b64_tr_b16 a[236:237], v13 offset:33024
    v_mfma_f32_16x16x32_bf16 v[252:255], a[92:95], v[116:119], v[252:255]
    v_exp_f32 v104, v104
    v_mfma_f32_16x16x32_bf16 v[96:99], a[32:35], v[40:43], 0
    ds_read_b64_tr_b16 a[124:125], v17 offset:25344
    v_mfma_f32_16x16x32_bf16 v[96:99], a[36:39], v[56:59], v[96:99]
    v_exp_f32 v105, v105
    v_mfma_f32_16x16x32_bf16 v[96:99], a[40:43], v[72:75], v[96:99]
    ds_read_b64_tr_b16 a[126:127], v17 offset:29440
    v_cvt_pk_bf16_f32 v116, v104, v105
    v_mfma_f32_16x16x32_bf16 v[96:99], a[44:47], v[88:91], v[96:99]
    v_exp_f32 v106, v106
    v_mfma_f32_16x16x32_bf16 v[100:103], a[48:51], v[40:43], 0
    ds_read_b64_tr_b16 a[238:239], v13 offset:35072
    v_mfma_f32_16x16x32_bf16 v[100:103], a[52:55], v[56:59], v[100:103]
    v_exp_f32 v107, v107
    v_mfma_f32_16x16x32_bf16 v[100:103], a[56:59], v[72:75], v[100:103]
    s_waitcnt lgkmcnt(15)
    v_cvt_pk_bf16_f32 v117, v106, v107
    v_mfma_f32_16x16x32_bf16 v[100:103], a[60:63], v[88:91], v[100:103]
    s_waitcnt vmcnt(7) lgkmcnt(0)
    v_exp_f32 v108, v108
    v_mfma_f32_16x16x32_bf16 a[128:131], a[144:147], v[112:115], a[128:131]
    s_barrier
    ds_read_b128 a[0:3], v18 offset:32768
    v_mfma_f32_16x16x32_bf16 v[128:131], a[96:99], v[112:115], v[128:131]
    v_exp_f32 v109, v109
    v_mfma_f32_16x16x32_bf16 v[132:135], a[100:103], v[112:115], v[132:135]
    ds_read_b128 a[4:7], v19 offset:32768
    v_cvt_pk_bf16_f32 v118, v108, v109
    v_mfma_f32_16x16x32_bf16 v[136:139], a[104:107], v[112:115], v[136:139]
    ds_read_b64_tr_b16 a[240:241], v12 offset:49152
    v_exp_f32 v110, v110
    v_mfma_f32_16x16x32_bf16 v[140:143], a[108:111], v[112:115], v[140:143]
    ds_read_b128 a[8:11], v20 offset:32768
    v_mfma_f32_16x16x32_bf16 v[144:147], a[112:115], v[112:115], v[144:147]
    s_add_u32 s82, s61, 65536
    ds_read_b64_tr_b16 a[242:243], v12 offset:51200
    v_exp_f32 v111, v111
    v_mfma_f32_16x16x32_bf16 v[148:151], a[116:119], v[112:115], v[148:151]
    ds_read_b128 a[12:15], v21 offset:32768
    v_cvt_pk_bf16_f32 v119, v110, v111
    v_mfma_f32_16x16x32_bf16 v[152:155], a[120:123], v[112:115], v[152:155]
    ds_read_b64_tr_b16 a[244:245], v13 offset:49152
    v_mfma_f32_16x16x32_bf16 v[156:159], a[124:127], v[112:115], v[156:159]
    ds_read_b64_tr_b16 a[246:247], v13 offset:51200
    v_exp_f32 v96, v96
    v_mfma_f32_16x16x32_bf16 v[104:107], a[32:35], v[44:47], 0
    ds_read_b128 a[16:19], v18 offset:36864
    v_mfma_f32_16x16x32_bf16 v[104:107], a[36:39], v[60:63], v[104:107]
    ds_read_b64_tr_b16 a[248:249], v12 offset:49408
    v_exp_f32 v97, v97
    v_mfma_f32_16x16x32_bf16 v[104:107], a[40:43], v[76:79], v[104:107]
    ds_read_b128 a[20:23], v19 offset:36864
    v_cvt_pk_bf16_f32 v112, v96, v97
    v_mfma_f32_16x16x32_bf16 v[104:107], a[44:47], v[92:95], v[104:107]
    ds_read_b64_tr_b16 a[250:251], v12 offset:51456
    v_exp_f32 v98, v98
    v_mfma_f32_16x16x32_bf16 v[108:111], a[48:51], v[44:47], 0
    s_waitcnt vmcnt(6)
    buffer_load_dword v28, v122, s[24:27], s79 offen
    v_mfma_f32_16x16x32_bf16 v[108:111], a[52:55], v[60:63], v[108:111]
    ds_read_b64_tr_b16 a[252:253], v13 offset:49408
    v_exp_f32 v99, v99
    v_mfma_f32_16x16x32_bf16 v[108:111], a[56:59], v[76:79], v[108:111]
    ds_read_b128 a[24:27], v20 offset:36864
    v_cvt_pk_bf16_f32 v113, v98, v99
    v_mfma_f32_16x16x32_bf16 v[108:111], a[60:63], v[92:95], v[108:111]
    ds_read_b64_tr_b16 a[254:255], v13 offset:51456
    v_exp_f32 v100, v100
    v_mfma_f32_16x16x32_bf16 a[132:135], a[144:147], v[116:119], a[132:135]
    ds_read_b128 a[28:31], v21 offset:36864
    v_mfma_f32_16x16x32_bf16 v[160:163], a[96:99], v[116:119], v[160:163]
    s_add_u32 m0, s62, 98304
    v_exp_f32 v101, v101
    v_mfma_f32_16x16x32_bf16 v[164:167], a[100:103], v[116:119], v[164:167]
    ds_read_b64_tr_b16 a[64:65], v16 offset:49152
    v_cvt_pk_bf16_f32 v114, v100, v101
    v_mfma_f32_16x16x32_bf16 v[168:171], a[104:107], v[116:119], v[168:171]
    v_exp_f32 v102, v102
    v_mfma_f32_16x16x32_bf16 v[172:175], a[108:111], v[116:119], v[172:175]
    global_load_dword v120, v[24:25], off
    v_mfma_f32_16x16x32_bf16 v[176:179], a[112:115], v[116:119], v[176:179]
    v_exp_f32 v103, v103
    v_mfma_f32_16x16x32_bf16 v[180:183], a[116:119], v[116:119], v[180:183]
    ds_read_b64_tr_b16 a[66:67], v16 offset:53248
    v_cvt_pk_bf16_f32 v115, v102, v103
    v_mfma_f32_16x16x32_bf16 v[184:187], a[120:123], v[116:119], v[184:187]
    buffer_load_dwordx4 v2, s[20:23], s82 offen offset:0 lds
    v_mfma_f32_16x16x32_bf16 v[188:191], a[124:127], v[116:119], v[188:191]
    s_waitcnt lgkmcnt(15)
    v_exp_f32 v104, v104
    v_mfma_f32_16x16x32_bf16 v[96:99], a[0:3], v[32:35], 0
    ds_read_b64_tr_b16 a[68:69], v17 offset:49152
    v_mfma_f32_16x16x32_bf16 v[96:99], a[4:7], v[48:51], v[96:99]
    s_waitcnt lgkmcnt(15)
    v_exp_f32 v105, v105
    v_mfma_f32_16x16x32_bf16 v[96:99], a[8:11], v[64:67], v[96:99]
    s_waitcnt lgkmcnt(13)
    ds_read_b64_tr_b16 a[70:71], v17 offset:53248
    v_cvt_pk_bf16_f32 v116, v104, v105
    v_mfma_f32_16x16x32_bf16 v[96:99], a[12:15], v[80:83], v[96:99]
    s_waitcnt lgkmcnt(6)
    v_exp_f32 v106, v106
    v_mfma_f32_16x16x32_bf16 v[100:103], a[16:19], v[32:35], 0
    buffer_load_dwordx4 v3, s[20:23], s82 offen offset:1024 lds
    v_mfma_f32_16x16x32_bf16 v[100:103], a[20:23], v[48:51], v[100:103]
    s_add_u32 s83, s61, 98304
    v_exp_f32 v107, v107
    v_mfma_f32_16x16x32_bf16 v[100:103], a[24:27], v[64:67], v[100:103]
    s_waitcnt lgkmcnt(4)
    ds_read_b64_tr_b16 a[72:73], v16 offset:49408
    v_cvt_pk_bf16_f32 v117, v106, v107
    v_mfma_f32_16x16x32_bf16 v[100:103], a[28:31], v[80:83], v[100:103]
    v_exp_f32 v108, v108
    v_mfma_f32_16x16x32_bf16 a[136:139], a[144:147], v[112:115], a[136:139]
    ds_read_b64_tr_b16 a[74:75], v16 offset:53504
    v_mfma_f32_16x16x32_bf16 v[192:195], a[96:99], v[112:115], v[192:195]
    v_exp_f32 v109, v109
    v_mfma_f32_16x16x32_bf16 v[196:199], a[100:103], v[112:115], v[196:199]
    ds_read_b64_tr_b16 a[76:77], v17 offset:49408
    v_cvt_pk_bf16_f32 v118, v108, v109
    v_mfma_f32_16x16x32_bf16 v[200:203], a[104:107], v[112:115], v[200:203]
    v_exp_f32 v110, v110
    v_mfma_f32_16x16x32_bf16 v[204:207], a[108:111], v[112:115], v[204:207]
    buffer_load_dwordx4 v4, s[20:23], s82 offen offset:2048 lds
    v_mfma_f32_16x16x32_bf16 v[208:211], a[112:115], v[112:115], v[208:211]
    v_exp_f32 v111, v111
    v_mfma_f32_16x16x32_bf16 v[212:215], a[116:119], v[112:115], v[212:215]
    ds_read_b64_tr_b16 a[78:79], v17 offset:53504
    v_cvt_pk_bf16_f32 v119, v110, v111
    v_mfma_f32_16x16x32_bf16 v[216:219], a[120:123], v[112:115], v[216:219]
    buffer_load_dwordx4 v5, s[20:23], s82 offen offset:3072 lds
    v_mfma_f32_16x16x32_bf16 v[220:223], a[124:127], v[112:115], v[220:223]
    v_exp_f32 v96, v96
    v_mfma_f32_16x16x32_bf16 v[104:107], a[0:3], v[36:39], 0
    s_add_u32 m0, s62, 114688
    ds_read_b64_tr_b16 a[80:81], v16 offset:49664
    v_mfma_f32_16x16x32_bf16 v[104:107], a[4:7], v[52:55], v[104:107]
    v_exp_f32 v97, v97
    v_mfma_f32_16x16x32_bf16 v[104:107], a[8:11], v[68:71], v[104:107]
    ds_read_b64_tr_b16 a[82:83], v16 offset:53760
    v_cvt_pk_bf16_f32 v112, v96, v97
    v_mfma_f32_16x16x32_bf16 v[104:107], a[12:15], v[84:87], v[104:107]
    v_exp_f32 v98, v98
    v_mfma_f32_16x16x32_bf16 v[108:111], a[16:19], v[36:39], 0
    buffer_load_dwordx4 v2, s[20:23], s83 offen offset:0 lds
    v_mfma_f32_16x16x32_bf16 v[108:111], a[20:23], v[52:55], v[108:111]
    v_exp_f32 v99, v99
    v_mfma_f32_16x16x32_bf16 v[108:111], a[24:27], v[68:71], v[108:111]
    ds_read_b64_tr_b16 a[84:85], v17 offset:49664
    v_cvt_pk_bf16_f32 v113, v98, v99
    v_mfma_f32_16x16x32_bf16 v[108:111], a[28:31], v[84:87], v[108:111]
    v_exp_f32 v100, v100
    v_mfma_f32_16x16x32_bf16 a[140:143], a[144:147], v[116:119], a[140:143]
    ds_read_b64_tr_b16 a[86:87], v17 offset:53760
    v_mfma_f32_16x16x32_bf16 v[224:227], a[96:99], v[116:119], v[224:227]
    v_exp_f32 v101, v101
    v_mfma_f32_16x16x32_bf16 v[228:231], a[100:103], v[116:119], v[228:231]
    ds_read_b64_tr_b16 a[88:89], v16 offset:49920
    v_cvt_pk_bf16_f32 v114, v100, v101
    v_mfma_f32_16x16x32_bf16 v[232:235], a[104:107], v[116:119], v[232:235]
    v_exp_f32 v102, v102
    v_mfma_f32_16x16x32_bf16 v[236:239], a[108:111], v[116:119], v[236:239]
    buffer_load_dwordx4 v3, s[20:23], s83 offen offset:1024 lds
    v_mfma_f32_16x16x32_bf16 v[240:243], a[112:115], v[116:119], v[240:243]
    v_exp_f32 v103, v103
    v_mfma_f32_16x16x32_bf16 v[244:247], a[116:119], v[116:119], v[244:247]
    ds_read_b64_tr_b16 a[90:91], v16 offset:54016
    v_cvt_pk_bf16_f32 v115, v102, v103
    v_mfma_f32_16x16x32_bf16 v[248:251], a[120:123], v[116:119], v[248:251]
    buffer_load_dwordx4 v4, s[20:23], s83 offen offset:2048 lds
    v_mfma_f32_16x16x32_bf16 v[252:255], a[124:127], v[116:119], v[252:255]
    v_exp_f32 v104, v104
    v_mfma_f32_16x16x32_bf16 v[96:99], a[0:3], v[40:43], 0
    ds_read_b64_tr_b16 a[92:93], v17 offset:49920
    v_mfma_f32_16x16x32_bf16 v[96:99], a[4:7], v[56:59], v[96:99]
    v_exp_f32 v105, v105
    v_mfma_f32_16x16x32_bf16 v[96:99], a[8:11], v[72:75], v[96:99]
    ds_read_b64_tr_b16 a[94:95], v17 offset:54016
    v_cvt_pk_bf16_f32 v116, v104, v105
    v_mfma_f32_16x16x32_bf16 v[96:99], a[12:15], v[88:91], v[96:99]
    v_exp_f32 v106, v106
    v_mfma_f32_16x16x32_bf16 v[100:103], a[16:19], v[40:43], 0
    buffer_load_dwordx4 v5, s[20:23], s83 offen offset:3072 lds
    v_mfma_f32_16x16x32_bf16 v[100:103], a[20:23], v[56:59], v[100:103]
    v_exp_f32 v107, v107
    v_mfma_f32_16x16x32_bf16 v[100:103], a[24:27], v[72:75], v[100:103]
    ds_read_b128 a[32:35], v18 offset:40960
    v_cvt_pk_bf16_f32 v117, v106, v107
    v_mfma_f32_16x16x32_bf16 v[100:103], a[28:31], v[88:91], v[100:103]
    v_exp_f32 v108, v108
    v_mfma_f32_16x16x32_bf16 a[128:131], a[144:147], v[112:115], a[128:131]
    s_waitcnt lgkmcnt(15)
    ds_read_b128 a[36:39], v19 offset:40960
    v_mfma_f32_16x16x32_bf16 v[128:131], a[64:67], v[112:115], v[128:131]
    s_waitcnt lgkmcnt(14)
    v_exp_f32 v109, v109
    v_mfma_f32_16x16x32_bf16 v[132:135], a[68:71], v[112:115], v[132:135]
    s_waitcnt lgkmcnt(12)
    ds_read_b128 a[40:43], v20 offset:40960
    v_cvt_pk_bf16_f32 v118, v108, v109
    v_mfma_f32_16x16x32_bf16 v[136:139], a[72:75], v[112:115], v[136:139]
    s_waitcnt lgkmcnt(11)
    v_exp_f32 v110, v110
    v_mfma_f32_16x16x32_bf16 v[140:143], a[76:79], v[112:115], v[140:143]
    s_waitcnt lgkmcnt(9)
    v_mfma_f32_16x16x32_bf16 v[144:147], a[80:83], v[112:115], v[144:147]
    s_waitcnt lgkmcnt(5)
    v_exp_f32 v111, v111
    v_mfma_f32_16x16x32_bf16 v[148:151], a[84:87], v[112:115], v[148:151]
    s_waitcnt vmcnt(14)
    ds_read_b128 a[44:47], v21 offset:40960
    v_cvt_pk_bf16_f32 v119, v110, v111
    v_mfma_f32_16x16x32_bf16 v[152:155], a[88:91], v[112:115], v[152:155]
    s_waitcnt lgkmcnt(4)
    v_mfma_f32_16x16x32_bf16 v[156:159], a[92:95], v[112:115], v[156:159]
    v_exp_f32 v96, v96
    s_mov_b64 exec, 1
    buffer_store_dword v30, v0, s[48:51], s70 offen sc1
    s_mov_b64 exec, -1
    v_mfma_f32_16x16x32_bf16 v[104:107], a[0:3], v[44:47], 0
    ds_read_b128 a[48:51], v18 offset:45056
    v_mfma_f32_16x16x32_bf16 v[104:107], a[4:7], v[60:63], v[104:107]
    v_exp_f32 v97, v97
    v_mfma_f32_16x16x32_bf16 v[104:107], a[8:11], v[76:79], v[104:107]
    ds_read_b128 a[52:55], v19 offset:45056
    v_cvt_pk_bf16_f32 v112, v96, v97
    v_mfma_f32_16x16x32_bf16 v[104:107], a[12:15], v[92:95], v[104:107]
    v_exp_f32 v98, v98
    v_mfma_f32_16x16x32_bf16 v[108:111], a[16:19], v[44:47], 0
    v_mfma_f32_16x16x32_bf16 v[108:111], a[20:23], v[60:63], v[108:111]
    v_exp_f32 v99, v99
    v_mfma_f32_16x16x32_bf16 v[108:111], a[24:27], v[76:79], v[108:111]
    ds_read_b128 a[56:59], v20 offset:45056
    v_cvt_pk_bf16_f32 v113, v98, v99
    v_mfma_f32_16x16x32_bf16 v[108:111], a[28:31], v[92:95], v[108:111]
    v_exp_f32 v100, v100
    v_mfma_f32_16x16x32_bf16 a[132:135], a[144:147], v[116:119], a[132:135]
    ds_read_b128 a[60:63], v21 offset:45056
    v_mfma_f32_16x16x32_bf16 v[160:163], a[64:67], v[116:119], v[160:163]
    ds_read_b64_tr_b16 a[0:1], v14 offset:0
    v_exp_f32 v101, v101
    v_mfma_f32_16x16x32_bf16 v[164:167], a[68:71], v[116:119], v[164:167]
    ds_read_b64_tr_b16 a[96:97], v16 offset:57344
    v_cvt_pk_bf16_f32 v114, v100, v101
    v_mfma_f32_16x16x32_bf16 v[168:171], a[72:75], v[116:119], v[168:171]
    ds_read_b64_tr_b16 a[2:3], v14 offset:2048
    v_exp_f32 v102, v102
    v_mfma_f32_16x16x32_bf16 v[172:175], a[76:79], v[116:119], v[172:175]
    ds_read_b64_tr_b16 a[4:5], v15 offset:0
    v_mfma_f32_16x16x32_bf16 v[176:179], a[80:83], v[116:119], v[176:179]
    ds_read_b64_tr_b16 a[6:7], v15 offset:2048
    v_exp_f32 v103, v103
    v_mfma_f32_16x16x32_bf16 v[180:183], a[84:87], v[116:119], v[180:183]
    ds_read_b64_tr_b16 a[98:99], v16 offset:61440
    v_cvt_pk_bf16_f32 v115, v102, v103
    v_mfma_f32_16x16x32_bf16 v[184:187], a[88:91], v[116:119], v[184:187]
    ds_read_b64_tr_b16 a[8:9], v14 offset:256
    v_mfma_f32_16x16x32_bf16 v[188:191], a[92:95], v[116:119], v[188:191]
    s_waitcnt lgkmcnt(14)
    ds_read_b64_tr_b16 a[10:11], v14 offset:2304
    v_exp_f32 v104, v104
    v_mfma_f32_16x16x32_bf16 v[96:99], a[32:35], v[32:35], 0
    s_waitcnt lgkmcnt(14)
    ds_read_b64_tr_b16 a[100:101], v17 offset:57344
    v_mfma_f32_16x16x32_bf16 v[96:99], a[36:39], v[48:51], v[96:99]
    s_waitcnt lgkmcnt(14)
    ds_read_b64_tr_b16 a[12:13], v15 offset:256
    v_exp_f32 v105, v105
L_hop1_7:
    s_cbranch_execz L_back1_0
    v_mfma_f32_16x16x32_bf16 v[96:99], a[40:43], v[64:67], v[96:99]
    s_waitcnt lgkmcnt(13)
    ds_read_b64_tr_b16 a[102:103], v17 offset:61440
    v_cvt_pk_bf16_f32 v116, v104, v105
    v_mfma_f32_16x16x32_bf16 v[96:99], a[44:47], v[80:83], v[96:99]
    s_waitcnt vmcnt(11)
    ds_read_b64_tr_b16 a[14:15], v15 offset:2304
    v_exp_f32 v106, v106
    v_mfma_f32_16x16x32_bf16 v[100:103], a[48:51], v[32:35], 0
    s_waitcnt lgkmcnt(14)
    ds_read_b64_tr_b16 a[16:17], v14 offset:16384
    v_mfma_f32_16x16x32_bf16 v[100:103], a[52:55], v[48:51], v[100:103]
    s_waitcnt lgkmcnt(14)
    ds_read_b64_tr_b16 a[18:19], v14 offset:18432
    v_exp_f32 v107, v107
    v_mfma_f32_16x16x32_bf16 v[100:103], a[56:59], v[64:67], v[100:103]
    s_waitcnt lgkmcnt(14)
    ds_read_b64_tr_b16 a[104:105], v16 offset:57600
    v_cvt_pk_bf16_f32 v117, v106, v107
    v_mfma_f32_16x16x32_bf16 v[100:103], a[60:63], v[80:83], v[100:103]
    ds_read_b64_tr_b16 a[20:21], v15 offset:16384
    v_exp_f32 v108, v108
    v_mfma_f32_16x16x32_bf16 a[136:139], a[144:147], v[112:115], a[136:139]
    s_waitcnt lgkmcnt(4)
    s_add_u32 m0, s62, 131072
    s_add_u32 s56, s61, 196736
    ds_read_b64_tr_b16 a[106:107], v16 offset:61696
    v_mfma_f32_16x16x32_bf16 v[192:195], a[64:67], v[112:115], v[192:195]
    ds_read_b64_tr_b16 a[22:23], v15 offset:18432
    v_exp_f32 v109, v109
    v_mfma_f32_16x16x32_bf16 v[196:199], a[68:71], v[112:115], v[196:199]
    ds_read_b64_tr_b16 a[108:109], v17 offset:57600
    v_cvt_pk_bf16_f32 v118, v108, v109
    v_mfma_f32_16x16x32_bf16 v[200:203], a[72:75], v[112:115], v[200:203]
    ds_read_b64_tr_b16 a[24:25], v14 offset:16640
    v_exp_f32 v110, v110
    v_mfma_f32_16x16x32_bf16 v[204:207], a[76:79], v[112:115], v[204:207]
    ds_read_b64_tr_b16 a[26:27], v14 offset:18688
    v_mfma_f32_16x16x32_bf16 v[208:211], a[80:83], v[112:115], v[208:211]
    ds_read_b64_tr_b16 a[28:29], v15 offset:16640
    v_exp_f32 v111, v111
    v_mfma_f32_16x16x32_bf16 v[212:215], a[84:87], v[112:115], v[212:215]
    ds_read_b64_tr_b16 a[110:111], v17 offset:61696
    v_cvt_pk_bf16_f32 v119, v110, v111
    v_mfma_f32_16x16x32_bf16 v[216:219], a[88:91], v[112:115], v[216:219]
    ds_read_b64_tr_b16 a[30:31], v15 offset:18688
    v_mfma_f32_16x16x32_bf16 v[220:223], a[92:95], v[112:115], v[220:223]
    buffer_load_dwordx4 v2, s[20:23], s56 offen offset:0 lds
    v_exp_f32 v96, v96
    v_mfma_f32_16x16x32_bf16 v[104:107], a[32:35], v[36:39], 0
    ds_read_b64_tr_b16 a[112:113], v16 offset:57856
    v_mfma_f32_16x16x32_bf16 v[104:107], a[36:39], v[52:55], v[104:107]
    buffer_load_dwordx4 v3, s[20:23], s56 offen offset:1024 lds
    v_exp_f32 v97, v97
    v_mfma_f32_16x16x32_bf16 v[104:107], a[40:43], v[68:71], v[104:107]
    ds_read_b64_tr_b16 a[114:115], v16 offset:61952
    v_cvt_pk_bf16_f32 v112, v96, v97
    v_mfma_f32_16x16x32_bf16 v[104:107], a[44:47], v[84:87], v[104:107]
    buffer_load_dwordx4 v4, s[20:23], s56 offen offset:2048 lds
    v_exp_f32 v98, v98
    v_mfma_f32_16x16x32_bf16 v[108:111], a[48:51], v[36:39], 0
    v_mfma_f32_16x16x32_bf16 v[108:111], a[52:55], v[52:55], v[108:111]
    buffer_load_dwordx4 v5, s[20:23], s56 offen offset:3072 lds
    v_exp_f32 v99, v99
    v_mfma_f32_16x16x32_bf16 v[108:111], a[56:59], v[68:71], v[108:111]
    s_waitcnt lgkmcnt(2)
    s_add_u32 m0, s62, 147456
    s_add_u32 s56, s61, 229504
    ds_read_b64_tr_b16 a[116:117], v17 offset:57856
    v_cvt_pk_bf16_f32 v113, v98, v99
    v_mfma_f32_16x16x32_bf16 v[108:111], a[60:63], v[84:87], v[108:111]
    v_exp_f32 v100, v100
    v_mfma_f32_16x16x32_bf16 a[140:143], a[144:147], v[116:119], a[140:143]
    ds_read_b64_tr_b16 a[118:119], v17 offset:61952
    v_mfma_f32_16x16x32_bf16 v[224:227], a[64:67], v[116:119], v[224:227]
    buffer_load_dwordx4 v2, s[20:23], s56 offen offset:0 lds
    v_exp_f32 v101, v101
    v_mfma_f32_16x16x32_bf16 v[228:231], a[68:71], v[116:119], v[228:231]
    ds_read_b64_tr_b16 a[120:121], v16 offset:58112
    v_cvt_pk_bf16_f32 v114, v100, v101
    v_mfma_f32_16x16x32_bf16 v[232:235], a[72:75], v[116:119], v[232:235]
    buffer_load_dwordx4 v3, s[20:23], s56 offen offset:1024 lds
    v_exp_f32 v102, v102
    v_mfma_f32_16x16x32_bf16 v[236:239], a[76:79], v[116:119], v[236:239]
    v_mfma_f32_16x16x32_bf16 v[240:243], a[80:83], v[116:119], v[240:243]
    buffer_load_dwordx4 v4, s[20:23], s56 offen offset:2048 lds
    v_exp_f32 v103, v103
    v_mfma_f32_16x16x32_bf16 v[244:247], a[84:87], v[116:119], v[244:247]
    ds_read_b64_tr_b16 a[122:123], v16 offset:62208
    v_cvt_pk_bf16_f32 v115, v102, v103
    v_mfma_f32_16x16x32_bf16 v[248:251], a[88:91], v[116:119], v[248:251]
    buffer_load_dwordx4 v5, s[20:23], s56 offen offset:3072 lds
    v_mfma_f32_16x16x32_bf16 v[252:255], a[92:95], v[116:119], v[252:255]
    s_waitcnt vmcnt(13)
    v_exp_f32 v104, v104
    v_mfma_f32_16x16x32_bf16 v[96:99], a[32:35], v[40:43], 0
    ds_read_b64_tr_b16 a[124:125], v17 offset:58112
    v_mfma_f32_16x16x32_bf16 v[96:99], a[36:39], v[56:59], v[96:99]
    ds_read_b64_tr_b16 a[64:65], v12 offset:32768
    v_exp_f32 v105, v105
    v_mfma_f32_16x16x32_bf16 v[96:99], a[40:43], v[72:75], v[96:99]
    ds_read_b64_tr_b16 a[126:127], v17 offset:62208
    v_cvt_pk_bf16_f32 v116, v104, v105
    v_mfma_f32_16x16x32_bf16 v[96:99], a[44:47], v[88:91], v[96:99]
    ds_read_b64_tr_b16 a[66:67], v12 offset:34816
    v_exp_f32 v106, v106
    v_mfma_f32_16x16x32_bf16 v[100:103], a[48:51], v[40:43], 0
    ds_read_b64_tr_b16 a[68:69], v13 offset:32768
    v_mfma_f32_16x16x32_bf16 v[100:103], a[52:55], v[56:59], v[100:103]
    ds_read_b64_tr_b16 a[70:71], v13 offset:34816
    v_exp_f32 v107, v107
    v_mfma_f32_16x16x32_bf16 v[100:103], a[56:59], v[72:75], v[100:103]
    ds_read_b64_tr_b16 a[72:73], v12 offset:33024
    v_cvt_pk_bf16_f32 v117, v106, v107
    v_mfma_f32_16x16x32_bf16 v[100:103], a[60:63], v[88:91], v[100:103]
    ds_read_b64_tr_b16 a[74:75], v12 offset:35072
    v_exp_f32 v108, v108
    v_mfma_f32_16x16x32_bf16 a[128:131], a[144:147], v[112:115], a[128:131]
    ds_read_b64_tr_b16 a[76:77], v13 offset:33024
    v_mfma_f32_16x16x32_bf16 v[128:131], a[96:99], v[112:115], v[128:131]
    s_waitcnt vmcnt(9)
    ds_read_b64_tr_b16 a[78:79], v13 offset:35072
    v_exp_f32 v109, v109
    v_mfma_f32_16x16x32_bf16 v[132:135], a[100:103], v[112:115], v[132:135]
    ds_read_b64_tr_b16 a[80:81], v12 offset:49152
    v_cvt_pk_bf16_f32 v118, v108, v109
    v_mfma_f32_16x16x32_bf16 v[136:139], a[104:107], v[112:115], v[136:139]
    ds_read_b64_tr_b16 a[82:83], v12 offset:51200
    v_exp_f32 v110, v110
    v_mfma_f32_16x16x32_bf16 v[140:143], a[108:111], v[112:115], v[140:143]
    s_waitcnt lgkmcnt(15)
    ds_read_b64_tr_b16 a[84:85], v13 offset:49152
    v_accvgpr_read_b32 v120, a128
    v_mfma_f32_16x16x32_bf16 v[144:147], a[112:115], v[112:115], v[144:147]
    s_waitcnt lgkmcnt(15)
    ds_read_b64_tr_b16 a[86:87], v13 offset:51200
    v_exp_f32 v111, v111
    v_mfma_f32_16x16x32_bf16 v[148:151], a[116:119], v[112:115], v[148:151]
    s_waitcnt lgkmcnt(14)
    ds_read_b64_tr_b16 a[88:89], v12 offset:49408
    v_cvt_pk_bf16_f32 v119, v110, v111
    v_mfma_f32_16x16x32_bf16 v[152:155], a[120:123], v[112:115], v[152:155]
    s_waitcnt lgkmcnt(12)
    ds_read_b64_tr_b16 a[90:91], v12 offset:51456
    v_med3_f32 v124, v120, v125, v126
    v_mfma_f32_16x16x32_bf16 v[156:159], a[124:127], v[112:115], v[156:159]
    ds_read_b64_tr_b16 a[92:93], v13 offset:49408
    v_exp_f32 v96, v96
    v_mfma_f32_16x16x32_bf16 v[104:107], a[32:35], v[44:47], 0
    ds_read_b64_tr_b16 a[94:95], v13 offset:51456
    v_cmp_neq_f32 vcc, v124, v120
    v_mfma_f32_16x16x32_bf16 v[104:107], a[36:39], v[60:63], v[104:107]
    v_exp_f32 v97, v97
    v_mfma_f32_16x16x32_bf16 v[104:107], a[40:43], v[76:79], v[104:107]
    v_cvt_pk_bf16_f32 v112, v96, v97
    v_mfma_f32_16x16x32_bf16 v[104:107], a[44:47], v[92:95], v[104:107]
    v_exp_f32 v98, v98
    v_mfma_f32_16x16x32_bf16 v[108:111], a[48:51], v[44:47], 0
    v_rcp_f32 v120, v120
    v_mfma_f32_16x16x32_bf16 v[108:111], a[52:55], v[60:63], v[108:111]
    s_or_b64 s[64:65], s[64:65], vcc
    v_exp_f32 v99, v99
    v_mfma_f32_16x16x32_bf16 v[108:111], a[56:59], v[76:79], v[108:111]
    v_cvt_pk_bf16_f32 v113, v98, v99
    v_mul_f32 v128, v128, v120
    v_mul_f32 v129, v129, v120
    v_mfma_f32_16x16x32_bf16 v[108:111], a[60:63], v[92:95], v[108:111]
    v_exp_f32 v100, v100
    v_mul_f32 v130, v130, v120
    v_mul_f32 v131, v131, v120
    v_mfma_f32_16x16x32_bf16 a[132:135], a[144:147], v[116:119], a[132:135]
    v_mul_f32 v132, v132, v120
    v_mul_f32 v133, v133, v120
    v_mfma_f32_16x16x32_bf16 v[160:163], a[96:99], v[116:119], v[160:163]
    v_exp_f32 v101, v101
    v_mul_f32 v134, v134, v120
    v_mul_f32 v135, v135, v120
    v_mfma_f32_16x16x32_bf16 v[164:167], a[100:103], v[116:119], v[164:167]
    v_cvt_pk_bf16_f32 v114, v100, v101
    v_cvt_pk_bf16_f32 v24, v128, v129
    v_cvt_pk_bf16_f32 v25, v130, v131
    v_mfma_f32_16x16x32_bf16 v[168:171], a[104:107], v[116:119], v[168:171]
    v_exp_f32 v102, v102
    v_cvt_pk_bf16_f32 v26, v132, v133
    v_cvt_pk_bf16_f32 v27, v134, v135
    v_mfma_f32_16x16x32_bf16 v[172:175], a[108:111], v[116:119], v[172:175]
    v_mfma_f32_16x16x32_bf16 v[176:179], a[112:115], v[116:119], v[176:179]
    ds_write_b128 v22, v[24:27] offset:0
    v_exp_f32 v103, v103
    v_mul_f32 v136, v136, v120
    v_mul_f32 v137, v137, v120
    v_mul_f32 v138, v138, v120
    v_mfma_f32_16x16x32_bf16 v[180:183], a[116:119], v[116:119], v[180:183]
    v_cvt_pk_bf16_f32 v115, v102, v103
    v_mul_f32 v139, v139, v120
    v_mul_f32 v140, v140, v120
    v_mfma_f32_16x16x32_bf16 v[184:187], a[120:123], v[116:119], v[184:187]
    v_mul_f32 v141, v141, v120
    v_mul_f32 v142, v142, v120
    v_mfma_f32_16x16x32_bf16 v[188:191], a[124:127], v[116:119], v[188:191]
    v_exp_f32 v104, v104
    v_mul_f32 v143, v143, v120
    v_cvt_pk_bf16_f32 v24, v136, v137
    v_mfma_f32_16x16x32_bf16 a[136:139], a[144:147], v[112:115], a[136:139]
    v_exp_f32 v105, v105
    v_cvt_pk_bf16_f32 v25, v138, v139
    v_cvt_pk_bf16_f32 v26, v140, v141
    v_mfma_f32_16x16x32_bf16 v[192:195], a[96:99], v[112:115], v[192:195]
    v_cvt_pk_bf16_f32 v116, v104, v105
    v_exp_f32 v106, v106
    v_cvt_pk_bf16_f32 v27, v142, v143
    v_mfma_f32_16x16x32_bf16 v[196:199], a[100:103], v[112:115], v[196:199]
    ds_write_b128 v22, v[24:27] offset:1024
    v_exp_f32 v107, v107
    v_mul_f32 v144, v144, v120
    v_mfma_f32_16x16x32_bf16 v[200:203], a[104:107], v[112:115], v[200:203]
    v_cvt_pk_bf16_f32 v117, v106, v107
    v_exp_f32 v108, v108
    v_mul_f32 v145, v145, v120
    v_mul_f32 v146, v146, v120
    v_mfma_f32_16x16x32_bf16 v[204:207], a[108:111], v[112:115], v[204:207]
    v_exp_f32 v109, v109
    v_mul_f32 v147, v147, v120
    v_mul_f32 v148, v148, v120
    v_mfma_f32_16x16x32_bf16 v[208:211], a[112:115], v[112:115], v[208:211]
    v_cvt_pk_bf16_f32 v118, v108, v109
    v_exp_f32 v110, v110
    v_mul_f32 v149, v149, v120
    v_mul_f32 v150, v150, v120
    v_mfma_f32_16x16x32_bf16 v[212:215], a[116:119], v[112:115], v[212:215]
    v_exp_f32 v111, v111
    v_mul_f32 v151, v151, v120
    v_cvt_pk_bf16_f32 v24, v144, v145
    v_mfma_f32_16x16x32_bf16 v[216:219], a[120:123], v[112:115], v[216:219]
    v_cvt_pk_bf16_f32 v119, v110, v111
    v_cvt_pk_bf16_f32 v25, v146, v147
    v_cvt_pk_bf16_f32 v26, v148, v149
    v_mfma_f32_16x16x32_bf16 v[220:223], a[124:127], v[112:115], v[220:223]
    v_cvt_pk_bf16_f32 v27, v150, v151
    v_mfma_f32_16x16x32_bf16 a[140:143], a[144:147], v[116:119], a[140:143]
    ds_write_b128 v22, v[24:27] offset:2048
    v_mul_f32 v152, v152, v120
    v_mul_f32 v153, v153, v120
    v_mfma_f32_16x16x32_bf16 v[224:227], a[96:99], v[116:119], v[224:227]
    v_mul_f32 v154, v154, v120
    v_mul_f32 v155, v155, v120
    v_mfma_f32_16x16x32_bf16 v[228:231], a[100:103], v[116:119], v[228:231]
    v_mul_f32 v156, v156, v120
    v_mul_f32 v157, v157, v120
    v_mfma_f32_16x16x32_bf16 v[232:235], a[104:107], v[116:119], v[232:235]
    v_mul_f32 v158, v158, v120
    v_mul_f32 v159, v159, v120
    v_mfma_f32_16x16x32_bf16 v[236:239], a[108:111], v[116:119], v[236:239]
    v_cvt_pk_bf16_f32 v24, v152, v153
    v_cvt_pk_bf16_f32 v25, v154, v155
    v_mfma_f32_16x16x32_bf16 v[240:243], a[112:115], v[116:119], v[240:243]
    v_cvt_pk_bf16_f32 v26, v156, v157
    v_cvt_pk_bf16_f32 v27, v158, v159
    v_mfma_f32_16x16x32_bf16 v[244:247], a[116:119], v[116:119], v[244:247]
    v_mfma_f32_16x16x32_bf16 v[248:251], a[120:123], v[116:119], v[248:251]
    ds_write_b128 v22, v[24:27] offset:3072
    v_mfma_f32_16x16x32_bf16 v[252:255], a[124:127], v[116:119], v[252:255]
    v_accvgpr_read_b32 v121, a132
    v_med3_f32 v124, v121, v125, v126
    v_cmp_neq_f32 vcc, v124, v121
    v_rcp_f32 v121, v121
    s_or_b64 s[64:65], s[64:65], vcc
    v_pk_mul_f32 v[160:161], v[160:161], v[120:121] op_sel:[0,1] op_sel_hi:[1,1]
    v_pk_mul_f32 v[162:163], v[162:163], v[120:121] op_sel:[0,1] op_sel_hi:[1,1]
    v_pk_mul_f32 v[164:165], v[164:165], v[120:121] op_sel:[0,1] op_sel_hi:[1,1]
    v_pk_mul_f32 v[166:167], v[166:167], v[120:121] op_sel:[0,1] op_sel_hi:[1,1]
    v_cvt_pk_bf16_f32 v96, v160, v161
    v_cvt_pk_bf16_f32 v97, v162, v163
    v_cvt_pk_bf16_f32 v98, v164, v165
    v_cvt_pk_bf16_f32 v99, v166, v167
    ds_write_b128 v22, v[96:99] offset:16384
    v_pk_mul_f32 v[168:169], v[168:169], v[120:121] op_sel:[0,1] op_sel_hi:[1,1]
    v_pk_mul_f32 v[170:171], v[170:171], v[120:121] op_sel:[0,1] op_sel_hi:[1,1]
    v_pk_mul_f32 v[172:173], v[172:173], v[120:121] op_sel:[0,1] op_sel_hi:[1,1]
    v_pk_mul_f32 v[174:175], v[174:175], v[120:121] op_sel:[0,1] op_sel_hi:[1,1]
    v_cvt_pk_bf16_f32 v100, v168, v169
    v_cvt_pk_bf16_f32 v101, v170, v171
    v_cvt_pk_bf16_f32 v102, v172, v173
    v_cvt_pk_bf16_f32 v103, v174, v175
    ds_write_b128 v22, v[100:103] offset:17408
    v_pk_mul_f32 v[176:177], v[176:177], v[120:121] op_sel:[0,1] op_sel_hi:[1,1]
    v_pk_mul_f32 v[178:179], v[178:179], v[120:121] op_sel:[0,1] op_sel_hi:[1,1]
    v_pk_mul_f32 v[180:181], v[180:181], v[120:121] op_sel:[0,1] op_sel_hi:[1,1]
    v_pk_mul_f32 v[182:183], v[182:183], v[120:121] op_sel:[0,1] op_sel_hi:[1,1]
    v_cvt_pk_bf16_f32 v104, v176, v177
    v_cvt_pk_bf16_f32 v105, v178, v179
    v_cvt_pk_bf16_f32 v106, v180, v181
    v_cvt_pk_bf16_f32 v107, v182, v183
    ds_write_b128 v22, v[104:107] offset:18432
    v_pk_mul_f32 v[184:185], v[184:185], v[120:121] op_sel:[0,1] op_sel_hi:[1,1]
    v_pk_mul_f32 v[186:187], v[186:187], v[120:121] op_sel:[0,1] op_sel_hi:[1,1]
    v_pk_mul_f32 v[188:189], v[188:189], v[120:121] op_sel:[0,1] op_sel_hi:[1,1]
    v_pk_mul_f32 v[190:191], v[190:191], v[120:121] op_sel:[0,1] op_sel_hi:[1,1]
    v_cvt_pk_bf16_f32 v108, v184, v185
    v_cvt_pk_bf16_f32 v109, v186, v187
    v_cvt_pk_bf16_f32 v110, v188, v189
    v_cvt_pk_bf16_f32 v111, v190, v191
    ds_write_b128 v22, v[108:111] offset:19456
    v_accvgpr_read_b32 v122, a136
    v_med3_f32 v124, v122, v125, v126
    v_cmp_neq_f32 vcc, v124, v122
    v_rcp_f32 v122, v122
    s_or_b64 s[64:65], s[64:65], vcc
    v_pk_mul_f32 v[192:193], v[192:193], v[122:123] op_sel_hi:[1,0]
    v_pk_mul_f32 v[194:195], v[194:195], v[122:123] op_sel_hi:[1,0]
    v_pk_mul_f32 v[196:197], v[196:197], v[122:123] op_sel_hi:[1,0]
    v_pk_mul_f32 v[198:199], v[198:199], v[122:123] op_sel_hi:[1,0]
    v_cvt_pk_bf16_f32 v96, v192, v193
    v_cvt_pk_bf16_f32 v97, v194, v195
    v_cvt_pk_bf16_f32 v98, v196, v197
    v_cvt_pk_bf16_f32 v99, v198, v199
    ds_write_b128 v22, v[96:99] offset:32768
    v_pk_mul_f32 v[200:201], v[200:201], v[122:123] op_sel_hi:[1,0]
    v_pk_mul_f32 v[202:203], v[202:203], v[122:123] op_sel_hi:[1,0]
    v_pk_mul_f32 v[204:205], v[204:205], v[122:123] op_sel_hi:[1,0]
    v_pk_mul_f32 v[206:207], v[206:207], v[122:123] op_sel_hi:[1,0]
    v_cvt_pk_bf16_f32 v100, v200, v201
    v_cvt_pk_bf16_f32 v101, v202, v203
    v_cvt_pk_bf16_f32 v102, v204, v205
    v_cvt_pk_bf16_f32 v103, v206, v207
    ds_write_b128 v22, v[100:103] offset:33792
    v_pk_mul_f32 v[208:209], v[208:209], v[122:123] op_sel_hi:[1,0]
    v_pk_mul_f32 v[210:211], v[210:211], v[122:123] op_sel_hi:[1,0]
    v_pk_mul_f32 v[212:213], v[212:213], v[122:123] op_sel_hi:[1,0]
    v_pk_mul_f32 v[214:215], v[214:215], v[122:123] op_sel_hi:[1,0]
    v_cvt_pk_bf16_f32 v104, v208, v209
    v_cvt_pk_bf16_f32 v105, v210, v211
    v_cvt_pk_bf16_f32 v106, v212, v213
    v_cvt_pk_bf16_f32 v107, v214, v215
    ds_write_b128 v22, v[104:107] offset:34816
    v_pk_mul_f32 v[216:217], v[216:217], v[122:123] op_sel_hi:[1,0]
    v_pk_mul_f32 v[218:219], v[218:219], v[122:123] op_sel_hi:[1,0]
    v_pk_mul_f32 v[220:221], v[220:221], v[122:123] op_sel_hi:[1,0]
    v_pk_mul_f32 v[222:223], v[222:223], v[122:123] op_sel_hi:[1,0]
    v_cvt_pk_bf16_f32 v108, v216, v217
    v_cvt_pk_bf16_f32 v109, v218, v219
    v_cvt_pk_bf16_f32 v110, v220, v221
    v_cvt_pk_bf16_f32 v111, v222, v223
    ds_write_b128 v22, v[108:111] offset:35840
    v_accvgpr_read_b32 v123, a140
    v_med3_f32 v124, v123, v125, v126
    v_cmp_neq_f32 vcc, v124, v123
    v_rcp_f32 v123, v123
    s_or_b64 s[64:65], s[64:65], vcc
    v_pk_mul_f32 v[224:225], v[224:225], v[122:123] op_sel:[0,1] op_sel_hi:[1,1]
    v_pk_mul_f32 v[226:227], v[226:227], v[122:123] op_sel:[0,1] op_sel_hi:[1,1]
    v_pk_mul_f32 v[228:229], v[228:229], v[122:123] op_sel:[0,1] op_sel_hi:[1,1]
    v_pk_mul_f32 v[230:231], v[230:231], v[122:123] op_sel:[0,1] op_sel_hi:[1,1]
    v_cvt_pk_bf16_f32 v96, v224, v225
    v_cvt_pk_bf16_f32 v97, v226, v227
    v_cvt_pk_bf16_f32 v98, v228, v229
    v_cvt_pk_bf16_f32 v99, v230, v231
    ds_write_b128 v22, v[96:99] offset:49152
    v_pk_mul_f32 v[232:233], v[232:233], v[122:123] op_sel:[0,1] op_sel_hi:[1,1]
    v_pk_mul_f32 v[234:235], v[234:235], v[122:123] op_sel:[0,1] op_sel_hi:[1,1]
    v_pk_mul_f32 v[236:237], v[236:237], v[122:123] op_sel:[0,1] op_sel_hi:[1,1]
    v_pk_mul_f32 v[238:239], v[238:239], v[122:123] op_sel:[0,1] op_sel_hi:[1,1]
    v_cvt_pk_bf16_f32 v100, v232, v233
    v_cvt_pk_bf16_f32 v101, v234, v235
    v_cvt_pk_bf16_f32 v102, v236, v237
    v_cvt_pk_bf16_f32 v103, v238, v239
    ds_write_b128 v22, v[100:103] offset:50176
    v_pk_mul_f32 v[240:241], v[240:241], v[122:123] op_sel:[0,1] op_sel_hi:[1,1]
    v_pk_mul_f32 v[242:243], v[242:243], v[122:123] op_sel:[0,1] op_sel_hi:[1,1]
    v_pk_mul_f32 v[244:245], v[244:245], v[122:123] op_sel:[0,1] op_sel_hi:[1,1]
    v_pk_mul_f32 v[246:247], v[246:247], v[122:123] op_sel:[0,1] op_sel_hi:[1,1]
    v_cvt_pk_bf16_f32 v104, v240, v241
    v_cvt_pk_bf16_f32 v105, v242, v243
    v_cvt_pk_bf16_f32 v106, v244, v245
    v_cvt_pk_bf16_f32 v107, v246, v247
    ds_write_b128 v22, v[104:107] offset:51200
    v_pk_mul_f32 v[248:249], v[248:249], v[122:123] op_sel:[0,1] op_sel_hi:[1,1]
    v_pk_mul_f32 v[250:251], v[250:251], v[122:123] op_sel:[0,1] op_sel_hi:[1,1]
    v_pk_mul_f32 v[252:253], v[252:253], v[122:123] op_sel:[0,1] op_sel_hi:[1,1]
    v_pk_mul_f32 v[254:255], v[254:255], v[122:123] op_sel:[0,1] op_sel_hi:[1,1]
    v_cvt_pk_bf16_f32 v108, v248, v249
    v_cvt_pk_bf16_f32 v109, v250, v251
    v_cvt_pk_bf16_f32 v110, v252, v253
    v_cvt_pk_bf16_f32 v111, v254, v255
    ds_write_b128 v22, v[108:111] offset:52224
    s_cmp_lg_u64 s[64:65], 0
    s_cbranch_scc1 L_slow
L_join:
    s_waitcnt lgkmcnt(0)
    s_barrier
    ds_read_b128 a[96:99], v23 offset:0
    ds_read_b128 a[100:103], v23 offset:16384
    ds_read_b128 a[104:107], v23 offset:32768
    ds_read_b128 a[108:111], v23 offset:49152
    ds_read_b128 a[112:115], v23 offset:1024
    ds_read_b128 a[116:119], v23 offset:17408
    ds_read_b128 a[120:123], v23 offset:33792
    ds_read_b128 a[124:127], v23 offset:50176
    ds_read_b128 a[128:131], v23 offset:2048
    s_waitcnt lgkmcnt(8)
    v_mfma_f32_16x16x32_bf16 v[128:131], a[0:3], a[96:99], 0
    s_waitcnt lgkmcnt(7)
    s_add_u32 s82, s61, 295040
    v_mfma_f32_16x16x32_bf16 v[144:147], a[0:3], a[100:103], 0
    s_waitcnt lgkmcnt(6)
    s_waitcnt vmcnt(4)
    ds_read_b64_tr_b16 v[32:33], v14 offset:0
    v_bfe_u32 v24, v0, 3, 1
    v_mfma_f32_16x16x32_bf16 v[160:163], a[0:3], a[104:107], 0
    s_waitcnt lgkmcnt(6)
    s_add_u32 s83, s61, 262272
    ds_read_b64_tr_b16 v[34:35], v14 offset:2048
    v_lshlrev_b32 v24, 14, v24
    v_mfma_f32_16x16x32_bf16 v[176:179], a[0:3], a[108:111], 0
    s_add_u32 m0, s62, 98304
    ds_read_b128 a[144:147], v23 offset:3072
    v_lshrrev_b32 v26, 4, v0
    v_mfma_f32_16x16x32_bf16 v[132:135], a[4:7], a[96:99], 0
    buffer_load_dwordx4 v2, s[20:23], s83 offen offset:0 lds
    v_mfma_f32_16x16x32_bf16 v[148:151], a[4:7], a[100:103], 0
    ds_read_b64_tr_b16 v[36:37], v15 offset:0
    v_lshl_add_u32 v24, v26, 7, v24
    v_mfma_f32_16x16x32_bf16 v[164:167], a[4:7], a[104:107], 0
    ds_read_b64_tr_b16 v[38:39], v15 offset:2048
    v_and_b32 v26, 7, v0
    v_mfma_f32_16x16x32_bf16 v[180:183], a[4:7], a[108:111], 0
    ds_read_b128 a[132:135], v23 offset:18432
    v_lshl_add_u32 v24, v26, 4, v24
    v_mfma_f32_16x16x32_bf16 v[136:139], a[8:11], a[96:99], 0
    buffer_load_dwordx4 v3, s[20:23], s83 offen offset:1024 lds
    v_mfma_f32_16x16x32_bf16 v[152:155], a[8:11], a[100:103], 0
    ds_read_b64_tr_b16 v[40:41], v14 offset:256
    v_lshrrev_b32 v21, 5, v0
    v_mfma_f32_16x16x32_bf16 v[168:171], a[8:11], a[104:107], 0
    ds_read_b64_tr_b16 v[42:43], v14 offset:2304
    v_lshlrev_b32 v21, 22, v21
    v_mfma_f32_16x16x32_bf16 v[184:187], a[8:11], a[108:111], 0
    ds_read_b128 a[148:151], v23 offset:19456
    v_and_b32 v26, 31, v0
    v_mfma_f32_16x16x32_bf16 v[140:143], a[12:15], a[96:99], 0
    buffer_load_dwordx4 v4, s[20:23], s83 offen offset:2048 lds
    v_mfma_f32_16x16x32_bf16 v[156:159], a[12:15], a[100:103], 0
    s_waitcnt lgkmcnt(12)
    ds_read_b64_tr_b16 v[44:45], v15 offset:256
    v_lshl_add_u32 v21, v26, 4, v21
    v_mfma_f32_16x16x32_bf16 v[172:175], a[12:15], a[104:107], 0
    s_lshl_b32 s57, s54, 15
    ds_read_b64_tr_b16 v[46:47], v15 offset:2304
    v_mfma_f32_16x16x32_bf16 v[188:191], a[12:15], a[108:111], 0
    s_lshl_b32 s55, s52, 9
    ds_read_b128 a[136:139], v23 offset:34816
    v_mfma_f32_16x16x32_bf16 v[128:131], a[16:19], a[112:115], v[128:131]
    buffer_load_dwordx4 v5, s[20:23], s83 offen offset:3072 lds
    v_mfma_f32_16x16x32_bf16 v[144:147], a[16:19], a[116:119], v[144:147]
    s_waitcnt lgkmcnt(14)
    s_waitcnt vmcnt(4)
    ds_read_b64_tr_b16 v[48:49], v14 offset:16384
    v_mfma_f32_16x16x32_bf16 v[160:163], a[16:19], a[120:123], v[160:163]
    s_waitcnt lgkmcnt(14)
    s_add_u32 m0, s62, 114688
    ds_read_b64_tr_b16 v[50:51], v14 offset:18432
    v_mfma_f32_16x16x32_bf16 v[176:179], a[16:19], a[124:127], v[176:179]
    s_add_u32 s83, s61, 327680
    ds_read_b128 a[152:155], v23 offset:35840
    v_mfma_f32_16x16x32_bf16 v[132:135], a[20:23], a[112:115], v[132:135]
    buffer_load_dwordx4 v2, s[20:23], s82 offen offset:0 lds
    v_mfma_f32_16x16x32_bf16 v[148:151], a[20:23], a[116:119], v[148:151]
    s_add_u32 s57, s57, s55
    ds_read_b64_tr_b16 v[52:53], v15 offset:16384
    v_mfma_f32_16x16x32_bf16 v[164:167], a[20:23], a[120:123], v[164:167]
    s_add_u32 s57, s57, 16777216
    ds_read_b64_tr_b16 v[54:55], v15 offset:18432
    v_mfma_f32_16x16x32_bf16 v[180:183], a[20:23], a[124:127], v[180:183]
    s_lshl_b32 s66, s53, 11
    ds_read_b128 a[140:143], v23 offset:51200
    v_mfma_f32_16x16x32_bf16 v[136:139], a[24:27], a[112:115], v[136:139]
    buffer_load_dwordx4 v3, s[20:23], s82 offen offset:1024 lds
    v_mfma_f32_16x16x32_bf16 v[152:155], a[24:27], a[116:119], v[152:155]
    s_add_u32 s66, s66, s57
    ds_read_b64_tr_b16 v[56:57], v14 offset:16640
    v_mfma_f32_16x16x32_bf16 v[168:171], a[24:27], a[120:123], v[168:171]
    s_xor_b32 s80, s66, 14336
    ds_read_b64_tr_b16 v[58:59], v14 offset:18688
    v_bfe_u32 v22, v0, 3, 1
    v_mfma_f32_16x16x32_bf16 v[184:187], a[24:27], a[124:127], v[184:187]
    ds_read_b128 a[156:159], v23 offset:52224
    v_lshlrev_b32 v22, 30, v22
    v_mfma_f32_16x16x32_bf16 v[140:143], a[28:31], a[112:115], v[140:143]
    buffer_load_dwordx4 v4, s[20:23], s82 offen offset:2048 lds
    v_mfma_f32_16x16x32_bf16 v[156:159], a[28:31], a[116:119], v[156:159]
    ds_read_b64_tr_b16 v[60:61], v15 offset:16640
    v_lshrrev_b32 v26, 4, v0
    v_mfma_f32_16x16x32_bf16 v[172:175], a[28:31], a[120:123], v[172:175]
    ds_read_b64_tr_b16 v[62:63], v15 offset:18688
    v_lshl_add_u32 v22, v26, 7, v22
    v_mfma_f32_16x16x32_bf16 v[188:191], a[28:31], a[124:127], v[188:191]
    s_waitcnt lgkmcnt(14)
    ds_read_b128 a[32:35], v23 offset:4096
    v_and_b32 v26, 7, v0
    v_mfma_f32_16x16x32_bf16 v[128:131], a[64:67], a[128:131], v[128:131]
    buffer_load_dwordx4 v5, s[20:23], s82 offen offset:3072 lds
    v_mfma_f32_16x16x32_bf16 v[128:131], a[80:83], a[144:147], v[128:131]
    s_add_u32 s82, s61, 360448
    v_lshl_add_u32 v22, v26, 4, v22
    v_mfma_f32_16x16x32_bf16 v[144:147], a[64:67], a[132:135], v[144:147]
    s_mov_b32 s96, s92
    v_lshlrev_b32 v10, 4, v0
    v_min_u32 v25, 24, v31
    v_mfma_f32_16x16x32_bf16 v[144:147], a[80:83], a[148:151], v[144:147]
    s_waitcnt lgkmcnt(12)
    s_add_u32 m0, s62, 65536
    ds_read_b128 a[48:51], v23 offset:5120
    v_mfma_f32_16x16x32_bf16 v[160:163], a[64:67], a[136:139], v[160:163]
    s_waitcnt lgkmcnt(10)
    buffer_load_dwordx4 v2, s[20:23], s83 offen offset:0 lds
    v_mfma_f32_16x16x32_bf16 v[160:163], a[80:83], a[152:155], v[160:163]
    s_waitcnt lgkmcnt(4)
    v_mfma_f32_16x16x32_bf16 v[176:179], a[64:67], a[140:143], v[176:179]
    buffer_load_dwordx4 v3, s[20:23], s83 offen offset:1024 lds
    v_mfma_f32_16x16x32_bf16 v[176:179], a[80:83], a[156:159], v[176:179]
    s_xor_b32 s55, s53, 7
    ds_read_b128 a[36:39], v23 offset:20480
    v_xor_b32 v28, s55, v0
    v_mfma_f32_16x16x32_bf16 v[132:135], a[68:71], a[128:131], v[132:135]
    buffer_load_dwordx4 v4, s[20:23], s83 offen offset:2048 lds
    v_mfma_f32_16x16x32_bf16 v[132:135], a[84:87], a[144:147], v[132:135]
    v_lshl_add_u32 v28, v28, 9, v31
    v_mfma_f32_16x16x32_bf16 v[148:151], a[68:71], a[132:135], v[148:151]
    buffer_load_dwordx4 v5, s[20:23], s83 offen offset:3072 lds
    v_mfma_f32_16x16x32_bf16 v[148:151], a[84:87], a[148:151], v[148:151]
    s_add_u32 m0, s62, 81920
    ds_read_b128 a[52:55], v23 offset:21504
    v_mfma_f32_16x16x32_bf16 v[164:167], a[68:71], a[136:139], v[164:167]
    buffer_load_dwordx4 v2, s[20:23], s82 offen offset:0 lds
    v_mfma_f32_16x16x32_bf16 v[164:167], a[84:87], a[152:155], v[164:167]
    s_lshl_b32 s57, s52, 7
    v_mfma_f32_16x16x32_bf16 v[180:183], a[68:71], a[140:143], v[180:183]
    buffer_load_dwordx4 v3, s[20:23], s82 offen offset:1024 lds
    v_mfma_f32_16x16x32_bf16 v[180:183], a[84:87], a[156:159], v[180:183]
    s_add_u32 s83, s61, 393216
    ds_read_b128 a[40:43], v23 offset:36864
    v_mfma_f32_16x16x32_bf16 v[136:139], a[72:75], a[128:131], v[136:139]
    buffer_load_dwordx4 v4, s[20:23], s82 offen offset:2048 lds
    v_mfma_f32_16x16x32_bf16 v[136:139], a[88:91], a[144:147], v[136:139]
    s_waitcnt vmcnt(11)
    ds_read_b64_tr_b16 v[64:65], v12 offset:32768
    v_mfma_f32_16x16x32_bf16 v[152:155], a[72:75], a[132:135], v[152:155]
    s_add_u32 s57, s57, 65536
    ds_read_b64_tr_b16 v[66:67], v12 offset:34816
    v_mfma_f32_16x16x32_bf16 v[152:155], a[88:91], a[148:151], v[152:155]
    s_lshl_b32 s70, s54, 12
    ds_read_b128 a[56:59], v23 offset:37888
    v_mfma_f32_16x16x32_bf16 v[168:171], a[72:75], a[136:139], v[168:171]
    buffer_load_dwordx4 v5, s[20:23], s82 offen offset:3072 lds
    v_mfma_f32_16x16x32_bf16 v[168:171], a[88:91], a[152:155], v[168:171]
    ds_read_b64_tr_b16 v[68:69], v13 offset:32768
    v_mfma_f32_16x16x32_bf16 v[184:187], a[72:75], a[140:143], v[184:187]
    s_add_u32 m0, s62, 131072
    ds_read_b64_tr_b16 v[70:71], v13 offset:34816
    v_mfma_f32_16x16x32_bf16 v[184:187], a[88:91], a[156:159], v[184:187]
    s_add_u32 s82, s61, 425984
    ds_read_b128 a[44:47], v23 offset:53248
    v_mfma_f32_16x16x32_bf16 v[140:143], a[76:79], a[128:131], v[140:143]
    buffer_load_dwordx4 v2, s[20:23], s83 offen offset:0 lds
    v_mfma_f32_16x16x32_bf16 v[140:143], a[92:95], a[144:147], v[140:143]
    s_add_u32 s70, s70, s57
    ds_read_b64_tr_b16 v[72:73], v12 offset:33024
    v_mfma_f32_16x16x32_bf16 v[156:159], a[76:79], a[132:135], v[156:159]
    s_lshl_b32 s84, s3, 9
    ds_read_b64_tr_b16 v[74:75], v12 offset:35072
    v_mfma_f32_16x16x32_bf16 v[156:159], a[92:95], a[148:151], v[156:159]
    s_add_u32 s84, s84, s57
    ds_read_b128 a[60:63], v23 offset:54272
    v_mfma_f32_16x16x32_bf16 v[172:175], a[76:79], a[136:139], v[172:175]
    buffer_load_dwordx4 v3, s[20:23], s83 offen offset:1024 lds
    v_mfma_f32_16x16x32_bf16 v[172:175], a[92:95], a[152:155], v[172:175]
    s_and_b32 s53, s2, 7
    ds_read_b64_tr_b16 v[76:77], v13 offset:33024
    v_mfma_f32_16x16x32_bf16 v[188:191], a[76:79], a[140:143], v[188:191]
    s_lshr_b32 s54, s2, 3
    ds_read_b64_tr_b16 v[78:79], v13 offset:35072
    v_mfma_f32_16x16x32_bf16 v[188:191], a[92:95], a[156:159], v[188:191]
L_hop1_8:
    s_cbranch_execz L_back1_0
    s_waitcnt lgkmcnt(15)
    s_mul_i32 s71, s73, 14
    ds_read_b128 a[0:3], v23 offset:6144
    v_mfma_f32_16x16x32_bf16 v[128:131], a[160:163], a[32:35], v[128:131]
    s_waitcnt lgkmcnt(15)
    buffer_load_dwordx4 v4, s[20:23], s83 offen offset:2048 lds
    v_mfma_f32_16x16x32_bf16 v[128:131], a[176:179], a[48:51], v[128:131]
    s_waitcnt lgkmcnt(14)
    s_waitcnt vmcnt(11)
    ds_read_b64_tr_b16 v[80:81], v12 offset:49152
    v_mfma_f32_16x16x32_bf16 v[144:147], a[160:163], a[36:39], v[144:147]
    s_waitcnt lgkmcnt(14)
    s_add_u32 s71, s71, s75
    ds_read_b64_tr_b16 v[82:83], v12 offset:51200
    v_mfma_f32_16x16x32_bf16 v[144:147], a[176:179], a[52:55], v[144:147]
    s_waitcnt lgkmcnt(14)
    s_lshl_b32 s71, s71, 7
    ds_read_b128 a[16:19], v23 offset:7168
    v_mfma_f32_16x16x32_bf16 v[160:163], a[160:163], a[40:43], v[160:163]
    s_waitcnt lgkmcnt(12)
    buffer_load_dwordx4 v5, s[20:23], s83 offen offset:3072 lds
    v_mfma_f32_16x16x32_bf16 v[160:163], a[176:179], a[56:59], v[160:163]
    s_waitcnt lgkmcnt(9)
    ds_read_b64_tr_b16 v[84:85], v13 offset:49152
    v_mfma_f32_16x16x32_bf16 v[176:179], a[160:163], a[44:47], v[176:179]
    s_waitcnt lgkmcnt(7)
    s_add_u32 m0, s62, 147456
    ds_read_b64_tr_b16 v[86:87], v13 offset:51200
    v_mfma_f32_16x16x32_bf16 v[176:179], a[176:179], a[60:63], v[176:179]
    s_add_u32 s83, s61, 458752
    ds_read_b128 a[4:7], v23 offset:22528
    v_mfma_f32_16x16x32_bf16 v[132:135], a[164:167], a[32:35], v[132:135]
    buffer_load_dwordx4 v2, s[20:23], s82 offen offset:0 lds
    v_mfma_f32_16x16x32_bf16 v[132:135], a[180:183], a[48:51], v[132:135]
    s_add_u32 s71, s71, 196608
    ds_read_b64_tr_b16 v[88:89], v12 offset:49408
    v_mfma_f32_16x16x32_bf16 v[148:151], a[164:167], a[36:39], v[148:151]
    s_lshl_b32 s79, s75, 8
    ds_read_b64_tr_b16 v[90:91], v12 offset:51456
    v_mfma_f32_16x16x32_bf16 v[148:151], a[180:183], a[52:55], v[148:151]
    s_mul_i32 s55, s52, 114688
    ds_read_b128 a[20:23], v23 offset:23552
    v_mfma_f32_16x16x32_bf16 v[164:167], a[164:167], a[40:43], v[164:167]
    buffer_load_dwordx4 v3, s[20:23], s82 offen offset:1024 lds
    v_mfma_f32_16x16x32_bf16 v[164:167], a[180:183], a[56:59], v[164:167]
    s_add_u32 s79, s79, s55
    ds_read_b64_tr_b16 v[92:93], v13 offset:49408
    v_bfe_u32 v6, v0, 2, 2
    v_mfma_f32_16x16x32_bf16 v[180:183], a[164:167], a[44:47], v[180:183]
    ds_read_b64_tr_b16 v[94:95], v13 offset:51456
    v_mul_u32_u24 v6, 3584, v6
    v_mfma_f32_16x16x32_bf16 v[180:183], a[180:183], a[60:63], v[180:183]
    ds_read_b128 a[8:11], v23 offset:38912
    v_bfe_u32 v26, v0, 4, 1
    v_mfma_f32_16x16x32_bf16 v[136:139], a[168:171], a[32:35], v[136:139]
    buffer_load_dwordx4 v4, s[20:23], s82 offen offset:2048 lds
    v_mfma_f32_16x16x32_bf16 v[136:139], a[184:187], a[48:51], v[136:139]
    s_waitcnt vmcnt(11)
    ds_read_b64_tr_b16 v[96:97], v12 offset:0
    v_lshl_add_u32 v6, v26, 6, v6
    v_mfma_f32_16x16x32_bf16 v[152:155], a[168:171], a[36:39], v[152:155]
    ds_read_b64_tr_b16 v[98:99], v12 offset:2048
    v_lshrrev_b32 v26, 5, v0
    v_mfma_f32_16x16x32_bf16 v[152:155], a[184:187], a[52:55], v[152:155]
    ds_read_b128 a[24:27], v23 offset:39936
    v_mul_u32_u24 v26, 14336, v26
    v_mfma_f32_16x16x32_bf16 v[168:171], a[168:171], a[40:43], v[168:171]
    buffer_load_dwordx4 v5, s[20:23], s82 offen offset:3072 lds
    v_mfma_f32_16x16x32_bf16 v[168:171], a[184:187], a[56:59], v[168:171]
    s_waitcnt lgkmcnt(15)
    ds_read_b64_tr_b16 v[100:101], v13 offset:0
    v_add_u32 v6, v6, v26
    v_mfma_f32_16x16x32_bf16 v[184:187], a[168:171], a[44:47], v[184:187]
    s_add_u32 m0, s62, 98304
    ds_read_b64_tr_b16 v[102:103], v13 offset:2048
    v_lshrrev_b32 v26, 4, v0
    v_mfma_f32_16x16x32_bf16 v[184:187], a[184:187], a[60:63], v[184:187]
    s_add_u32 s82, s61, 491520
    ds_read_b128 a[12:15], v23 offset:55296
    v_and_b32 v26, 2, v26
    v_mfma_f32_16x16x32_bf16 v[140:143], a[172:175], a[32:35], v[140:143]
    buffer_load_dwordx4 v2, s[20:23], s83 offen offset:0 lds
    v_mfma_f32_16x16x32_bf16 v[140:143], a[188:191], a[48:51], v[140:143]
    ds_read_b64_tr_b16 v[104:105], v12 offset:256
    v_xor_b32 v26, v26, v0
    v_mfma_f32_16x16x32_bf16 v[156:159], a[172:175], a[36:39], v[156:159]
    ds_read_b64_tr_b16 v[106:107], v12 offset:2304
    v_and_b32 v26, 3, v26
    v_mfma_f32_16x16x32_bf16 v[156:159], a[188:191], a[52:55], v[156:159]
    ds_read_b128 a[28:31], v23 offset:56320
    v_lshl_add_u32 v6, v26, 4, v6
    v_mfma_f32_16x16x32_bf16 v[172:175], a[172:175], a[40:43], v[172:175]
    buffer_load_dwordx4 v3, s[20:23], s83 offen offset:1024 lds
    v_mfma_f32_16x16x32_bf16 v[172:175], a[188:191], a[56:59], v[172:175]
    ds_read_b64_tr_b16 v[108:109], v13 offset:256
    v_add_u32 v7, 27648, v6
    v_mfma_f32_16x16x32_bf16 v[188:191], a[172:175], a[44:47], v[188:191]
    ds_read_b64_tr_b16 v[110:111], v13 offset:2304
    v_add_u32 v8, 55296, v6
    v_mfma_f32_16x16x32_bf16 v[188:191], a[188:191], a[60:63], v[188:191]
    s_waitcnt lgkmcnt(14)
    ds_read_b128 a[64:67], v23 offset:8192
    v_add_u32 v9, 82944, v6
    v_mfma_f32_16x16x32_bf16 v[128:131], a[192:195], a[0:3], v[128:131]
    buffer_load_dwordx4 v4, s[20:23], s83 offen offset:2048 lds
    v_mfma_f32_16x16x32_bf16 v[128:131], a[208:211], a[16:19], v[128:131]
    s_waitcnt vmcnt(11)
    ds_read_b64_tr_b16 v[112:113], v12 offset:16384
    v_mfma_f32_16x16x32_bf16 v[144:147], a[192:195], a[4:7], v[144:147]
    s_add_u32 s55, s54, 4
    ds_read_b64_tr_b16 v[114:115], v12 offset:18432
    v_mfma_f32_16x16x32_bf16 v[144:147], a[208:211], a[20:23], v[144:147]
    s_waitcnt lgkmcnt(14)
    s_lshr_b32 s55, s55, 5
    ds_read_b128 a[80:83], v23 offset:9216
    v_mfma_f32_16x16x32_bf16 v[160:163], a[192:195], a[8:11], v[160:163]
    s_waitcnt lgkmcnt(12)
    buffer_load_dwordx4 v5, s[20:23], s83 offen offset:3072 lds
    v_mfma_f32_16x16x32_bf16 v[160:163], a[208:211], a[24:27], v[160:163]
    s_waitcnt lgkmcnt(9)
    ds_read_b64_tr_b16 v[116:117], v13 offset:16384
    v_mfma_f32_16x16x32_bf16 v[176:179], a[192:195], a[12:15], v[176:179]
    s_waitcnt lgkmcnt(7)
    s_add_u32 m0, s62, 114688
    ds_read_b64_tr_b16 v[118:119], v13 offset:18432
    v_mfma_f32_16x16x32_bf16 v[176:179], a[208:211], a[28:31], v[176:179]
    s_add_u32 s83, s61, 131200
    ds_read_b128 a[68:71], v23 offset:24576
    v_mfma_f32_16x16x32_bf16 v[132:135], a[196:199], a[0:3], v[132:135]
    buffer_load_dwordx4 v2, s[20:23], s82 offen offset:0 lds
    v_mfma_f32_16x16x32_bf16 v[132:135], a[212:215], a[16:19], v[132:135]
    s_sub_u32 s76, s54, 32
    ds_read_b64_tr_b16 v[120:121], v12 offset:16640
    v_mfma_f32_16x16x32_bf16 v[148:151], a[196:199], a[4:7], v[148:151]
    s_mul_i32 s76, s76, s55
    ds_read_b64_tr_b16 v[122:123], v12 offset:18688
    v_mfma_f32_16x16x32_bf16 v[148:151], a[212:215], a[20:23], v[148:151]
    s_add_u32 s76, s76, s73
    ds_read_b128 a[84:87], v23 offset:25600
    v_mfma_f32_16x16x32_bf16 v[164:167], a[196:199], a[8:11], v[164:167]
    buffer_load_dwordx4 v3, s[20:23], s82 offen offset:1024 lds
    v_mfma_f32_16x16x32_bf16 v[164:167], a[212:215], a[24:27], v[164:167]
    s_and_b32 s57, s53, 1
    ds_read_b64_tr_b16 v[124:125], v13 offset:16640
    v_mfma_f32_16x16x32_bf16 v[180:183], a[196:199], a[12:15], v[180:183]
    s_lshl1_add_u32 s76, s76, s57
    ds_read_b64_tr_b16 v[126:127], v13 offset:18688
    v_mfma_f32_16x16x32_bf16 v[180:183], a[212:215], a[28:31], v[180:183]
    s_mul_i32 s57, s57, 7
    ds_read_b128 a[72:75], v23 offset:40960
    v_mfma_f32_16x16x32_bf16 v[136:139], a[200:203], a[0:3], v[136:139]
    buffer_load_dwordx4 v4, s[20:23], s82 offen offset:2048 lds
    v_mfma_f32_16x16x32_bf16 v[136:139], a[216:219], a[16:19], v[136:139]
    s_waitcnt vmcnt(11)
    ds_read_b64_tr_b16 v[192:193], v14 offset:0
    v_mfma_f32_16x16x32_bf16 v[152:155], a[200:203], a[4:7], v[152:155]
    s_sub_u32 s77, s75, s57
    ds_read_b64_tr_b16 v[194:195], v14 offset:2048
    v_mfma_f32_16x16x32_bf16 v[152:155], a[216:219], a[20:23], v[152:155]
    s_mul_i32 s55, s55, 7
    ds_read_b128 a[88:91], v23 offset:41984
    v_mfma_f32_16x16x32_bf16 v[168:171], a[200:203], a[8:11], v[168:171]
    buffer_load_dwordx4 v5, s[20:23], s82 offen offset:3072 lds
    v_mfma_f32_16x16x32_bf16 v[168:171], a[216:219], a[24:27], v[168:171]
    s_waitcnt lgkmcnt(15)
    ds_read_b64_tr_b16 v[196:197], v15 offset:0
    v_mfma_f32_16x16x32_bf16 v[184:187], a[200:203], a[12:15], v[184:187]
    s_add_u32 m0, s62, 65536
    ds_read_b64_tr_b16 v[198:199], v15 offset:2048
    v_mfma_f32_16x16x32_bf16 v[184:187], a[216:219], a[28:31], v[184:187]
    s_add_u32 s82, s61, 163968
    ds_read_b128 a[76:79], v23 offset:57344
    v_mfma_f32_16x16x32_bf16 v[140:143], a[204:207], a[0:3], v[140:143]
    buffer_load_dwordx4 v2, s[20:23], s83 offen offset:0 lds
    v_mfma_f32_16x16x32_bf16 v[140:143], a[220:223], a[16:19], v[140:143]
    s_max_u32 s77, s77, s55
    ds_read_b64_tr_b16 v[200:201], v14 offset:256
    v_mfma_f32_16x16x32_bf16 v[156:159], a[204:207], a[4:7], v[156:159]
    s_mul_i32 s78, s52, 458752
    ds_read_b64_tr_b16 v[202:203], v14 offset:2304
    v_mfma_f32_16x16x32_bf16 v[156:159], a[220:223], a[20:23], v[156:159]
    s_lshl_b32 s55, s77, 7
    ds_read_b128 a[92:95], v23 offset:58368
    v_mfma_f32_16x16x32_bf16 v[172:175], a[204:207], a[8:11], v[172:175]
    buffer_load_dwordx4 v3, s[20:23], s83 offen offset:1024 lds
    v_mfma_f32_16x16x32_bf16 v[172:175], a[220:223], a[24:27], v[172:175]
    s_add_u32 s78, s78, s55
    ds_read_b64_tr_b16 v[204:205], v15 offset:256
    v_mfma_f32_16x16x32_bf16 v[188:191], a[204:207], a[12:15], v[188:191]
    s_lshl_b32 s32, s3, 13
    ds_read_b64_tr_b16 v[206:207], v15 offset:2304
    v_mfma_f32_16x16x32_bf16 v[188:191], a[220:223], a[28:31], v[188:191]
    s_lshl_b32 s55, s52, 8
    ds_read_b128 a[160:163], v23 offset:10240
    v_mfma_f32_16x16x32_bf16 v[128:131], a[224:227], a[64:67], v[128:131]
    s_waitcnt lgkmcnt(15)
    buffer_load_dwordx4 v4, s[20:23], s83 offen offset:2048 lds
    v_mfma_f32_16x16x32_bf16 v[128:131], a[240:243], a[80:83], v[128:131]
    s_waitcnt vmcnt(11)
    ds_read_b64_tr_b16 v[208:209], v14 offset:16384
    v_mfma_f32_16x16x32_bf16 v[144:147], a[224:227], a[68:71], v[144:147]
    s_add_u32 s32, s32, s55
    ds_read_b64_tr_b16 v[210:211], v14 offset:18432
    v_mfma_f32_16x16x32_bf16 v[144:147], a[240:243], a[84:87], v[144:147]
    s_waitcnt lgkmcnt(14)
    s_add_u32 s33, s32, 3072
    ds_read_b128 a[176:179], v23 offset:11264
    v_mfma_f32_16x16x32_bf16 v[160:163], a[224:227], a[72:75], v[160:163]
    s_waitcnt lgkmcnt(12)
    buffer_load_dwordx4 v5, s[20:23], s83 offen offset:3072 lds
    v_mfma_f32_16x16x32_bf16 v[160:163], a[240:243], a[88:91], v[160:163]
    s_waitcnt lgkmcnt(9)
    ds_read_b64_tr_b16 v[212:213], v15 offset:16384
    v_mfma_f32_16x16x32_bf16 v[176:179], a[224:227], a[76:79], v[176:179]
    s_waitcnt lgkmcnt(7)
    s_add_u32 m0, s62, 81920
    ds_read_b64_tr_b16 v[214:215], v15 offset:18432
    v_mfma_f32_16x16x32_bf16 v[176:179], a[240:243], a[92:95], v[176:179]
    s_add_u32 s83, s61, 128
    ds_read_b128 a[164:167], v23 offset:26624
    v_mfma_f32_16x16x32_bf16 v[132:135], a[228:231], a[64:67], v[132:135]
    buffer_load_dwordx4 v2, s[20:23], s82 offen offset:0 lds
    v_mfma_f32_16x16x32_bf16 v[132:135], a[244:247], a[80:83], v[132:135]
    s_lshl_b32 s34, s52, 9
    ds_read_b64_tr_b16 v[216:217], v14 offset:16640
    v_mfma_f32_16x16x32_bf16 v[148:151], a[228:231], a[68:71], v[148:151]
    s_add_u32 s34, s34, 2048
    ds_read_b64_tr_b16 v[218:219], v14 offset:18688
    v_mfma_f32_16x16x32_bf16 v[148:151], a[244:247], a[84:87], v[148:151]
    s_add_u32 s35, s34, 3072
    ds_read_b128 a[180:183], v23 offset:27648
    v_lshrrev_b32 v11, 4, v0
    v_mfma_f32_16x16x32_bf16 v[164:167], a[228:231], a[72:75], v[164:167]
    buffer_load_dwordx4 v3, s[20:23], s82 offen offset:1024 lds
    v_mfma_f32_16x16x32_bf16 v[164:167], a[244:247], a[88:91], v[164:167]
    ds_read_b64_tr_b16 v[220:221], v15 offset:16640
    v_lshlrev_b32 v11, 10, v11
    v_mfma_f32_16x16x32_bf16 v[180:183], a[228:231], a[76:79], v[180:183]
    ds_read_b64_tr_b16 v[222:223], v15 offset:18688
    v_and_b32 v26, 15, v0
    v_mfma_f32_16x16x32_bf16 v[180:183], a[244:247], a[92:95], v[180:183]
    ds_read_b128 a[168:171], v23 offset:43008
    v_lshl_add_u32 v11, v26, 4, v11
    v_mfma_f32_16x16x32_bf16 v[136:139], a[232:235], a[64:67], v[136:139]
    buffer_load_dwordx4 v4, s[20:23], s82 offen offset:2048 lds
    v_mfma_f32_16x16x32_bf16 v[136:139], a[248:251], a[80:83], v[136:139]
    s_waitcnt vmcnt(11)
    ds_read_b64_tr_b16 v[224:225], v12 offset:32768
    v_lshrrev_b32 v20, 5, v0
    v_mfma_f32_16x16x32_bf16 v[152:155], a[232:235], a[68:71], v[152:155]
    ds_read_b64_tr_b16 v[226:227], v12 offset:34816
    v_lshlrev_b32 v20, 11, v20
    v_mfma_f32_16x16x32_bf16 v[152:155], a[248:251], a[84:87], v[152:155]
    ds_read_b128 a[184:187], v23 offset:44032
    v_and_b32 v26, 31, v0
    v_mfma_f32_16x16x32_bf16 v[168:171], a[232:235], a[72:75], v[168:171]
    buffer_load_dwordx4 v5, s[20:23], s82 offen offset:3072 lds
    v_mfma_f32_16x16x32_bf16 v[168:171], a[248:251], a[88:91], v[168:171]
    s_waitcnt lgkmcnt(15)
    ds_read_b64_tr_b16 v[228:229], v13 offset:32768
    v_lshl_add_u32 v20, v26, 4, v20
    v_mfma_f32_16x16x32_bf16 v[184:187], a[232:235], a[76:79], v[184:187]
    s_add_u32 m0, s62, 131072
    ds_read_b64_tr_b16 v[230:231], v13 offset:34816
    v_mfma_f32_16x16x32_bf16 v[184:187], a[248:251], a[92:95], v[184:187]
    s_add_u32 s82, s61, 32896
    ds_read_b128 a[172:175], v23 offset:59392
    v_mfma_f32_16x16x32_bf16 v[140:143], a[236:239], a[64:67], v[140:143]
    buffer_load_dwordx4 v2, s[20:23], s83 offen offset:0 lds
    v_mfma_f32_16x16x32_bf16 v[140:143], a[252:255], a[80:83], v[140:143]
    s_and_b32 s55, s52, 1
    ds_read_b64_tr_b16 v[232:233], v12 offset:33024
    v_mfma_f32_16x16x32_bf16 v[156:159], a[236:239], a[68:71], v[156:159]
    s_lshl_b32 s55, s55, 15
    ds_read_b64_tr_b16 v[234:235], v12 offset:35072
    v_mfma_f32_16x16x32_bf16 v[156:159], a[252:255], a[84:87], v[156:159]
    s_sub_u32 s55, s55, s62
    ds_read_b128 a[188:191], v23 offset:60416
    v_subrev_u32 v16, 0x10000, v12
    v_mfma_f32_16x16x32_bf16 v[172:175], a[236:239], a[72:75], v[172:175]
    buffer_load_dwordx4 v3, s[20:23], s83 offen offset:1024 lds
    v_mfma_f32_16x16x32_bf16 v[172:175], a[252:255], a[88:91], v[172:175]
    ds_read_b64_tr_b16 v[236:237], v13 offset:33024
    v_add_u32 v18, s55, v16
    v_mfma_f32_16x16x32_bf16 v[188:191], a[236:239], a[76:79], v[188:191]
    ds_read_b64_tr_b16 v[238:239], v13 offset:35072
    v_subrev_u32 v17, 0x10000, v13
    v_mfma_f32_16x16x32_bf16 v[188:191], a[252:255], a[92:95], v[188:191]
    s_waitcnt lgkmcnt(14)
    ds_read_b128 a[192:195], v23 offset:12288
    v_add_u32 v19, s55, v17
    v_mfma_f32_16x16x32_bf16 v[128:131], v[96:99], a[160:163], v[128:131]
    buffer_load_dwordx4 v4, s[20:23], s83 offen offset:2048 lds
    v_mfma_f32_16x16x32_bf16 v[128:131], v[112:115], a[176:179], v[128:131]
    s_waitcnt vmcnt(11)
    ds_read_b64_tr_b16 v[240:241], v12 offset:49152
    v_mfma_f32_16x16x32_bf16 v[144:147], v[96:99], a[164:167], v[144:147]
    s_add_u32 s55, s62, 149504
    ds_read_b64_tr_b16 v[242:243], v12 offset:51200
    v_lshrrev_b32 v26, 5, v0
    v_mfma_f32_16x16x32_bf16 v[144:147], v[112:115], a[180:183], v[144:147]
    s_waitcnt lgkmcnt(5)
    ds_read_b128 a[208:211], v23 offset:13312
    v_lshlrev_b32 v26, 10, v26
    v_mfma_f32_16x16x32_bf16 v[160:163], v[96:99], a[168:171], v[160:163]
    buffer_load_dwordx4 v5, s[20:23], s83 offen offset:3072 lds
    v_mfma_f32_16x16x32_bf16 v[160:163], v[112:115], a[184:187], v[160:163]
    ds_read_b64_tr_b16 v[244:245], v13 offset:49152
    v_bfe_u32 v27, v0, 3, 2
    v_mfma_f32_16x16x32_bf16 v[176:179], v[96:99], a[172:175], v[176:179]
    s_add_u32 m0, s62, 147456
    ds_read_b64_tr_b16 v[246:247], v13 offset:51200
    v_lshl_add_u32 v26, v27, 8, v26
    v_mfma_f32_16x16x32_bf16 v[176:179], v[112:115], a[188:191], v[176:179]
    s_add_u32 s83, s61, 65664
    ds_read_b128 a[224:227], v23 offset:14336
    v_and_b32 v27, 7, v0
    v_mfma_f32_16x16x32_bf16 v[132:135], v[100:103], a[160:163], v[132:135]
    buffer_load_dwordx4 v2, s[20:23], s82 offen offset:0 lds
    v_mfma_f32_16x16x32_bf16 v[132:135], v[116:119], a[176:179], v[132:135]
    ds_read_b64_tr_b16 v[248:249], v12 offset:49408
    v_lshl_add_u32 v26, v27, 4, v26
    v_mfma_f32_16x16x32_bf16 v[148:151], v[100:103], a[164:167], v[148:151]
    ds_read_b64_tr_b16 v[250:251], v12 offset:51456
    v_add_u32 v26, s55, v26
    v_mfma_f32_16x16x32_bf16 v[148:151], v[116:119], a[180:183], v[148:151]
    ds_read_b128 a[240:243], v23 offset:15360
    v_add_u32 v27, s55, v10
    v_mfma_f32_16x16x32_bf16 v[164:167], v[100:103], a[168:171], v[164:167]
    buffer_load_dwordx4 v3, s[20:23], s82 offen offset:1024 lds
    v_mfma_f32_16x16x32_bf16 v[164:167], v[116:119], a[184:187], v[164:167]
    ds_read_b64_tr_b16 v[252:253], v13 offset:49408
    v_mfma_f32_16x16x32_bf16 v[180:183], v[100:103], a[172:175], v[180:183]
    ds_read_b64_tr_b16 v[254:255], v13 offset:51456
    v_mfma_f32_16x16x32_bf16 v[180:183], v[116:119], a[188:191], v[180:183]
    ds_read_b128 a[196:199], v23 offset:28672
    v_mfma_f32_16x16x32_bf16 v[136:139], v[104:107], a[160:163], v[136:139]
    buffer_load_dwordx4 v4, s[20:23], s82 offen offset:2048 lds
    v_mfma_f32_16x16x32_bf16 v[136:139], v[120:123], a[176:179], v[136:139]
    v_mfma_f32_16x16x32_bf16 v[152:155], v[104:107], a[164:167], v[152:155]
    buffer_load_dwordx4 v5, s[20:23], s82 offen offset:3072 lds
    v_mfma_f32_16x16x32_bf16 v[152:155], v[120:123], a[180:183], v[152:155]
    s_waitcnt lgkmcnt(13)
    ds_read_b128 a[212:215], v23 offset:29696
    v_mfma_f32_16x16x32_bf16 v[168:171], v[104:107], a[168:171], v[168:171]
    s_add_u32 m0, s62, 98304
    v_mfma_f32_16x16x32_bf16 v[168:171], v[120:123], a[184:187], v[168:171]
    buffer_load_dwordx4 v2, s[20:23], s83 offen offset:0 lds
    v_mfma_f32_16x16x32_bf16 v[184:187], v[104:107], a[172:175], v[184:187]
    v_mfma_f32_16x16x32_bf16 v[184:187], v[120:123], a[188:191], v[184:187]
    s_add_u32 s82, s61, 98432
    ds_read_b128 a[228:231], v23 offset:30720
    v_mfma_f32_16x16x32_bf16 v[140:143], v[108:111], a[160:163], v[140:143]
    buffer_load_dwordx4 v3, s[20:23], s83 offen offset:1024 lds
    v_mfma_f32_16x16x32_bf16 v[140:143], v[124:127], a[176:179], v[140:143]
    v_mfma_f32_16x16x32_bf16 v[156:159], v[108:111], a[164:167], v[156:159]
    buffer_load_dwordx4 v4, s[20:23], s83 offen offset:2048 lds
    v_mfma_f32_16x16x32_bf16 v[156:159], v[124:127], a[180:183], v[156:159]
    ds_read_b128 a[244:247], v23 offset:31744
    v_mfma_f32_16x16x32_bf16 v[172:175], v[108:111], a[168:171], v[172:175]
    buffer_load_dwordx4 v5, s[20:23], s83 offen offset:3072 lds
    v_mfma_f32_16x16x32_bf16 v[172:175], v[124:127], a[184:187], v[172:175]
    v_mfma_f32_16x16x32_bf16 v[188:191], v[108:111], a[172:175], v[188:191]
    s_waitcnt lgkmcnt(9)
    v_mfma_f32_16x16x32_bf16 v[188:191], v[124:127], a[188:191], v[188:191]
    s_waitcnt lgkmcnt(4)
    ds_read_b128 a[200:203], v23 offset:45056
    v_mfma_f32_16x16x32_bf16 v[128:131], v[192:195], a[192:195], v[128:131]
    s_add_u32 m0, s62, 114688
    v_mfma_f32_16x16x32_bf16 v[128:131], v[208:211], a[208:211], v[128:131]
    buffer_load_dwordx4 v2, s[20:23], s82 offen offset:0 lds
    v_mfma_f32_16x16x32_bf16 v[128:131], v[224:227], a[224:227], v[128:131]
    v_mfma_f32_16x16x32_bf16 v[128:131], v[240:243], a[240:243], v[128:131]
    ds_read_b128 a[216:219], v23 offset:46080
    v_mfma_f32_16x16x32_bf16 v[132:135], v[196:199], a[192:195], v[132:135]
    buffer_load_dwordx4 v3, s[20:23], s82 offen offset:1024 lds
    v_mfma_f32_16x16x32_bf16 v[132:135], v[212:215], a[208:211], v[132:135]
    v_mfma_f32_16x16x32_bf16 v[132:135], v[228:231], a[224:227], v[132:135]
    buffer_load_dwordx4 v4, s[20:23], s82 offen offset:2048 lds
    v_mfma_f32_16x16x32_bf16 v[132:135], v[244:247], a[240:243], v[132:135]
    ds_read_b128 a[232:235], v23 offset:47104
    v_mfma_f32_16x16x32_bf16 v[136:139], v[200:203], a[192:195], v[136:139]
    buffer_load_dwordx4 v5, s[20:23], s82 offen offset:3072 lds
    v_mfma_f32_16x16x32_bf16 v[136:139], v[216:219], a[208:211], v[136:139]
    v_mfma_f32_16x16x32_bf16 v[136:139], v[232:235], a[224:227], v[136:139]
    v_mfma_f32_16x16x32_bf16 v[136:139], v[248:251], a[240:243], v[136:139]
    ds_read_b128 a[248:251], v23 offset:48128
    v_mfma_f32_16x16x32_bf16 v[140:143], v[204:207], a[192:195], v[140:143]
    v_mfma_f32_16x16x32_bf16 v[140:143], v[220:223], a[208:211], v[140:143]
    v_mfma_f32_16x16x32_bf16 v[140:143], v[236:239], a[224:227], v[140:143]
    v_mfma_f32_16x16x32_bf16 v[140:143], v[252:255], a[240:243], v[140:143]
    s_waitcnt lgkmcnt(7)
    ds_read_b128 a[204:207], v23 offset:61440
    v_mfma_f32_16x16x32_bf16 v[144:147], v[192:195], a[196:199], v[144:147]
    s_waitcnt lgkmcnt(7)
    v_mfma_f32_16x16x32_bf16 v[144:147], v[208:211], a[212:215], v[144:147]
    s_waitcnt lgkmcnt(5)
    v_mfma_f32_16x16x32_bf16 v[144:147], v[224:227], a[228:231], v[144:147]
    s_add_u32 s67, s66, 0
    v_cvt_pk_bf16_f32 v128, v128, v129
    v_cvt_pk_bf16_f32 v129, v130, v131
    v_mfma_f32_16x16x32_bf16 v[144:147], v[240:243], a[244:247], v[144:147]
    ds_read_b128 a[220:223], v23 offset:62464
    v_cvt_pk_bf16_f32 v130, v132, v133
    v_mfma_f32_16x16x32_bf16 v[148:151], v[196:199], a[196:199], v[148:151]
    v_cvt_pk_bf16_f32 v131, v134, v135
    v_mfma_f32_16x16x32_bf16 v[148:151], v[212:215], a[212:215], v[148:151]
    buffer_store_dwordx4 v[128:131], v24, s[48:51], s67 offen sc1
    v_mfma_f32_16x16x32_bf16 v[148:151], v[228:231], a[228:231], v[148:151]
    v_cvt_pk_bf16_f32 v136, v136, v137
    v_cvt_pk_bf16_f32 v137, v138, v139
    v_mfma_f32_16x16x32_bf16 v[148:151], v[244:247], a[244:247], v[148:151]
    ds_read_b128 a[236:239], v23 offset:63488
    v_cvt_pk_bf16_f32 v138, v140, v141
    v_mfma_f32_16x16x32_bf16 v[152:155], v[200:203], a[196:199], v[152:155]
    s_add_u32 s68, s66, 4194304
    v_cvt_pk_bf16_f32 v139, v142, v143
    v_mfma_f32_16x16x32_bf16 v[152:155], v[216:219], a[212:215], v[152:155]
    v_mfma_f32_16x16x32_bf16 v[152:155], v[232:235], a[228:231], v[152:155]
    v_mfma_f32_16x16x32_bf16 v[152:155], v[248:251], a[244:247], v[152:155]
    ds_read_b128 a[252:255], v23 offset:64512
    v_mfma_f32_16x16x32_bf16 v[156:159], v[204:207], a[196:199], v[156:159]
    buffer_store_dwordx4 v[136:139], v24, s[48:51], s68 offen sc1
    v_mfma_f32_16x16x32_bf16 v[156:159], v[220:223], a[212:215], v[156:159]
    v_mfma_f32_16x16x32_bf16 v[156:159], v[236:239], a[228:231], v[156:159]
    v_mfma_f32_16x16x32_bf16 v[156:159], v[252:255], a[244:247], v[156:159]
    s_waitcnt lgkmcnt(7)
    v_mfma_f32_16x16x32_bf16 v[160:163], v[192:195], a[200:203], v[160:163]
    s_waitcnt lgkmcnt(6)
    v_mfma_f32_16x16x32_bf16 v[160:163], v[208:211], a[216:219], v[160:163]
    s_waitcnt lgkmcnt(4)
    v_mfma_f32_16x16x32_bf16 v[160:163], v[224:227], a[232:235], v[160:163]
    s_add_u32 s67, s66, 1048576
    v_cvt_pk_bf16_f32 v144, v144, v145
    v_cvt_pk_bf16_f32 v145, v146, v147
    v_mfma_f32_16x16x32_bf16 v[160:163], v[240:243], a[248:251], v[160:163]
    v_cvt_pk_bf16_f32 v146, v148, v149
    v_cvt_pk_bf16_f32 v147, v150, v151
    v_mfma_f32_16x16x32_bf16 v[164:167], v[196:199], a[200:203], v[164:167]
    buffer_store_dwordx4 v[144:147], v24, s[48:51], s67 offen sc1
    v_mfma_f32_16x16x32_bf16 v[164:167], v[212:215], a[216:219], v[164:167]
    v_cvt_pk_bf16_f32 v152, v152, v153
    v_cvt_pk_bf16_f32 v153, v154, v155
    v_mfma_f32_16x16x32_bf16 v[164:167], v[228:231], a[232:235], v[164:167]
    v_cvt_pk_bf16_f32 v154, v156, v157
    v_cvt_pk_bf16_f32 v155, v158, v159
    v_mfma_f32_16x16x32_bf16 v[164:167], v[244:247], a[248:251], v[164:167]
    s_add_u32 s68, s66, 5242880
    v_mfma_f32_16x16x32_bf16 v[168:171], v[200:203], a[200:203], v[168:171]
    v_mfma_f32_16x16x32_bf16 v[168:171], v[216:219], a[216:219], v[168:171]
    v_mfma_f32_16x16x32_bf16 v[168:171], v[232:235], a[232:235], v[168:171]
    buffer_store_dwordx4 v[152:155], v24, s[48:51], s68 offen sc1
    v_mfma_f32_16x16x32_bf16 v[168:171], v[248:251], a[248:251], v[168:171]
    v_mfma_f32_16x16x32_bf16 v[172:175], v[204:207], a[200:203], v[172:175]
    v_mfma_f32_16x16x32_bf16 v[172:175], v[220:223], a[216:219], v[172:175]
    s_waitcnt vmcnt(16)
    ds_read_b64_tr_b16 v[96:97], v14 offset:0
    v_mfma_f32_16x16x32_bf16 v[172:175], v[236:239], a[232:235], v[172:175]
    ds_read_b64_tr_b16 v[98:99], v14 offset:2048
    v_mfma_f32_16x16x32_bf16 v[172:175], v[252:255], a[248:251], v[172:175]
    s_waitcnt lgkmcnt(5)
    v_mfma_f32_16x16x32_bf16 v[176:179], v[192:195], a[204:207], v[176:179]
    s_waitcnt lgkmcnt(2)
    v_mfma_f32_16x16x32_bf16 v[176:179], v[208:211], a[220:223], v[176:179]
    s_waitcnt vmcnt(12)
    ds_read_b64_tr_b16 v[100:101], v14 offset:16384
    v_mfma_f32_16x16x32_bf16 v[176:179], v[224:227], a[236:239], v[176:179]
    s_add_u32 s67, s66, 2097152
    ds_read_b64_tr_b16 v[102:103], v14 offset:18432
    v_cvt_pk_bf16_f32 v160, v160, v161
    v_mfma_f32_16x16x32_bf16 v[176:179], v[240:243], a[252:255], v[176:179]
    v_cvt_pk_bf16_f32 v161, v162, v163
    v_cvt_pk_bf16_f32 v162, v164, v165
    v_mfma_f32_16x16x32_bf16 v[180:183], v[196:199], a[204:207], v[180:183]
    v_cvt_pk_bf16_f32 v163, v166, v167
    v_mfma_f32_16x16x32_bf16 v[180:183], v[212:215], a[220:223], v[180:183]
    ds_read_b64_tr_b16 v[104:105], v15 offset:0
    v_cvt_pk_bf16_f32 v168, v168, v169
    v_mfma_f32_16x16x32_bf16 v[180:183], v[228:231], a[236:239], v[180:183]
    ds_read_b64_tr_b16 v[106:107], v15 offset:2048
    v_cvt_pk_bf16_f32 v169, v170, v171
    v_mfma_f32_16x16x32_bf16 v[180:183], v[244:247], a[252:255], v[180:183]
    buffer_store_dwordx4 v[160:163], v24, s[48:51], s67 offen sc1
    v_mfma_f32_16x16x32_bf16 v[184:187], v[200:203], a[204:207], v[184:187]
    v_cvt_pk_bf16_f32 v170, v172, v173
    v_cvt_pk_bf16_f32 v171, v174, v175
    v_mfma_f32_16x16x32_bf16 v[184:187], v[216:219], a[220:223], v[184:187]
    ds_read_b64_tr_b16 v[108:109], v15 offset:16384
    v_mfma_f32_16x16x32_bf16 v[184:187], v[232:235], a[236:239], v[184:187]
    s_add_u32 s68, s66, 6291456
    ds_read_b64_tr_b16 v[110:111], v15 offset:18432
    v_mfma_f32_16x16x32_bf16 v[184:187], v[248:251], a[252:255], v[184:187]
    v_mfma_f32_16x16x32_bf16 v[188:191], v[204:207], a[204:207], v[188:191]
    v_mfma_f32_16x16x32_bf16 v[188:191], v[220:223], a[220:223], v[188:191]
    ds_read_b64_tr_b16 v[112:113], v14 offset:256
    v_mfma_f32_16x16x32_bf16 v[188:191], v[236:239], a[236:239], v[188:191]
    s_waitcnt lgkmcnt(7)
    ds_read_b64_tr_b16 v[114:115], v14 offset:2304
    v_mfma_f32_16x16x32_bf16 v[188:191], v[252:255], a[252:255], v[188:191]
    buffer_store_dwordx4 v[168:171], v24, s[48:51], s68 offen sc1
    s_add_u32 s86, s48, s84
    s_addc_u32 s87, s49, 0
    s_cmp_lt_u32 s54, 28
    s_cselect_b32 s79, s79, 0x40000000
    v_mfma_f32_16x16x32_bf16 v[192:195], v[96:99], a[96:99], 0
    s_waitcnt lgkmcnt(6)
    v_mfma_f32_16x16x32_bf16 v[192:195], v[100:103], a[112:115], v[192:195]
    ds_read_b64_tr_b16 v[116:117], v14 offset:16640
    v_mfma_f32_16x16x32_bf16 v[208:211], v[96:99], a[100:103], 0
    s_add_u32 s67, s66, 3145728
    ds_read_b64_tr_b16 v[118:119], v14 offset:18688
    v_cvt_pk_bf16_f32 v176, v176, v177
    v_mfma_f32_16x16x32_bf16 v[208:211], v[100:103], a[116:119], v[208:211]
    v_cvt_pk_bf16_f32 v177, v178, v179
    v_cvt_pk_bf16_f32 v178, v180, v181
    v_mfma_f32_16x16x32_bf16 v[224:227], v[96:99], a[104:107], 0
    v_cvt_pk_bf16_f32 v179, v182, v183
    v_mfma_f32_16x16x32_bf16 v[224:227], v[100:103], a[120:123], v[224:227]
    ds_read_b64_tr_b16 v[120:121], v15 offset:256
    v_cvt_pk_bf16_f32 v184, v184, v185
    v_mfma_f32_16x16x32_bf16 v[240:243], v[96:99], a[108:111], 0
    s_waitcnt lgkmcnt(7)
    ds_read_b64_tr_b16 v[122:123], v15 offset:2304
    v_cvt_pk_bf16_f32 v185, v186, v187
    v_mfma_f32_16x16x32_bf16 v[240:243], v[100:103], a[124:127], v[240:243]
    buffer_store_dwordx4 v[176:179], v22, s[48:51], s67 offen sc1
    v_mfma_f32_16x16x32_bf16 v[196:199], v[104:107], a[96:99], 0
    s_waitcnt lgkmcnt(6)
    v_cvt_pk_bf16_f32 v186, v188, v189
    v_cvt_pk_bf16_f32 v187, v190, v191
    v_mfma_f32_16x16x32_bf16 v[196:199], v[108:111], a[112:115], v[196:199]
    ds_read_b64_tr_b16 v[124:125], v15 offset:16640
    v_mfma_f32_16x16x32_bf16 v[212:215], v[104:107], a[100:103], 0
    s_add_u32 s68, s66, 7340032
    ds_read_b64_tr_b16 v[126:127], v15 offset:18688
    v_mfma_f32_16x16x32_bf16 v[212:215], v[108:111], a[116:119], v[212:215]
    v_mfma_f32_16x16x32_bf16 v[228:231], v[104:107], a[104:107], 0
    v_mfma_f32_16x16x32_bf16 v[228:231], v[108:111], a[120:123], v[228:231]
    s_waitcnt vmcnt(11)
    ds_read_b64_tr_b16 v[96:97], v12 offset:32768
    v_mfma_f32_16x16x32_bf16 v[244:247], v[104:107], a[108:111], 0
    s_waitcnt lgkmcnt(7)
    ds_read_b64_tr_b16 v[98:99], v12 offset:34816
    v_mfma_f32_16x16x32_bf16 v[244:247], v[108:111], a[124:127], v[244:247]
    buffer_store_dwordx4 v[184:187], v22, s[48:51], s68 offen sc1
    v_mfma_f32_16x16x32_bf16 v[200:203], v[112:115], a[96:99], 0
    s_waitcnt lgkmcnt(6)
    v_mfma_f32_16x16x32_bf16 v[200:203], v[116:119], a[112:115], v[200:203]
    s_waitcnt vmcnt(8)
    ds_read_b64_tr_b16 v[100:101], v12 offset:49152
    v_mfma_f32_16x16x32_bf16 v[216:219], v[112:115], a[100:103], 0
    s_waitcnt lgkmcnt(3)
    ds_read_b64_tr_b16 v[102:103], v12 offset:51200
    v_mfma_f32_16x16x32_bf16 v[216:219], v[116:119], a[116:119], v[216:219]
    ds_write_b128 v27, v[176:179] offset:0
    v_mfma_f32_16x16x32_bf16 v[232:235], v[112:115], a[104:107], 0
    ds_write_b128 v27, v[184:187] offset:1024
    v_mfma_f32_16x16x32_bf16 v[232:235], v[116:119], a[120:123], v[232:235]
L_hop1_9:
    s_cbranch_execz L_back1_0
    ds_read_b64_tr_b16 v[104:105], v13 offset:32768
    v_mfma_f32_16x16x32_bf16 v[248:251], v[112:115], a[108:111], 0
    ds_read_b64_tr_b16 v[106:107], v13 offset:34816
    v_mfma_f32_16x16x32_bf16 v[248:251], v[116:119], a[124:127], v[248:251]
    ds_read_b128 v[156:159], v26 offset:128
    v_mfma_f32_16x16x32_bf16 v[204:207], v[120:123], a[96:99], 0
    v_mfma_f32_16x16x32_bf16 v[204:207], v[124:127], a[112:115], v[204:207]
    ds_read_b64_tr_b16 v[108:109], v13 offset:49152
    v_mfma_f32_16x16x32_bf16 v[220:223], v[120:123], a[100:103], 0
    ds_read_b64_tr_b16 v[110:111], v13 offset:51200
    v_mfma_f32_16x16x32_bf16 v[220:223], v[124:127], a[116:119], v[220:223]
    v_mfma_f32_16x16x32_bf16 v[236:239], v[120:123], a[104:107], 0
    v_mfma_f32_16x16x32_bf16 v[236:239], v[124:127], a[120:123], v[236:239]
    ds_read_b64_tr_b16 v[112:113], v12 offset:33024
    v_mfma_f32_16x16x32_bf16 v[252:255], v[120:123], a[108:111], 0
    ds_read_b64_tr_b16 v[114:115], v12 offset:35072
    v_mfma_f32_16x16x32_bf16 v[252:255], v[124:127], a[124:127], v[252:255]
    s_waitcnt lgkmcnt(11)
    v_mfma_f32_16x16x32_bf16 v[192:195], v[96:99], a[128:131], v[192:195]
    s_waitcnt lgkmcnt(9)
    v_mfma_f32_16x16x32_bf16 v[192:195], v[100:103], a[144:147], v[192:195]
    ds_read_b64_tr_b16 v[116:117], v12 offset:49408
    v_mfma_f32_16x16x32_bf16 v[208:211], v[96:99], a[132:135], v[208:211]
    ds_read_b64_tr_b16 v[118:119], v12 offset:51456
    v_mfma_f32_16x16x32_bf16 v[208:211], v[100:103], a[148:151], v[208:211]
    v_mfma_f32_16x16x32_bf16 v[224:227], v[96:99], a[136:139], v[224:227]
    v_mfma_f32_16x16x32_bf16 v[224:227], v[100:103], a[152:155], v[224:227]
    s_add_u32 s83, s61, 327808
    ds_read_b64_tr_b16 v[120:121], v13 offset:33024
    v_mfma_f32_16x16x32_bf16 v[240:243], v[96:99], a[140:143], v[240:243]
    ds_read_b64_tr_b16 v[122:123], v13 offset:35072
    v_mfma_f32_16x16x32_bf16 v[240:243], v[100:103], a[156:159], v[240:243]
    s_waitcnt lgkmcnt(9)
    v_mfma_f32_16x16x32_bf16 v[196:199], v[104:107], a[128:131], v[196:199]
    s_waitcnt lgkmcnt(6)
    v_mfma_f32_16x16x32_bf16 v[196:199], v[108:111], a[144:147], v[196:199]
    ds_read_b64_tr_b16 v[124:125], v13 offset:49408
    v_mfma_f32_16x16x32_bf16 v[212:215], v[104:107], a[132:135], v[212:215]
    ds_read_b64_tr_b16 v[126:127], v13 offset:51456
    v_mfma_f32_16x16x32_bf16 v[212:215], v[108:111], a[148:151], v[212:215]
    v_mfma_f32_16x16x32_bf16 v[228:231], v[104:107], a[136:139], v[228:231]
    v_mfma_f32_16x16x32_bf16 v[228:231], v[108:111], a[152:155], v[228:231]
    ds_read_b64_tr_b16 v[96:97], v12 offset:0
    v_mfma_f32_16x16x32_bf16 v[244:247], v[104:107], a[140:143], v[244:247]
    s_waitcnt lgkmcnt(7)
    ds_read_b64_tr_b16 v[98:99], v12 offset:2048
    v_mfma_f32_16x16x32_bf16 v[244:247], v[108:111], a[156:159], v[244:247]
    v_mfma_f32_16x16x32_bf16 v[200:203], v[112:115], a[128:131], v[200:203]
    s_waitcnt lgkmcnt(6)
    v_mfma_f32_16x16x32_bf16 v[200:203], v[116:119], a[144:147], v[200:203]
    ds_read_b64_tr_b16 v[100:101], v12 offset:16384
    v_mfma_f32_16x16x32_bf16 v[216:219], v[112:115], a[132:135], v[216:219]
    s_add_u32 m0, s62, 131072
    ds_read_b64_tr_b16 v[102:103], v12 offset:18432
    v_mfma_f32_16x16x32_bf16 v[216:219], v[116:119], a[148:151], v[216:219]
    buffer_load_dwordx4 v2, s[20:23], s83 offen offset:0 lds
    v_mfma_f32_16x16x32_bf16 v[232:235], v[112:115], a[136:139], v[232:235]
    v_mfma_f32_16x16x32_bf16 v[232:235], v[116:119], a[152:155], v[232:235]
    s_add_u32 s82, s61, 360576
    ds_read_b64_tr_b16 v[104:105], v13 offset:0
    v_mfma_f32_16x16x32_bf16 v[248:251], v[112:115], a[140:143], v[248:251]
    s_waitcnt lgkmcnt(7)
    ds_read_b64_tr_b16 v[106:107], v13 offset:2048
    v_mfma_f32_16x16x32_bf16 v[248:251], v[116:119], a[156:159], v[248:251]
    buffer_load_dwordx4 v3, s[20:23], s83 offen offset:1024 lds
    v_mfma_f32_16x16x32_bf16 v[204:207], v[120:123], a[128:131], v[204:207]
    s_waitcnt lgkmcnt(6)
    v_mfma_f32_16x16x32_bf16 v[204:207], v[124:127], a[144:147], v[204:207]
    ds_read_b64_tr_b16 v[108:109], v13 offset:16384
    v_mfma_f32_16x16x32_bf16 v[220:223], v[120:123], a[132:135], v[220:223]
    ds_read_b64_tr_b16 v[110:111], v13 offset:18432
    v_mfma_f32_16x16x32_bf16 v[220:223], v[124:127], a[148:151], v[220:223]
    buffer_load_dwordx4 v4, s[20:23], s83 offen offset:2048 lds
    v_mfma_f32_16x16x32_bf16 v[236:239], v[120:123], a[136:139], v[236:239]
    v_mfma_f32_16x16x32_bf16 v[236:239], v[124:127], a[152:155], v[236:239]
    ds_read_b64_tr_b16 v[112:113], v12 offset:256
    v_mfma_f32_16x16x32_bf16 v[252:255], v[120:123], a[140:143], v[252:255]
    s_waitcnt lgkmcnt(7)
    ds_read_b64_tr_b16 v[114:115], v12 offset:2304
    v_mfma_f32_16x16x32_bf16 v[252:255], v[124:127], a[156:159], v[252:255]
    buffer_load_dwordx4 v5, s[20:23], s83 offen offset:3072 lds
    v_mfma_f32_16x16x32_bf16 v[192:195], v[96:99], a[32:35], v[192:195]
    s_waitcnt lgkmcnt(6)
    v_mfma_f32_16x16x32_bf16 v[192:195], v[100:103], a[48:51], v[192:195]
    ds_read_b64_tr_b16 v[116:117], v12 offset:16640
    v_mfma_f32_16x16x32_bf16 v[208:211], v[96:99], a[36:39], v[208:211]
    s_add_u32 m0, s62, 147456
    ds_read_b64_tr_b16 v[118:119], v12 offset:18688
    v_mfma_f32_16x16x32_bf16 v[208:211], v[100:103], a[52:55], v[208:211]
    buffer_load_dwordx4 v2, s[20:23], s82 offen offset:0 lds
    v_mfma_f32_16x16x32_bf16 v[224:227], v[96:99], a[40:43], v[224:227]
    v_mfma_f32_16x16x32_bf16 v[224:227], v[100:103], a[56:59], v[224:227]
    s_add_u32 s83, s61, 393344
    ds_read_b64_tr_b16 v[120:121], v13 offset:256
    v_mov_b32 v30, 1
    s_waitcnt vmcnt(5)
    s_mov_b64 exec, 0x7f
    buffer_store_dword v30, v28, s[48:51], s70 offen sc1
    s_mov_b64 exec, -1
    v_mfma_f32_16x16x32_bf16 v[240:243], v[96:99], a[44:47], v[240:243]
    s_waitcnt lgkmcnt(7)
    ds_read_b64_tr_b16 v[122:123], v13 offset:2304
    v_mfma_f32_16x16x32_bf16 v[240:243], v[100:103], a[60:63], v[240:243]
    buffer_load_dwordx4 v3, s[20:23], s82 offen offset:1024 lds
    v_mfma_f32_16x16x32_bf16 v[196:199], v[104:107], a[32:35], v[196:199]
    s_waitcnt lgkmcnt(6)
    v_mfma_f32_16x16x32_bf16 v[196:199], v[108:111], a[48:51], v[196:199]
    ds_read_b64_tr_b16 v[124:125], v13 offset:16640
    v_mfma_f32_16x16x32_bf16 v[212:215], v[104:107], a[36:39], v[212:215]
    ds_read_b64_tr_b16 v[126:127], v13 offset:18688
    v_mfma_f32_16x16x32_bf16 v[212:215], v[108:111], a[52:55], v[212:215]
    buffer_load_dwordx4 v4, s[20:23], s82 offen offset:2048 lds
    v_mfma_f32_16x16x32_bf16 v[228:231], v[104:107], a[40:43], v[228:231]
    v_mfma_f32_16x16x32_bf16 v[228:231], v[108:111], a[56:59], v[228:231]
    s_waitcnt lgkmcnt(4)
    v_mfma_f32_16x16x32_bf16 v[244:247], v[104:107], a[44:47], v[244:247]
    buffer_load_dwordx4 v5, s[20:23], s82 offen offset:3072 lds
    v_mfma_f32_16x16x32_bf16 v[244:247], v[108:111], a[60:63], v[244:247]
    v_mfma_f32_16x16x32_bf16 v[200:203], v[112:115], a[32:35], v[200:203]
    s_add_u32 m0, s62, 98304
    v_mfma_f32_16x16x32_bf16 v[200:203], v[116:119], a[48:51], v[200:203]
    buffer_load_dwordx4 v2, s[20:23], s83 offen offset:0 lds
    v_mfma_f32_16x16x32_bf16 v[216:219], v[112:115], a[36:39], v[216:219]
    v_mfma_f32_16x16x32_bf16 v[216:219], v[116:119], a[52:55], v[216:219]
    s_add_u32 s82, s61, 426112
    v_mfma_f32_16x16x32_bf16 v[232:235], v[112:115], a[40:43], v[232:235]
    buffer_load_dwordx4 v3, s[20:23], s83 offen offset:1024 lds
    v_mfma_f32_16x16x32_bf16 v[232:235], v[116:119], a[56:59], v[232:235]
    v_mfma_f32_16x16x32_bf16 v[248:251], v[112:115], a[44:47], v[248:251]
    s_waitcnt lgkmcnt(2)
    v_mfma_f32_16x16x32_bf16 v[248:251], v[116:119], a[60:63], v[248:251]
    buffer_load_dwordx4 v4, s[20:23], s83 offen offset:2048 lds
    v_mfma_f32_16x16x32_bf16 v[204:207], v[120:123], a[32:35], v[204:207]
    s_waitcnt lgkmcnt(0)
    v_mfma_f32_16x16x32_bf16 v[204:207], v[124:127], a[48:51], v[204:207]
    v_mfma_f32_16x16x32_bf16 v[220:223], v[120:123], a[36:39], v[220:223]
    buffer_load_dwordx4 v5, s[20:23], s83 offen offset:3072 lds
    v_mfma_f32_16x16x32_bf16 v[220:223], v[124:127], a[52:55], v[220:223]
    v_mfma_f32_16x16x32_bf16 v[236:239], v[120:123], a[40:43], v[236:239]
    v_mfma_f32_16x16x32_bf16 v[236:239], v[124:127], a[56:59], v[236:239]
    v_mfma_f32_16x16x32_bf16 v[252:255], v[120:123], a[44:47], v[252:255]
    v_mfma_f32_16x16x32_bf16 v[252:255], v[124:127], a[60:63], v[252:255]
    v_mfma_f32_16x16x32_bf16 v[192:195], v[32:35], a[0:3], v[192:195]
    s_add_u32 m0, s62, 114688
    v_mfma_f32_16x16x32_bf16 v[192:195], v[48:51], a[16:19], v[192:195]
    buffer_load_dwordx4 v2, s[20:23], s82 offen offset:0 lds
    v_mfma_f32_16x16x32_bf16 v[192:195], v[64:67], a[64:67], v[192:195]
    v_mfma_f32_16x16x32_bf16 v[192:195], v[80:83], a[80:83], v[192:195]
    s_add_u32 s83, s61, 458880
    v_mfma_f32_16x16x32_bf16 v[208:211], v[32:35], a[4:7], v[208:211]
    buffer_load_dwordx4 v3, s[20:23], s82 offen offset:1024 lds
    v_mfma_f32_16x16x32_bf16 v[208:211], v[48:51], a[20:23], v[208:211]
    s_waitcnt vmcnt(11)
    ds_read_b64_tr_b16 a[32:33], v14 offset:0
    v_mfma_f32_16x16x32_bf16 v[208:211], v[64:67], a[68:71], v[208:211]
    ds_read_b64_tr_b16 a[34:35], v14 offset:2048
    v_mfma_f32_16x16x32_bf16 v[208:211], v[80:83], a[84:87], v[208:211]
    buffer_load_dwordx4 v4, s[20:23], s82 offen offset:2048 lds
    v_mfma_f32_16x16x32_bf16 v[224:227], v[32:35], a[8:11], v[224:227]
    v_mfma_f32_16x16x32_bf16 v[224:227], v[48:51], a[24:27], v[224:227]
    ds_read_b64_tr_b16 a[36:37], v15 offset:0
    v_mfma_f32_16x16x32_bf16 v[224:227], v[64:67], a[72:75], v[224:227]
    ds_read_b64_tr_b16 a[38:39], v15 offset:2048
    v_mfma_f32_16x16x32_bf16 v[224:227], v[80:83], a[88:91], v[224:227]
    buffer_load_dwordx4 v5, s[20:23], s82 offen offset:3072 lds
    v_mfma_f32_16x16x32_bf16 v[240:243], v[32:35], a[12:15], v[240:243]
    v_mfma_f32_16x16x32_bf16 v[240:243], v[48:51], a[28:31], v[240:243]
    ds_read_b64_tr_b16 a[40:41], v14 offset:256
    v_mfma_f32_16x16x32_bf16 v[240:243], v[64:67], a[76:79], v[240:243]
    ds_read_b64_tr_b16 a[42:43], v14 offset:2304
    v_mfma_f32_16x16x32_bf16 v[240:243], v[80:83], a[92:95], v[240:243]
    v_mfma_f32_16x16x32_bf16 v[196:199], v[36:39], a[0:3], v[196:199]
    v_mfma_f32_16x16x32_bf16 v[196:199], v[52:55], a[16:19], v[196:199]
    ds_read_b64_tr_b16 a[44:45], v15 offset:256
    v_mfma_f32_16x16x32_bf16 v[196:199], v[68:71], a[64:67], v[196:199]
    s_add_u32 m0, s62, 65536
    ds_read_b64_tr_b16 a[46:47], v15 offset:2304
    v_mfma_f32_16x16x32_bf16 v[196:199], v[84:87], a[80:83], v[196:199]
    buffer_load_dwordx4 v2, s[20:23], s83 offen offset:0 lds
    v_mfma_f32_16x16x32_bf16 v[212:215], v[36:39], a[4:7], v[212:215]
    v_mfma_f32_16x16x32_bf16 v[212:215], v[52:55], a[20:23], v[212:215]
    s_waitcnt vmcnt(9)
    ds_read_b64_tr_b16 a[48:49], v14 offset:16384
    v_mfma_f32_16x16x32_bf16 v[212:215], v[68:71], a[68:71], v[212:215]
    s_add_u32 s82, s61, 491648
    ds_read_b64_tr_b16 a[50:51], v14 offset:18432
    v_mfma_f32_16x16x32_bf16 v[212:215], v[84:87], a[84:87], v[212:215]
    buffer_load_dwordx4 v3, s[20:23], s83 offen offset:1024 lds
    v_mfma_f32_16x16x32_bf16 v[228:231], v[36:39], a[8:11], v[228:231]
    v_mfma_f32_16x16x32_bf16 v[228:231], v[52:55], a[24:27], v[228:231]
    ds_read_b64_tr_b16 a[52:53], v15 offset:16384
    v_mfma_f32_16x16x32_bf16 v[228:231], v[68:71], a[72:75], v[228:231]
    ds_read_b64_tr_b16 a[54:55], v15 offset:18432
    v_mfma_f32_16x16x32_bf16 v[228:231], v[84:87], a[88:91], v[228:231]
    buffer_load_dwordx4 v4, s[20:23], s83 offen offset:2048 lds
    v_mfma_f32_16x16x32_bf16 v[244:247], v[36:39], a[12:15], v[244:247]
    v_mfma_f32_16x16x32_bf16 v[244:247], v[52:55], a[28:31], v[244:247]
    ds_read_b64_tr_b16 a[56:57], v14 offset:16640
    v_mfma_f32_16x16x32_bf16 v[244:247], v[68:71], a[76:79], v[244:247]
    ds_read_b64_tr_b16 a[58:59], v14 offset:18688
    v_mfma_f32_16x16x32_bf16 v[244:247], v[84:87], a[92:95], v[244:247]
    buffer_load_dwordx4 v5, s[20:23], s83 offen offset:3072 lds
    v_mfma_f32_16x16x32_bf16 v[200:203], v[40:43], a[0:3], v[200:203]
    v_mfma_f32_16x16x32_bf16 v[200:203], v[56:59], a[16:19], v[200:203]
    ds_read_b64_tr_b16 a[60:61], v15 offset:16640
    v_mfma_f32_16x16x32_bf16 v[200:203], v[72:75], a[64:67], v[200:203]
    s_add_u32 m0, s62, 81920
    ds_read_b64_tr_b16 a[62:63], v15 offset:18688
    v_mfma_f32_16x16x32_bf16 v[200:203], v[88:91], a[80:83], v[200:203]
    buffer_load_dwordx4 v2, s[20:23], s82 offen offset:0 lds
    v_mfma_f32_16x16x32_bf16 v[216:219], v[40:43], a[4:7], v[216:219]
    buffer_load_dword v29, v25, s[48:51], s84 offen sc1
    v_mfma_f32_16x16x32_bf16 v[216:219], v[56:59], a[20:23], v[216:219]
    s_waitcnt vmcnt(10)
    ds_read_b64_tr_b16 a[96:97], v12 offset:32768
    v_mfma_f32_16x16x32_bf16 v[216:219], v[72:75], a[68:71], v[216:219]
    ds_read_b64_tr_b16 a[98:99], v12 offset:34816
    v_mfma_f32_16x16x32_bf16 v[216:219], v[88:91], a[84:87], v[216:219]
    buffer_load_dwordx4 v3, s[20:23], s82 offen offset:1024 lds
    v_mfma_f32_16x16x32_bf16 v[232:235], v[40:43], a[8:11], v[232:235]
    v_mfma_f32_16x16x32_bf16 v[232:235], v[56:59], a[24:27], v[232:235]
    ds_read_b64_tr_b16 a[100:101], v13 offset:32768
    v_mfma_f32_16x16x32_bf16 v[232:235], v[72:75], a[72:75], v[232:235]
    ds_read_b64_tr_b16 a[102:103], v13 offset:34816
    v_mfma_f32_16x16x32_bf16 v[232:235], v[88:91], a[88:91], v[232:235]
    buffer_load_dwordx4 v4, s[20:23], s82 offen offset:2048 lds
    v_mfma_f32_16x16x32_bf16 v[248:251], v[40:43], a[12:15], v[248:251]
    v_mfma_f32_16x16x32_bf16 v[248:251], v[56:59], a[28:31], v[248:251]
    ds_read_b64_tr_b16 a[104:105], v12 offset:33024
    v_mfma_f32_16x16x32_bf16 v[248:251], v[72:75], a[76:79], v[248:251]
    ds_read_b64_tr_b16 a[106:107], v12 offset:35072
    v_mfma_f32_16x16x32_bf16 v[248:251], v[88:91], a[92:95], v[248:251]
    buffer_load_dwordx4 v5, s[20:23], s82 offen offset:3072 lds
    v_mfma_f32_16x16x32_bf16 v[204:207], v[44:47], a[0:3], v[204:207]
    v_mfma_f32_16x16x32_bf16 v[204:207], v[60:63], a[16:19], v[204:207]
    s_waitcnt lgkmcnt(14)
    ds_read_b64_tr_b16 a[108:109], v13 offset:33024
    v_mfma_f32_16x16x32_bf16 v[204:207], v[76:79], a[64:67], v[204:207]
    s_add_u32 m0, s62, 131072
    ds_read_b64_tr_b16 a[110:111], v13 offset:35072
    v_mfma_f32_16x16x32_bf16 v[204:207], v[92:95], a[80:83], v[204:207]
    buffer_load_dwordx4 v11, s[4:7], s32 offen offset:0 lds
    v_mfma_f32_16x16x32_bf16 v[220:223], v[44:47], a[4:7], v[220:223]
    buffer_load_dwordx4 v11, s[4:7], s33 offen offset:1024 lds
    v_mfma_f32_16x16x32_bf16 v[220:223], v[60:63], a[20:23], v[220:223]
    s_waitcnt vmcnt(11)
    ds_read_b64_tr_b16 a[112:113], v12 offset:49152
    v_mfma_f32_16x16x32_bf16 v[220:223], v[76:79], a[68:71], v[220:223]
    ds_read_b64_tr_b16 a[114:115], v12 offset:51200
    v_mfma_f32_16x16x32_bf16 v[220:223], v[92:95], a[84:87], v[220:223]
    buffer_load_dwordx4 v20, s[48:51], s34 offen offset:2048 sc1 lds
    v_mfma_f32_16x16x32_bf16 v[236:239], v[44:47], a[8:11], v[236:239]
    buffer_load_dwordx4 v20, s[48:51], s35 offen offset:3072 sc1 lds
    s_waitcnt vmcnt(7)
    v_cmp_gt_u32 vcc, 1, v29
    s_nop 0
    s_cmp_eq_u64 vcc, 0
    s_cselect_b32 s72, 1, 0
    s_cselect_b32 s85, s80, 0x40000000
    v_mfma_f32_16x16x32_bf16 v[236:239], v[60:63], a[24:27], v[236:239]
    s_xor_b32 s58, s85, 0
    ds_read_b64_tr_b16 a[116:117], v13 offset:49152
    v_mfma_f32_16x16x32_bf16 v[236:239], v[76:79], a[72:75], v[236:239]
    ds_read_b64_tr_b16 a[118:119], v13 offset:51200
    v_mfma_f32_16x16x32_bf16 v[236:239], v[92:95], a[88:91], v[236:239]
    buffer_load_dwordx4 v[128:131], v21, s[48:51], s58 offen sc1 nt
    v_mfma_f32_16x16x32_bf16 v[252:255], v[44:47], a[12:15], v[252:255]
    v_mfma_f32_16x16x32_bf16 v[252:255], v[60:63], a[28:31], v[252:255]
    s_xor_b32 s58, s85, 18432
    ds_read_b64_tr_b16 a[120:121], v12 offset:49408
    v_mfma_f32_16x16x32_bf16 v[252:255], v[76:79], a[76:79], v[252:255]
    ds_read_b64_tr_b16 a[122:123], v12 offset:51456
    v_mfma_f32_16x16x32_bf16 v[252:255], v[92:95], a[92:95], v[252:255]
    buffer_load_dwordx4 v[132:135], v21, s[48:51], s58 offen sc1 nt
    v_mfma_f32_16x16x32_bf16 v[192:195], a[32:35], a[160:163], v[192:195]
    s_waitcnt lgkmcnt(15)
    v_mfma_f32_16x16x32_bf16 v[192:195], a[48:51], a[176:179], v[192:195]
    s_xor_b32 s58, s85, 1052672
    ds_read_b64_tr_b16 a[124:125], v13 offset:49408
    v_mfma_f32_16x16x32_bf16 v[208:211], a[32:35], a[164:167], v[208:211]
    ds_read_b64_tr_b16 a[126:127], v13 offset:51456
    v_mfma_f32_16x16x32_bf16 v[208:211], a[48:51], a[180:183], v[208:211]
    buffer_load_dwordx4 v[136:139], v21, s[48:51], s58 offen sc1 nt
    v_mfma_f32_16x16x32_bf16 v[224:227], a[32:35], a[168:171], v[224:227]
    v_mfma_f32_16x16x32_bf16 v[224:227], a[48:51], a[184:187], v[224:227]
    ds_read_b64_tr_b16 a[128:129], v12 offset:0
    v_mfma_f32_16x16x32_bf16 v[240:243], a[32:35], a[172:175], v[240:243]
    s_xor_b32 s58, s85, 1071104
    ds_read_b64_tr_b16 a[130:131], v12 offset:2048
    v_mfma_f32_16x16x32_bf16 v[240:243], a[48:51], a[188:191], v[240:243]
    buffer_load_dwordx4 v[140:143], v21, s[48:51], s58 offen sc1 nt
    v_mfma_f32_16x16x32_bf16 v[196:199], a[36:39], a[160:163], v[196:199]
    v_mfma_f32_16x16x32_bf16 v[196:199], a[52:55], a[176:179], v[196:199]
    s_xor_b32 s58, s85, 2105344
    ds_read_b64_tr_b16 a[132:133], v13 offset:0
    v_mfma_f32_16x16x32_bf16 v[212:215], a[36:39], a[164:167], v[212:215]
    ds_read_b64_tr_b16 a[134:135], v13 offset:2048
    v_mfma_f32_16x16x32_bf16 v[212:215], a[52:55], a[180:183], v[212:215]
    buffer_load_dwordx4 v[144:147], v21, s[48:51], s58 offen sc1 nt
    v_mfma_f32_16x16x32_bf16 v[228:231], a[36:39], a[168:171], v[228:231]
    v_mfma_f32_16x16x32_bf16 v[228:231], a[52:55], a[184:187], v[228:231]
    s_xor_b32 s58, s85, 2123776
    ds_read_b64_tr_b16 a[136:137], v12 offset:256
    v_mfma_f32_16x16x32_bf16 v[244:247], a[36:39], a[172:175], v[244:247]
    ds_read_b64_tr_b16 a[138:139], v12 offset:2304
    v_mfma_f32_16x16x32_bf16 v[244:247], a[52:55], a[188:191], v[244:247]
    buffer_load_dwordx4 v[148:151], v21, s[48:51], s58 offen sc1 nt
    v_mfma_f32_16x16x32_bf16 v[200:203], a[40:43], a[160:163], v[200:203]
    v_mfma_f32_16x16x32_bf16 v[200:203], a[56:59], a[176:179], v[200:203]
    s_xor_b32 s58, s85, 3158016
    ds_read_b64_tr_b16 a[140:141], v13 offset:256
    v_mfma_f32_16x16x32_bf16 v[216:219], a[40:43], a[164:167], v[216:219]
    ds_read_b64_tr_b16 a[142:143], v13 offset:2304
    v_mfma_f32_16x16x32_bf16 v[216:219], a[56:59], a[180:183], v[216:219]
    s_waitcnt vmcnt(10)
    ds_read_b64_tr_b16 a[144:145], v12 offset:16384
    v_mfma_f32_16x16x32_bf16 v[232:235], a[40:43], a[168:171], v[232:235]
    ds_read_b64_tr_b16 a[146:147], v12 offset:18432
    v_mfma_f32_16x16x32_bf16 v[232:235], a[56:59], a[184:187], v[232:235]
    buffer_load_dwordx4 v[152:155], v21, s[48:51], s58 offen sc1 nt
    v_mfma_f32_16x16x32_bf16 v[248:251], a[40:43], a[172:175], v[248:251]
    v_mfma_f32_16x16x32_bf16 v[248:251], a[56:59], a[188:191], v[248:251]
    ds_read_b64_tr_b16 a[148:149], v13 offset:16384
    v_mfma_f32_16x16x32_bf16 v[204:207], a[44:47], a[160:163], v[204:207]
    s_waitcnt lgkmcnt(15)
    ds_read_b64_tr_b16 a[150:151], v13 offset:18432
    v_mfma_f32_16x16x32_bf16 v[204:207], a[60:63], a[176:179], v[204:207]
    v_mfma_f32_16x16x32_bf16 v[220:223], a[44:47], a[164:167], v[220:223]
    v_mfma_f32_16x16x32_bf16 v[220:223], a[60:63], a[180:183], v[220:223]
    ds_read_b64_tr_b16 a[152:153], v12 offset:16640
    v_mfma_f32_16x16x32_bf16 v[236:239], a[44:47], a[168:171], v[236:239]
    ds_read_b64_tr_b16 a[154:155], v12 offset:18688
    v_mfma_f32_16x16x32_bf16 v[236:239], a[60:63], a[184:187], v[236:239]
    v_mfma_f32_16x16x32_bf16 v[252:255], a[44:47], a[172:175], v[252:255]
    v_mfma_f32_16x16x32_bf16 v[252:255], a[60:63], a[188:191], v[252:255]
    ds_read_b64_tr_b16 a[156:157], v13 offset:16640
    v_mfma_f32_16x16x32_bf16 v[192:195], a[96:99], a[192:195], v[192:195]
    ds_read_b64_tr_b16 a[158:159], v13 offset:18688
    v_mfma_f32_16x16x32_bf16 v[192:195], a[112:115], a[208:211], v[192:195]
    s_waitcnt lgkmcnt(14)
    v_mfma_f32_16x16x32_bf16 v[192:195], a[128:131], a[224:227], v[192:195]
    s_waitcnt lgkmcnt(6)
    v_mfma_f32_16x16x32_bf16 v[192:195], a[144:147], a[240:243], v[192:195]
    v_mfma_f32_16x16x32_bf16 v[196:199], a[100:103], a[192:195], v[196:199]
    v_mfma_f32_16x16x32_bf16 v[196:199], a[116:119], a[208:211], v[196:199]
    s_waitcnt lgkmcnt(0)
    s_barrier
    v_mfma_f32_16x16x32_bf16 v[196:199], a[132:135], a[224:227], v[196:199]
    v_mfma_f32_16x16x32_bf16 v[196:199], a[148:151], a[240:243], v[196:199]
    v_mfma_f32_16x16x32_bf16 v[200:203], a[104:107], a[192:195], v[200:203]
    v_mfma_f32_16x16x32_bf16 v[200:203], a[120:123], a[208:211], v[200:203]
    v_mfma_f32_16x16x32_bf16 v[200:203], a[136:139], a[224:227], v[200:203]
    v_mfma_f32_16x16x32_bf16 v[200:203], a[152:155], a[240:243], v[200:203]
    v_mfma_f32_16x16x32_bf16 v[204:207], a[108:111], a[192:195], v[204:207]
    v_mfma_f32_16x16x32_bf16 v[204:207], a[124:127], a[208:211], v[204:207]
    v_mfma_f32_16x16x32_bf16 v[204:207], a[140:143], a[224:227], v[204:207]
    v_mfma_f32_16x16x32_bf16 v[204:207], a[156:159], a[240:243], v[204:207]
    v_mfma_f32_16x16x32_bf16 v[208:211], a[96:99], a[196:199], v[208:211]
    v_mfma_f32_16x16x32_bf16 v[208:211], a[112:115], a[212:215], v[208:211]
    v_mfma_f32_16x16x32_bf16 v[208:211], a[128:131], a[228:231], v[208:211]
    s_add_u32 s67, s66, 8388608
    v_cvt_pk_bf16_f32 v192, v192, v193
    v_cvt_pk_bf16_f32 v193, v194, v195
    v_mfma_f32_16x16x32_bf16 v[208:211], a[144:147], a[244:247], v[208:211]
    v_cvt_pk_bf16_f32 v194, v196, v197
    v_cvt_pk_bf16_f32 v195, v198, v199
    v_mfma_f32_16x16x32_bf16 v[212:215], a[100:103], a[196:199], v[212:215]
    buffer_store_dwordx4 v[192:195], v24, s[48:51], s67 offen sc1
    v_mfma_f32_16x16x32_bf16 v[212:215], a[116:119], a[212:215], v[212:215]
    s_add_u32 s68, s66, 12582912
    v_cvt_pk_bf16_f32 v200, v200, v201
    v_cvt_pk_bf16_f32 v201, v202, v203
    v_mfma_f32_16x16x32_bf16 v[212:215], a[132:135], a[228:231], v[212:215]
    v_cvt_pk_bf16_f32 v202, v204, v205
    v_cvt_pk_bf16_f32 v203, v206, v207
    v_mfma_f32_16x16x32_bf16 v[212:215], a[148:151], a[244:247], v[212:215]
    buffer_store_dwordx4 v[200:203], v24, s[48:51], s68 offen sc1
    v_mfma_f32_16x16x32_bf16 v[216:219], a[104:107], a[196:199], v[216:219]
    v_mfma_f32_16x16x32_bf16 v[216:219], a[120:123], a[212:215], v[216:219]
    v_mfma_f32_16x16x32_bf16 v[216:219], a[136:139], a[228:231], v[216:219]
    v_mfma_f32_16x16x32_bf16 v[216:219], a[152:155], a[244:247], v[216:219]
    v_mfma_f32_16x16x32_bf16 v[220:223], a[108:111], a[196:199], v[220:223]
    v_mfma_f32_16x16x32_bf16 v[220:223], a[124:127], a[212:215], v[220:223]
    v_mfma_f32_16x16x32_bf16 v[220:223], a[140:143], a[228:231], v[220:223]
    v_mfma_f32_16x16x32_bf16 v[220:223], a[156:159], a[244:247], v[220:223]
    v_mfma_f32_16x16x32_bf16 v[224:227], a[96:99], a[200:203], v[224:227]
    v_mfma_f32_16x16x32_bf16 v[224:227], a[112:115], a[216:219], v[224:227]
    v_mfma_f32_16x16x32_bf16 v[224:227], a[128:131], a[232:235], v[224:227]
    s_add_u32 s67, s66, 9437184
    v_cvt_pk_bf16_f32 v208, v208, v209
    v_cvt_pk_bf16_f32 v209, v210, v211
    v_mfma_f32_16x16x32_bf16 v[224:227], a[144:147], a[248:251], v[224:227]
    v_cvt_pk_bf16_f32 v210, v212, v213
    v_cvt_pk_bf16_f32 v211, v214, v215
    v_mfma_f32_16x16x32_bf16 v[228:231], a[100:103], a[200:203], v[228:231]
    buffer_store_dwordx4 v[208:211], v24, s[48:51], s67 offen sc1
    v_mfma_f32_16x16x32_bf16 v[228:231], a[116:119], a[216:219], v[228:231]
    s_add_u32 s68, s66, 13631488
    v_cvt_pk_bf16_f32 v216, v216, v217
    v_cvt_pk_bf16_f32 v217, v218, v219
    v_mfma_f32_16x16x32_bf16 v[228:231], a[132:135], a[232:235], v[228:231]
    v_cvt_pk_bf16_f32 v218, v220, v221
    v_cvt_pk_bf16_f32 v219, v222, v223
    v_mfma_f32_16x16x32_bf16 v[228:231], a[148:151], a[248:251], v[228:231]
    buffer_store_dwordx4 v[216:219], v24, s[48:51], s68 offen sc1
    v_mfma_f32_16x16x32_bf16 v[232:235], a[104:107], a[200:203], v[232:235]
    v_mfma_f32_16x16x32_bf16 v[232:235], a[120:123], a[216:219], v[232:235]
    v_mfma_f32_16x16x32_bf16 v[232:235], a[136:139], a[232:235], v[232:235]
    v_mfma_f32_16x16x32_bf16 v[232:235], a[152:155], a[248:251], v[232:235]
    v_mfma_f32_16x16x32_bf16 v[236:239], a[108:111], a[200:203], v[236:239]
    v_mfma_f32_16x16x32_bf16 v[236:239], a[124:127], a[216:219], v[236:239]
    v_mfma_f32_16x16x32_bf16 v[236:239], a[140:143], a[232:235], v[236:239]
    v_mfma_f32_16x16x32_bf16 v[236:239], a[156:159], a[248:251], v[236:239]
    v_mfma_f32_16x16x32_bf16 v[240:243], a[96:99], a[204:207], v[240:243]
    v_mfma_f32_16x16x32_bf16 v[240:243], a[112:115], a[220:223], v[240:243]
    v_mfma_f32_16x16x32_bf16 v[240:243], a[128:131], a[236:239], v[240:243]
    s_add_u32 s67, s66, 10485760
    v_cvt_pk_bf16_f32 v224, v224, v225
    v_cvt_pk_bf16_f32 v225, v226, v227
    v_mfma_f32_16x16x32_bf16 v[240:243], a[144:147], a[252:255], v[240:243]
    v_cvt_pk_bf16_f32 v226, v228, v229
    v_cvt_pk_bf16_f32 v227, v230, v231
    v_mfma_f32_16x16x32_bf16 v[244:247], a[100:103], a[204:207], v[244:247]
    buffer_store_dwordx4 v[224:227], v24, s[48:51], s67 offen sc1
    v_mfma_f32_16x16x32_bf16 v[244:247], a[116:119], a[220:223], v[244:247]
    s_add_u32 s68, s66, 14680064
    v_cvt_pk_bf16_f32 v232, v232, v233
    v_cvt_pk_bf16_f32 v233, v234, v235
    v_mfma_f32_16x16x32_bf16 v[244:247], a[132:135], a[236:239], v[244:247]
    v_cvt_pk_bf16_f32 v234, v236, v237
    v_cvt_pk_bf16_f32 v235, v238, v239
    v_mfma_f32_16x16x32_bf16 v[244:247], a[148:151], a[252:255], v[244:247]
    buffer_store_dwordx4 v[232:235], v24, s[48:51], s68 offen sc1
    v_mfma_f32_16x16x32_bf16 v[248:251], a[104:107], a[204:207], v[248:251]
    v_mfma_f32_16x16x32_bf16 v[248:251], a[120:123], a[220:223], v[248:251]
    v_mfma_f32_16x16x32_bf16 v[248:251], a[136:139], a[236:239], v[248:251]
    v_mfma_f32_16x16x32_bf16 v[248:251], a[152:155], a[252:255], v[248:251]
    v_mfma_f32_16x16x32_bf16 v[252:255], a[108:111], a[204:207], v[252:255]
    v_mfma_f32_16x16x32_bf16 v[252:255], a[124:127], a[220:223], v[252:255]
    v_mfma_f32_16x16x32_bf16 v[252:255], a[140:143], a[236:239], v[252:255]
    v_mfma_f32_16x16x32_bf16 v[252:255], a[156:159], a[252:255], v[252:255]
    s_add_u32 s67, s66, 11534336
    s_add_u32 s68, s66, 15728640
    v_cvt_pk_bf16_f32 v240, v240, v241
    v_cvt_pk_bf16_f32 v241, v242, v243
    v_cvt_pk_bf16_f32 v242, v244, v245
    v_cvt_pk_bf16_f32 v243, v246, v247
    buffer_store_dwordx4 v[240:243], v22, s[48:51], s67 offen sc1
    v_cvt_pk_bf16_f32 v248, v248, v249
    v_cvt_pk_bf16_f32 v249, v250, v251
    v_cvt_pk_bf16_f32 v250, v252, v253
    v_cvt_pk_bf16_f32 v251, v254, v255
    buffer_store_dwordx4 v[248:251], v22, s[48:51], s68 offen sc1
    ds_write_b128 v27, v[240:243] offset:0
    ds_write_b128 v27, v[248:251] offset:1024
    ds_read_b128 v[188:191], v26 offset:128
    s_waitcnt vmcnt(15)
    v_and_b32 v120, 7, v0
    v_lshlrev_b32 v120, 8, v120
    v_lshrrev_b32 v121, 5, v0
    v_lshl_add_u32 v120, v121, 6, v120
    v_bfe_u32 v121, v0, 3, 2
    v_lshl_add_u32 v120, v121, 3, v120
    v_lshrrev_b32 v121, 5, v0
    v_lshlrev_b32 v121, 7, v121
    v_bfe_u32 v122, v0, 3, 2
    v_lshl_add_u32 v121, v122, 4, v121
    s_add_u32 s55, s62, 131072
    v_add_u32 v120, s55, v120
    v_add_u32 v121, s55, v121
    ds_read_b64 v[96:97], v120 offset:0
    ds_read_b64 v[98:99], v120 offset:32
    ds_read_b64 v[100:101], v120 offset:128
    ds_read_b64 v[102:103], v120 offset:160
    ds_read_b128 v[192:195], v121 offset:2048
    ds_read_b128 v[196:199], v121 offset:2112
    ds_read_b128 v[200:203], v121 offset:2304
    ds_read_b128 v[204:207], v121 offset:2368
    ds_read_b128 v[208:211], v121 offset:2560
    ds_read_b128 v[212:215], v121 offset:2624
    ds_read_b128 v[216:219], v121 offset:2816
    ds_read_b128 v[220:223], v121 offset:2880
    ds_read_b128 v[224:227], v121 offset:3072
    ds_read_b128 v[228:231], v121 offset:3136
    ds_read_b128 v[232:235], v121 offset:3328
    ds_read_b128 v[236:239], v121 offset:3392
    s_waitcnt lgkmcnt(15)
    v_lshlrev_b32 v64, 16, v96
    v_and_b32 v65, s59, v96
    v_lshlrev_b32 v66, 16, v97
    v_and_b32 v67, s59, v97
    s_waitcnt lgkmcnt(14)
    v_lshlrev_b32 v68, 16, v98
    v_and_b32 v69, s59, v98
    v_lshlrev_b32 v70, 16, v99
    v_and_b32 v71, s59, v99
    s_waitcnt lgkmcnt(13)
    v_lshlrev_b32 v72, 16, v100
    v_and_b32 v73, s59, v100
    v_lshlrev_b32 v74, 16, v101
    v_and_b32 v75, s59, v101
    s_waitcnt lgkmcnt(12)
    v_lshlrev_b32 v76, 16, v102
    v_and_b32 v77, s59, v102
    v_lshlrev_b32 v78, 16, v103
    v_and_b32 v79, s59, v103
    v_mov_b32 v122, 0x3f80
    v_mov_b32 v123, 0x3f800000
    v_mov_b32 v30, 2
    s_waitcnt vmcnt(6)
    s_mov_b64 exec, 0x03
    buffer_store_dword v30, v28, s[48:51], s70 offen sc1
    s_mov_b64 exec, -1
    v_and_b32 v125, 7, v0
    v_lshlrev_b32 v125, 6, v125
    v_add_u32 v125, 147456, v125
    s_lshl_b32 s56, s52, 4
    v_lshrrev_b32 v124, 4, v0
    v_lshl_add_u32 v124, v124, 2, v125
    v_add_u32 v124, s56, v124
    v_lshrrev_b32 v126, 3, v0
    v_lshlrev_b32 v126, 8, v126
    v_and_b32 v127, 7, v0
    v_lshl_add_u32 v126, v127, 4, v126
    s_lshr_b32 s64, s3, 1
    s_lshl_b32 s64, s64, 14
    s_and_b32 s56, s3, 1
    s_lshl_b32 s56, s56, 7
    s_add_u32 s64, s64, s56
    s_add_u32 s64, s64, s62
    s_add_u32 s64, s64, 4194304
    s_lshl_b32 s65, s3, 13
    s_lshl_b32 s56, s52, 11
    s_add_u32 s65, s65, s56
    s_add_u32 s65, s65, 2097152
    v_mov_b32 v30, 2
    s_waitcnt vmcnt(5)
    s_mov_b64 exec, 0x0c
    buffer_store_dword v30, v28, s[48:51], s70 offen sc1
    s_mov_b64 exec, -1
    s_add_u32 m0, s62, 0
    s_add_u32 s57, s79, 0
    buffer_load_dwordx4 v6, s[24:27], s57 offen offset:0 lds
    buffer_load_dwordx4 v7, s[24:27], s57 offen offset:1024 lds
    buffer_load_dwordx4 v8, s[24:27], s57 offen offset:2048 lds
    buffer_load_dwordx4 v9, s[24:27], s57 offen offset:3072 lds
    s_add_u32 m0, s62, 16384
    s_add_u32 s57, s79, 458752
    buffer_load_dwordx4 v6, s[24:27], s57 offen offset:0 lds
    buffer_load_dwordx4 v7, s[24:27], s57 offen offset:1024 lds
    buffer_load_dwordx4 v8, s[24:27], s57 offen offset:2048 lds
    buffer_load_dwordx4 v9, s[24:27], s57 offen offset:3072 lds
    v_mov_b32 v30, 2
    s_waitcnt vmcnt(12)
    s_mov_b64 exec, 0x30
    buffer_store_dword v30, v28, s[48:51], s70 offen sc1
    s_mov_b64 exec, -1
    v_mov_b32 v30, 2
    s_waitcnt vmcnt(11)
    s_mov_b64 exec, 0x40
    buffer_store_dword v30, v28, s[48:51], s70 offen sc1
L_hop1_10:
    s_cbranch_execz L_back1_0
    s_mov_b64 exec, -1
    s_waitcnt lgkmcnt(0)
    s_cmp_lg_u32 s72, 0
    s_cbranch_scc1 L_late_23
    s_mov_b32 s98, 0x200000
L_sp_24:
    s_load_dwordx8 s[88:95], s[86:87], 0 glc
    s_sub_u32 s98, s98, 1
    s_waitcnt lgkmcnt(0)
    s_cbranch_scc1 L_spout_25
    s_min_u32 s88, s88, s89
    s_min_u32 s90, s90, s91
    s_min_u32 s92, s92, s93
    s_min_u32 s88, s88, s90
    s_min_u32 s92, s92, s94
    s_min_u32 s88, s88, s92
    s_cmp_lt_u32 s88, 1
    s_cbranch_scc1 L_sp_24
L_spout_25:
    s_xor_b32 s55, s80, 0
    buffer_load_dwordx4 v[128:131], v21, s[48:51], s55 offen sc1 nt
    s_xor_b32 s55, s80, 18432
    buffer_load_dwordx4 v[132:135], v21, s[48:51], s55 offen sc1 nt
    s_xor_b32 s55, s80, 1052672
    buffer_load_dwordx4 v[136:139], v21, s[48:51], s55 offen sc1 nt
    s_xor_b32 s55, s80, 1071104
    buffer_load_dwordx4 v[140:143], v21, s[48:51], s55 offen sc1 nt
    s_xor_b32 s55, s80, 2105344
    buffer_load_dwordx4 v[144:147], v21, s[48:51], s55 offen sc1 nt
    s_xor_b32 s55, s80, 2123776
    buffer_load_dwordx4 v[148:151], v21, s[48:51], s55 offen sc1 nt
    s_xor_b32 s55, s80, 3158016
    buffer_load_dwordx4 v[152:155], v21, s[48:51], s55 offen sc1 nt
L_late_23:
    s_add_u32 m0, s62, 32768
    s_add_u32 s57, s79, 128
    buffer_load_dwordx4 v6, s[24:27], s57 offen offset:0 lds
    buffer_load_dwordx4 v7, s[24:27], s57 offen offset:1024 lds
    buffer_load_dwordx4 v8, s[24:27], s57 offen offset:2048 lds
    buffer_load_dwordx4 v9, s[24:27], s57 offen offset:3072 lds
    s_add_u32 m0, s62, 49152
    s_add_u32 s57, s79, 458880
    buffer_load_dwordx4 v6, s[24:27], s57 offen offset:0 lds
    buffer_load_dwordx4 v7, s[24:27], s57 offen offset:1024 lds
    buffer_load_dwordx4 v8, s[24:27], s57 offen offset:2048 lds
    buffer_load_dwordx4 v9, s[24:27], s57 offen offset:3072 lds
    s_add_u32 m0, s62, 65536
    s_add_u32 s57, s79, 917504
    buffer_load_dwordx4 v6, s[24:27], s57 offen offset:0 lds
    buffer_load_dwordx4 v7, s[24:27], s57 offen offset:1024 lds
    buffer_load_dwordx4 v8, s[24:27], s57 offen offset:2048 lds
    buffer_load_dwordx4 v9, s[24:27], s57 offen offset:3072 lds
    s_add_u32 m0, s62, 81920
    s_add_u32 s57, s79, 1376256
    buffer_load_dwordx4 v6, s[24:27], s57 offen offset:0 lds
    buffer_load_dwordx4 v7, s[24:27], s57 offen offset:1024 lds
    buffer_load_dwordx4 v8, s[24:27], s57 offen offset:2048 lds
    buffer_load_dwordx4 v9, s[24:27], s57 offen offset:3072 lds
    s_load_dwordx8 s[88:95], s[86:87], 0 glc
    s_add_u32 m0, s62, 98304
    s_add_u32 s57, s79, 917632
    buffer_load_dwordx4 v6, s[24:27], s57 offen offset:0 lds
    buffer_load_dwordx4 v7, s[24:27], s57 offen offset:1024 lds
    buffer_load_dwordx4 v8, s[24:27], s57 offen offset:2048 lds
    buffer_load_dwordx4 v9, s[24:27], s57 offen offset:3072 lds
    s_add_u32 m0, s62, 114688
    s_add_u32 s57, s79, 1376384
    buffer_load_dwordx4 v6, s[24:27], s57 offen offset:0 lds
    buffer_load_dwordx4 v7, s[24:27], s57 offen offset:1024 lds
    buffer_load_dwordx4 v8, s[24:27], s57 offen offset:2048 lds
    buffer_load_dwordx4 v9, s[24:27], s57 offen offset:3072 lds
    s_waitcnt lgkmcnt(0)
    s_min_u32 s88, s88, s89
    s_min_u32 s90, s90, s91
    s_min_u32 s92, s92, s93
    s_min_u32 s88, s88, s90
    s_min_u32 s92, s92, s94
    s_min_u32 s88, s88, s92
    s_cmp_lt_u32 s88, 2
    s_cbranch_scc0 L_fcj_27
    s_mov_b32 s98, 0x200000
L_sp_28:
    s_load_dwordx8 s[88:95], s[86:87], 0 glc
    s_sub_u32 s98, s98, 1
    s_waitcnt lgkmcnt(0)
    s_cbranch_scc1 L_spout_29
    s_min_u32 s88, s88, s89
    s_min_u32 s90, s90, s91
    s_min_u32 s92, s92, s93
    s_min_u32 s88, s88, s90
    s_min_u32 s92, s92, s94
    s_min_u32 s88, s88, s92
    s_cmp_lt_u32 s88, 2
    s_cbranch_scc1 L_sp_28
L_spout_29:
L_fcj_27:
    s_xor_b32 s55, s80, 8388608
    buffer_load_dwordx4 v[160:163], v21, s[48:51], s55 offen sc1 nt
    s_xor_b32 s55, s80, 8407040
    buffer_load_dwordx4 v[164:167], v21, s[48:51], s55 offen sc1 nt
    s_xor_b32 s55, s80, 9441280
    buffer_load_dwordx4 v[168:171], v21, s[48:51], s55 offen sc1 nt
    s_xor_b32 s55, s80, 9459712
    buffer_load_dwordx4 v[172:175], v21, s[48:51], s55 offen sc1 nt
    s_xor_b32 s55, s80, 10493952
    buffer_load_dwordx4 v[176:179], v21, s[48:51], s55 offen sc1 nt
    s_xor_b32 s55, s80, 10512384
    buffer_load_dwordx4 v[180:183], v21, s[48:51], s55 offen sc1 nt
    s_xor_b32 s55, s80, 11546624
    buffer_load_dwordx4 v[184:187], v21, s[48:51], s55 offen sc1 nt
    s_mov_b64 exec, 0
    s_cmp_eq_u32 s52, 0
    s_cbranch_scc1 L_hop2_0
    s_cmp_eq_u32 s52, 1
    s_cbranch_scc1 L_hop2_1
    s_cmp_eq_u32 s52, 2
    s_cbranch_scc1 L_hop2_2
    s_branch L_hop2_3
L_back2_0:
L_hop2_3:
    s_mov_b64 exec, -1
    v_lshlrev_b32 v28, 7, v0
    s_lshr_b32 s70, s3, 4
    s_mul_i32 s70, s70, 1792
    s_and_b32 s55, s3, 15
    s_lshl2_add_u32 s70, s55, s70
    s_add_u32 s70, s70, 196608
    s_waitcnt vmcnt(23)
    s_barrier
    ds_read_b64_tr_b16 a[0:1], v18 offset:0
    ds_read_b64_tr_b16 a[2:3], v18 offset:2048
    ds_read_b64_tr_b16 a[4:5], v19 offset:0
    ds_read_b64_tr_b16 a[6:7], v19 offset:2048
    ds_read_b64_tr_b16 a[8:9], v18 offset:256
    ds_read_b64_tr_b16 a[10:11], v18 offset:2304
    ds_read_b64_tr_b16 a[12:13], v19 offset:256
    ds_read_b64_tr_b16 a[14:15], v19 offset:2304
    ds_read_b64_tr_b16 a[16:17], v18 offset:4096
    ds_read_b64_tr_b16 a[18:19], v18 offset:6144
    ds_read_b64_tr_b16 a[20:21], v19 offset:4096
    ds_read_b64_tr_b16 a[22:23], v19 offset:6144
    ds_read_b64_tr_b16 a[24:25], v18 offset:4352
    ds_read_b64_tr_b16 a[26:27], v18 offset:6400
    ds_read_b64_tr_b16 a[28:29], v19 offset:4352
    ds_read_b64_tr_b16 a[30:31], v19 offset:6400
    ds_read_b64_tr_b16 a[32:33], v18 offset:8192
    ds_read_b64_tr_b16 a[34:35], v18 offset:10240
    ds_read_b64_tr_b16 a[36:37], v19 offset:8192
    ds_read_b64_tr_b16 a[38:39], v19 offset:10240
    ds_read_b64_tr_b16 a[40:41], v18 offset:8448
    ds_read_b64_tr_b16 a[42:43], v18 offset:10496
    ds_read_b64_tr_b16 a[44:45], v19 offset:8448
    ds_read_b64_tr_b16 a[46:47], v19 offset:10496
    ds_read_b64_tr_b16 a[48:49], v18 offset:12288
    ds_read_b64_tr_b16 a[50:51], v18 offset:14336
    ds_read_b64_tr_b16 a[52:53], v19 offset:12288
    ds_read_b64_tr_b16 a[54:55], v19 offset:14336
    ds_read_b64_tr_b16 a[56:57], v18 offset:12544
    ds_read_b64_tr_b16 a[58:59], v18 offset:14592
    ds_read_b64_tr_b16 a[60:61], v19 offset:12544
    ds_read_b64_tr_b16 a[62:63], v19 offset:14592
    ds_read_b64_tr_b16 a[64:65], v18 offset:16384
    ds_read_b64_tr_b16 a[66:67], v18 offset:18432
    ds_read_b64_tr_b16 a[68:69], v19 offset:16384
    ds_read_b64_tr_b16 a[70:71], v19 offset:18432
    ds_read_b64_tr_b16 a[72:73], v18 offset:16640
    ds_read_b64_tr_b16 a[74:75], v18 offset:18688
    ds_read_b64_tr_b16 a[76:77], v19 offset:16640
    ds_read_b64_tr_b16 a[78:79], v19 offset:18688
    ds_read_b64_tr_b16 a[80:81], v18 offset:20480
    ds_read_b64_tr_b16 a[82:83], v18 offset:22528
    ds_read_b64_tr_b16 a[84:85], v19 offset:20480
    ds_read_b64_tr_b16 a[86:87], v19 offset:22528
    ds_read_b64_tr_b16 a[88:89], v18 offset:20736
    ds_read_b64_tr_b16 a[90:91], v18 offset:22784
    ds_read_b64_tr_b16 a[92:93], v19 offset:20736
    ds_read_b64_tr_b16 a[94:95], v19 offset:22784
    ds_read_b64_tr_b16 a[96:97], v18 offset:24576
    ds_read_b64_tr_b16 a[98:99], v18 offset:26624
    ds_read_b64_tr_b16 a[100:101], v19 offset:24576
    ds_read_b64_tr_b16 a[102:103], v19 offset:26624
    ds_read_b64_tr_b16 a[104:105], v18 offset:24832
    ds_read_b64_tr_b16 a[106:107], v18 offset:26880
    ds_read_b64_tr_b16 a[108:109], v19 offset:24832
    ds_read_b64_tr_b16 a[110:111], v19 offset:26880
    ds_read_b64_tr_b16 a[112:113], v18 offset:28672
    ds_read_b64_tr_b16 a[114:115], v18 offset:30720
    ds_read_b64_tr_b16 a[116:117], v19 offset:28672
    ds_read_b64_tr_b16 a[118:119], v19 offset:30720
    ds_read_b64_tr_b16 a[120:121], v18 offset:28928
    ds_read_b64_tr_b16 a[122:123], v18 offset:30976
    ds_read_b64_tr_b16 a[124:125], v19 offset:28928
    ds_read_b64_tr_b16 a[126:127], v19 offset:30976
    v_add_u32 v18, 0x10000, v18
    v_add_u32 v19, 0x10000, v19
    s_waitcnt vmcnt(7)
    v_lshlrev_b32 v80, 16, v156
    v_and_b32 v81, s59, v156
    v_lshlrev_b32 v82, 16, v157
    v_and_b32 v83, s59, v157
    v_lshlrev_b32 v84, 16, v158
    v_and_b32 v85, s59, v158
    v_lshlrev_b32 v86, 16, v159
    v_and_b32 v87, s59, v159
    v_dot2c_f32_bf16 v80, v128, v122
    v_dot2c_f32_bf16 v81, v128, v123
    v_dot2c_f32_bf16 v82, v129, v122
    v_dot2c_f32_bf16 v83, v129, v123
    v_dot2c_f32_bf16 v84, v130, v122
    v_dot2c_f32_bf16 v85, v130, v123
    v_dot2c_f32_bf16 v86, v131, v122
    v_dot2c_f32_bf16 v87, v131, v123
    v_dot2c_f32_bf16 v80, v132, v122
    v_dot2c_f32_bf16 v81, v132, v123
    v_dot2c_f32_bf16 v82, v133, v122
    v_dot2c_f32_bf16 v83, v133, v123
    v_dot2c_f32_bf16 v84, v134, v122
    v_dot2c_f32_bf16 v85, v134, v123
    v_dot2c_f32_bf16 v86, v135, v122
    v_dot2c_f32_bf16 v87, v135, v123
    v_dot2c_f32_bf16 v80, v136, v122
    v_dot2c_f32_bf16 v81, v136, v123
    v_dot2c_f32_bf16 v82, v137, v122
    v_dot2c_f32_bf16 v83, v137, v123
    v_dot2c_f32_bf16 v84, v138, v122
    v_dot2c_f32_bf16 v85, v138, v123
    v_dot2c_f32_bf16 v86, v139, v122
    v_dot2c_f32_bf16 v87, v139, v123
    v_dot2c_f32_bf16 v80, v140, v122
    v_dot2c_f32_bf16 v81, v140, v123
    v_dot2c_f32_bf16 v82, v141, v122
    v_dot2c_f32_bf16 v83, v141, v123
    v_dot2c_f32_bf16 v84, v142, v122
    v_dot2c_f32_bf16 v85, v142, v123
    v_dot2c_f32_bf16 v86, v143, v122
    v_dot2c_f32_bf16 v87, v143, v123
    v_dot2c_f32_bf16 v80, v144, v122
    v_dot2c_f32_bf16 v81, v144, v123
    v_dot2c_f32_bf16 v82, v145, v122
    v_dot2c_f32_bf16 v83, v145, v123
    v_dot2c_f32_bf16 v84, v146, v122
    v_dot2c_f32_bf16 v85, v146, v123
    v_dot2c_f32_bf16 v86, v147, v122
    v_dot2c_f32_bf16 v87, v147, v123
    v_dot2c_f32_bf16 v80, v148, v122
    v_dot2c_f32_bf16 v81, v148, v123
    v_dot2c_f32_bf16 v82, v149, v122
    v_dot2c_f32_bf16 v83, v149, v123
    v_dot2c_f32_bf16 v84, v150, v122
    v_dot2c_f32_bf16 v85, v150, v123
    v_dot2c_f32_bf16 v86, v151, v122
    v_dot2c_f32_bf16 v87, v151, v123
    v_dot2c_f32_bf16 v80, v152, v122
    v_dot2c_f32_bf16 v81, v152, v123
    v_dot2c_f32_bf16 v82, v153, v122
    v_dot2c_f32_bf16 v83, v153, v123
    v_dot2c_f32_bf16 v84, v154, v122
    v_dot2c_f32_bf16 v85, v154, v123
    v_dot2c_f32_bf16 v86, v155, v122
    v_dot2c_f32_bf16 v87, v155, v123
    v_pk_fma_f32 v[80:81], v[80:81], v[192:193], v[64:65]
    v_pk_fma_f32 v[82:83], v[82:83], v[194:195], v[66:67]
    v_pk_fma_f32 v[84:85], v[84:85], v[196:197], v[68:69]
    v_pk_fma_f32 v[86:87], v[86:87], v[198:199], v[70:71]
    v_pk_add_f32 v[100:101], v[80:81], v[82:83]
    v_pk_mul_f32 v[98:99], v[80:81], v[80:81]
    v_pk_add_f32 v[96:97], v[84:85], v[86:87]
    v_pk_fma_f32 v[98:99], v[82:83], v[82:83], v[98:99]
    v_pk_fma_f32 v[98:99], v[84:85], v[84:85], v[98:99]
    v_pk_add_f32 v[96:97], v[96:97], v[100:101]
    v_pk_fma_f32 v[98:99], v[86:87], v[86:87], v[98:99]
L_sum0_30:
    v_lshlrev_b32 v88, 16, v188
    v_and_b32 v89, s59, v188
    v_lshlrev_b32 v90, 16, v189
    v_and_b32 v91, s59, v189
    v_lshlrev_b32 v92, 16, v190
    v_and_b32 v93, s59, v190
    v_lshlrev_b32 v94, 16, v191
    v_and_b32 v95, s59, v191
    s_waitcnt vmcnt(6)
    v_dot2c_f32_bf16 v88, v160, v122
    v_dot2c_f32_bf16 v89, v160, v123
    v_dot2c_f32_bf16 v90, v161, v122
    v_dot2c_f32_bf16 v91, v161, v123
    v_dot2c_f32_bf16 v92, v162, v122
    v_dot2c_f32_bf16 v93, v162, v123
    v_dot2c_f32_bf16 v94, v163, v122
    v_dot2c_f32_bf16 v95, v163, v123
    s_waitcnt vmcnt(5)
    v_dot2c_f32_bf16 v88, v164, v122
    v_dot2c_f32_bf16 v89, v164, v123
    v_dot2c_f32_bf16 v90, v165, v122
    v_dot2c_f32_bf16 v91, v165, v123
    v_dot2c_f32_bf16 v92, v166, v122
    v_dot2c_f32_bf16 v93, v166, v123
    v_dot2c_f32_bf16 v94, v167, v122
    v_dot2c_f32_bf16 v95, v167, v123
    s_waitcnt vmcnt(4)
    v_dot2c_f32_bf16 v88, v168, v122
    v_dot2c_f32_bf16 v89, v168, v123
    v_dot2c_f32_bf16 v90, v169, v122
    v_dot2c_f32_bf16 v91, v169, v123
    v_dot2c_f32_bf16 v92, v170, v122
    v_dot2c_f32_bf16 v93, v170, v123
    v_dot2c_f32_bf16 v94, v171, v122
    v_dot2c_f32_bf16 v95, v171, v123
    s_waitcnt vmcnt(3)
    v_dot2c_f32_bf16 v88, v172, v122
    v_dot2c_f32_bf16 v89, v172, v123
    v_dot2c_f32_bf16 v90, v173, v122
    v_dot2c_f32_bf16 v91, v173, v123
    v_dot2c_f32_bf16 v92, v174, v122
    v_dot2c_f32_bf16 v93, v174, v123
    v_dot2c_f32_bf16 v94, v175, v122
    v_dot2c_f32_bf16 v95, v175, v123
    s_waitcnt vmcnt(2)
    v_dot2c_f32_bf16 v88, v176, v122
    v_dot2c_f32_bf16 v89, v176, v123
    v_dot2c_f32_bf16 v90, v177, v122
    v_dot2c_f32_bf16 v91, v177, v123
    v_dot2c_f32_bf16 v92, v178, v122
    v_dot2c_f32_bf16 v93, v178, v123
    v_dot2c_f32_bf16 v94, v179, v122
    v_dot2c_f32_bf16 v95, v179, v123
    s_waitcnt vmcnt(1)
    v_dot2c_f32_bf16 v88, v180, v122
    v_dot2c_f32_bf16 v89, v180, v123
    v_dot2c_f32_bf16 v90, v181, v122
    v_dot2c_f32_bf16 v91, v181, v123
    v_dot2c_f32_bf16 v92, v182, v122
    v_dot2c_f32_bf16 v93, v182, v123
    v_dot2c_f32_bf16 v94, v183, v122
    v_dot2c_f32_bf16 v95, v183, v123
    s_waitcnt vmcnt(0)
    v_dot2c_f32_bf16 v88, v184, v122
    v_dot2c_f32_bf16 v89, v184, v123
    v_dot2c_f32_bf16 v90, v185, v122
    v_dot2c_f32_bf16 v91, v185, v123
    v_dot2c_f32_bf16 v92, v186, v122
    v_dot2c_f32_bf16 v93, v186, v123
    v_dot2c_f32_bf16 v94, v187, v122
    v_dot2c_f32_bf16 v95, v187, v123
    v_pk_fma_f32 v[88:89], v[88:89], v[200:201], v[72:73]
    v_pk_fma_f32 v[90:91], v[90:91], v[202:203], v[74:75]
    v_pk_fma_f32 v[92:93], v[92:93], v[204:205], v[76:77]
    v_pk_fma_f32 v[94:95], v[94:95], v[206:207], v[78:79]
    v_pk_add_f32 v[100:101], v[88:89], v[90:91]
    v_pk_fma_f32 v[98:99], v[88:89], v[88:89], v[98:99]
    v_pk_add_f32 v[96:97], v[96:97], v[92:93]
    v_pk_fma_f32 v[98:99], v[90:91], v[90:91], v[98:99]
    v_pk_add_f32 v[100:101], v[100:101], v[94:95]
    v_pk_fma_f32 v[98:99], v[92:93], v[92:93], v[98:99]
    v_pk_add_f32 v[96:97], v[96:97], v[100:101]
    v_pk_fma_f32 v[98:99], v[94:95], v[94:95], v[98:99]
    v_add_f32 v96, v96, v97
    v_add_f32 v98, v98, v99
    v_cvt_pk_bf16_f32 v112, v80, v81
    v_cvt_pk_bf16_f32 v113, v82, v83
    v_permlane16_swap_b32 v96, v98
    v_add_f32 v96, v96, v98
    v_cvt_pk_bf16_f32 v114, v84, v85
    v_cvt_pk_bf16_f32 v115, v86, v87
    v_add_f32_dpp v96, v96, v96 row_ror:8 row_mask:0xf bank_mask:0xf
    ds_write_b32 v124, v96
    v_cvt_pk_bf16_f32 v116, v88, v89
    v_cvt_pk_bf16_f32 v117, v90, v91
    v_cvt_pk_bf16_f32 v118, v92, v93
    v_cvt_pk_bf16_f32 v119, v94, v95
    s_waitcnt lgkmcnt(0)
    s_barrier
    ds_read_b128 v[128:131], v125 offset:0
    ds_read_b128 v[132:135], v125 offset:16
    ds_read_b128 v[136:139], v125 offset:32
    ds_read_b128 v[140:143], v125 offset:48
    buffer_store_dwordx4 v[112:115], v10, s[48:51], s65 offen offset:0 sc1
    buffer_store_dwordx4 v[116:119], v10, s[48:51], s65 offen offset:1024 sc1
    s_waitcnt lgkmcnt(3)
    v_pk_add_f32 v[128:129], v[128:129], v[130:131]
    s_waitcnt lgkmcnt(2)
    v_pk_add_f32 v[132:133], v[132:133], v[134:135]
    s_waitcnt lgkmcnt(1)
    v_pk_add_f32 v[136:137], v[136:137], v[138:139]
    s_waitcnt lgkmcnt(0)
    v_pk_add_f32 v[140:141], v[140:141], v[142:143]
    v_pk_add_f32 v[128:129], v[128:129], v[132:133]
    v_pk_add_f32 v[136:137], v[136:137], v[140:141]
    v_pk_add_f32 v[128:129], v[128:129], v[136:137]
    v_mul_f32 v108, 0xbb000000, v128
    v_mul_f32 v109, 0x3b000000, v129
    v_fma_f32 v109, -v108, v108, v109
    v_max_f32 v109, 0, v109
    v_add_f32 v109, 0x3727c5ac, v109
    v_rsq_f32 v109, v109
    s_nop 0
    v_mul_f32 v108, v108, v109
    v_pk_fma_f32 v[80:81], v[80:81], v[108:109], v[108:109] op_sel:[0,1,0] op_sel_hi:[1,1,0]
    v_pk_fma_f32 v[82:83], v[82:83], v[108:109], v[108:109] op_sel:[0,1,0] op_sel_hi:[1,1,0]
    v_pk_fma_f32 v[84:85], v[84:85], v[108:109], v[108:109] op_sel:[0,1,0] op_sel_hi:[1,1,0]
    v_pk_fma_f32 v[86:87], v[86:87], v[108:109], v[108:109] op_sel:[0,1,0] op_sel_hi:[1,1,0]
    v_pk_fma_f32 v[80:81], v[80:81], v[224:225], v[208:209]
    v_pk_fma_f32 v[82:83], v[82:83], v[226:227], v[210:211]
    v_pk_fma_f32 v[84:85], v[84:85], v[228:229], v[212:213]
    v_pk_fma_f32 v[86:87], v[86:87], v[230:231], v[214:215]
    v_cvt_pk_bf16_f32 v96, v80, v81
    v_cvt_pk_bf16_f32 v97, v82, v83
    v_cvt_pk_bf16_f32 v98, v84, v85
    v_cvt_pk_bf16_f32 v99, v86, v87
    buffer_store_dwordx4 v[96:99], v126, s[48:51], s64 offen offset:0 sc1
    v_pk_fma_f32 v[88:89], v[88:89], v[108:109], v[108:109] op_sel:[0,1,0] op_sel_hi:[1,1,0]
    v_pk_fma_f32 v[90:91], v[90:91], v[108:109], v[108:109] op_sel:[0,1,0] op_sel_hi:[1,1,0]
    v_pk_fma_f32 v[92:93], v[92:93], v[108:109], v[108:109] op_sel:[0,1,0] op_sel_hi:[1,1,0]
    v_pk_fma_f32 v[94:95], v[94:95], v[108:109], v[108:109] op_sel:[0,1,0] op_sel_hi:[1,1,0]
    v_pk_fma_f32 v[88:89], v[88:89], v[232:233], v[216:217]
    v_pk_fma_f32 v[90:91], v[90:91], v[234:235], v[218:219]
    v_pk_fma_f32 v[92:93], v[92:93], v[236:237], v[220:221]
    v_pk_fma_f32 v[94:95], v[94:95], v[238:239], v[222:223]
    v_cvt_pk_bf16_f32 v100, v88, v89
    v_cvt_pk_bf16_f32 v101, v90, v91
    v_cvt_pk_bf16_f32 v102, v92, v93
    v_cvt_pk_bf16_f32 v103, v94, v95
    buffer_store_dwordx4 v[100:103], v126, s[48:51], s64 offen offset:2048 sc1
    ds_read_b64_tr_b16 a[128:129], v18 offset:0
    ds_read_b64_tr_b16 a[130:131], v18 offset:2048
    ds_read_b64_tr_b16 a[132:133], v19 offset:0
    ds_read_b64_tr_b16 a[134:135], v19 offset:2048
    ds_read_b64_tr_b16 a[136:137], v18 offset:256
    ds_read_b64_tr_b16 a[138:139], v18 offset:2304
    ds_read_b64_tr_b16 a[140:141], v19 offset:256
    ds_read_b64_tr_b16 a[142:143], v19 offset:2304
    ds_read_b64_tr_b16 a[144:145], v18 offset:4096
    ds_read_b64_tr_b16 a[146:147], v18 offset:6144
    ds_read_b64_tr_b16 a[148:149], v19 offset:4096
    ds_read_b64_tr_b16 a[150:151], v19 offset:6144
    ds_read_b64_tr_b16 a[152:153], v18 offset:4352
    ds_read_b64_tr_b16 a[154:155], v18 offset:6400
    ds_read_b64_tr_b16 a[156:157], v19 offset:4352
    ds_read_b64_tr_b16 a[158:159], v19 offset:6400
    ds_read_b64_tr_b16 a[160:161], v18 offset:8192
    ds_read_b64_tr_b16 a[162:163], v18 offset:10240
    ds_read_b64_tr_b16 a[164:165], v19 offset:8192
    ds_read_b64_tr_b16 a[166:167], v19 offset:10240
    ds_read_b64_tr_b16 a[168:169], v18 offset:8448
    ds_read_b64_tr_b16 a[170:171], v18 offset:10496
    ds_read_b64_tr_b16 a[172:173], v19 offset:8448
    ds_read_b64_tr_b16 a[174:175], v19 offset:10496
    ds_read_b64_tr_b16 a[176:177], v18 offset:12288
    ds_read_b64_tr_b16 a[178:179], v18 offset:14336
    ds_read_b64_tr_b16 a[180:181], v19 offset:12288
    ds_read_b64_tr_b16 a[182:183], v19 offset:14336
    ds_read_b64_tr_b16 a[184:185], v18 offset:12544
    ds_read_b64_tr_b16 a[186:187], v18 offset:14592
    ds_read_b64_tr_b16 a[188:189], v19 offset:12544
    ds_read_b64_tr_b16 a[190:191], v19 offset:14592
    ds_read_b64_tr_b16 a[192:193], v18 offset:16384
    ds_read_b64_tr_b16 a[194:195], v18 offset:18432
    ds_read_b64_tr_b16 a[196:197], v19 offset:16384
    ds_read_b64_tr_b16 a[198:199], v19 offset:18432
    ds_read_b64_tr_b16 a[200:201], v18 offset:16640
    ds_read_b64_tr_b16 a[202:203], v18 offset:18688
    ds_read_b64_tr_b16 a[204:205], v19 offset:16640
    ds_read_b64_tr_b16 a[206:207], v19 offset:18688
    ds_read_b64_tr_b16 a[208:209], v18 offset:20480
    ds_read_b64_tr_b16 a[210:211], v18 offset:22528
    ds_read_b64_tr_b16 a[212:213], v19 offset:20480
    ds_read_b64_tr_b16 a[214:215], v19 offset:22528
    ds_read_b64_tr_b16 a[216:217], v18 offset:20736
    ds_read_b64_tr_b16 a[218:219], v18 offset:22784
    ds_read_b64_tr_b16 a[220:221], v19 offset:20736
    ds_read_b64_tr_b16 a[222:223], v19 offset:22784
    ds_read_b64_tr_b16 a[224:225], v18 offset:24576
    ds_read_b64_tr_b16 a[226:227], v18 offset:26624
    ds_read_b64_tr_b16 a[228:229], v19 offset:24576
    ds_read_b64_tr_b16 a[230:231], v19 offset:26624
    ds_read_b64_tr_b16 a[232:233], v18 offset:24832
    ds_read_b64_tr_b16 a[234:235], v18 offset:26880
    ds_read_b64_tr_b16 a[236:237], v19 offset:24832
    ds_read_b64_tr_b16 a[238:239], v19 offset:26880
    ds_read_b64_tr_b16 a[240:241], v18 offset:28672
    ds_read_b64_tr_b16 a[242:243], v18 offset:30720
    ds_read_b64_tr_b16 a[244:245], v19 offset:28672
    ds_read_b64_tr_b16 a[246:247], v19 offset:30720
    ds_read_b64_tr_b16 a[248:249], v18 offset:28928
    ds_read_b64_tr_b16 a[250:251], v18 offset:30976
    ds_read_b64_tr_b16 a[252:253], v19 offset:28928
    ds_read_b64_tr_b16 a[254:255], v19 offset:30976
    s_add_u32 m0, s62, 32768
    s_add_u32 s56, s78, 0
    buffer_load_dwordx4 v2, s[28:31], s56 offen offset:0 lds
    buffer_load_dwordx4 v3, s[28:31], s56 offen offset:1024 lds
    buffer_load_dwordx4 v4, s[28:31], s56 offen offset:2048 lds
    buffer_load_dwordx4 v5, s[28:31], s56 offen offset:3072 lds
    s_add_u32 m0, s62, 49152
    s_add_u32 s56, s78, 32768
    buffer_load_dwordx4 v2, s[28:31], s56 offen offset:0 lds
    buffer_load_dwordx4 v3, s[28:31], s56 offen offset:1024 lds
    buffer_load_dwordx4 v4, s[28:31], s56 offen offset:2048 lds
    buffer_load_dwordx4 v5, s[28:31], s56 offen offset:3072 lds
    s_add_u32 s86, s48, s71
    s_addc_u32 s87, s49, 0
    s_mul_i32 s55, s52, 896
    s_lshl_b32 s57, s76, 12
    s_add_u32 s57, s57, s55
    s_add_u32 s57, s57, 229376
    s_add_u32 s36, s48, s57
    s_addc_u32 s37, s49, 0
    s_waitcnt vmcnt(8)
    s_waitcnt lgkmcnt(0)
    s_barrier
    s_cmp_lg_u32 s52, 0
    s_cbranch_scc1 L_sig_31
    s_mov_b64 exec, 0x3fff
    buffer_store_dword v30, v28, s[48:51], s70 offen offset:0 sc1
    s_mov_b64 exec, -1
L_sig_31:
    s_load_dword s88, s[36:37], 0 glc
    s_load_dword s89, s[36:37], 128 glc
    s_load_dword s90, s[36:37], 256 glc
    s_load_dword s91, s[36:37], 384 glc
    s_load_dword s92, s[36:37], 512 glc
    s_load_dword s93, s[36:37], 640 glc
    s_load_dword s94, s[36:37], 768 glc
    s_add_u32 m0, s62, 65536
    s_add_u32 s56, s78, 65536
    buffer_load_dwordx4 v2, s[28:31], s56 offen offset:0 lds
    buffer_load_dwordx4 v3, s[28:31], s56 offen offset:1024 lds
    buffer_load_dwordx4 v4, s[28:31], s56 offen offset:2048 lds
    buffer_load_dwordx4 v5, s[28:31], s56 offen offset:3072 lds
    s_add_u32 m0, s62, 81920
    s_add_u32 s56, s78, 98304
    buffer_load_dwordx4 v2, s[28:31], s56 offen offset:0 lds
    buffer_load_dwordx4 v3, s[28:31], s56 offen offset:1024 lds
    buffer_load_dwordx4 v4, s[28:31], s56 offen offset:2048 lds
    buffer_load_dwordx4 v5, s[28:31], s56 offen offset:3072 lds
    s_add_u32 m0, s62, 131072
    s_add_u32 s56, s78, 262144
    buffer_load_dwordx4 v2, s[28:31], s56 offen offset:0 lds
    buffer_load_dwordx4 v3, s[28:31], s56 offen offset:1024 lds
    buffer_load_dwordx4 v4, s[28:31], s56 offen offset:2048 lds
    buffer_load_dwordx4 v5, s[28:31], s56 offen offset:3072 lds
    s_add_u32 m0, s62, 147456
    s_add_u32 s56, s78, 294912
    buffer_load_dwordx4 v2, s[28:31], s56 offen offset:0 lds
    buffer_load_dwordx4 v3, s[28:31], s56 offen offset:1024 lds
    buffer_load_dwordx4 v4, s[28:31], s56 offen offset:2048 lds
    buffer_load_dwordx4 v5, s[28:31], s56 offen offset:3072 lds
    s_cmp_lg_u32 s52, 1
    s_cbranch_scc1 L_pb_32
    s_load_dwordx16 s[4:19], s[86:87], 0 glc
L_pb_32:
    v_lshlrev_b32 v26, 7, v0
    v_min_u32 v25, 768, v26
    s_mul_i32 s81, s76, 229376
    s_mul_i32 s55, s52, 14336
    s_add_u32 s81, s81, s55
    s_add_u32 s81, s81, 6291456
    s_lshr_b32 s56, s52, 1
    s_and_b32 s58, s52, 1
    s_lshl_b32 s85, s74, 16
    s_lshl_b32 s55, s58, 13
    s_add_u32 s85, s85, s55
    s_add_u32 s85, s85, 4194304
    s_add_u32 s66, s96, 0
    s_add_u32 s67, s96, 57344
    s_add_u32 s68, s96, 114688
    s_add_u32 s69, s96, 172032
    s_lshl_b32 s63, s52, 13
    s_lshl_b32 s56, s56, 14
    v_add_u32 v22, s56, v10
    s_waitcnt vmcnt(20)
    ds_read_b64_tr_b16 v[32:33], v16 offset:32768
    ds_read_b64_tr_b16 v[34:35], v16 offset:34816
    ds_read_b64_tr_b16 v[36:37], v17 offset:32768
    ds_read_b64_tr_b16 v[38:39], v17 offset:34816
    ds_read_b64_tr_b16 v[40:41], v16 offset:33024
    ds_read_b64_tr_b16 v[42:43], v16 offset:35072
    ds_read_b64_tr_b16 v[44:45], v17 offset:33024
    ds_read_b64_tr_b16 v[46:47], v17 offset:35072
    s_waitcnt vmcnt(16)
    ds_read_b64_tr_b16 v[48:49], v16 offset:49152
    ds_read_b64_tr_b16 v[50:51], v16 offset:51200
    ds_read_b64_tr_b16 v[52:53], v17 offset:49152
    ds_read_b64_tr_b16 v[54:55], v17 offset:51200
    ds_read_b64_tr_b16 v[56:57], v16 offset:49408
    ds_read_b64_tr_b16 v[58:59], v16 offset:51456
    ds_read_b64_tr_b16 v[60:61], v17 offset:49408
    ds_read_b64_tr_b16 v[62:63], v17 offset:51456
    s_waitcnt lgkmcnt(0)
    s_min_u32 s88, s88, s89
    s_min_u32 s90, s90, s91
    s_min_u32 s92, s92, s93
    s_min_u32 s88, s88, s90
    s_min_u32 s92, s92, s94
    s_min_u32 s88, s88, s92
    s_cmp_lt_u32 s88, 1
    s_cbranch_scc1 L_fc_33
L_fcj_34:
    s_cmp_ge_u32 s54, 28
    s_cbranch_scc1 L_nog1_35
    s_and_b32 s56, s53, 1
    s_mul_i32 s56, s56, 7
    s_sub_u32 s56, s75, s56
    s_lshl2_add_u32 s56, s56, s52
    s_mul_i32 s56, s56, 4736
    s_min_u32 s56, s56, 126336
    s_andn2_b32 s57, s85, 0x1ffff
    s_add_u32 s57, s56, s57
    s_cmp_lg_u32 s52, 1
    s_cbranch_scc1 L_nb_37
    s_min_u32 s4, s4, s5
    s_min_u32 s6, s6, s7
    s_min_u32 s8, s8, s9
    s_min_u32 s10, s10, s11
    s_min_u32 s12, s12, s13
    s_min_u32 s14, s14, s15
    s_min_u32 s16, s16, s17
    s_min_u32 s18, s18, s19
    s_min_u32 s4, s4, s6
    s_min_u32 s8, s8, s10
    s_min_u32 s12, s12, s14
    s_min_u32 s16, s16, s18
    s_min_u32 s4, s4, s8
    s_min_u32 s12, s12, s16
    s_min_u32 s4, s4, s12
    s_cmp_lt_u32 s4, 1
    s_cbranch_scc0 L_fcj_39
    s_mov_b32 s98, 0x200000
L_sp_40:
    s_load_dwordx16 s[4:19], s[86:87], 0 glc
    s_sub_u32 s98, s98, 1
    s_waitcnt lgkmcnt(0)
    s_cbranch_scc1 L_spout_41
    s_min_u32 s4, s4, s5
    s_min_u32 s6, s6, s7
    s_min_u32 s8, s8, s9
    s_min_u32 s10, s10, s11
    s_min_u32 s12, s12, s13
    s_min_u32 s14, s14, s15
    s_min_u32 s16, s16, s17
    s_min_u32 s18, s18, s19
    s_min_u32 s4, s4, s6
    s_min_u32 s8, s8, s10
    s_min_u32 s12, s12, s14
    s_min_u32 s16, s16, s18
    s_min_u32 s4, s4, s8
    s_min_u32 s12, s12, s16
    s_min_u32 s4, s4, s12
    s_cmp_lt_u32 s4, 1
    s_cbranch_scc1 L_sp_40
L_spout_41:
L_fcj_39:
L_nb_37:
    s_waitcnt lgkmcnt(0)
    s_barrier
    s_add_u32 m0, s63, 0
    s_add_u32 s56, s85, 0
    buffer_load_dwordx4 v10, s[48:51], s56 offen offset:0 sc1 lds
    buffer_load_dwordx4 v10, s[48:51], s56 offen offset:1024 sc1 lds
    buffer_load_dwordx4 v10, s[48:51], s56 offen offset:2048 sc1 lds
    buffer_load_dwordx4 v10, s[48:51], s56 offen offset:3072 sc1 lds
    s_add_u32 m0, s63, 4096
    s_add_u32 s56, s85, 4096
    buffer_load_dwordx4 v10, s[48:51], s56 offen offset:0 sc1 lds
    buffer_load_dwordx4 v10, s[48:51], s56 offen offset:1024 sc1 lds
    buffer_load_dwordx4 v10, s[48:51], s56 offen offset:2048 sc1 lds
    buffer_load_dwordx4 v10, s[48:51], s56 offen offset:3072 sc1 lds
    s_mov_b32 exec_lo, -1
    s_mov_b32 exec_hi, 0x1f
    buffer_load_dword v27, v26, s[48:51], s57 offen
    s_mov_b64 exec, -1
    s_waitcnt vmcnt(21)
    ds_read_b64_tr_b16 v[64:65], v12 offset:0
    ds_read_b64_tr_b16 v[66:67], v12 offset:2048
L_hop2_0:
    s_cbranch_execz L_back2_0
    ds_read_b64_tr_b16 v[68:69], v13 offset:0
    ds_read_b64_tr_b16 v[70:71], v13 offset:2048
    ds_read_b64_tr_b16 v[72:73], v12 offset:256
    ds_read_b64_tr_b16 v[74:75], v12 offset:2304
    ds_read_b64_tr_b16 v[76:77], v13 offset:256
    ds_read_b64_tr_b16 v[78:79], v13 offset:2304
    s_waitcnt vmcnt(17)
    ds_read_b64_tr_b16 v[80:81], v12 offset:16384
    ds_read_b64_tr_b16 v[82:83], v12 offset:18432
    ds_read_b64_tr_b16 v[84:85], v13 offset:16384
    ds_read_b64_tr_b16 v[86:87], v13 offset:18432
    ds_read_b64_tr_b16 v[88:89], v12 offset:16640
    ds_read_b64_tr_b16 v[90:91], v12 offset:18688
    ds_read_b64_tr_b16 v[92:93], v13 offset:16640
    ds_read_b64_tr_b16 v[94:95], v13 offset:18688
    s_waitcnt vmcnt(13)
    ds_read_b64_tr_b16 v[224:225], v14 offset:0
    ds_read_b64_tr_b16 v[226:227], v14 offset:2048
    ds_read_b64_tr_b16 v[228:229], v15 offset:0
    ds_read_b64_tr_b16 v[230:231], v15 offset:2048
    ds_read_b64_tr_b16 v[232:233], v14 offset:256
    ds_read_b64_tr_b16 v[234:235], v14 offset:2304
    ds_read_b64_tr_b16 v[236:237], v15 offset:256
    ds_read_b64_tr_b16 v[238:239], v15 offset:2304
    s_waitcnt vmcnt(9)
    ds_read_b64_tr_b16 v[240:241], v14 offset:16384
    ds_read_b64_tr_b16 v[242:243], v14 offset:18432
    ds_read_b64_tr_b16 v[244:245], v15 offset:16384
    ds_read_b64_tr_b16 v[246:247], v15 offset:18432
    ds_read_b64_tr_b16 v[248:249], v14 offset:16640
    ds_read_b64_tr_b16 v[250:251], v14 offset:18688
    ds_read_b64_tr_b16 v[252:253], v15 offset:16640
    ds_read_b64_tr_b16 v[254:255], v15 offset:18688
    s_waitcnt vmcnt(1)
    s_waitcnt lgkmcnt(0)
    s_barrier
    ds_read_b128 v[96:99], v22 offset:0
    ds_read_b128 v[100:103], v22 offset:1024
    ds_read_b128 v[104:107], v22 offset:2048
    ds_read_b128 v[108:111], v22 offset:3072
    ds_read_b128 v[112:115], v22 offset:4096
    ds_read_b128 v[116:119], v22 offset:5120
    ds_read_b128 v[120:123], v22 offset:6144
    s_waitcnt lgkmcnt(6)
    v_mfma_f32_16x16x32_bf16 v[128:131], a[0:3], v[96:99], 0
    s_waitcnt lgkmcnt(5)
    s_add_u32 s83, s85, 16384
    v_mfma_f32_16x16x32_bf16 v[128:131], a[16:19], v[100:103], v[128:131]
    v_lshrrev_b32 v24, 4, v0
    v_and_b32 v23, 15, v0
    v_mfma_f32_16x16x32_bf16 v[132:135], a[4:7], v[96:99], 0
    v_xor_b32 v6, v24, v23
    v_lshlrev_b32 v6, 4, v6
    v_mfma_f32_16x16x32_bf16 v[132:135], a[20:23], v[100:103], v[132:135]
    s_add_u32 m0, s63, 32768
    ds_read_b128 v[124:127], v22 offset:7168
    v_lshl_add_u32 v6, v24, 8, v6
    v_mfma_f32_16x16x32_bf16 v[136:139], a[8:11], v[96:99], 0
    buffer_load_dwordx4 v10, s[48:51], s83 offen offset:0 sc1 lds
    v_mfma_f32_16x16x32_bf16 v[136:139], a[24:27], v[100:103], v[136:139]
    s_add_u32 s56, s62, 65536
    v_add_u32 v6, s56, v6
    v_xor_b32 v7, 64, v6
    v_mfma_f32_16x16x32_bf16 v[140:143], a[12:15], v[96:99], 0
    s_waitcnt lgkmcnt(4)
    v_xor_b32 v8, 128, v6
    v_xor_b32 v9, 192, v6
    v_mfma_f32_16x16x32_bf16 v[140:143], a[28:31], v[100:103], v[140:143]
    s_add_u32 s82, s85, 20480
    ds_read_b128 v[96:99], v22 offset:8192
    v_mfma_f32_16x16x32_bf16 v[128:131], a[32:35], v[104:107], v[128:131]
    buffer_load_dwordx4 v10, s[48:51], s83 offen offset:1024 sc1 lds
    v_mfma_f32_16x16x32_bf16 v[128:131], a[48:51], v[108:111], v[128:131]
    v_mfma_f32_16x16x32_bf16 v[132:135], a[36:39], v[104:107], v[132:135]
    v_mfma_f32_16x16x32_bf16 v[132:135], a[52:55], v[108:111], v[132:135]
    s_lshl_b32 s56, s52, 2
    ds_read_b128 v[100:103], v22 offset:9216
    v_add_u32 v24, s56, v24
    v_mfma_f32_16x16x32_bf16 v[136:139], a[40:43], v[104:107], v[136:139]
    buffer_load_dwordx4 v10, s[48:51], s83 offen offset:2048 sc1 lds
    v_mfma_f32_16x16x32_bf16 v[136:139], a[56:59], v[108:111], v[136:139]
    v_xor_b32 v11, v24, v23
    v_lshlrev_b32 v11, 4, v11
    v_mfma_f32_16x16x32_bf16 v[140:143], a[44:47], v[104:107], v[140:143]
    v_lshl_add_u32 v11, v23, 8, v11
    v_add_u32 v11, 65536, v11
    v_mfma_f32_16x16x32_bf16 v[140:143], a[60:63], v[108:111], v[140:143]
    s_waitcnt lgkmcnt(4)
    ds_read_b128 v[104:107], v22 offset:10240
    v_lshlrev_b32 v21, 3, v23
    v_mfma_f32_16x16x32_bf16 v[128:131], a[64:67], v[112:115], v[128:131]
    buffer_load_dwordx4 v10, s[48:51], s83 offen offset:3072 sc1 lds
    v_mfma_f32_16x16x32_bf16 v[128:131], a[80:83], v[116:119], v[128:131]
    v_lshl_add_u32 v21, v24, 10, v21
    v_bfe_u32 v20, v0, 3, 1
    v_mfma_f32_16x16x32_bf16 v[132:135], a[68:71], v[112:115], v[132:135]
    v_lshlrev_b32 v20, 9, v20
    v_and_b32 v24, 3, v0
    v_mfma_f32_16x16x32_bf16 v[132:135], a[84:87], v[116:119], v[132:135]
    s_add_u32 m0, s63, 36864
    ds_read_b128 v[108:111], v22 offset:11264
    v_lshl_add_u32 v20, v24, 7, v20
    v_mfma_f32_16x16x32_bf16 v[136:139], a[72:75], v[112:115], v[136:139]
    buffer_load_dwordx4 v10, s[48:51], s82 offen offset:0 sc1 lds
    v_mfma_f32_16x16x32_bf16 v[136:139], a[88:91], v[116:119], v[136:139]
    v_bfe_u32 v24, v0, 2, 1
    v_lshl_add_u32 v20, v24, 3, v20
    v_mfma_f32_16x16x32_bf16 v[140:143], a[76:79], v[112:115], v[140:143]
    s_waitcnt lgkmcnt(4)
    v_lshrrev_b32 v24, 4, v0
    v_lshl_add_u32 v20, v24, 4, v20
    v_mfma_f32_16x16x32_bf16 v[140:143], a[92:95], v[116:119], v[140:143]
    s_add_u32 s83, s78, 131072
    ds_read_b128 v[112:115], v22 offset:12288
    v_mfma_f32_16x16x32_bf16 v[128:131], a[96:99], v[120:123], v[128:131]
    buffer_load_dwordx4 v10, s[48:51], s82 offen offset:1024 sc1 lds
    v_mfma_f32_16x16x32_bf16 v[128:131], a[112:115], v[124:127], v[128:131]
    v_mfma_f32_16x16x32_bf16 v[132:135], a[100:103], v[120:123], v[132:135]
    v_mfma_f32_16x16x32_bf16 v[132:135], a[116:119], v[124:127], v[132:135]
    s_lshr_b32 s56, s52, 1
    ds_read_b128 v[116:119], v22 offset:13312
    v_mfma_f32_16x16x32_bf16 v[136:139], a[104:107], v[120:123], v[136:139]
    buffer_load_dwordx4 v10, s[48:51], s82 offen offset:2048 sc1 lds
    v_mfma_f32_16x16x32_bf16 v[136:139], a[120:123], v[124:127], v[136:139]
    v_mfma_f32_16x16x32_bf16 v[140:143], a[108:111], v[120:123], v[140:143]
    s_waitcnt lgkmcnt(4)
    v_mfma_f32_16x16x32_bf16 v[140:143], a[124:127], v[124:127], v[140:143]
    s_lshl_b32 s56, s56, 10
    ds_read_b128 v[120:123], v22 offset:14336
    v_mfma_f32_16x16x32_bf16 v[128:131], a[128:131], v[96:99], v[128:131]
    buffer_load_dwordx4 v10, s[48:51], s82 offen offset:3072 sc1 lds
    v_mfma_f32_16x16x32_bf16 v[128:131], a[144:147], v[100:103], v[128:131]
    s_add_u32 s82, s78, 163840
    v_mfma_f32_16x16x32_bf16 v[132:135], a[132:135], v[96:99], v[132:135]
    s_and_b32 s57, s52, 1
    v_mfma_f32_16x16x32_bf16 v[132:135], a[148:151], v[100:103], v[132:135]
    s_add_u32 m0, s62, 65536
    ds_read_b128 v[124:127], v22 offset:15360
    v_mfma_f32_16x16x32_bf16 v[136:139], a[136:139], v[96:99], v[136:139]
    buffer_load_dwordx4 v2, s[28:31], s83 offen offset:0 lds
    v_mfma_f32_16x16x32_bf16 v[136:139], a[152:155], v[100:103], v[136:139]
    s_lshl_b32 s57, s57, 6
    v_mfma_f32_16x16x32_bf16 v[140:143], a[140:143], v[96:99], v[140:143]
    buffer_load_dwordx4 v3, s[28:31], s83 offen offset:1024 lds
    v_mfma_f32_16x16x32_bf16 v[140:143], a[156:159], v[100:103], v[140:143]
    s_waitcnt lgkmcnt(5)
    s_add_u32 s56, s56, s57
    v_add_u32 v20, s56, v20
    v_lshlrev_b32 v23, 4, v23
    v_mfma_f32_16x16x32_bf16 v[128:131], a[160:163], v[104:107], v[128:131]
    s_waitcnt lgkmcnt(4)
    buffer_load_dwordx4 v4, s[28:31], s83 offen offset:2048 lds
    v_mfma_f32_16x16x32_bf16 v[128:131], a[176:179], v[108:111], v[128:131]
    s_lshl_b32 s60, s76, 16
    v_mfma_f32_16x16x32_bf16 v[132:135], a[164:167], v[104:107], v[132:135]
    buffer_load_dwordx4 v5, s[28:31], s83 offen offset:3072 lds
    v_mfma_f32_16x16x32_bf16 v[132:135], a[180:183], v[108:111], v[132:135]
    s_add_u32 m0, s62, 81920
    v_mfma_f32_16x16x32_bf16 v[136:139], a[168:171], v[104:107], v[136:139]
    buffer_load_dwordx4 v2, s[28:31], s82 offen offset:0 lds
    v_mfma_f32_16x16x32_bf16 v[136:139], a[184:187], v[108:111], v[136:139]
    s_add_u32 s83, s85, 32768
    v_mfma_f32_16x16x32_bf16 v[140:143], a[172:175], v[104:107], v[140:143]
    buffer_load_dwordx4 v3, s[28:31], s82 offen offset:1024 lds
    v_mfma_f32_16x16x32_bf16 v[140:143], a[188:191], v[108:111], v[140:143]
    s_waitcnt lgkmcnt(3)
    s_lshl_b32 s56, s77, 7
    v_mfma_f32_16x16x32_bf16 v[128:131], a[192:195], v[112:115], v[128:131]
    s_waitcnt lgkmcnt(2)
    buffer_load_dwordx4 v4, s[28:31], s82 offen offset:2048 lds
    v_mfma_f32_16x16x32_bf16 v[128:131], a[208:211], v[116:119], v[128:131]
    s_add_u32 s61, s60, s56
    v_mfma_f32_16x16x32_bf16 v[132:135], a[196:199], v[112:115], v[132:135]
    buffer_load_dwordx4 v5, s[28:31], s82 offen offset:3072 lds
    v_mfma_f32_16x16x32_bf16 v[132:135], a[212:215], v[116:119], v[132:135]
    s_waitcnt vmcnt(8)
    s_waitcnt lgkmcnt(0)
    s_barrier
    ds_read_b128 v[96:99], v22 offset:32768
    v_mfma_f32_16x16x32_bf16 v[136:139], a[200:203], v[112:115], v[136:139]
    s_lshl_b32 s56, s52, 14
    v_mfma_f32_16x16x32_bf16 v[136:139], a[216:219], v[116:119], v[136:139]
    s_add_u32 m0, s63, 0
    ds_read_b128 v[100:103], v22 offset:33792
    v_mfma_f32_16x16x32_bf16 v[140:143], a[204:207], v[112:115], v[140:143]
    buffer_load_dwordx4 v10, s[48:51], s83 offen offset:0 sc1 lds
    v_mfma_f32_16x16x32_bf16 v[140:143], a[220:223], v[116:119], v[140:143]
    s_add_u32 s82, s85, 36864
    ds_read_b128 v[104:107], v22 offset:34816
    v_mfma_f32_16x16x32_bf16 v[128:131], a[224:227], v[120:123], v[128:131]
    v_mfma_f32_16x16x32_bf16 v[128:131], a[240:243], v[124:127], v[128:131]
    s_add_u32 s60, s60, s56
    ds_read_b128 v[108:111], v22 offset:35840
    v_mfma_f32_16x16x32_bf16 v[132:135], a[228:231], v[120:123], v[132:135]
    buffer_load_dwordx4 v10, s[48:51], s83 offen offset:1024 sc1 lds
    v_mfma_f32_16x16x32_bf16 v[132:135], a[244:247], v[124:127], v[132:135]
    s_lshl_b32 s56, s77, 10
    ds_read_b128 v[112:115], v22 offset:36864
    v_mfma_f32_16x16x32_bf16 v[136:139], a[232:235], v[120:123], v[136:139]
    s_waitcnt lgkmcnt(4)
    v_mfma_f32_16x16x32_bf16 v[136:139], a[248:251], v[124:127], v[136:139]
    s_add_u32 s60, s60, s56
    ds_read_b128 v[116:119], v22 offset:37888
    v_mfma_f32_16x16x32_bf16 v[140:143], a[236:239], v[120:123], v[140:143]
    buffer_load_dwordx4 v10, s[48:51], s83 offen offset:2048 sc1 lds
    v_mfma_f32_16x16x32_bf16 v[140:143], a[252:255], v[124:127], v[140:143]
    s_add_u32 s60, s60, 2097152
    ds_read_b128 v[120:123], v22 offset:38912
    v_mfma_f32_16x16x32_bf16 v[144:147], a[0:3], v[96:99], 0
    s_waitcnt lgkmcnt(5)
    s_lshl_b32 s72, s77, 8
    v_mfma_f32_16x16x32_bf16 v[144:147], a[16:19], v[100:103], v[144:147]
    s_add_u32 s72, s72, 10240
    v_mfma_f32_16x16x32_bf16 v[148:151], a[4:7], v[96:99], 0
    buffer_load_dwordx4 v10, s[48:51], s83 offen offset:3072 sc1 lds
    v_mfma_f32_16x16x32_bf16 v[148:151], a[20:23], v[100:103], v[148:151]
    s_add_u32 m0, s63, 4096
    ds_read_b128 v[124:127], v22 offset:39936
    v_mfma_f32_16x16x32_bf16 v[152:155], a[8:11], v[96:99], 0
    buffer_load_dwordx4 v10, s[48:51], s82 offen offset:0 sc1 lds
    v_mfma_f32_16x16x32_bf16 v[152:155], a[24:27], v[100:103], v[152:155]
    v_exp_f32 v160, v128
    v_exp_f32 v161, v129
    v_mfma_f32_16x16x32_bf16 v[156:159], a[12:15], v[96:99], 0
    s_waitcnt lgkmcnt(4)
    v_add_f32 v160, 1.0, v160
    v_exp_f32 v162, v130
    v_mfma_f32_16x16x32_bf16 v[156:159], a[28:31], v[100:103], v[156:159]
    s_add_u32 s83, s78, 196608
    ds_read_b128 v[96:99], v22 offset:40960
    v_rcp_f32 v160, v160
    v_mfma_f32_16x16x32_bf16 v[144:147], a[32:35], v[104:107], v[144:147]
    buffer_load_dwordx4 v10, s[48:51], s82 offen offset:1024 sc1 lds
    v_mfma_f32_16x16x32_bf16 v[144:147], a[48:51], v[108:111], v[144:147]
    v_mul_f32 v160, v128, v160
    v_exp_f32 v163, v131
    v_mfma_f32_16x16x32_bf16 v[148:151], a[36:39], v[104:107], v[148:151]
    v_add_f32 v161, 1.0, v161
    v_exp_f32 v164, v132
    v_mfma_f32_16x16x32_bf16 v[148:151], a[52:55], v[108:111], v[148:151]
    ds_read_b128 v[100:103], v22 offset:41984
    v_rcp_f32 v161, v161
    v_mfma_f32_16x16x32_bf16 v[152:155], a[40:43], v[104:107], v[152:155]
    buffer_load_dwordx4 v10, s[48:51], s82 offen offset:2048 sc1 lds
    v_mfma_f32_16x16x32_bf16 v[152:155], a[56:59], v[108:111], v[152:155]
    v_mul_f32 v161, v129, v161
    v_exp_f32 v165, v133
    v_mfma_f32_16x16x32_bf16 v[156:159], a[44:47], v[104:107], v[156:159]
    v_cvt_pk_bf16_f32 v176, v160, v161
    v_add_f32 v162, 1.0, v162
    v_add_f32 v163, 1.0, v163
    v_mfma_f32_16x16x32_bf16 v[156:159], a[60:63], v[108:111], v[156:159]
    s_waitcnt lgkmcnt(4)
    ds_read_b128 v[104:107], v22 offset:43008
    v_rcp_f32 v162, v162
    v_mfma_f32_16x16x32_bf16 v[144:147], a[64:67], v[112:115], v[144:147]
    buffer_load_dwordx4 v10, s[48:51], s82 offen offset:3072 sc1 lds
    v_mfma_f32_16x16x32_bf16 v[144:147], a[80:83], v[116:119], v[144:147]
    v_max_u32 v176, 1, v176
    v_rcp_f32 v163, v163
    v_mfma_f32_16x16x32_bf16 v[148:151], a[68:71], v[112:115], v[148:151]
    v_mul_f32 v162, v130, v162
    v_exp_f32 v166, v134
    v_mfma_f32_16x16x32_bf16 v[148:151], a[84:87], v[116:119], v[148:151]
    s_add_u32 m0, s62, 98304
    ds_read_b128 v[108:111], v22 offset:44032
    v_mul_f32 v163, v131, v163
    v_add_f32 v164, 1.0, v164
    v_mfma_f32_16x16x32_bf16 v[152:155], a[72:75], v[112:115], v[152:155]
    buffer_load_dwordx4 v2, s[28:31], s83 offen offset:0 lds
    v_mfma_f32_16x16x32_bf16 v[152:155], a[88:91], v[116:119], v[152:155]
    v_cvt_pk_bf16_f32 v177, v162, v163
    v_rcp_f32 v164, v164
    v_mfma_f32_16x16x32_bf16 v[156:159], a[76:79], v[112:115], v[156:159]
    s_waitcnt lgkmcnt(4)
    v_max_u32 v177, 1, v177
    v_exp_f32 v167, v135
    v_mfma_f32_16x16x32_bf16 v[156:159], a[92:95], v[116:119], v[156:159]
    s_add_u32 s82, s78, 229376
    ds_read_b128 v[112:115], v22 offset:45056
    v_mul_f32 v164, v132, v164
    v_add_f32 v165, 1.0, v165
    v_mfma_f32_16x16x32_bf16 v[144:147], a[96:99], v[120:123], v[144:147]
    buffer_load_dwordx4 v3, s[28:31], s83 offen offset:1024 lds
    v_mfma_f32_16x16x32_bf16 v[144:147], a[112:115], v[124:127], v[144:147]
    v_add_f32 v166, 1.0, v166
    v_rcp_f32 v165, v165
    v_mfma_f32_16x16x32_bf16 v[148:151], a[100:103], v[120:123], v[148:151]
    v_mul_f32 v165, v133, v165
    v_rcp_f32 v166, v166
    v_mfma_f32_16x16x32_bf16 v[148:151], a[116:119], v[124:127], v[148:151]
    ds_read_b128 v[116:119], v22 offset:46080
    v_exp_f32 v168, v136
    v_mfma_f32_16x16x32_bf16 v[152:155], a[104:107], v[120:123], v[152:155]
    buffer_load_dwordx4 v4, s[28:31], s83 offen offset:2048 lds
    v_mfma_f32_16x16x32_bf16 v[152:155], a[120:123], v[124:127], v[152:155]
    v_cvt_pk_bf16_f32 v178, v164, v165
    v_exp_f32 v169, v137
    v_mfma_f32_16x16x32_bf16 v[156:159], a[108:111], v[120:123], v[156:159]
    v_max_u32 v178, 1, v178
    v_mul_f32 v166, v134, v166
    v_add_f32 v167, 1.0, v167
    v_mfma_f32_16x16x32_bf16 v[156:159], a[124:127], v[124:127], v[156:159]
    s_waitcnt lgkmcnt(4)
    ds_read_b128 v[120:123], v22 offset:47104
    v_rcp_f32 v167, v167
    v_mfma_f32_16x16x32_bf16 v[144:147], a[128:131], v[96:99], v[144:147]
    buffer_load_dwordx4 v5, s[28:31], s83 offen offset:3072 lds
    v_mfma_f32_16x16x32_bf16 v[144:147], a[144:147], v[100:103], v[144:147]
    v_mul_f32 v167, v135, v167
    v_exp_f32 v170, v138
    v_mfma_f32_16x16x32_bf16 v[148:151], a[132:135], v[96:99], v[148:151]
    s_add_u32 s83, s85, 49152
    v_cvt_pk_bf16_f32 v179, v166, v167
    v_exp_f32 v171, v139
    v_mfma_f32_16x16x32_bf16 v[148:151], a[148:151], v[100:103], v[148:151]
    s_add_u32 m0, s62, 114688
    ds_read_b128 v[124:127], v22 offset:48128
    v_max_u32 v179, 1, v179
    v_add_f32 v168, 1.0, v168
    v_mfma_f32_16x16x32_bf16 v[152:155], a[136:139], v[96:99], v[152:155]
    buffer_load_dwordx4 v2, s[28:31], s82 offen offset:0 lds
    v_mfma_f32_16x16x32_bf16 v[152:155], a[152:155], v[100:103], v[152:155]
    v_add_f32 v169, 1.0, v169
    v_rcp_f32 v168, v168
    v_mfma_f32_16x16x32_bf16 v[156:159], a[140:143], v[96:99], v[156:159]
    s_waitcnt lgkmcnt(5)
    v_mul_f32 v168, v136, v168
    v_rcp_f32 v169, v169
    v_mfma_f32_16x16x32_bf16 v[156:159], a[156:159], v[100:103], v[156:159]
    buffer_load_dwordx4 v3, s[28:31], s82 offen offset:1024 lds
    v_mfma_f32_16x16x32_bf16 v[144:147], a[160:163], v[104:107], v[144:147]
    s_waitcnt lgkmcnt(4)
    v_mul_f32 v169, v137, v169
    v_exp_f32 v172, v140
    v_mfma_f32_16x16x32_bf16 v[144:147], a[176:179], v[108:111], v[144:147]
    v_cvt_pk_bf16_f32 v180, v168, v169
    v_exp_f32 v173, v141
    v_mfma_f32_16x16x32_bf16 v[148:151], a[164:167], v[104:107], v[148:151]
    buffer_load_dwordx4 v4, s[28:31], s82 offen offset:2048 lds
    v_mfma_f32_16x16x32_bf16 v[148:151], a[180:183], v[108:111], v[148:151]
    v_max_u32 v180, 1, v180
    v_add_f32 v170, 1.0, v170
    v_add_f32 v171, 1.0, v171
    v_mfma_f32_16x16x32_bf16 v[152:155], a[168:171], v[104:107], v[152:155]
    s_waitcnt lgkmcnt(3)
    v_add_f32 v172, 1.0, v172
    v_rcp_f32 v170, v170
    v_mfma_f32_16x16x32_bf16 v[152:155], a[184:187], v[108:111], v[152:155]
    s_waitcnt vmcnt(7)
    s_waitcnt lgkmcnt(0)
    s_barrier
    ds_read_b128 v[96:99], v22 offset:0
    v_rcp_f32 v171, v171
    v_mfma_f32_16x16x32_bf16 v[156:159], a[172:175], v[104:107], v[156:159]
    buffer_load_dwordx4 v5, s[28:31], s82 offen offset:3072 lds
    v_mfma_f32_16x16x32_bf16 v[156:159], a[188:191], v[108:111], v[156:159]
    s_add_u32 m0, s63, 32768
    ds_read_b128 v[100:103], v22 offset:1024
    v_rcp_f32 v172, v172
    v_mfma_f32_16x16x32_bf16 v[144:147], a[192:195], v[112:115], v[144:147]
    buffer_load_dwordx4 v10, s[48:51], s83 offen offset:0 sc1 lds
    v_mfma_f32_16x16x32_bf16 v[144:147], a[208:211], v[116:119], v[144:147]
    s_add_u32 s82, s85, 53248
    ds_read_b128 v[104:107], v22 offset:2048
    v_mul_f32 v170, v138, v170
    v_mul_f32 v171, v139, v171
    v_mfma_f32_16x16x32_bf16 v[148:151], a[196:199], v[112:115], v[148:151]
    v_cvt_pk_bf16_f32 v181, v170, v171
    v_exp_f32 v174, v142
    v_mfma_f32_16x16x32_bf16 v[148:151], a[212:215], v[116:119], v[148:151]
    ds_read_b128 v[108:111], v22 offset:3072
    v_max_u32 v181, 1, v181
    v_mul_f32 v172, v140, v172
    v_mfma_f32_16x16x32_bf16 v[152:155], a[200:203], v[112:115], v[152:155]
    buffer_load_dwordx4 v10, s[48:51], s83 offen offset:1024 sc1 lds
    v_mfma_f32_16x16x32_bf16 v[152:155], a[216:219], v[116:119], v[152:155]
    v_add_f32 v173, 1.0, v173
    v_exp_f32 v175, v143
    v_mfma_f32_16x16x32_bf16 v[156:159], a[204:207], v[112:115], v[156:159]
    v_add_f32 v174, 1.0, v174
    v_rcp_f32 v173, v173
    v_mfma_f32_16x16x32_bf16 v[156:159], a[220:223], v[116:119], v[156:159]
    ds_read_b128 v[112:115], v22 offset:4096
    v_rcp_f32 v174, v174
    v_mfma_f32_16x16x32_bf16 v[144:147], a[224:227], v[120:123], v[144:147]
    buffer_load_dwordx4 v10, s[48:51], s83 offen offset:2048 sc1 lds
    v_mfma_f32_16x16x32_bf16 v[144:147], a[240:243], v[124:127], v[144:147]
    v_mul_f32 v173, v141, v173
    v_mul_f32 v174, v142, v174
    v_add_f32 v175, 1.0, v175
    v_mfma_f32_16x16x32_bf16 v[148:151], a[228:231], v[120:123], v[148:151]
    v_cvt_pk_bf16_f32 v182, v172, v173
    v_rcp_f32 v175, v175
    v_mfma_f32_16x16x32_bf16 v[148:151], a[244:247], v[124:127], v[148:151]
    ds_read_b128 v[116:119], v22 offset:5120
    v_max_u32 v182, 1, v182
    v_mul_f32 v175, v143, v175
    v_mfma_f32_16x16x32_bf16 v[152:155], a[232:235], v[120:123], v[152:155]
    buffer_load_dwordx4 v10, s[48:51], s83 offen offset:3072 sc1 lds
    v_mfma_f32_16x16x32_bf16 v[152:155], a[248:251], v[124:127], v[152:155]
    v_cvt_pk_bf16_f32 v183, v174, v175
    v_mfma_f32_16x16x32_bf16 v[156:159], a[236:239], v[120:123], v[156:159]
    s_waitcnt lgkmcnt(4)
    v_max_u32 v183, 1, v183
    v_mfma_f32_16x16x32_bf16 v[156:159], a[252:255], v[124:127], v[156:159]
    s_add_u32 m0, s63, 36864
    ds_read_b128 v[120:123], v22 offset:6144
    v_mfma_f32_16x16x32_bf16 v[128:131], a[0:3], v[96:99], 0
    buffer_store_dwordx4 v[176:179], v10, s[48:51], s66 offen offset:0 sc1
    v_mfma_f32_16x16x32_bf16 v[128:131], a[16:19], v[100:103], v[128:131]
    buffer_store_dwordx4 v[180:183], v10, s[48:51], s66 offen offset:1024 sc1
    v_mfma_f32_16x16x32_bf16 v[132:135], a[4:7], v[96:99], 0
    buffer_load_dwordx4 v10, s[48:51], s82 offen offset:0 sc1 lds
    v_mfma_f32_16x16x32_bf16 v[132:135], a[20:23], v[100:103], v[132:135]
    s_add_u32 s83, s78, 393216
    ds_read_b128 v[124:127], v22 offset:7168
    v_mfma_f32_16x16x32_bf16 v[136:139], a[8:11], v[96:99], 0
    v_exp_f32 v160, v144
    v_mfma_f32_16x16x32_bf16 v[136:139], a[24:27], v[100:103], v[136:139]
    v_add_f32 v160, 1.0, v160
    v_exp_f32 v161, v145
    v_mfma_f32_16x16x32_bf16 v[140:143], a[12:15], v[96:99], 0
    buffer_load_dwordx4 v10, s[48:51], s82 offen offset:1024 sc1 lds
    v_mfma_f32_16x16x32_bf16 v[140:143], a[28:31], v[100:103], v[140:143]
    s_waitcnt lgkmcnt(5)
    ds_read_b128 v[96:99], v22 offset:8192
    v_rcp_f32 v160, v160
    v_mfma_f32_16x16x32_bf16 v[128:131], a[32:35], v[104:107], v[128:131]
    s_waitcnt lgkmcnt(5)
    v_mul_f32 v160, v144, v160
    v_exp_f32 v162, v146
    v_mfma_f32_16x16x32_bf16 v[128:131], a[48:51], v[108:111], v[128:131]
    v_add_f32 v161, 1.0, v161
    v_exp_f32 v163, v147
    v_mfma_f32_16x16x32_bf16 v[132:135], a[36:39], v[104:107], v[132:135]
    buffer_load_dwordx4 v10, s[48:51], s82 offen offset:2048 sc1 lds
    v_mfma_f32_16x16x32_bf16 v[132:135], a[52:55], v[108:111], v[132:135]
    ds_read_b128 v[100:103], v22 offset:9216
    v_rcp_f32 v161, v161
    v_mfma_f32_16x16x32_bf16 v[136:139], a[40:43], v[104:107], v[136:139]
    v_mul_f32 v161, v145, v161
    v_exp_f32 v164, v148
    v_mfma_f32_16x16x32_bf16 v[136:139], a[56:59], v[108:111], v[136:139]
    s_waitcnt lgkmcnt(4)
    v_cvt_pk_bf16_f32 v184, v160, v161
    v_exp_f32 v165, v149
    v_mfma_f32_16x16x32_bf16 v[140:143], a[44:47], v[104:107], v[140:143]
    buffer_load_dwordx4 v10, s[48:51], s82 offen offset:3072 sc1 lds
    v_mfma_f32_16x16x32_bf16 v[140:143], a[60:63], v[108:111], v[140:143]
    s_add_u32 m0, s62, 131072
    ds_read_b128 v[104:107], v22 offset:10240
    v_max_u32 v184, 1, v184
    v_mfma_f32_16x16x32_bf16 v[128:131], a[64:67], v[112:115], v[128:131]
    buffer_load_dwordx4 v2, s[28:31], s83 offen offset:0 lds
    v_mfma_f32_16x16x32_bf16 v[128:131], a[80:83], v[116:119], v[128:131]
    v_add_f32 v162, 1.0, v162
    v_exp_f32 v166, v150
    v_mfma_f32_16x16x32_bf16 v[132:135], a[68:71], v[112:115], v[132:135]
    v_add_f32 v163, 1.0, v163
    v_rcp_f32 v162, v162
    v_mfma_f32_16x16x32_bf16 v[132:135], a[84:87], v[116:119], v[132:135]
    s_add_u32 s82, s78, 425984
    ds_read_b128 v[108:111], v22 offset:11264
    v_mul_f32 v162, v146, v162
    v_add_f32 v164, 1.0, v164
    v_mfma_f32_16x16x32_bf16 v[136:139], a[72:75], v[112:115], v[136:139]
    buffer_load_dwordx4 v3, s[28:31], s83 offen offset:1024 lds
    v_mfma_f32_16x16x32_bf16 v[136:139], a[88:91], v[116:119], v[136:139]
    v_add_f32 v165, 1.0, v165
    v_rcp_f32 v163, v163
    v_mfma_f32_16x16x32_bf16 v[140:143], a[76:79], v[112:115], v[140:143]
    v_mul_f32 v163, v147, v163
    v_rcp_f32 v164, v164
    v_mfma_f32_16x16x32_bf16 v[140:143], a[92:95], v[116:119], v[140:143]
    s_waitcnt lgkmcnt(4)
    ds_read_b128 v[112:115], v22 offset:12288
    v_rcp_f32 v165, v165
    v_mfma_f32_16x16x32_bf16 v[128:131], a[96:99], v[120:123], v[128:131]
    buffer_load_dwordx4 v4, s[28:31], s83 offen offset:2048 lds
    v_mfma_f32_16x16x32_bf16 v[128:131], a[112:115], v[124:127], v[128:131]
    v_cvt_pk_bf16_f32 v185, v162, v163
    v_exp_f32 v167, v151
    v_mfma_f32_16x16x32_bf16 v[132:135], a[100:103], v[120:123], v[132:135]
    v_max_u32 v185, 1, v185
    v_mul_f32 v164, v148, v164
    v_mul_f32 v165, v149, v165
    v_mfma_f32_16x16x32_bf16 v[132:135], a[116:119], v[124:127], v[132:135]
    ds_read_b128 v[116:119], v22 offset:13312
    v_exp_f32 v168, v152
    v_mfma_f32_16x16x32_bf16 v[136:139], a[104:107], v[120:123], v[136:139]
    buffer_load_dwordx4 v5, s[28:31], s83 offen offset:3072 lds
    v_mfma_f32_16x16x32_bf16 v[136:139], a[120:123], v[124:127], v[136:139]
    v_cvt_pk_bf16_f32 v186, v164, v165
    v_add_f32 v166, 1.0, v166
    v_mfma_f32_16x16x32_bf16 v[140:143], a[108:111], v[120:123], v[140:143]
    s_waitcnt lgkmcnt(4)
    v_max_u32 v186, 1, v186
    v_rcp_f32 v166, v166
    v_mfma_f32_16x16x32_bf16 v[140:143], a[124:127], v[124:127], v[140:143]
    s_add_u32 m0, s62, 147456
    ds_read_b128 v[120:123], v22 offset:14336
    v_exp_f32 v169, v153
    v_mfma_f32_16x16x32_bf16 v[128:131], a[128:131], v[96:99], v[128:131]
    buffer_load_dwordx4 v2, s[28:31], s82 offen offset:0 lds
    v_mfma_f32_16x16x32_bf16 v[128:131], a[144:147], v[100:103], v[128:131]
    v_mul_f32 v166, v150, v166
    v_exp_f32 v170, v154
    v_mfma_f32_16x16x32_bf16 v[132:135], a[132:135], v[96:99], v[132:135]
    v_add_f32 v167, 1.0, v167
    v_exp_f32 v171, v155
    v_mfma_f32_16x16x32_bf16 v[132:135], a[148:151], v[100:103], v[132:135]
    ds_read_b128 v[124:127], v22 offset:15360
    v_rcp_f32 v167, v167
    v_mfma_f32_16x16x32_bf16 v[136:139], a[136:139], v[96:99], v[136:139]
    buffer_load_dwordx4 v3, s[28:31], s82 offen offset:1024 lds
    v_mfma_f32_16x16x32_bf16 v[136:139], a[152:155], v[100:103], v[136:139]
    v_mul_f32 v167, v151, v167
    v_add_f32 v168, 1.0, v168
    v_add_f32 v169, 1.0, v169
    v_mfma_f32_16x16x32_bf16 v[140:143], a[140:143], v[96:99], v[140:143]
    s_waitcnt lgkmcnt(4)
    v_cvt_pk_bf16_f32 v187, v166, v167
    v_rcp_f32 v168, v168
    v_mfma_f32_16x16x32_bf16 v[140:143], a[156:159], v[100:103], v[140:143]
    buffer_load_dwordx4 v4, s[28:31], s82 offen offset:2048 lds
    v_mfma_f32_16x16x32_bf16 v[128:131], a[160:163], v[104:107], v[128:131]
    s_add_u32 s83, s78, 327680
    v_max_u32 v187, 1, v187
    v_rcp_f32 v169, v169
    v_mfma_f32_16x16x32_bf16 v[128:131], a[176:179], v[108:111], v[128:131]
    v_mul_f32 v168, v152, v168
    v_exp_f32 v172, v156
    v_mfma_f32_16x16x32_bf16 v[132:135], a[164:167], v[104:107], v[132:135]
    buffer_load_dwordx4 v5, s[28:31], s82 offen offset:3072 lds
    v_mfma_f32_16x16x32_bf16 v[132:135], a[180:183], v[108:111], v[132:135]
    v_mul_f32 v169, v153, v169
    v_exp_f32 v173, v157
    v_mfma_f32_16x16x32_bf16 v[136:139], a[168:171], v[104:107], v[136:139]
    v_cvt_pk_bf16_f32 v188, v168, v169
    v_add_f32 v170, 1.0, v170
    v_mfma_f32_16x16x32_bf16 v[136:139], a[184:187], v[108:111], v[136:139]
    v_max_u32 v188, 1, v188
    v_rcp_f32 v170, v170
    v_mfma_f32_16x16x32_bf16 v[140:143], a[172:175], v[104:107], v[140:143]
    v_mul_f32 v170, v154, v170
    v_exp_f32 v174, v158
    v_mfma_f32_16x16x32_bf16 v[140:143], a[188:191], v[108:111], v[140:143]
    s_waitcnt lgkmcnt(3)
    v_add_f32 v171, 1.0, v171
    v_exp_f32 v175, v159
    v_mfma_f32_16x16x32_bf16 v[128:131], a[192:195], v[112:115], v[128:131]
    s_waitcnt lgkmcnt(2)
    v_add_f32 v172, 1.0, v172
    v_rcp_f32 v171, v171
    v_mfma_f32_16x16x32_bf16 v[128:131], a[208:211], v[116:119], v[128:131]
    v_mul_f32 v171, v155, v171
    v_rcp_f32 v172, v172
    v_mfma_f32_16x16x32_bf16 v[132:135], a[196:199], v[112:115], v[132:135]
    v_cvt_pk_bf16_f32 v189, v170, v171
    v_mul_f32 v172, v156, v172
    v_add_f32 v173, 1.0, v173
    v_mfma_f32_16x16x32_bf16 v[132:135], a[212:215], v[116:119], v[132:135]
    s_waitcnt vmcnt(8)
    s_waitcnt lgkmcnt(0)
    s_barrier
    ds_read_b128 v[96:99], v22 offset:32768
    v_rcp_f32 v173, v173
    v_mfma_f32_16x16x32_bf16 v[136:139], a[200:203], v[112:115], v[136:139]
    v_max_u32 v189, 1, v189
    v_mul_f32 v173, v157, v173
    v_add_f32 v174, 1.0, v174
    v_mfma_f32_16x16x32_bf16 v[136:139], a[216:219], v[116:119], v[136:139]
    s_add_u32 m0, s62, 0
    ds_read_b128 v[100:103], v22 offset:33792
    v_rcp_f32 v174, v174
    v_mfma_f32_16x16x32_bf16 v[140:143], a[204:207], v[112:115], v[140:143]
    buffer_load_dwordx4 v2, s[28:31], s83 offen offset:0 lds
    v_mfma_f32_16x16x32_bf16 v[140:143], a[220:223], v[116:119], v[140:143]
    s_add_u32 s82, s78, 360448
    ds_read_b128 v[104:107], v22 offset:34816
    v_cvt_pk_bf16_f32 v190, v172, v173
    v_mfma_f32_16x16x32_bf16 v[128:131], a[224:227], v[120:123], v[128:131]
    v_max_u32 v190, 1, v190
    v_mul_f32 v174, v158, v174
    v_add_f32 v175, 1.0, v175
    v_mfma_f32_16x16x32_bf16 v[128:131], a[240:243], v[124:127], v[128:131]
    ds_read_b128 v[108:111], v22 offset:35840
    v_rcp_f32 v175, v175
    v_mfma_f32_16x16x32_bf16 v[132:135], a[228:231], v[120:123], v[132:135]
    buffer_load_dwordx4 v3, s[28:31], s83 offen offset:1024 lds
    v_mfma_f32_16x16x32_bf16 v[132:135], a[244:247], v[124:127], v[132:135]
    ds_read_b128 v[112:115], v22 offset:36864
    v_mul_f32 v175, v159, v175
    v_mfma_f32_16x16x32_bf16 v[136:139], a[232:235], v[120:123], v[136:139]
    v_cvt_pk_bf16_f32 v191, v174, v175
    v_mfma_f32_16x16x32_bf16 v[136:139], a[248:251], v[124:127], v[136:139]
    ds_read_b128 v[116:119], v22 offset:37888
    v_max_u32 v191, 1, v191
    v_mfma_f32_16x16x32_bf16 v[140:143], a[236:239], v[120:123], v[140:143]
    buffer_load_dwordx4 v4, s[28:31], s83 offen offset:2048 lds
    v_mfma_f32_16x16x32_bf16 v[140:143], a[252:255], v[124:127], v[140:143]
    s_waitcnt lgkmcnt(4)
    ds_read_b128 v[120:123], v22 offset:38912
    v_mfma_f32_16x16x32_bf16 v[144:147], a[0:3], v[96:99], 0
    buffer_store_dwordx4 v[184:187], v10, s[48:51], s67 offen offset:0 sc1
    v_mfma_f32_16x16x32_bf16 v[144:147], a[16:19], v[100:103], v[144:147]
    buffer_store_dwordx4 v[188:191], v10, s[48:51], s67 offen offset:1024 sc1
    v_mfma_f32_16x16x32_bf16 v[148:151], a[4:7], v[96:99], 0
    buffer_load_dwordx4 v5, s[28:31], s83 offen offset:3072 lds
    v_mfma_f32_16x16x32_bf16 v[148:151], a[20:23], v[100:103], v[148:151]
    s_add_u32 m0, s62, 16384
    ds_read_b128 v[124:127], v22 offset:39936
    v_mfma_f32_16x16x32_bf16 v[152:155], a[8:11], v[96:99], 0
    buffer_load_dwordx4 v2, s[28:31], s82 offen offset:0 lds
    v_mfma_f32_16x16x32_bf16 v[152:155], a[24:27], v[100:103], v[152:155]
    v_exp_f32 v160, v128
    v_mfma_f32_16x16x32_bf16 v[156:159], a[12:15], v[96:99], 0
    v_exp_f32 v161, v129
    v_mfma_f32_16x16x32_bf16 v[156:159], a[28:31], v[100:103], v[156:159]
    s_waitcnt lgkmcnt(4)
    ds_read_b128 v[96:99], v22 offset:40960
    v_exp_f32 v162, v130
    v_mfma_f32_16x16x32_bf16 v[144:147], a[32:35], v[104:107], v[144:147]
    buffer_load_dwordx4 v3, s[28:31], s82 offen offset:1024 lds
    v_mfma_f32_16x16x32_bf16 v[144:147], a[48:51], v[108:111], v[144:147]
L_hop2_1:
    s_cbranch_execz L_back2_0
    v_add_f32 v160, 1.0, v160
    v_exp_f32 v163, v131
    v_mfma_f32_16x16x32_bf16 v[148:151], a[36:39], v[104:107], v[148:151]
    v_rcp_f32 v160, v160
    v_mfma_f32_16x16x32_bf16 v[148:151], a[52:55], v[108:111], v[148:151]
    ds_read_b128 v[100:103], v22 offset:41984
    v_mul_f32 v160, v128, v160
    v_add_f32 v161, 1.0, v161
    v_mfma_f32_16x16x32_bf16 v[152:155], a[40:43], v[104:107], v[152:155]
    buffer_load_dwordx4 v4, s[28:31], s82 offen offset:2048 lds
    v_mfma_f32_16x16x32_bf16 v[152:155], a[56:59], v[108:111], v[152:155]
    v_add_f32 v162, 1.0, v162
    v_rcp_f32 v161, v161
    v_mfma_f32_16x16x32_bf16 v[156:159], a[44:47], v[104:107], v[156:159]
    v_rcp_f32 v162, v162
    v_mfma_f32_16x16x32_bf16 v[156:159], a[60:63], v[108:111], v[156:159]
    s_waitcnt lgkmcnt(4)
    ds_read_b128 v[104:107], v22 offset:43008
    v_exp_f32 v164, v132
    v_mfma_f32_16x16x32_bf16 v[144:147], a[64:67], v[112:115], v[144:147]
    buffer_load_dwordx4 v5, s[28:31], s82 offen offset:3072 lds
    v_mfma_f32_16x16x32_bf16 v[144:147], a[80:83], v[116:119], v[144:147]
    v_mul_f32 v161, v129, v161
    v_exp_f32 v165, v133
    v_mfma_f32_16x16x32_bf16 v[148:151], a[68:71], v[112:115], v[148:151]
    v_cvt_pk_bf16_f32 v176, v160, v161
    v_mul_f32 v162, v130, v162
    v_mfma_f32_16x16x32_bf16 v[148:151], a[84:87], v[116:119], v[148:151]
    ds_read_b128 v[108:111], v22 offset:44032
    v_max_u32 v176, 1, v176
    v_add_f32 v163, 1.0, v163
    v_mfma_f32_16x16x32_bf16 v[152:155], a[72:75], v[112:115], v[152:155]
    v_add_f32 v164, 1.0, v164
    v_rcp_f32 v163, v163
    v_mfma_f32_16x16x32_bf16 v[152:155], a[88:91], v[116:119], v[152:155]
    v_rcp_f32 v164, v164
    v_mfma_f32_16x16x32_bf16 v[156:159], a[76:79], v[112:115], v[156:159]
    v_mul_f32 v163, v131, v163
    v_exp_f32 v166, v134
    v_mfma_f32_16x16x32_bf16 v[156:159], a[92:95], v[116:119], v[156:159]
    s_waitcnt lgkmcnt(5)
    ds_read_b128 v[112:115], v22 offset:45056
    v_cvt_pk_bf16_f32 v177, v162, v163
    v_mul_f32 v164, v132, v164
    v_mfma_f32_16x16x32_bf16 v[144:147], a[96:99], v[120:123], v[144:147]
    s_waitcnt lgkmcnt(5)
    v_exp_f32 v167, v135
    v_mfma_f32_16x16x32_bf16 v[144:147], a[112:115], v[124:127], v[144:147]
    v_max_u32 v177, 1, v177
    v_exp_f32 v168, v136
    v_mfma_f32_16x16x32_bf16 v[148:151], a[100:103], v[120:123], v[148:151]
    v_add_f32 v165, 1.0, v165
    v_exp_f32 v169, v137
    v_mfma_f32_16x16x32_bf16 v[148:151], a[116:119], v[124:127], v[148:151]
    ds_read_b128 v[116:119], v22 offset:46080
    v_add_f32 v166, 1.0, v166
    v_mfma_f32_16x16x32_bf16 v[152:155], a[104:107], v[120:123], v[152:155]
    v_add_f32 v167, 1.0, v167
    v_rcp_f32 v165, v165
    v_mfma_f32_16x16x32_bf16 v[152:155], a[120:123], v[124:127], v[152:155]
    v_mul_f32 v165, v133, v165
    v_rcp_f32 v166, v166
    v_mfma_f32_16x16x32_bf16 v[156:159], a[108:111], v[120:123], v[156:159]
    v_cvt_pk_bf16_f32 v178, v164, v165
    v_mul_f32 v166, v134, v166
    v_mfma_f32_16x16x32_bf16 v[156:159], a[124:127], v[124:127], v[156:159]
    s_waitcnt lgkmcnt(5)
    ds_read_b128 v[120:123], v22 offset:47104
    v_rcp_f32 v167, v167
    v_mfma_f32_16x16x32_bf16 v[144:147], a[128:131], v[96:99], v[144:147]
    s_waitcnt lgkmcnt(5)
    v_max_u32 v178, 1, v178
    v_exp_f32 v170, v138
    v_mfma_f32_16x16x32_bf16 v[144:147], a[144:147], v[100:103], v[144:147]
    v_mul_f32 v167, v135, v167
    v_add_f32 v168, 1.0, v168
    v_mfma_f32_16x16x32_bf16 v[148:151], a[132:135], v[96:99], v[148:151]
    v_cvt_pk_bf16_f32 v179, v166, v167
    v_rcp_f32 v168, v168
    v_mfma_f32_16x16x32_bf16 v[148:151], a[148:151], v[100:103], v[148:151]
    ds_read_b128 v[124:127], v22 offset:48128
    v_max_u32 v179, 1, v179
    v_mfma_f32_16x16x32_bf16 v[152:155], a[136:139], v[96:99], v[152:155]
    v_mul_f32 v168, v136, v168
    v_exp_f32 v171, v139
    v_mfma_f32_16x16x32_bf16 v[152:155], a[152:155], v[100:103], v[152:155]
    v_add_f32 v169, 1.0, v169
    v_exp_f32 v172, v140
    v_mfma_f32_16x16x32_bf16 v[156:159], a[140:143], v[96:99], v[156:159]
    v_rcp_f32 v169, v169
    v_mfma_f32_16x16x32_bf16 v[156:159], a[156:159], v[100:103], v[156:159]
    s_waitcnt lgkmcnt(5)
    v_mul_f32 v169, v137, v169
    v_exp_f32 v173, v141
    v_mfma_f32_16x16x32_bf16 v[144:147], a[160:163], v[104:107], v[144:147]
    s_waitcnt lgkmcnt(4)
    v_cvt_pk_bf16_f32 v180, v168, v169
    v_add_f32 v170, 1.0, v170
    v_add_f32 v171, 1.0, v171
    v_mfma_f32_16x16x32_bf16 v[144:147], a[176:179], v[108:111], v[144:147]
    v_rcp_f32 v170, v170
    v_mfma_f32_16x16x32_bf16 v[148:151], a[164:167], v[104:107], v[148:151]
    v_max_u32 v180, 1, v180
    v_rcp_f32 v171, v171
    v_mfma_f32_16x16x32_bf16 v[148:151], a[180:183], v[108:111], v[148:151]
    v_mul_f32 v170, v138, v170
    v_exp_f32 v174, v142
    v_mfma_f32_16x16x32_bf16 v[152:155], a[168:171], v[104:107], v[152:155]
    v_mul_f32 v171, v139, v171
    v_add_f32 v172, 1.0, v172
    v_mfma_f32_16x16x32_bf16 v[152:155], a[184:187], v[108:111], v[152:155]
    s_waitcnt lgkmcnt(2)
    v_cvt_pk_bf16_f32 v181, v170, v171
    v_rcp_f32 v172, v172
    v_mfma_f32_16x16x32_bf16 v[156:159], a[172:175], v[104:107], v[156:159]
    s_add_u32 s55, s81, 0
    v_max_u32 v181, 1, v181
    v_exp_f32 v175, v143
    v_mfma_f32_16x16x32_bf16 v[156:159], a[188:191], v[108:111], v[156:159]
    buffer_load_dwordx4 v[192:195], v10, s[48:51], s55 offen offset:0 sc1
    v_mfma_f32_16x16x32_bf16 v[144:147], a[192:195], v[112:115], v[144:147]
    buffer_load_dwordx4 v[196:199], v10, s[48:51], s55 offen offset:1024 sc1
    v_mfma_f32_16x16x32_bf16 v[144:147], a[208:211], v[116:119], v[144:147]
    v_mul_f32 v172, v140, v172
    v_add_f32 v173, 1.0, v173
    v_mfma_f32_16x16x32_bf16 v[148:151], a[196:199], v[112:115], v[148:151]
    buffer_load_dwordx4 v[200:203], v10, s[48:51], s55 offen offset:2048 sc1
    v_mfma_f32_16x16x32_bf16 v[148:151], a[212:215], v[116:119], v[148:151]
    v_add_f32 v174, 1.0, v174
    v_rcp_f32 v173, v173
    v_mfma_f32_16x16x32_bf16 v[152:155], a[200:203], v[112:115], v[152:155]
    buffer_load_dwordx4 v[204:207], v10, s[48:51], s55 offen offset:3072 sc1
    v_mfma_f32_16x16x32_bf16 v[152:155], a[216:219], v[116:119], v[152:155]
    s_waitcnt lgkmcnt(0)
    v_mul_f32 v173, v141, v173
    v_rcp_f32 v174, v174
    v_mfma_f32_16x16x32_bf16 v[156:159], a[204:207], v[112:115], v[156:159]
    s_add_u32 s55, s81, 4096
    v_cvt_pk_bf16_f32 v182, v172, v173
    v_mul_f32 v174, v142, v174
    v_mfma_f32_16x16x32_bf16 v[156:159], a[220:223], v[116:119], v[156:159]
    buffer_load_dwordx4 v[208:211], v10, s[48:51], s55 offen offset:0 sc1
    v_mfma_f32_16x16x32_bf16 v[144:147], a[224:227], v[120:123], v[144:147]
    buffer_load_dwordx4 v[212:215], v10, s[48:51], s55 offen offset:1024 sc1
    v_mfma_f32_16x16x32_bf16 v[144:147], a[240:243], v[124:127], v[144:147]
    v_max_u32 v182, 1, v182
    v_add_f32 v175, 1.0, v175
    v_mfma_f32_16x16x32_bf16 v[148:151], a[228:231], v[120:123], v[148:151]
    buffer_load_dwordx4 v[216:219], v10, s[48:51], s55 offen offset:2048 sc1
    v_mfma_f32_16x16x32_bf16 v[148:151], a[244:247], v[124:127], v[148:151]
    v_rcp_f32 v175, v175
    v_mfma_f32_16x16x32_bf16 v[152:155], a[232:235], v[120:123], v[152:155]
    buffer_load_dwordx4 v[220:223], v10, s[48:51], s55 offen offset:3072 sc1
    v_mfma_f32_16x16x32_bf16 v[152:155], a[248:251], v[124:127], v[152:155]
    v_mul_f32 v175, v143, v175
    v_mfma_f32_16x16x32_bf16 v[156:159], a[236:239], v[120:123], v[156:159]
    v_cvt_pk_bf16_f32 v183, v174, v175
    v_mfma_f32_16x16x32_bf16 v[156:159], a[252:255], v[124:127], v[156:159]
    v_max_u32 v183, 1, v183
    s_waitcnt vmcnt(8)
    s_branch L_nog1j_36
L_nog1_35:
    s_waitcnt vmcnt(0)
    ds_read_b64_tr_b16 v[64:65], v12 offset:0
    ds_read_b64_tr_b16 v[66:67], v12 offset:2048
    ds_read_b64_tr_b16 v[68:69], v13 offset:0
    ds_read_b64_tr_b16 v[70:71], v13 offset:2048
    ds_read_b64_tr_b16 v[72:73], v12 offset:256
    ds_read_b64_tr_b16 v[74:75], v12 offset:2304
    ds_read_b64_tr_b16 v[76:77], v13 offset:256
    ds_read_b64_tr_b16 v[78:79], v13 offset:2304
    ds_read_b64_tr_b16 v[80:81], v12 offset:16384
    ds_read_b64_tr_b16 v[82:83], v12 offset:18432
    ds_read_b64_tr_b16 v[84:85], v13 offset:16384
    ds_read_b64_tr_b16 v[86:87], v13 offset:18432
    ds_read_b64_tr_b16 v[88:89], v12 offset:16640
    ds_read_b64_tr_b16 v[90:91], v12 offset:18688
    ds_read_b64_tr_b16 v[92:93], v13 offset:16640
    ds_read_b64_tr_b16 v[94:95], v13 offset:18688
    ds_read_b64_tr_b16 v[224:225], v14 offset:0
    ds_read_b64_tr_b16 v[226:227], v14 offset:2048
    ds_read_b64_tr_b16 v[228:229], v15 offset:0
    ds_read_b64_tr_b16 v[230:231], v15 offset:2048
    ds_read_b64_tr_b16 v[232:233], v14 offset:256
    ds_read_b64_tr_b16 v[234:235], v14 offset:2304
    ds_read_b64_tr_b16 v[236:237], v15 offset:256
    ds_read_b64_tr_b16 v[238:239], v15 offset:2304
    ds_read_b64_tr_b16 v[240:241], v14 offset:16384
    ds_read_b64_tr_b16 v[242:243], v14 offset:18432
    ds_read_b64_tr_b16 v[244:245], v15 offset:16384
    ds_read_b64_tr_b16 v[246:247], v15 offset:18432
    ds_read_b64_tr_b16 v[248:249], v14 offset:16640
    ds_read_b64_tr_b16 v[250:251], v14 offset:18688
    ds_read_b64_tr_b16 v[252:253], v15 offset:16640
    ds_read_b64_tr_b16 v[254:255], v15 offset:18688
    s_waitcnt lgkmcnt(0)
    s_barrier
    s_mul_i32 s55, s52, 458752
    s_lshl_b32 s56, s54, 13
    s_add_u32 s55, s55, s56
    s_add_u32 s56, s55, -32768
    buffer_load_dword v27, v26, s[28:31], s56 offen
    s_add_u32 s56, s55, 0
    buffer_load_dword v27, v26, s[28:31], s56 offen
    s_add_u32 s56, s55, 98304
    buffer_load_dword v27, v26, s[28:31], s56 offen
    s_add_u32 s56, s55, 131072
    buffer_load_dword v27, v26, s[28:31], s56 offen
    s_add_u32 s56, s55, 163840
    buffer_load_dword v27, v26, s[28:31], s56 offen
    s_add_u32 s56, s55, 196608
    buffer_load_dword v27, v26, s[28:31], s56 offen
    s_add_u32 m0, s62, 65536
    s_add_u32 s56, s78, 131072
    buffer_load_dwordx4 v2, s[28:31], s56 offen offset:0 lds
    buffer_load_dwordx4 v3, s[28:31], s56 offen offset:1024 lds
    buffer_load_dwordx4 v4, s[28:31], s56 offen offset:2048 lds
    buffer_load_dwordx4 v5, s[28:31], s56 offen offset:3072 lds
    s_add_u32 m0, s62, 81920
    s_add_u32 s56, s78, 163840
    buffer_load_dwordx4 v2, s[28:31], s56 offen offset:0 lds
    buffer_load_dwordx4 v3, s[28:31], s56 offen offset:1024 lds
    buffer_load_dwordx4 v4, s[28:31], s56 offen offset:2048 lds
    buffer_load_dwordx4 v5, s[28:31], s56 offen offset:3072 lds
    s_add_u32 m0, s62, 98304
    s_add_u32 s56, s78, 196608
    buffer_load_dwordx4 v2, s[28:31], s56 offen offset:0 lds
    buffer_load_dwordx4 v3, s[28:31], s56 offen offset:1024 lds
    buffer_load_dwordx4 v4, s[28:31], s56 offen offset:2048 lds
    buffer_load_dwordx4 v5, s[28:31], s56 offen offset:3072 lds
    s_add_u32 m0, s62, 114688
    s_add_u32 s56, s78, 229376
    buffer_load_dwordx4 v2, s[28:31], s56 offen offset:0 lds
    buffer_load_dwordx4 v3, s[28:31], s56 offen offset:1024 lds
    buffer_load_dwordx4 v4, s[28:31], s56 offen offset:2048 lds
    buffer_load_dwordx4 v5, s[28:31], s56 offen offset:3072 lds
    s_add_u32 m0, s62, 0
    s_add_u32 s56, s78, 327680
    buffer_load_dwordx4 v2, s[28:31], s56 offen offset:0 lds
    buffer_load_dwordx4 v3, s[28:31], s56 offen offset:1024 lds
    buffer_load_dwordx4 v4, s[28:31], s56 offen offset:2048 lds
    buffer_load_dwordx4 v5, s[28:31], s56 offen offset:3072 lds
    s_add_u32 m0, s62, 16384
    s_add_u32 s56, s78, 360448
    buffer_load_dwordx4 v2, s[28:31], s56 offen offset:0 lds
    buffer_load_dwordx4 v3, s[28:31], s56 offen offset:1024 lds
    buffer_load_dwordx4 v4, s[28:31], s56 offen offset:2048 lds
    buffer_load_dwordx4 v5, s[28:31], s56 offen offset:3072 lds
    s_add_u32 m0, s62, 131072
    s_add_u32 s56, s78, 393216
    buffer_load_dwordx4 v2, s[28:31], s56 offen offset:0 lds
    buffer_load_dwordx4 v3, s[28:31], s56 offen offset:1024 lds
    buffer_load_dwordx4 v4, s[28:31], s56 offen offset:2048 lds
    buffer_load_dwordx4 v5, s[28:31], s56 offen offset:3072 lds
    s_add_u32 m0, s62, 147456
    s_add_u32 s56, s78, 425984
    buffer_load_dwordx4 v2, s[28:31], s56 offen offset:0 lds
    buffer_load_dwordx4 v3, s[28:31], s56 offen offset:1024 lds
    buffer_load_dwordx4 v4, s[28:31], s56 offen offset:2048 lds
    buffer_load_dwordx4 v5, s[28:31], s56 offen offset:3072 lds
    v_lshrrev_b32 v24, 4, v0
    v_and_b32 v23, 15, v0
    v_xor_b32 v6, v24, v23
    v_lshlrev_b32 v6, 4, v6
    v_lshl_add_u32 v6, v24, 8, v6
    s_add_u32 s56, s62, 65536
    v_add_u32 v6, s56, v6
    v_xor_b32 v7, 64, v6
    v_xor_b32 v8, 128, v6
    v_xor_b32 v9, 192, v6
    s_lshl_b32 s56, s52, 2
    v_add_u32 v24, s56, v24
    v_xor_b32 v11, v24, v23
    v_lshlrev_b32 v11, 4, v11
    v_lshl_add_u32 v11, v23, 8, v11
    v_add_u32 v11, 65536, v11
    v_lshlrev_b32 v21, 3, v23
    v_lshl_add_u32 v21, v24, 10, v21
    v_bfe_u32 v20, v0, 3, 1
    v_lshlrev_b32 v20, 9, v20
    v_and_b32 v24, 3, v0
    v_lshl_add_u32 v20, v24, 7, v20
    v_bfe_u32 v24, v0, 2, 1
    v_lshl_add_u32 v20, v24, 3, v20
    v_lshrrev_b32 v24, 4, v0
    v_lshl_add_u32 v20, v24, 4, v20
    s_lshr_b32 s56, s52, 1
    s_lshl_b32 s56, s56, 10
    s_and_b32 s57, s52, 1
    s_lshl_b32 s57, s57, 6
    s_add_u32 s56, s56, s57
    v_add_u32 v20, s56, v20
    v_lshlrev_b32 v23, 4, v23
    s_lshl_b32 s60, s76, 16
    s_lshl_b32 s56, s77, 7
    s_add_u32 s61, s60, s56
    s_lshl_b32 s56, s52, 14
    s_add_u32 s60, s60, s56
    s_lshl_b32 s56, s77, 10
    s_add_u32 s60, s60, s56
    s_add_u32 s60, s60, 2097152
    s_lshl_b32 s72, s77, 8
    s_add_u32 s72, s72, 10240
    s_add_u32 s58, s81, 13312
    s_mov_b32 s98, 1048576
L_gate_42:
    buffer_load_dword v29, off, s[48:51], s58 sc1
    s_sub_u32 s98, s98, 1
    s_cbranch_scc1 L_gateout_43
    s_waitcnt vmcnt(0)
    v_cmp_eq_u32 vcc, 0, v29
    s_nop 0
    s_cbranch_vccnz L_gate_42
L_gateout_43:
    s_waitcnt vmcnt(0)
    s_add_u32 s55, s81, 0
    buffer_load_dwordx4 v[192:195], v10, s[48:51], s55 offen offset:0 sc1
    buffer_load_dwordx4 v[196:199], v10, s[48:51], s55 offen offset:1024 sc1
    buffer_load_dwordx4 v[200:203], v10, s[48:51], s55 offen offset:2048 sc1
    buffer_load_dwordx4 v[204:207], v10, s[48:51], s55 offen offset:3072 sc1
    s_add_u32 s55, s81, 4096
    buffer_load_dwordx4 v[208:211], v10, s[48:51], s55 offen offset:0 sc1
    buffer_load_dwordx4 v[212:215], v10, s[48:51], s55 offen offset:1024 sc1
    buffer_load_dwordx4 v[216:219], v10, s[48:51], s55 offen offset:2048 sc1
    buffer_load_dwordx4 v[220:223], v10, s[48:51], s55 offen offset:3072 sc1
L_nog1j_36:
    buffer_store_dwordx4 v[176:179], v10, s[48:51], s68 offen offset:0 sc1
    buffer_store_dwordx4 v[180:183], v10, s[48:51], s68 offen offset:1024 sc1
    ds_read_b64_tr_b16 a[96:97], v16 offset:0
    ds_read_b64_tr_b16 a[98:99], v16 offset:2048
    ds_read_b64_tr_b16 a[100:101], v17 offset:0
    ds_read_b64_tr_b16 a[102:103], v17 offset:2048
    ds_read_b64_tr_b16 a[104:105], v16 offset:256
    ds_read_b64_tr_b16 a[106:107], v16 offset:2304
    ds_read_b64_tr_b16 a[108:109], v17 offset:256
    ds_read_b64_tr_b16 a[110:111], v17 offset:2304
    v_exp_f32 v160, v144
    v_exp_f32 v162, v146
    v_exp_f32 v164, v148
    v_exp_f32 v166, v150
    v_exp_f32 v161, v145
    v_exp_f32 v163, v147
    v_exp_f32 v165, v149
    v_exp_f32 v167, v151
    ds_read_b64_tr_b16 a[0:1], v12 offset:0
    ds_read_b64_tr_b16 a[2:3], v12 offset:2048
    ds_read_b64_tr_b16 a[4:5], v13 offset:0
    ds_read_b64_tr_b16 a[6:7], v13 offset:2048
    ds_read_b64_tr_b16 a[8:9], v12 offset:256
    ds_read_b64_tr_b16 a[10:11], v12 offset:2304
    ds_read_b64_tr_b16 a[12:13], v13 offset:256
    ds_read_b64_tr_b16 a[14:15], v13 offset:2304
    v_add_f32 v160, 1.0, v160
    v_add_f32 v162, 1.0, v162
    v_add_f32 v164, 1.0, v164
    v_add_f32 v166, 1.0, v166
    v_add_f32 v161, 1.0, v161
    v_add_f32 v163, 1.0, v163
    v_add_f32 v165, 1.0, v165
    v_add_f32 v167, 1.0, v167
    ds_read_b64_tr_b16 a[16:17], v12 offset:16384
    ds_read_b64_tr_b16 a[18:19], v12 offset:18432
    ds_read_b64_tr_b16 a[20:21], v13 offset:16384
    ds_read_b64_tr_b16 a[22:23], v13 offset:18432
    ds_read_b64_tr_b16 a[24:25], v12 offset:16640
    ds_read_b64_tr_b16 a[26:27], v12 offset:18688
    ds_read_b64_tr_b16 a[28:29], v13 offset:16640
    ds_read_b64_tr_b16 a[30:31], v13 offset:18688
    v_rcp_f32 v160, v160
    v_rcp_f32 v162, v162
    v_rcp_f32 v164, v164
    v_rcp_f32 v166, v166
    v_rcp_f32 v161, v161
    v_rcp_f32 v163, v163
    v_rcp_f32 v165, v165
    v_rcp_f32 v167, v167
    s_waitcnt lgkmcnt(15)
    s_mov_b32 m0, s62
    s_add_u32 s56, s60, 7168
    buffer_load_dwordx4 v10, s[48:51], s60 offen offset:0 sc1 lds
    buffer_load_dwordx4 v10, s[48:51], s56 offen offset:1024 sc1 lds
    ds_read_b64_tr_b16 a[32:33], v12 offset:32768
    ds_read_b64_tr_b16 a[34:35], v12 offset:34816
    ds_read_b64_tr_b16 a[36:37], v13 offset:32768
    ds_read_b64_tr_b16 a[38:39], v13 offset:34816
    ds_read_b64_tr_b16 a[40:41], v12 offset:33024
    ds_read_b64_tr_b16 a[42:43], v12 offset:35072
    ds_read_b64_tr_b16 a[44:45], v13 offset:33024
    ds_read_b64_tr_b16 a[46:47], v13 offset:35072
    v_mul_f32 v160, v144, v160
    v_mul_f32 v162, v146, v162
    v_mul_f32 v164, v148, v164
    v_mul_f32 v166, v150, v166
    v_mul_f32 v161, v145, v161
    v_mul_f32 v163, v147, v163
    v_mul_f32 v165, v149, v165
    v_mul_f32 v167, v151, v167
    buffer_load_dwordx4 v[2:5], v23, s[48:51], s72 offen sc1
    s_add_u32 s55, s81, 8192
    buffer_load_dwordx4 v[96:99], v10, s[48:51], s55 offen offset:0 sc1
    ds_read_b64_tr_b16 a[48:49], v12 offset:49152
    ds_read_b64_tr_b16 a[50:51], v12 offset:51200
    ds_read_b64_tr_b16 a[52:53], v13 offset:49152
    ds_read_b64_tr_b16 a[54:55], v13 offset:51200
    ds_read_b64_tr_b16 a[56:57], v12 offset:49408
    ds_read_b64_tr_b16 a[58:59], v12 offset:51456
    ds_read_b64_tr_b16 a[60:61], v13 offset:49408
    ds_read_b64_tr_b16 a[62:63], v13 offset:51456
    v_cvt_pk_bf16_f32 v184, v160, v161
    v_cvt_pk_bf16_f32 v185, v162, v163
    v_cvt_pk_bf16_f32 v186, v164, v165
    v_cvt_pk_bf16_f32 v187, v166, v167
    v_max_u32 v184, 1, v184
    v_max_u32 v185, 1, v185
    v_max_u32 v186, 1, v186
    v_max_u32 v187, 1, v187
    buffer_load_dwordx4 v[100:103], v10, s[48:51], s55 offen offset:1024 sc1
    buffer_load_dwordx4 v[104:107], v10, s[48:51], s55 offen offset:2048 sc1
    ds_read_b64_tr_b16 a[112:113], v16 offset:16384
    ds_read_b64_tr_b16 a[114:115], v16 offset:18432
    ds_read_b64_tr_b16 a[116:117], v17 offset:16384
    ds_read_b64_tr_b16 a[118:119], v17 offset:18432
    ds_read_b64_tr_b16 a[120:121], v16 offset:16640
    ds_read_b64_tr_b16 a[122:123], v16 offset:18688
    ds_read_b64_tr_b16 a[124:125], v17 offset:16640
    ds_read_b64_tr_b16 a[126:127], v17 offset:18688
    v_exp_f32 v168, v152
    v_exp_f32 v170, v154
    v_exp_f32 v172, v156
    v_exp_f32 v174, v158
    v_exp_f32 v169, v153
    v_exp_f32 v171, v155
    v_exp_f32 v173, v157
    v_exp_f32 v175, v159
    buffer_load_dwordx4 v[108:111], v10, s[48:51], s55 offen offset:3072 sc1
    s_add_u32 s55, s81, 12288
    buffer_load_dwordx4 v[112:115], v10, s[48:51], s55 offen offset:0 sc1
    v_add_f32 v168, 1.0, v168
    v_add_f32 v170, 1.0, v170
    v_add_f32 v172, 1.0, v172
    v_add_f32 v174, 1.0, v174
    v_add_f32 v169, 1.0, v169
    v_add_f32 v171, 1.0, v171
    v_add_f32 v173, 1.0, v173
    v_add_f32 v175, 1.0, v175
    buffer_load_dwordx4 v[116:119], v10, s[48:51], s55 offen offset:1024 sc1
    v_rcp_f32 v168, v168
    v_rcp_f32 v170, v170
    v_rcp_f32 v172, v172
    v_rcp_f32 v174, v174
    v_rcp_f32 v169, v169
    v_rcp_f32 v171, v171
    v_rcp_f32 v173, v173
    v_rcp_f32 v175, v175
    v_mul_f32 v168, v152, v168
    v_mul_f32 v170, v154, v170
    v_mul_f32 v172, v156, v172
    v_mul_f32 v174, v158, v174
    v_mul_f32 v169, v153, v169
    v_mul_f32 v171, v155, v171
    v_mul_f32 v173, v157, v173
    v_mul_f32 v175, v159, v175
    v_cvt_pk_bf16_f32 v188, v168, v169
    v_cvt_pk_bf16_f32 v189, v170, v171
    v_cvt_pk_bf16_f32 v190, v172, v173
    v_cvt_pk_bf16_f32 v191, v174, v175
    v_max_u32 v188, 1, v188
    v_max_u32 v189, 1, v189
    v_max_u32 v190, 1, v190
    v_max_u32 v191, 1, v191
    buffer_store_dwordx4 v[184:187], v10, s[48:51], s69 offen offset:0 sc1
    buffer_store_dwordx4 v[188:191], v10, s[48:51], s69 offen offset:1024 sc1
    s_waitcnt vmcnt(20)
    v_min3_u32 v160, v192, v193, v194
    s_waitcnt vmcnt(19)
    v_min3_u32 v161, v195, v196, v197
    v_min3_u32 v160, v160, v198, v199
    v_min_u32 v160, v160, v161
    v_cmp_eq_u32 vcc, 0, v160
    s_nop 0
    s_cbranch_vccnz L_redo_44
L_redoj_45:
    v_mfma_f32_16x16x32_bf16 v[128:131], v[32:35], v[192:195], 0
    v_mfma_f32_16x16x32_bf16 v[132:135], v[36:39], v[192:195], 0
    ds_read_b64_tr_b16 a[128:129], v14 offset:0
    v_mfma_f32_16x16x32_bf16 v[136:139], v[40:43], v[192:195], 0
    s_waitcnt vmcnt(17)
    ds_read_b64_tr_b16 a[130:131], v14 offset:2048
    v_min3_u32 v162, v200, v201, v202
    v_min3_u32 v163, v203, v204, v205
    v_mfma_f32_16x16x32_bf16 v[140:143], v[44:47], v[192:195], 0
    ds_read_b64_tr_b16 a[132:133], v15 offset:0
    v_min3_u32 v162, v162, v206, v207
    v_min_u32 v162, v162, v163
    v_mfma_f32_16x16x32_bf16 v[128:131], v[48:51], v[196:199], v[128:131]
    ds_read_b64_tr_b16 a[134:135], v15 offset:2048
    v_mfma_f32_16x16x32_bf16 v[132:135], v[52:55], v[196:199], v[132:135]
    ds_read_b64_tr_b16 a[136:137], v14 offset:256
    v_cmp_eq_u32 vcc, 0, v162
    v_mfma_f32_16x16x32_bf16 v[136:139], v[56:59], v[196:199], v[136:139]
    ds_read_b64_tr_b16 a[138:139], v14 offset:2304
    v_mfma_f32_16x16x32_bf16 v[140:143], v[60:63], v[196:199], v[140:143]
    s_cbranch_vccnz L_redo_46
L_redoj_47:
    ds_read_b64_tr_b16 a[140:141], v15 offset:256
    v_mfma_f32_16x16x32_bf16 v[128:131], v[64:67], v[200:203], v[128:131]
    ds_read_b64_tr_b16 a[142:143], v15 offset:2304
    v_mfma_f32_16x16x32_bf16 v[132:135], v[68:71], v[200:203], v[132:135]
    ds_read_b64_tr_b16 a[144:145], v14 offset:16384
    v_mfma_f32_16x16x32_bf16 v[136:139], v[72:75], v[200:203], v[136:139]
    s_waitcnt vmcnt(15)
    ds_read_b64_tr_b16 a[146:147], v14 offset:18432
    v_min3_u32 v160, v208, v209, v210
    v_min3_u32 v161, v211, v212, v213
    v_mfma_f32_16x16x32_bf16 v[140:143], v[76:79], v[200:203], v[140:143]
    ds_read_b64_tr_b16 a[148:149], v15 offset:16384
    v_min3_u32 v160, v160, v214, v215
    v_min_u32 v160, v160, v161
    v_mfma_f32_16x16x32_bf16 v[128:131], v[80:83], v[204:207], v[128:131]
    ds_read_b64_tr_b16 a[150:151], v15 offset:18432
    v_mfma_f32_16x16x32_bf16 v[132:135], v[84:87], v[204:207], v[132:135]
    s_waitcnt lgkmcnt(15)
    ds_read_b64_tr_b16 a[152:153], v14 offset:16640
    v_cmp_eq_u32 vcc, 0, v160
    v_mfma_f32_16x16x32_bf16 v[136:139], v[88:91], v[204:207], v[136:139]
    s_add_u32 s55, s81, 57344
    ds_read_b64_tr_b16 a[154:155], v14 offset:18688
    v_mfma_f32_16x16x32_bf16 v[140:143], v[92:95], v[204:207], v[140:143]
    s_cbranch_vccnz L_redo_48
L_redoj_49:
    ds_read_b64_tr_b16 a[156:157], v15 offset:16640
    v_mfma_f32_16x16x32_bf16 v[128:131], a[0:3], v[208:211], v[128:131]
    buffer_load_dwordx4 v[120:123], v10, s[48:51], s55 offen offset:0 sc1
    v_mfma_f32_16x16x32_bf16 v[132:135], a[4:7], v[208:211], v[132:135]
    ds_read_b64_tr_b16 a[158:159], v15 offset:18688
    v_mfma_f32_16x16x32_bf16 v[136:139], a[8:11], v[208:211], v[136:139]
    s_waitcnt vmcnt(14)
    v_min3_u32 v162, v216, v217, v218
    v_min3_u32 v163, v219, v220, v221
    v_mfma_f32_16x16x32_bf16 v[140:143], a[12:15], v[208:211], v[140:143]
    v_min3_u32 v162, v162, v222, v223
    v_min_u32 v162, v162, v163
    v_mfma_f32_16x16x32_bf16 v[128:131], a[16:19], v[212:215], v[128:131]
    buffer_load_dwordx4 v[124:127], v10, s[48:51], s55 offen offset:1024 sc1
    v_mfma_f32_16x16x32_bf16 v[132:135], a[20:23], v[212:215], v[132:135]
    v_cmp_eq_u32 vcc, 0, v162
    v_mfma_f32_16x16x32_bf16 v[136:139], a[24:27], v[212:215], v[136:139]
    v_mfma_f32_16x16x32_bf16 v[140:143], a[28:31], v[212:215], v[140:143]
    s_cbranch_vccnz L_redo_50
L_redoj_51:
    v_mfma_f32_16x16x32_bf16 v[128:131], a[32:35], v[216:219], v[128:131]
    buffer_load_dwordx4 v[192:195], v10, s[48:51], s55 offen offset:2048 sc1
    v_mfma_f32_16x16x32_bf16 v[132:135], a[36:39], v[216:219], v[132:135]
    v_mfma_f32_16x16x32_bf16 v[136:139], a[40:43], v[216:219], v[136:139]
    s_waitcnt vmcnt(9)
    v_min3_u32 v160, v96, v97, v98
    v_min3_u32 v161, v99, v100, v101
    v_mfma_f32_16x16x32_bf16 v[140:143], a[44:47], v[216:219], v[140:143]
    v_min3_u32 v160, v160, v102, v103
    v_min_u32 v160, v160, v161
    v_mfma_f32_16x16x32_bf16 v[128:131], a[48:51], v[220:223], v[128:131]
    buffer_load_dwordx4 v[196:199], v10, s[48:51], s55 offen offset:3072 sc1
    v_mfma_f32_16x16x32_bf16 v[132:135], a[52:55], v[220:223], v[132:135]
    v_cmp_eq_u32 vcc, 0, v160
    v_mfma_f32_16x16x32_bf16 v[136:139], a[56:59], v[220:223], v[136:139]
    s_add_u32 s55, s81, 61440
    v_mfma_f32_16x16x32_bf16 v[140:143], a[60:63], v[220:223], v[140:143]
    s_cbranch_vccnz L_redo_52
L_redoj_53:
    v_mfma_f32_16x16x32_bf16 v[128:131], v[224:227], v[96:99], v[128:131]
    buffer_load_dwordx4 v[200:203], v10, s[48:51], s55 offen offset:0 sc1
    v_mfma_f32_16x16x32_bf16 v[132:135], v[228:231], v[96:99], v[132:135]
    v_mfma_f32_16x16x32_bf16 v[136:139], v[232:235], v[96:99], v[136:139]
    s_waitcnt vmcnt(9)
    v_min3_u32 v162, v104, v105, v106
    v_min3_u32 v163, v107, v108, v109
    v_mfma_f32_16x16x32_bf16 v[140:143], v[236:239], v[96:99], v[140:143]
    v_min3_u32 v162, v162, v110, v111
    v_min_u32 v162, v162, v163
    v_mfma_f32_16x16x32_bf16 v[128:131], v[240:243], v[100:103], v[128:131]
    buffer_load_dwordx4 v[204:207], v10, s[48:51], s55 offen offset:1024 sc1
    v_mfma_f32_16x16x32_bf16 v[132:135], v[244:247], v[100:103], v[132:135]
    v_cmp_eq_u32 vcc, 0, v162
    v_mfma_f32_16x16x32_bf16 v[136:139], v[248:251], v[100:103], v[136:139]
    v_mfma_f32_16x16x32_bf16 v[140:143], v[252:255], v[100:103], v[140:143]
    s_cbranch_vccnz L_redo_54
L_redoj_55:
    v_mfma_f32_16x16x32_bf16 v[128:131], a[96:99], v[104:107], v[128:131]
    buffer_load_dwordx4 v[208:211], v10, s[48:51], s55 offen offset:2048 sc1
    v_mfma_f32_16x16x32_bf16 v[132:135], a[100:103], v[104:107], v[132:135]
    v_mfma_f32_16x16x32_bf16 v[136:139], a[104:107], v[104:107], v[136:139]
    s_waitcnt vmcnt(9)
    v_min3_u32 v160, v112, v113, v114
    v_min3_u32 v161, v115, v116, v117
    v_mfma_f32_16x16x32_bf16 v[140:143], a[108:111], v[104:107], v[140:143]
    v_min3_u32 v160, v160, v118, v119
    v_min_u32 v160, v160, v161
    v_mfma_f32_16x16x32_bf16 v[128:131], a[112:115], v[108:111], v[128:131]
    buffer_load_dwordx4 v[212:215], v10, s[48:51], s55 offen offset:3072 sc1
    v_mfma_f32_16x16x32_bf16 v[132:135], a[116:119], v[108:111], v[132:135]
    s_waitcnt lgkmcnt(12)
    v_cmp_eq_u32 vcc, 0, v160
    v_mfma_f32_16x16x32_bf16 v[136:139], a[120:123], v[108:111], v[136:139]
    s_add_u32 s55, s81, 65536
    v_mfma_f32_16x16x32_bf16 v[140:143], a[124:127], v[108:111], v[140:143]
    s_cbranch_vccnz L_redo_56
L_redoj_57:
    v_mfma_f32_16x16x32_bf16 v[128:131], a[128:131], v[112:115], v[128:131]
    buffer_load_dwordx4 v[216:219], v10, s[48:51], s55 offen offset:0 sc1
    v_mfma_f32_16x16x32_bf16 v[132:135], a[132:135], v[112:115], v[132:135]
    s_waitcnt lgkmcnt(8)
    v_mfma_f32_16x16x32_bf16 v[136:139], a[136:139], v[112:115], v[136:139]
    s_waitcnt vmcnt(7)
    v_min3_u32 v162, v120, v121, v122
    v_min3_u32 v163, v123, v124, v125
    v_mfma_f32_16x16x32_bf16 v[140:143], a[140:143], v[112:115], v[140:143]
    s_waitcnt lgkmcnt(4)
    v_min3_u32 v162, v162, v126, v127
    v_min_u32 v162, v162, v163
    v_mfma_f32_16x16x32_bf16 v[128:131], a[144:147], v[116:119], v[128:131]
    buffer_load_dwordx4 v[220:223], v10, s[48:51], s55 offen offset:1024 sc1
    v_mfma_f32_16x16x32_bf16 v[132:135], a[148:151], v[116:119], v[132:135]
    s_waitcnt lgkmcnt(2)
    v_cmp_eq_u32 vcc, 0, v162
    v_mfma_f32_16x16x32_bf16 v[136:139], a[152:155], v[116:119], v[136:139]
    s_waitcnt lgkmcnt(0)
    v_mfma_f32_16x16x32_bf16 v[140:143], a[156:159], v[116:119], v[140:143]
    s_cbranch_vccnz L_redo_58
L_redoj_59:
    v_mfma_f32_16x16x32_bf16 v[144:147], v[32:35], v[120:123], 0
    buffer_load_dwordx4 v[96:99], v10, s[48:51], s55 offen offset:2048 sc1
    v_mfma_f32_16x16x32_bf16 v[148:151], v[36:39], v[120:123], 0
    v_mfma_f32_16x16x32_bf16 v[152:155], v[40:43], v[120:123], 0
    s_waitcnt vmcnt(7)
    v_min3_u32 v160, v192, v193, v194
    v_min3_u32 v161, v195, v196, v197
    v_mfma_f32_16x16x32_bf16 v[156:159], v[44:47], v[120:123], 0
    v_min3_u32 v160, v160, v198, v199
    v_min_u32 v160, v160, v161
    v_mfma_f32_16x16x32_bf16 v[144:147], v[48:51], v[124:127], v[144:147]
    buffer_load_dwordx4 v[100:103], v10, s[48:51], s55 offen offset:3072 sc1
    v_mfma_f32_16x16x32_bf16 v[148:151], v[52:55], v[124:127], v[148:151]
L_hop2_2:
    s_cbranch_execz L_back2_0
    ds_write_b128 v6, v[128:131] offset:0
    v_cmp_eq_u32 vcc, 0, v160
    v_mfma_f32_16x16x32_bf16 v[152:155], v[56:59], v[124:127], v[152:155]
    s_add_u32 s55, s81, 69632
    v_mfma_f32_16x16x32_bf16 v[156:159], v[60:63], v[124:127], v[156:159]
    s_cbranch_vccnz L_redo_60
L_redoj_61:
    v_mfma_f32_16x16x32_bf16 v[144:147], v[64:67], v[192:195], v[144:147]
    buffer_load_dwordx4 v[104:107], v10, s[48:51], s55 offen offset:0 sc1
    v_mfma_f32_16x16x32_bf16 v[148:151], v[68:71], v[192:195], v[148:151]
    ds_write_b128 v7, v[132:135] offset:1024
    v_mfma_f32_16x16x32_bf16 v[152:155], v[72:75], v[192:195], v[152:155]
    s_waitcnt vmcnt(7)
    v_min3_u32 v162, v200, v201, v202
    v_min3_u32 v163, v203, v204, v205
    v_mfma_f32_16x16x32_bf16 v[156:159], v[76:79], v[192:195], v[156:159]
    v_min3_u32 v162, v162, v206, v207
    v_min_u32 v162, v162, v163
    v_mfma_f32_16x16x32_bf16 v[144:147], v[80:83], v[196:199], v[144:147]
    buffer_load_dwordx4 v[108:111], v10, s[48:51], s55 offen offset:1024 sc1
    v_mfma_f32_16x16x32_bf16 v[148:151], v[84:87], v[196:199], v[148:151]
    ds_write_b128 v8, v[136:139] offset:2048
    v_cmp_eq_u32 vcc, 0, v162
    v_mfma_f32_16x16x32_bf16 v[152:155], v[88:91], v[196:199], v[152:155]
    s_add_u32 s55, s81, 114688
    v_mfma_f32_16x16x32_bf16 v[156:159], v[92:95], v[196:199], v[156:159]
    s_cbranch_vccnz L_redo_62
L_redoj_63:
    v_mfma_f32_16x16x32_bf16 v[144:147], a[0:3], v[200:203], v[144:147]
    buffer_load_dwordx4 v[112:115], v10, s[48:51], s55 offen offset:0 sc1
    v_mfma_f32_16x16x32_bf16 v[148:151], a[4:7], v[200:203], v[148:151]
    ds_write_b128 v9, v[140:143] offset:3072
    v_mfma_f32_16x16x32_bf16 v[152:155], a[8:11], v[200:203], v[152:155]
    s_waitcnt vmcnt(7)
    v_min3_u32 v160, v208, v209, v210
    v_min3_u32 v161, v211, v212, v213
    v_mfma_f32_16x16x32_bf16 v[156:159], a[12:15], v[200:203], v[156:159]
    v_min3_u32 v160, v160, v214, v215
    v_min_u32 v160, v160, v161
    v_mfma_f32_16x16x32_bf16 v[144:147], a[16:19], v[204:207], v[144:147]
    buffer_load_dwordx4 v[116:119], v10, s[48:51], s55 offen offset:1024 sc1
    v_mfma_f32_16x16x32_bf16 v[148:151], a[20:23], v[204:207], v[148:151]
    v_cmp_eq_u32 vcc, 0, v160
    v_mfma_f32_16x16x32_bf16 v[152:155], a[24:27], v[204:207], v[152:155]
    v_mfma_f32_16x16x32_bf16 v[156:159], a[28:31], v[204:207], v[156:159]
    s_cbranch_vccnz L_redo_64
L_redoj_65:
    v_mfma_f32_16x16x32_bf16 v[144:147], a[32:35], v[208:211], v[144:147]
    buffer_load_dwordx4 v[120:123], v10, s[48:51], s55 offen offset:2048 sc1
    v_mfma_f32_16x16x32_bf16 v[148:151], a[36:39], v[208:211], v[148:151]
    v_mfma_f32_16x16x32_bf16 v[152:155], a[40:43], v[208:211], v[152:155]
    s_waitcnt vmcnt(7)
    v_min3_u32 v162, v216, v217, v218
    v_min3_u32 v163, v219, v220, v221
    v_mfma_f32_16x16x32_bf16 v[156:159], a[44:47], v[208:211], v[156:159]
    s_waitcnt lgkmcnt(0)
    s_barrier
    v_min3_u32 v162, v162, v222, v223
    v_min_u32 v162, v162, v163
    v_mfma_f32_16x16x32_bf16 v[144:147], a[48:51], v[212:215], v[144:147]
    buffer_load_dwordx4 v[124:127], v10, s[48:51], s55 offen offset:3072 sc1
    v_mfma_f32_16x16x32_bf16 v[148:151], a[52:55], v[212:215], v[148:151]
    ds_read_b128 v[164:167], v11 offset:0
    v_cmp_eq_u32 vcc, 0, v162
    v_mfma_f32_16x16x32_bf16 v[152:155], a[56:59], v[212:215], v[152:155]
    s_add_u32 s55, s81, 118784
    ds_read_b128 v[168:171], v11 offset:4096
    v_mfma_f32_16x16x32_bf16 v[156:159], a[60:63], v[212:215], v[156:159]
    s_cbranch_vccnz L_redo_66
L_redoj_67:
    ds_read_b128 v[172:175], v11 offset:8192
    v_mfma_f32_16x16x32_bf16 v[144:147], v[224:227], v[216:219], v[144:147]
    buffer_load_dwordx4 v[192:195], v10, s[48:51], s55 offen offset:0 sc1
    v_mfma_f32_16x16x32_bf16 v[148:151], v[228:231], v[216:219], v[148:151]
    ds_read_b128 v[176:179], v11 offset:12288
    v_mfma_f32_16x16x32_bf16 v[152:155], v[232:235], v[216:219], v[152:155]
    s_waitcnt vmcnt(7)
    v_min3_u32 v160, v96, v97, v98
    v_min3_u32 v161, v99, v100, v101
    v_mfma_f32_16x16x32_bf16 v[156:159], v[236:239], v[216:219], v[156:159]
    v_min3_u32 v160, v160, v102, v103
    v_min_u32 v160, v160, v161
    v_mfma_f32_16x16x32_bf16 v[144:147], v[240:243], v[220:223], v[144:147]
    buffer_load_dwordx4 v[196:199], v10, s[48:51], s55 offen offset:1024 sc1
    v_mfma_f32_16x16x32_bf16 v[148:151], v[244:247], v[220:223], v[148:151]
    ds_read_b64 v[180:181], v20 offset:0
    v_cmp_eq_u32 vcc, 0, v160
    v_mfma_f32_16x16x32_bf16 v[152:155], v[248:251], v[220:223], v[152:155]
    v_mfma_f32_16x16x32_bf16 v[156:159], v[252:255], v[220:223], v[156:159]
    s_cbranch_vccnz L_redo_68
L_redoj_69:
    v_mfma_f32_16x16x32_bf16 v[144:147], a[96:99], v[96:99], v[144:147]
    buffer_load_dwordx4 v[200:203], v10, s[48:51], s55 offen offset:2048 sc1
    v_mfma_f32_16x16x32_bf16 v[148:151], a[100:103], v[96:99], v[148:151]
    v_mfma_f32_16x16x32_bf16 v[152:155], a[104:107], v[96:99], v[152:155]
    s_waitcnt vmcnt(7)
    v_min3_u32 v162, v104, v105, v106
    v_min3_u32 v163, v107, v108, v109
    v_mfma_f32_16x16x32_bf16 v[156:159], a[108:111], v[96:99], v[156:159]
    s_waitcnt lgkmcnt(0)
    v_min3_u32 v162, v162, v110, v111
    v_min_u32 v162, v162, v163
    v_mfma_f32_16x16x32_bf16 v[144:147], a[112:115], v[100:103], v[144:147]
    buffer_load_dwordx4 v[204:207], v10, s[48:51], s55 offen offset:3072 sc1
    v_mfma_f32_16x16x32_bf16 v[148:151], a[116:119], v[100:103], v[148:151]
    v_cmp_eq_u32 vcc, 0, v162
    v_add_f32 v164, v164, v168
    v_mfma_f32_16x16x32_bf16 v[152:155], a[120:123], v[100:103], v[152:155]
    s_add_u32 s55, s81, 122880
    v_add_f32 v172, v172, v176
    v_add_f32 v165, v165, v169
    v_mfma_f32_16x16x32_bf16 v[156:159], a[124:127], v[100:103], v[156:159]
    s_cbranch_vccnz L_redo_70
L_redoj_71:
    v_add_f32 v173, v173, v177
    v_add_f32 v166, v166, v170
    v_mfma_f32_16x16x32_bf16 v[144:147], a[128:131], v[104:107], v[144:147]
    buffer_load_dwordx4 v[208:211], v10, s[48:51], s55 offen offset:0 sc1
    v_mfma_f32_16x16x32_bf16 v[148:151], a[132:135], v[104:107], v[148:151]
    v_add_f32 v174, v174, v178
    v_add_f32 v167, v167, v171
    v_mfma_f32_16x16x32_bf16 v[152:155], a[136:139], v[104:107], v[152:155]
    s_waitcnt vmcnt(7)
    v_min3_u32 v160, v112, v113, v114
    v_min3_u32 v161, v115, v116, v117
    v_mfma_f32_16x16x32_bf16 v[156:159], a[140:143], v[104:107], v[156:159]
    v_min3_u32 v160, v160, v118, v119
    v_min_u32 v160, v160, v161
    v_mfma_f32_16x16x32_bf16 v[144:147], a[144:147], v[108:111], v[144:147]
    buffer_load_dwordx4 v[212:215], v10, s[48:51], s55 offen offset:1024 sc1
    v_mfma_f32_16x16x32_bf16 v[148:151], a[148:151], v[108:111], v[148:151]
    v_cmp_eq_u32 vcc, 0, v160
    v_add_f32 v175, v175, v179
    v_mfma_f32_16x16x32_bf16 v[152:155], a[152:155], v[108:111], v[152:155]
    v_lshlrev_b32 v182, 16, v180
    v_and_b32 v183, s59, v180
    v_mfma_f32_16x16x32_bf16 v[156:159], a[156:159], v[108:111], v[156:159]
    s_cbranch_vccnz L_redo_72
L_redoj_73:
    v_lshlrev_b32 v184, 16, v181
    v_and_b32 v185, s59, v181
    v_mfma_f32_16x16x32_bf16 v[128:131], v[32:35], v[112:115], 0
    buffer_load_dwordx4 v[216:219], v10, s[48:51], s55 offen offset:2048 sc1
    v_mfma_f32_16x16x32_bf16 v[132:135], v[36:39], v[112:115], 0
    v_add_f32 v164, v164, v172
    v_add_f32 v165, v165, v173
    v_mfma_f32_16x16x32_bf16 v[136:139], v[40:43], v[112:115], 0
    s_waitcnt vmcnt(7)
    v_min3_u32 v162, v120, v121, v122
    v_min3_u32 v163, v123, v124, v125
    v_mfma_f32_16x16x32_bf16 v[140:143], v[44:47], v[112:115], 0
    v_min3_u32 v162, v162, v126, v127
    v_min_u32 v162, v162, v163
    v_mfma_f32_16x16x32_bf16 v[128:131], v[48:51], v[116:119], v[128:131]
    buffer_load_dwordx4 v[220:223], v10, s[48:51], s55 offen offset:3072 sc1
    v_mfma_f32_16x16x32_bf16 v[132:135], v[52:55], v[116:119], v[132:135]
    ds_write_b128 v6, v[144:147] offset:16384
    v_cmp_eq_u32 vcc, 0, v162
    v_add_f32 v166, v166, v174
    v_mfma_f32_16x16x32_bf16 v[136:139], v[56:59], v[116:119], v[136:139]
    s_add_u32 s55, s81, 126976
    v_add_f32 v167, v167, v175
    v_fmac_f32 v182, v164, v2
    v_mfma_f32_16x16x32_bf16 v[140:143], v[60:63], v[116:119], v[140:143]
    s_cbranch_vccnz L_redo_74
L_redoj_75:
    v_fmac_f32 v183, v165, v3
    v_fmac_f32 v184, v166, v4
    v_mfma_f32_16x16x32_bf16 v[128:131], v[64:67], v[120:123], v[128:131]
    buffer_load_dwordx4 v[96:99], v10, s[48:51], s55 offen offset:0 sc1
    v_mfma_f32_16x16x32_bf16 v[132:135], v[68:71], v[120:123], v[132:135]
    ds_write_b128 v7, v[148:151] offset:17408
    v_fmac_f32 v185, v167, v5
    v_cvt_pk_bf16_f32 v186, v182, v183
    v_mfma_f32_16x16x32_bf16 v[136:139], v[72:75], v[120:123], v[136:139]
    s_waitcnt vmcnt(7)
    v_min3_u32 v160, v192, v193, v194
    v_min3_u32 v161, v195, v196, v197
    v_mfma_f32_16x16x32_bf16 v[140:143], v[76:79], v[120:123], v[140:143]
    v_min3_u32 v160, v160, v198, v199
    v_min_u32 v160, v160, v161
    v_mfma_f32_16x16x32_bf16 v[128:131], v[80:83], v[124:127], v[128:131]
    buffer_load_dwordx4 v[100:103], v10, s[48:51], s55 offen offset:1024 sc1
    v_mfma_f32_16x16x32_bf16 v[132:135], v[84:87], v[124:127], v[132:135]
    ds_write_b128 v8, v[152:155] offset:18432
    v_cmp_eq_u32 vcc, 0, v160
    v_cvt_pk_bf16_f32 v187, v184, v185
    v_mfma_f32_16x16x32_bf16 v[136:139], v[88:91], v[124:127], v[136:139]
    s_add_u32 s55, s81, 172032
    v_mfma_f32_16x16x32_bf16 v[140:143], v[92:95], v[124:127], v[140:143]
    s_cbranch_vccnz L_redo_76
L_redoj_77:
    v_mfma_f32_16x16x32_bf16 v[128:131], a[0:3], v[192:195], v[128:131]
    buffer_load_dwordx4 v[104:107], v10, s[48:51], s55 offen offset:0 sc1
    v_mfma_f32_16x16x32_bf16 v[132:135], a[4:7], v[192:195], v[132:135]
    ds_write_b128 v9, v[156:159] offset:19456
    v_mfma_f32_16x16x32_bf16 v[136:139], a[8:11], v[192:195], v[136:139]
    s_waitcnt vmcnt(7)
    v_min3_u32 v162, v200, v201, v202
    v_min3_u32 v163, v203, v204, v205
    v_mfma_f32_16x16x32_bf16 v[140:143], a[12:15], v[192:195], v[140:143]
    s_add_u32 s56, s61, 0
    v_min3_u32 v162, v162, v206, v207
    v_min_u32 v162, v162, v163
    v_mfma_f32_16x16x32_bf16 v[128:131], a[16:19], v[196:199], v[128:131]
    buffer_load_dwordx4 v[108:111], v10, s[48:51], s55 offen offset:1024 sc1
    v_mfma_f32_16x16x32_bf16 v[132:135], a[20:23], v[196:199], v[132:135]
    v_cmp_eq_u32 vcc, 0, v162
    v_mfma_f32_16x16x32_bf16 v[136:139], a[24:27], v[196:199], v[136:139]
    buffer_store_dwordx2 v[186:187], v21, s[40:43], s56 offen
    v_mfma_f32_16x16x32_bf16 v[140:143], a[28:31], v[196:199], v[140:143]
    s_cbranch_vccnz L_redo_78
L_redoj_79:
    v_mfma_f32_16x16x32_bf16 v[128:131], a[32:35], v[200:203], v[128:131]
    buffer_load_dwordx4 v[112:115], v10, s[48:51], s55 offen offset:2048 sc1
    v_mfma_f32_16x16x32_bf16 v[132:135], a[36:39], v[200:203], v[132:135]
    v_mfma_f32_16x16x32_bf16 v[136:139], a[40:43], v[200:203], v[136:139]
    s_waitcnt vmcnt(8)
    v_min3_u32 v160, v208, v209, v210
    v_min3_u32 v161, v211, v212, v213
    v_mfma_f32_16x16x32_bf16 v[140:143], a[44:47], v[200:203], v[140:143]
    s_waitcnt lgkmcnt(0)
    s_barrier
    v_min3_u32 v160, v160, v214, v215
    v_min_u32 v160, v160, v161
    v_mfma_f32_16x16x32_bf16 v[128:131], a[48:51], v[204:207], v[128:131]
    buffer_load_dwordx4 v[116:119], v10, s[48:51], s55 offen offset:3072 sc1
    v_mfma_f32_16x16x32_bf16 v[132:135], a[52:55], v[204:207], v[132:135]
    ds_read_b128 v[164:167], v11 offset:16384
    v_cmp_eq_u32 vcc, 0, v160
    v_mfma_f32_16x16x32_bf16 v[136:139], a[56:59], v[204:207], v[136:139]
    s_add_u32 s55, s81, 176128
    ds_read_b128 v[168:171], v11 offset:20480
    v_mfma_f32_16x16x32_bf16 v[140:143], a[60:63], v[204:207], v[140:143]
    s_cbranch_vccnz L_redo_80
L_redoj_81:
    ds_read_b128 v[172:175], v11 offset:24576
    v_mfma_f32_16x16x32_bf16 v[128:131], v[224:227], v[208:211], v[128:131]
    buffer_load_dwordx4 v[120:123], v10, s[48:51], s55 offen offset:0 sc1
    v_mfma_f32_16x16x32_bf16 v[132:135], v[228:231], v[208:211], v[132:135]
    ds_read_b128 v[176:179], v11 offset:28672
    v_mfma_f32_16x16x32_bf16 v[136:139], v[232:235], v[208:211], v[136:139]
    s_waitcnt vmcnt(8)
    v_min3_u32 v162, v216, v217, v218
    v_min3_u32 v163, v219, v220, v221
    v_mfma_f32_16x16x32_bf16 v[140:143], v[236:239], v[208:211], v[140:143]
    v_min3_u32 v162, v162, v222, v223
    v_min_u32 v162, v162, v163
    v_mfma_f32_16x16x32_bf16 v[128:131], v[240:243], v[212:215], v[128:131]
    buffer_load_dwordx4 v[124:127], v10, s[48:51], s55 offen offset:1024 sc1
    v_mfma_f32_16x16x32_bf16 v[132:135], v[244:247], v[212:215], v[132:135]
    ds_read_b64 v[180:181], v20 offset:4096
    v_cmp_eq_u32 vcc, 0, v162
    v_mfma_f32_16x16x32_bf16 v[136:139], v[248:251], v[212:215], v[136:139]
    v_mfma_f32_16x16x32_bf16 v[140:143], v[252:255], v[212:215], v[140:143]
    s_cbranch_vccnz L_redo_82
L_redoj_83:
    v_mfma_f32_16x16x32_bf16 v[128:131], a[96:99], v[216:219], v[128:131]
    buffer_load_dwordx4 v[192:195], v10, s[48:51], s55 offen offset:2048 sc1
    v_mfma_f32_16x16x32_bf16 v[132:135], a[100:103], v[216:219], v[132:135]
    v_mfma_f32_16x16x32_bf16 v[136:139], a[104:107], v[216:219], v[136:139]
    s_waitcnt vmcnt(8)
    v_min3_u32 v160, v96, v97, v98
    v_min3_u32 v161, v99, v100, v101
    v_mfma_f32_16x16x32_bf16 v[140:143], a[108:111], v[216:219], v[140:143]
    s_waitcnt lgkmcnt(0)
    v_min3_u32 v160, v160, v102, v103
    v_min_u32 v160, v160, v161
    v_mfma_f32_16x16x32_bf16 v[128:131], a[112:115], v[220:223], v[128:131]
    buffer_load_dwordx4 v[196:199], v10, s[48:51], s55 offen offset:3072 sc1
    v_mfma_f32_16x16x32_bf16 v[132:135], a[116:119], v[220:223], v[132:135]
    v_cmp_eq_u32 vcc, 0, v160
    v_add_f32 v164, v164, v168
    v_mfma_f32_16x16x32_bf16 v[136:139], a[120:123], v[220:223], v[136:139]
    s_add_u32 s55, s81, 180224
    v_add_f32 v172, v172, v176
    v_add_f32 v165, v165, v169
    v_mfma_f32_16x16x32_bf16 v[140:143], a[124:127], v[220:223], v[140:143]
    s_cbranch_vccnz L_redo_84
L_redoj_85:
    v_add_f32 v173, v173, v177
    v_add_f32 v166, v166, v170
    v_mfma_f32_16x16x32_bf16 v[128:131], a[128:131], v[96:99], v[128:131]
    buffer_load_dwordx4 v[200:203], v10, s[48:51], s55 offen offset:0 sc1
    v_mfma_f32_16x16x32_bf16 v[132:135], a[132:135], v[96:99], v[132:135]
    v_add_f32 v174, v174, v178
    v_add_f32 v167, v167, v171
    v_mfma_f32_16x16x32_bf16 v[136:139], a[136:139], v[96:99], v[136:139]
    s_waitcnt vmcnt(8)
    v_min3_u32 v162, v104, v105, v106
    v_min3_u32 v163, v107, v108, v109
    v_mfma_f32_16x16x32_bf16 v[140:143], a[140:143], v[96:99], v[140:143]
    v_min3_u32 v162, v162, v110, v111
    v_min_u32 v162, v162, v163
    v_mfma_f32_16x16x32_bf16 v[128:131], a[144:147], v[100:103], v[128:131]
    buffer_load_dwordx4 v[204:207], v10, s[48:51], s55 offen offset:1024 sc1
    v_mfma_f32_16x16x32_bf16 v[132:135], a[148:151], v[100:103], v[132:135]
    v_cmp_eq_u32 vcc, 0, v162
    v_add_f32 v175, v175, v179
    v_mfma_f32_16x16x32_bf16 v[136:139], a[152:155], v[100:103], v[136:139]
    v_lshlrev_b32 v182, 16, v180
    v_and_b32 v183, s59, v180
    v_mfma_f32_16x16x32_bf16 v[140:143], a[156:159], v[100:103], v[140:143]
    s_cbranch_vccnz L_redo_86
L_redoj_87:
    v_lshlrev_b32 v184, 16, v181
    v_and_b32 v185, s59, v181
    v_mfma_f32_16x16x32_bf16 v[144:147], v[32:35], v[104:107], 0
    buffer_load_dwordx4 v[208:211], v10, s[48:51], s55 offen offset:2048 sc1
    v_mfma_f32_16x16x32_bf16 v[148:151], v[36:39], v[104:107], 0
    v_add_f32 v164, v164, v172
    v_add_f32 v165, v165, v173
    v_mfma_f32_16x16x32_bf16 v[152:155], v[40:43], v[104:107], 0
    s_waitcnt vmcnt(7)
    v_min3_u32 v160, v112, v113, v114
    v_min3_u32 v161, v115, v116, v117
    v_mfma_f32_16x16x32_bf16 v[156:159], v[44:47], v[104:107], 0
    v_min3_u32 v160, v160, v118, v119
    v_min_u32 v160, v160, v161
    v_mfma_f32_16x16x32_bf16 v[144:147], v[48:51], v[108:111], v[144:147]
    buffer_load_dwordx4 v[212:215], v10, s[48:51], s55 offen offset:3072 sc1
    v_mfma_f32_16x16x32_bf16 v[148:151], v[52:55], v[108:111], v[148:151]
    ds_write_b128 v6, v[128:131] offset:32768
    v_cmp_eq_u32 vcc, 0, v160
    v_add_f32 v166, v166, v174
    v_mfma_f32_16x16x32_bf16 v[152:155], v[56:59], v[108:111], v[152:155]
    s_add_u32 s55, s81, 184320
    v_add_f32 v167, v167, v175
    v_fmac_f32 v182, v164, v2
    v_mfma_f32_16x16x32_bf16 v[156:159], v[60:63], v[108:111], v[156:159]
    s_cbranch_vccnz L_redo_88
L_redoj_89:
    v_fmac_f32 v183, v165, v3
    v_fmac_f32 v184, v166, v4
    v_mfma_f32_16x16x32_bf16 v[144:147], v[64:67], v[112:115], v[144:147]
    buffer_load_dwordx4 v[216:219], v10, s[48:51], s55 offen offset:0 sc1
    v_mfma_f32_16x16x32_bf16 v[148:151], v[68:71], v[112:115], v[148:151]
    ds_write_b128 v7, v[132:135] offset:33792
    v_fmac_f32 v185, v167, v5
    v_cvt_pk_bf16_f32 v186, v182, v183
    v_mfma_f32_16x16x32_bf16 v[152:155], v[72:75], v[112:115], v[152:155]
    s_waitcnt vmcnt(7)
    v_min3_u32 v162, v120, v121, v122
    v_min3_u32 v163, v123, v124, v125
    v_mfma_f32_16x16x32_bf16 v[156:159], v[76:79], v[112:115], v[156:159]
    v_min3_u32 v162, v162, v126, v127
    v_min_u32 v162, v162, v163
    v_mfma_f32_16x16x32_bf16 v[144:147], v[80:83], v[116:119], v[144:147]
    buffer_load_dwordx4 v[220:223], v10, s[48:51], s55 offen offset:1024 sc1
    v_mfma_f32_16x16x32_bf16 v[148:151], v[84:87], v[116:119], v[148:151]
    ds_write_b128 v8, v[136:139] offset:34816
    v_cmp_eq_u32 vcc, 0, v162
    v_cvt_pk_bf16_f32 v187, v184, v185
    v_mfma_f32_16x16x32_bf16 v[152:155], v[88:91], v[116:119], v[152:155]
    s_add_u32 s56, s61, 16384
    v_mfma_f32_16x16x32_bf16 v[156:159], v[92:95], v[116:119], v[156:159]
    s_cbranch_vccnz L_redo_90
L_redoj_91:
    v_mfma_f32_16x16x32_bf16 v[144:147], a[0:3], v[120:123], v[144:147]
    buffer_store_dwordx2 v[186:187], v21, s[40:43], s56 offen
    v_mfma_f32_16x16x32_bf16 v[148:151], a[4:7], v[120:123], v[148:151]
    ds_write_b128 v9, v[140:143] offset:35840
    v_mfma_f32_16x16x32_bf16 v[152:155], a[8:11], v[120:123], v[152:155]
    s_waitcnt vmcnt(7)
    v_min3_u32 v160, v192, v193, v194
    v_min3_u32 v161, v195, v196, v197
    v_mfma_f32_16x16x32_bf16 v[156:159], a[12:15], v[120:123], v[156:159]
    v_min3_u32 v160, v160, v198, v199
    v_min_u32 v160, v160, v161
    v_mfma_f32_16x16x32_bf16 v[144:147], a[16:19], v[124:127], v[144:147]
    v_mfma_f32_16x16x32_bf16 v[148:151], a[20:23], v[124:127], v[148:151]
    v_cmp_eq_u32 vcc, 0, v160
    v_mfma_f32_16x16x32_bf16 v[152:155], a[24:27], v[124:127], v[152:155]
    v_mfma_f32_16x16x32_bf16 v[156:159], a[28:31], v[124:127], v[156:159]
    s_cbranch_vccnz L_redo_92
L_redoj_93:
    v_mfma_f32_16x16x32_bf16 v[144:147], a[32:35], v[192:195], v[144:147]
    v_mfma_f32_16x16x32_bf16 v[148:151], a[36:39], v[192:195], v[148:151]
    v_mfma_f32_16x16x32_bf16 v[152:155], a[40:43], v[192:195], v[152:155]
    s_waitcnt vmcnt(5)
    v_min3_u32 v162, v200, v201, v202
    v_min3_u32 v163, v203, v204, v205
    v_mfma_f32_16x16x32_bf16 v[156:159], a[44:47], v[192:195], v[156:159]
    s_waitcnt lgkmcnt(0)
    s_barrier
    v_min3_u32 v162, v162, v206, v207
    v_min_u32 v162, v162, v163
    v_mfma_f32_16x16x32_bf16 v[144:147], a[48:51], v[196:199], v[144:147]
    ds_read_b128 v[164:167], v11 offset:32768
    v_mfma_f32_16x16x32_bf16 v[148:151], a[52:55], v[196:199], v[148:151]
    ds_read_b128 v[168:171], v11 offset:36864
    v_cmp_eq_u32 vcc, 0, v162
    v_mfma_f32_16x16x32_bf16 v[152:155], a[56:59], v[196:199], v[152:155]
    ds_read_b128 v[172:175], v11 offset:40960
    v_mfma_f32_16x16x32_bf16 v[156:159], a[60:63], v[196:199], v[156:159]
    s_cbranch_vccnz L_redo_94
L_redoj_95:
    ds_read_b128 v[176:179], v11 offset:45056
    v_mfma_f32_16x16x32_bf16 v[144:147], v[224:227], v[200:203], v[144:147]
    ds_read_b64 v[180:181], v20 offset:8192
    v_mfma_f32_16x16x32_bf16 v[148:151], v[228:231], v[200:203], v[148:151]
    v_mfma_f32_16x16x32_bf16 v[152:155], v[232:235], v[200:203], v[152:155]
    s_waitcnt vmcnt(3)
    v_min3_u32 v160, v208, v209, v210
    v_min3_u32 v161, v211, v212, v213
    v_mfma_f32_16x16x32_bf16 v[156:159], v[236:239], v[200:203], v[156:159]
    v_min3_u32 v160, v160, v214, v215
    v_min_u32 v160, v160, v161
    v_mfma_f32_16x16x32_bf16 v[144:147], v[240:243], v[204:207], v[144:147]
    v_mfma_f32_16x16x32_bf16 v[148:151], v[244:247], v[204:207], v[148:151]
    v_cmp_eq_u32 vcc, 0, v160
    v_mfma_f32_16x16x32_bf16 v[152:155], v[248:251], v[204:207], v[152:155]
    s_waitcnt lgkmcnt(0)
    v_mfma_f32_16x16x32_bf16 v[156:159], v[252:255], v[204:207], v[156:159]
    s_cbranch_vccnz L_redo_96
L_redoj_97:
    v_mfma_f32_16x16x32_bf16 v[144:147], a[96:99], v[208:211], v[144:147]
    v_add_f32 v164, v164, v168
    v_add_f32 v172, v172, v176
    v_mfma_f32_16x16x32_bf16 v[148:151], a[100:103], v[208:211], v[148:151]
    v_add_f32 v165, v165, v169
    v_add_f32 v173, v173, v177
    v_mfma_f32_16x16x32_bf16 v[152:155], a[104:107], v[208:211], v[152:155]
    s_waitcnt vmcnt(1)
    v_min3_u32 v162, v216, v217, v218
    v_min3_u32 v163, v219, v220, v221
    v_mfma_f32_16x16x32_bf16 v[156:159], a[108:111], v[208:211], v[156:159]
    v_min3_u32 v162, v162, v222, v223
    v_min_u32 v162, v162, v163
    v_mfma_f32_16x16x32_bf16 v[144:147], a[112:115], v[212:215], v[144:147]
    v_add_f32 v166, v166, v170
    v_add_f32 v174, v174, v178
    v_mfma_f32_16x16x32_bf16 v[148:151], a[116:119], v[212:215], v[148:151]
    v_cmp_eq_u32 vcc, 0, v162
    v_add_f32 v167, v167, v171
    v_mfma_f32_16x16x32_bf16 v[152:155], a[120:123], v[212:215], v[152:155]
    v_add_f32 v175, v175, v179
    v_lshlrev_b32 v182, 16, v180
    v_mfma_f32_16x16x32_bf16 v[156:159], a[124:127], v[212:215], v[156:159]
    s_cbranch_vccnz L_redo_98
L_redoj_99:
    v_and_b32 v183, s59, v180
    v_lshlrev_b32 v184, 16, v181
    v_mfma_f32_16x16x32_bf16 v[144:147], a[128:131], v[216:219], v[144:147]
    v_and_b32 v185, s59, v181
    v_add_f32 v164, v164, v172
    v_mfma_f32_16x16x32_bf16 v[148:151], a[132:135], v[216:219], v[148:151]
    v_add_f32 v165, v165, v173
    v_add_f32 v166, v166, v174
    v_mfma_f32_16x16x32_bf16 v[152:155], a[136:139], v[216:219], v[152:155]
    v_add_f32 v167, v167, v175
    v_fmac_f32 v182, v164, v2
    v_mfma_f32_16x16x32_bf16 v[156:159], a[140:143], v[216:219], v[156:159]
    v_fmac_f32 v183, v165, v3
    v_fmac_f32 v184, v166, v4
    v_mfma_f32_16x16x32_bf16 v[144:147], a[144:147], v[220:223], v[144:147]
    v_fmac_f32 v185, v167, v5
    v_cvt_pk_bf16_f32 v186, v182, v183
    v_mfma_f32_16x16x32_bf16 v[148:151], a[148:151], v[220:223], v[148:151]
    v_cvt_pk_bf16_f32 v187, v184, v185
    v_mfma_f32_16x16x32_bf16 v[152:155], a[152:155], v[220:223], v[152:155]
    s_add_u32 s56, s61, 32768
    v_mfma_f32_16x16x32_bf16 v[156:159], a[156:159], v[220:223], v[156:159]
    buffer_store_dwordx2 v[186:187], v21, s[40:43], s56 offen
    ds_write_b128 v6, v[144:147] offset:49152
    s_nop 1
    ds_write_b128 v7, v[148:151] offset:50176
    s_nop 0
    ds_write_b128 v8, v[152:155] offset:51200
    s_nop 0
    ds_write_b128 v9, v[156:159] offset:52224
    s_waitcnt lgkmcnt(0)
    s_barrier
    ds_read_b128 v[164:167], v11 offset:49152
    ds_read_b128 v[168:171], v11 offset:53248
    ds_read_b128 v[172:175], v11 offset:57344
    ds_read_b128 v[176:179], v11 offset:61440
    ds_read_b64 v[180:181], v20 offset:12288
    s_waitcnt lgkmcnt(3)
    v_add_f32 v164, v164, v168
    s_waitcnt lgkmcnt(1)
    v_add_f32 v172, v172, v176
    v_add_f32 v165, v165, v169
    v_add_f32 v173, v173, v177
    v_add_f32 v166, v166, v170
    v_add_f32 v174, v174, v178
    v_add_f32 v167, v167, v171
    v_add_f32 v175, v175, v179
    s_waitcnt lgkmcnt(0)
    v_lshlrev_b32 v182, 16, v180
    v_and_b32 v183, s59, v180
    v_lshlrev_b32 v184, 16, v181
    v_and_b32 v185, s59, v181
    v_add_f32 v164, v164, v172
    v_add_f32 v165, v165, v173
    v_add_f32 v166, v166, v174
    v_add_f32 v167, v167, v175
    v_fmac_f32 v182, v164, v2
    v_fmac_f32 v183, v165, v3
    v_fmac_f32 v184, v166, v4
    v_fmac_f32 v185, v167, v5
    v_cvt_pk_bf16_f32 v186, v182, v183
    v_cvt_pk_bf16_f32 v187, v184, v185
    s_add_u32 s56, s61, 49152
    buffer_store_dwordx2 v[186:187], v21, s[40:43], s56 offen
L_end:
    s_endpgm
L_spins:
L_fc_33:
    s_mov_b32 s98, 0x200000
L_sp_100:
    s_load_dword s88, s[36:37], 0 glc
    s_load_dword s89, s[36:37], 128 glc
    s_load_dword s90, s[36:37], 256 glc
    s_load_dword s91, s[36:37], 384 glc
    s_load_dword s92, s[36:37], 512 glc
    s_load_dword s93, s[36:37], 640 glc
    s_load_dword s94, s[36:37], 768 glc
    s_sub_u32 s98, s98, 1
    s_waitcnt lgkmcnt(0)
    s_cbranch_scc1 L_spout_101
    s_min_u32 s88, s88, s89
    s_min_u32 s90, s90, s91
    s_min_u32 s92, s92, s93
    s_min_u32 s88, s88, s90
    s_min_u32 s92, s92, s94
    s_min_u32 s88, s88, s92
    s_cmp_lt_u32 s88, 1
    s_cbranch_scc1 L_sp_100
L_spout_101:
    s_branch L_fcj_34
L_code_end:
L_slow:
    s_waitcnt vmcnt(0) lgkmcnt(0)
    s_nop 15
    s_nop 3
    s_sub_u32 s57, s63, s62
    v_and_b32 v124, 15, v0
    v_lshlrev_b32 v124, 8, v124
    v_lshrrev_b32 v125, 5, v0
    v_lshl_add_u32 v124, v125, 4, v124
    v_bfe_u32 v125, v0, 4, 1
    v_lshl_add_u32 v124, v125, 5, v124
    s_sub_u32 s55, s62, 32768
    v_add_u32 v125, s55, v16
    v_add_u32 v126, s55, v17
    v_mov_b32 v120, 0
    v_mov_b32 v24, 0xff800000
    v_mov_b32 v25, 0xff800000
    v_mov_b32 v26, 0xff800000
    v_mov_b32 v27, 0xff800000
    v_accvgpr_write_b32 a128, v120
    v_accvgpr_write_b32 a129, v120
    v_accvgpr_write_b32 a130, v120
    v_accvgpr_write_b32 a131, v120
    v_accvgpr_write_b32 a132, v120
    v_accvgpr_write_b32 a133, v120
    v_accvgpr_write_b32 a134, v120
    v_accvgpr_write_b32 a135, v120
    v_accvgpr_write_b32 a136, v120
    v_accvgpr_write_b32 a137, v120
    v_accvgpr_write_b32 a138, v120
    v_accvgpr_write_b32 a139, v120
    v_accvgpr_write_b32 a140, v120
    v_accvgpr_write_b32 a141, v120
    v_accvgpr_write_b32 a142, v120
    v_accvgpr_write_b32 a143, v120
    v_mov_b32 v128, 0
    v_mov_b32 v129, 0
    v_mov_b32 v130, 0
    v_mov_b32 v131, 0
    v_mov_b32 v132, 0
    v_mov_b32 v133, 0
    v_mov_b32 v134, 0
    v_mov_b32 v135, 0
    v_mov_b32 v136, 0
    v_mov_b32 v137, 0
    v_mov_b32 v138, 0
    v_mov_b32 v139, 0
    v_mov_b32 v140, 0
    v_mov_b32 v141, 0
    v_mov_b32 v142, 0
    v_mov_b32 v143, 0
    v_mov_b32 v144, 0
    v_mov_b32 v145, 0
    v_mov_b32 v146, 0
    v_mov_b32 v147, 0
    v_mov_b32 v148, 0
    v_mov_b32 v149, 0
    v_mov_b32 v150, 0
    v_mov_b32 v151, 0
    v_mov_b32 v152, 0
    v_mov_b32 v153, 0
    v_mov_b32 v154, 0
    v_mov_b32 v155, 0
    v_mov_b32 v156, 0
    v_mov_b32 v157, 0
    v_mov_b32 v158, 0
    v_mov_b32 v159, 0
    v_mov_b32 v160, 0
    v_mov_b32 v161, 0
    v_mov_b32 v162, 0
    v_mov_b32 v163, 0
    v_mov_b32 v164, 0
    v_mov_b32 v165, 0
    v_mov_b32 v166, 0
    v_mov_b32 v167, 0
    v_mov_b32 v168, 0
    v_mov_b32 v169, 0
    v_mov_b32 v170, 0
    v_mov_b32 v171, 0
    v_mov_b32 v172, 0
    v_mov_b32 v173, 0
    v_mov_b32 v174, 0
    v_mov_b32 v175, 0
    v_mov_b32 v176, 0
    v_mov_b32 v177, 0
    v_mov_b32 v178, 0
    v_mov_b32 v179, 0
    v_mov_b32 v180, 0
    v_mov_b32 v181, 0
    v_mov_b32 v182, 0
    v_mov_b32 v183, 0
    v_mov_b32 v184, 0
    v_mov_b32 v185, 0
    v_mov_b32 v186, 0
    v_mov_b32 v187, 0
    v_mov_b32 v188, 0
    v_mov_b32 v189, 0
    v_mov_b32 v190, 0
    v_mov_b32 v191, 0
    v_mov_b32 v192, 0
    v_mov_b32 v193, 0
    v_mov_b32 v194, 0
    v_mov_b32 v195, 0
    v_mov_b32 v196, 0
    v_mov_b32 v197, 0
    v_mov_b32 v198, 0
    v_mov_b32 v199, 0
    v_mov_b32 v200, 0
    v_mov_b32 v201, 0
    v_mov_b32 v202, 0
    v_mov_b32 v203, 0
    v_mov_b32 v204, 0
    v_mov_b32 v205, 0
    v_mov_b32 v206, 0
    v_mov_b32 v207, 0
    v_mov_b32 v208, 0
    v_mov_b32 v209, 0
    v_mov_b32 v210, 0
    v_mov_b32 v211, 0
    v_mov_b32 v212, 0
    v_mov_b32 v213, 0
    v_mov_b32 v214, 0
    v_mov_b32 v215, 0
    v_mov_b32 v216, 0
    v_mov_b32 v217, 0
    v_mov_b32 v218, 0
    v_mov_b32 v219, 0
    v_mov_b32 v220, 0
    v_mov_b32 v221, 0
    v_mov_b32 v222, 0
    v_mov_b32 v223, 0
    v_mov_b32 v224, 0
    v_mov_b32 v225, 0
    v_mov_b32 v226, 0
    v_mov_b32 v227, 0
    v_mov_b32 v228, 0
    v_mov_b32 v229, 0
    v_mov_b32 v230, 0
    v_mov_b32 v231, 0
    v_mov_b32 v232, 0
    v_mov_b32 v233, 0
    v_mov_b32 v234, 0
    v_mov_b32 v235, 0
    v_mov_b32 v236, 0
    v_mov_b32 v237, 0
    v_mov_b32 v238, 0
    v_mov_b32 v239, 0
    v_mov_b32 v240, 0
    v_mov_b32 v241, 0
    v_mov_b32 v242, 0
    v_mov_b32 v243, 0
    v_mov_b32 v244, 0
    v_mov_b32 v245, 0
    v_mov_b32 v246, 0
    v_mov_b32 v247, 0
    v_mov_b32 v248, 0
    v_mov_b32 v249, 0
    v_mov_b32 v250, 0
    v_mov_b32 v251, 0
    v_mov_b32 v252, 0
    v_mov_b32 v253, 0
    v_mov_b32 v254, 0
    v_mov_b32 v255, 0
    s_mov_b32 s98, 0
    s_waitcnt vmcnt(0) lgkmcnt(0)
    s_nop 15
    s_nop 3
L_slowloop_102:
    s_add_u32 m0, s62, 0
    s_add_u32 s55, s57, 0
    buffer_load_dwordx4 v10, s[12:15], s55 offen offset:0 lds
    buffer_load_dwordx4 v11, s[12:15], s55 offen offset:1024 lds
    buffer_load_dwordx4 v10, s[12:15], s55 offen offset:2048 lds
    buffer_load_dwordx4 v11, s[12:15], s55 offen offset:3072 lds
    s_add_u32 m0, s62, 16384
    s_add_u32 s55, s57, 4096
    buffer_load_dwordx4 v10, s[12:15], s55 offen offset:0 lds
    buffer_load_dwordx4 v11, s[12:15], s55 offen offset:1024 lds
    buffer_load_dwordx4 v10, s[12:15], s55 offen offset:2048 lds
    buffer_load_dwordx4 v11, s[12:15], s55 offen offset:3072 lds
    s_add_u32 s55, s57, 0
    buffer_load_dwordx4 a[32:35], v124, s[8:11], s55 offen offset:0
    buffer_load_dwordx4 a[36:39], v124, s[8:11], s55 offen offset:64
    buffer_load_dwordx4 a[40:43], v124, s[8:11], s55 offen offset:128
    buffer_load_dwordx4 a[44:47], v124, s[8:11], s55 offen offset:192
    s_add_u32 s55, s57, 4096
    buffer_load_dwordx4 a[48:51], v124, s[8:11], s55 offen offset:0
    buffer_load_dwordx4 a[52:55], v124, s[8:11], s55 offen offset:64
    buffer_load_dwordx4 a[56:59], v124, s[8:11], s55 offen offset:128
    buffer_load_dwordx4 a[60:63], v124, s[8:11], s55 offen offset:192
    s_waitcnt vmcnt(0)
    ds_read_b64_tr_b16 a[96:97], v125 offset:0
    ds_read_b64_tr_b16 a[98:99], v125 offset:16384
    ds_read_b64_tr_b16 a[100:101], v126 offset:0
    ds_read_b64_tr_b16 a[102:103], v126 offset:16384
    ds_read_b64_tr_b16 a[104:105], v125 offset:256
    ds_read_b64_tr_b16 a[106:107], v125 offset:16640
    ds_read_b64_tr_b16 a[108:109], v126 offset:256
    ds_read_b64_tr_b16 a[110:111], v126 offset:16640
    ds_read_b64_tr_b16 a[112:113], v125 offset:512
    ds_read_b64_tr_b16 a[114:115], v125 offset:16896
    ds_read_b64_tr_b16 a[116:117], v126 offset:512
    ds_read_b64_tr_b16 a[118:119], v126 offset:16896
    ds_read_b64_tr_b16 a[120:121], v125 offset:768
    ds_read_b64_tr_b16 a[122:123], v125 offset:17152
    ds_read_b64_tr_b16 a[124:125], v126 offset:768
    ds_read_b64_tr_b16 a[126:127], v126 offset:17152
    v_mfma_f32_16x16x32_bf16 v[96:99], a[32:35], v[32:35], 0
    v_mfma_f32_16x16x32_bf16 v[96:99], a[36:39], v[48:51], v[96:99]
    v_mfma_f32_16x16x32_bf16 v[96:99], a[40:43], v[64:67], v[96:99]
    v_mfma_f32_16x16x32_bf16 v[96:99], a[44:47], v[80:83], v[96:99]
    v_mfma_f32_16x16x32_bf16 v[100:103], a[48:51], v[32:35], 0
    v_mfma_f32_16x16x32_bf16 v[100:103], a[52:55], v[48:51], v[100:103]
    v_mfma_f32_16x16x32_bf16 v[100:103], a[56:59], v[64:67], v[100:103]
    v_mfma_f32_16x16x32_bf16 v[100:103], a[60:63], v[80:83], v[100:103]
    s_nop 3
    v_max3_f32 v120, v96, v97, v24
    v_max3_f32 v120, v98, v99, v120
    s_nop 1
    v_max3_f32 v120, v100, v101, v120
    v_max3_f32 v120, v102, v103, v120
    v_mov_b32 v121, v120
    s_nop 1
    v_permlane16_swap_b32 v120, v121
    v_max_f32 v120, v120, v121
    v_mov_b32 v121, v120
    s_nop 1
    v_permlane32_swap_b32 v120, v121
    v_max_f32 v120, v120, v121
    v_sub_f32 v121, v24, v120
    v_exp_f32 v121, v121
    v_mov_b32 v24, v120
    v_accvgpr_read_b32 v122, a128
    v_mul_f32 v122, v122, v121
    v_accvgpr_write_b32 a128, v122
    v_accvgpr_write_b32 a129, v122
    v_accvgpr_write_b32 a130, v122
    v_accvgpr_write_b32 a131, v122
    v_mul_f32 v128, v128, v121
    v_mul_f32 v129, v129, v121
    v_mul_f32 v130, v130, v121
    v_mul_f32 v131, v131, v121
    v_mul_f32 v132, v132, v121
    v_mul_f32 v133, v133, v121
    v_mul_f32 v134, v134, v121
    v_mul_f32 v135, v135, v121
    v_mul_f32 v136, v136, v121
    v_mul_f32 v137, v137, v121
    v_mul_f32 v138, v138, v121
    v_mul_f32 v139, v139, v121
    v_mul_f32 v140, v140, v121
    v_mul_f32 v141, v141, v121
    v_mul_f32 v142, v142, v121
    v_mul_f32 v143, v143, v121
    v_mul_f32 v144, v144, v121
    v_mul_f32 v145, v145, v121
    v_mul_f32 v146, v146, v121
    v_mul_f32 v147, v147, v121
    v_mul_f32 v148, v148, v121
    v_mul_f32 v149, v149, v121
    v_mul_f32 v150, v150, v121
    v_mul_f32 v151, v151, v121
    v_mul_f32 v152, v152, v121
    v_mul_f32 v153, v153, v121
    v_mul_f32 v154, v154, v121
    v_mul_f32 v155, v155, v121
    v_mul_f32 v156, v156, v121
    v_mul_f32 v157, v157, v121
    v_mul_f32 v158, v158, v121
    v_mul_f32 v159, v159, v121
    v_sub_f32 v96, v96, v120
    v_sub_f32 v97, v97, v120
    v_sub_f32 v98, v98, v120
    v_sub_f32 v99, v99, v120
    v_sub_f32 v100, v100, v120
    v_sub_f32 v101, v101, v120
    v_sub_f32 v102, v102, v120
    v_sub_f32 v103, v103, v120
    v_exp_f32 v96, v96
    v_exp_f32 v97, v97
    v_exp_f32 v98, v98
    v_exp_f32 v99, v99
    v_exp_f32 v100, v100
    v_exp_f32 v101, v101
    v_exp_f32 v102, v102
    v_exp_f32 v103, v103
    v_cvt_pk_bf16_f32 v112, v96, v97
    v_cvt_pk_bf16_f32 v113, v98, v99
    v_cvt_pk_bf16_f32 v114, v100, v101
    v_cvt_pk_bf16_f32 v115, v102, v103
    s_nop 1
    v_mfma_f32_16x16x32_bf16 a[128:131], a[144:147], v[112:115], a[128:131]
    s_waitcnt lgkmcnt(14)
    v_mfma_f32_16x16x32_bf16 v[128:131], a[96:99], v[112:115], v[128:131]
    s_waitcnt lgkmcnt(12)
    v_mfma_f32_16x16x32_bf16 v[132:135], a[100:103], v[112:115], v[132:135]
    s_waitcnt lgkmcnt(10)
    v_mfma_f32_16x16x32_bf16 v[136:139], a[104:107], v[112:115], v[136:139]
    s_waitcnt lgkmcnt(8)
    v_mfma_f32_16x16x32_bf16 v[140:143], a[108:111], v[112:115], v[140:143]
    s_waitcnt lgkmcnt(6)
    v_mfma_f32_16x16x32_bf16 v[144:147], a[112:115], v[112:115], v[144:147]
    s_waitcnt lgkmcnt(4)
    v_mfma_f32_16x16x32_bf16 v[148:151], a[116:119], v[112:115], v[148:151]
    s_waitcnt lgkmcnt(2)
    v_mfma_f32_16x16x32_bf16 v[152:155], a[120:123], v[112:115], v[152:155]
    s_waitcnt lgkmcnt(0)
    v_mfma_f32_16x16x32_bf16 v[156:159], a[124:127], v[112:115], v[156:159]
    v_mfma_f32_16x16x32_bf16 v[96:99], a[32:35], v[36:39], 0
    v_mfma_f32_16x16x32_bf16 v[96:99], a[36:39], v[52:55], v[96:99]
    v_mfma_f32_16x16x32_bf16 v[96:99], a[40:43], v[68:71], v[96:99]
    v_mfma_f32_16x16x32_bf16 v[96:99], a[44:47], v[84:87], v[96:99]
    v_mfma_f32_16x16x32_bf16 v[100:103], a[48:51], v[36:39], 0
    v_mfma_f32_16x16x32_bf16 v[100:103], a[52:55], v[52:55], v[100:103]
    v_mfma_f32_16x16x32_bf16 v[100:103], a[56:59], v[68:71], v[100:103]
    v_mfma_f32_16x16x32_bf16 v[100:103], a[60:63], v[84:87], v[100:103]
    s_nop 3
    v_max3_f32 v120, v96, v97, v25
    v_max3_f32 v120, v98, v99, v120
    s_nop 1
    v_max3_f32 v120, v100, v101, v120
    v_max3_f32 v120, v102, v103, v120
    v_mov_b32 v121, v120
    s_nop 1
    v_permlane16_swap_b32 v120, v121
    v_max_f32 v120, v120, v121
    v_mov_b32 v121, v120
    s_nop 1
    v_permlane32_swap_b32 v120, v121
    v_max_f32 v120, v120, v121
    v_sub_f32 v121, v25, v120
    v_exp_f32 v121, v121
    v_mov_b32 v25, v120
    v_accvgpr_read_b32 v122, a132
    v_mul_f32 v122, v122, v121
    v_accvgpr_write_b32 a132, v122
    v_accvgpr_write_b32 a133, v122
    v_accvgpr_write_b32 a134, v122
    v_accvgpr_write_b32 a135, v122
    v_mul_f32 v160, v160, v121
    v_mul_f32 v161, v161, v121
    v_mul_f32 v162, v162, v121
    v_mul_f32 v163, v163, v121
    v_mul_f32 v164, v164, v121
    v_mul_f32 v165, v165, v121
    v_mul_f32 v166, v166, v121
    v_mul_f32 v167, v167, v121
    v_mul_f32 v168, v168, v121
    v_mul_f32 v169, v169, v121
    v_mul_f32 v170, v170, v121
    v_mul_f32 v171, v171, v121
    v_mul_f32 v172, v172, v121
    v_mul_f32 v173, v173, v121
    v_mul_f32 v174, v174, v121
    v_mul_f32 v175, v175, v121
    v_mul_f32 v176, v176, v121
    v_mul_f32 v177, v177, v121
    v_mul_f32 v178, v178, v121
    v_mul_f32 v179, v179, v121
    v_mul_f32 v180, v180, v121
    v_mul_f32 v181, v181, v121
    v_mul_f32 v182, v182, v121
    v_mul_f32 v183, v183, v121
    v_mul_f32 v184, v184, v121
    v_mul_f32 v185, v185, v121
    v_mul_f32 v186, v186, v121
    v_mul_f32 v187, v187, v121
    v_mul_f32 v188, v188, v121
    v_mul_f32 v189, v189, v121
    v_mul_f32 v190, v190, v121
    v_mul_f32 v191, v191, v121
    v_sub_f32 v96, v96, v120
    v_sub_f32 v97, v97, v120
    v_sub_f32 v98, v98, v120
    v_sub_f32 v99, v99, v120
    v_sub_f32 v100, v100, v120
    v_sub_f32 v101, v101, v120
    v_sub_f32 v102, v102, v120
    v_sub_f32 v103, v103, v120
    v_exp_f32 v96, v96
    v_exp_f32 v97, v97
    v_exp_f32 v98, v98
    v_exp_f32 v99, v99
    v_exp_f32 v100, v100
    v_exp_f32 v101, v101
    v_exp_f32 v102, v102
    v_exp_f32 v103, v103
    v_cvt_pk_bf16_f32 v112, v96, v97
    v_cvt_pk_bf16_f32 v113, v98, v99
    v_cvt_pk_bf16_f32 v114, v100, v101
    v_cvt_pk_bf16_f32 v115, v102, v103
    s_nop 1
    v_mfma_f32_16x16x32_bf16 a[132:135], a[144:147], v[112:115], a[132:135]
    v_mfma_f32_16x16x32_bf16 v[160:163], a[96:99], v[112:115], v[160:163]
    v_mfma_f32_16x16x32_bf16 v[164:167], a[100:103], v[112:115], v[164:167]
    v_mfma_f32_16x16x32_bf16 v[168:171], a[104:107], v[112:115], v[168:171]
    v_mfma_f32_16x16x32_bf16 v[172:175], a[108:111], v[112:115], v[172:175]
    v_mfma_f32_16x16x32_bf16 v[176:179], a[112:115], v[112:115], v[176:179]
    v_mfma_f32_16x16x32_bf16 v[180:183], a[116:119], v[112:115], v[180:183]
    v_mfma_f32_16x16x32_bf16 v[184:187], a[120:123], v[112:115], v[184:187]
    v_mfma_f32_16x16x32_bf16 v[188:191], a[124:127], v[112:115], v[188:191]
    v_mfma_f32_16x16x32_bf16 v[96:99], a[32:35], v[40:43], 0
    v_mfma_f32_16x16x32_bf16 v[96:99], a[36:39], v[56:59], v[96:99]
    v_mfma_f32_16x16x32_bf16 v[96:99], a[40:43], v[72:75], v[96:99]
    v_mfma_f32_16x16x32_bf16 v[96:99], a[44:47], v[88:91], v[96:99]
    v_mfma_f32_16x16x32_bf16 v[100:103], a[48:51], v[40:43], 0
    v_mfma_f32_16x16x32_bf16 v[100:103], a[52:55], v[56:59], v[100:103]
    v_mfma_f32_16x16x32_bf16 v[100:103], a[56:59], v[72:75], v[100:103]
    v_mfma_f32_16x16x32_bf16 v[100:103], a[60:63], v[88:91], v[100:103]
    s_nop 3
    v_max3_f32 v120, v96, v97, v26
    v_max3_f32 v120, v98, v99, v120
    s_nop 1
    v_max3_f32 v120, v100, v101, v120
    v_max3_f32 v120, v102, v103, v120
    v_mov_b32 v121, v120
    s_nop 1
    v_permlane16_swap_b32 v120, v121
    v_max_f32 v120, v120, v121
    v_mov_b32 v121, v120
    s_nop 1
    v_permlane32_swap_b32 v120, v121
    v_max_f32 v120, v120, v121
    v_sub_f32 v121, v26, v120
    v_exp_f32 v121, v121
    v_mov_b32 v26, v120
    v_accvgpr_read_b32 v122, a136
    v_mul_f32 v122, v122, v121
    v_accvgpr_write_b32 a136, v122
    v_accvgpr_write_b32 a137, v122
    v_accvgpr_write_b32 a138, v122
    v_accvgpr_write_b32 a139, v122
    v_mul_f32 v192, v192, v121
    v_mul_f32 v193, v193, v121
    v_mul_f32 v194, v194, v121
    v_mul_f32 v195, v195, v121
    v_mul_f32 v196, v196, v121
    v_mul_f32 v197, v197, v121
    v_mul_f32 v198, v198, v121
    v_mul_f32 v199, v199, v121
    v_mul_f32 v200, v200, v121
    v_mul_f32 v201, v201, v121
    v_mul_f32 v202, v202, v121
    v_mul_f32 v203, v203, v121
    v_mul_f32 v204, v204, v121
    v_mul_f32 v205, v205, v121
    v_mul_f32 v206, v206, v121
    v_mul_f32 v207, v207, v121
    v_mul_f32 v208, v208, v121
    v_mul_f32 v209, v209, v121
    v_mul_f32 v210, v210, v121
    v_mul_f32 v211, v211, v121
    v_mul_f32 v212, v212, v121
    v_mul_f32 v213, v213, v121
    v_mul_f32 v214, v214, v121
    v_mul_f32 v215, v215, v121
    v_mul_f32 v216, v216, v121
    v_mul_f32 v217, v217, v121
    v_mul_f32 v218, v218, v121
    v_mul_f32 v219, v219, v121
    v_mul_f32 v220, v220, v121
    v_mul_f32 v221, v221, v121
    v_mul_f32 v222, v222, v121
    v_mul_f32 v223, v223, v121
    v_sub_f32 v96, v96, v120
    v_sub_f32 v97, v97, v120
    v_sub_f32 v98, v98, v120
    v_sub_f32 v99, v99, v120
    v_sub_f32 v100, v100, v120
    v_sub_f32 v101, v101, v120
    v_sub_f32 v102, v102, v120
    v_sub_f32 v103, v103, v120
    v_exp_f32 v96, v96
    v_exp_f32 v97, v97
    v_exp_f32 v98, v98
    v_exp_f32 v99, v99
    v_exp_f32 v100, v100
    v_exp_f32 v101, v101
    v_exp_f32 v102, v102
    v_exp_f32 v103, v103
    v_cvt_pk_bf16_f32 v112, v96, v97
    v_cvt_pk_bf16_f32 v113, v98, v99
    v_cvt_pk_bf16_f32 v114, v100, v101
    v_cvt_pk_bf16_f32 v115, v102, v103
    s_nop 1
    v_mfma_f32_16x16x32_bf16 a[136:139], a[144:147], v[112:115], a[136:139]
    v_mfma_f32_16x16x32_bf16 v[192:195], a[96:99], v[112:115], v[192:195]
    v_mfma_f32_16x16x32_bf16 v[196:199], a[100:103], v[112:115], v[196:199]
    v_mfma_f32_16x16x32_bf16 v[200:203], a[104:107], v[112:115], v[200:203]
    v_mfma_f32_16x16x32_bf16 v[204:207], a[108:111], v[112:115], v[204:207]
    v_mfma_f32_16x16x32_bf16 v[208:211], a[112:115], v[112:115], v[208:211]
    v_mfma_f32_16x16x32_bf16 v[212:215], a[116:119], v[112:115], v[212:215]
    v_mfma_f32_16x16x32_bf16 v[216:219], a[120:123], v[112:115], v[216:219]
    v_mfma_f32_16x16x32_bf16 v[220:223], a[124:127], v[112:115], v[220:223]
    v_mfma_f32_16x16x32_bf16 v[96:99], a[32:35], v[44:47], 0
    v_mfma_f32_16x16x32_bf16 v[96:99], a[36:39], v[60:63], v[96:99]
    v_mfma_f32_16x16x32_bf16 v[96:99], a[40:43], v[76:79], v[96:99]
    v_mfma_f32_16x16x32_bf16 v[96:99], a[44:47], v[92:95], v[96:99]
    v_mfma_f32_16x16x32_bf16 v[100:103], a[48:51], v[44:47], 0
    v_mfma_f32_16x16x32_bf16 v[100:103], a[52:55], v[60:63], v[100:103]
    v_mfma_f32_16x16x32_bf16 v[100:103], a[56:59], v[76:79], v[100:103]
    v_mfma_f32_16x16x32_bf16 v[100:103], a[60:63], v[92:95], v[100:103]
    s_nop 3
    v_max3_f32 v120, v96, v97, v27
    v_max3_f32 v120, v98, v99, v120
    s_nop 1
    v_max3_f32 v120, v100, v101, v120
    v_max3_f32 v120, v102, v103, v120
    v_mov_b32 v121, v120
    s_nop 1
    v_permlane16_swap_b32 v120, v121
    v_max_f32 v120, v120, v121
    v_mov_b32 v121, v120
    s_nop 1
    v_permlane32_swap_b32 v120, v121
    v_max_f32 v120, v120, v121
    v_sub_f32 v121, v27, v120
    v_exp_f32 v121, v121
    v_mov_b32 v27, v120
    v_accvgpr_read_b32 v122, a140
    v_mul_f32 v122, v122, v121
    v_accvgpr_write_b32 a140, v122
    v_accvgpr_write_b32 a141, v122
    v_accvgpr_write_b32 a142, v122
    v_accvgpr_write_b32 a143, v122
    v_mul_f32 v224, v224, v121
    v_mul_f32 v225, v225, v121
    v_mul_f32 v226, v226, v121
    v_mul_f32 v227, v227, v121
    v_mul_f32 v228, v228, v121
    v_mul_f32 v229, v229, v121
    v_mul_f32 v230, v230, v121
    v_mul_f32 v231, v231, v121
    v_mul_f32 v232, v232, v121
    v_mul_f32 v233, v233, v121
    v_mul_f32 v234, v234, v121
    v_mul_f32 v235, v235, v121
    v_mul_f32 v236, v236, v121
    v_mul_f32 v237, v237, v121
    v_mul_f32 v238, v238, v121
    v_mul_f32 v239, v239, v121
    v_mul_f32 v240, v240, v121
    v_mul_f32 v241, v241, v121
    v_mul_f32 v242, v242, v121
    v_mul_f32 v243, v243, v121
    v_mul_f32 v244, v244, v121
    v_mul_f32 v245, v245, v121
    v_mul_f32 v246, v246, v121
    v_mul_f32 v247, v247, v121
    v_mul_f32 v248, v248, v121
    v_mul_f32 v249, v249, v121
    v_mul_f32 v250, v250, v121
    v_mul_f32 v251, v251, v121
    v_mul_f32 v252, v252, v121
    v_mul_f32 v253, v253, v121
    v_mul_f32 v254, v254, v121
    v_mul_f32 v255, v255, v121
    v_sub_f32 v96, v96, v120
    v_sub_f32 v97, v97, v120
    v_sub_f32 v98, v98, v120
    v_sub_f32 v99, v99, v120
    v_sub_f32 v100, v100, v120
    v_sub_f32 v101, v101, v120
    v_sub_f32 v102, v102, v120
    v_sub_f32 v103, v103, v120
    v_exp_f32 v96, v96
    v_exp_f32 v97, v97
    v_exp_f32 v98, v98
    v_exp_f32 v99, v99
    v_exp_f32 v100, v100
    v_exp_f32 v101, v101
    v_exp_f32 v102, v102
    v_exp_f32 v103, v103
    v_cvt_pk_bf16_f32 v112, v96, v97
    v_cvt_pk_bf16_f32 v113, v98, v99
    v_cvt_pk_bf16_f32 v114, v100, v101
    v_cvt_pk_bf16_f32 v115, v102, v103
    s_nop 1
    v_mfma_f32_16x16x32_bf16 a[140:143], a[144:147], v[112:115], a[140:143]
    v_mfma_f32_16x16x32_bf16 v[224:227], a[96:99], v[112:115], v[224:227]
    v_mfma_f32_16x16x32_bf16 v[228:231], a[100:103], v[112:115], v[228:231]
    v_mfma_f32_16x16x32_bf16 v[232:235], a[104:107], v[112:115], v[232:235]
    v_mfma_f32_16x16x32_bf16 v[236:239], a[108:111], v[112:115], v[236:239]
    v_mfma_f32_16x16x32_bf16 v[240:243], a[112:115], v[112:115], v[240:243]
    v_mfma_f32_16x16x32_bf16 v[244:247], a[116:119], v[112:115], v[244:247]
    v_mfma_f32_16x16x32_bf16 v[248:251], a[120:123], v[112:115], v[248:251]
    v_mfma_f32_16x16x32_bf16 v[252:255], a[124:127], v[112:115], v[252:255]
    s_add_u32 s57, s57, 8192
    s_waitcnt vmcnt(0) lgkmcnt(0)
    s_nop 15
    s_nop 3
    s_add_u32 s98, s98, 1
    s_cmp_lt_u32 s98, 16
    s_cbranch_scc1 L_slowloop_102
    v_accvgpr_read_b32 v120, a128
    v_rcp_f32 v120, v120
    v_accvgpr_read_b32 v121, a132
    v_rcp_f32 v121, v121
    v_accvgpr_read_b32 v122, a136
    v_rcp_f32 v122, v122
    v_accvgpr_read_b32 v123, a140
    v_rcp_f32 v123, v123
    v_pk_mul_f32 v[128:129], v[128:129], v[120:121] op_sel_hi:[1,0]
    v_pk_mul_f32 v[130:131], v[130:131], v[120:121] op_sel_hi:[1,0]
    v_pk_mul_f32 v[132:133], v[132:133], v[120:121] op_sel_hi:[1,0]
    v_pk_mul_f32 v[134:135], v[134:135], v[120:121] op_sel_hi:[1,0]
    v_cvt_pk_bf16_f32 v96, v128, v129
    v_cvt_pk_bf16_f32 v97, v130, v131
    v_cvt_pk_bf16_f32 v98, v132, v133
    v_cvt_pk_bf16_f32 v99, v134, v135
    ds_write_b128 v22, v[96:99] offset:0
    v_pk_mul_f32 v[136:137], v[136:137], v[120:121] op_sel_hi:[1,0]
    v_pk_mul_f32 v[138:139], v[138:139], v[120:121] op_sel_hi:[1,0]
    v_pk_mul_f32 v[140:141], v[140:141], v[120:121] op_sel_hi:[1,0]
    v_pk_mul_f32 v[142:143], v[142:143], v[120:121] op_sel_hi:[1,0]
    v_cvt_pk_bf16_f32 v100, v136, v137
    v_cvt_pk_bf16_f32 v101, v138, v139
    v_cvt_pk_bf16_f32 v102, v140, v141
    v_cvt_pk_bf16_f32 v103, v142, v143
    ds_write_b128 v22, v[100:103] offset:1024
    v_pk_mul_f32 v[144:145], v[144:145], v[120:121] op_sel_hi:[1,0]
    v_pk_mul_f32 v[146:147], v[146:147], v[120:121] op_sel_hi:[1,0]
    v_pk_mul_f32 v[148:149], v[148:149], v[120:121] op_sel_hi:[1,0]
    v_pk_mul_f32 v[150:151], v[150:151], v[120:121] op_sel_hi:[1,0]
    v_cvt_pk_bf16_f32 v104, v144, v145
    v_cvt_pk_bf16_f32 v105, v146, v147
    v_cvt_pk_bf16_f32 v106, v148, v149
    v_cvt_pk_bf16_f32 v107, v150, v151
    ds_write_b128 v22, v[104:107] offset:2048
    v_pk_mul_f32 v[152:153], v[152:153], v[120:121] op_sel_hi:[1,0]
    v_pk_mul_f32 v[154:155], v[154:155], v[120:121] op_sel_hi:[1,0]
    v_pk_mul_f32 v[156:157], v[156:157], v[120:121] op_sel_hi:[1,0]
    v_pk_mul_f32 v[158:159], v[158:159], v[120:121] op_sel_hi:[1,0]
    v_cvt_pk_bf16_f32 v108, v152, v153
    v_cvt_pk_bf16_f32 v109, v154, v155
    v_cvt_pk_bf16_f32 v110, v156, v157
    v_cvt_pk_bf16_f32 v111, v158, v159
    ds_write_b128 v22, v[108:111] offset:3072
    v_pk_mul_f32 v[160:161], v[160:161], v[120:121] op_sel:[0,1] op_sel_hi:[1,1]
    v_pk_mul_f32 v[162:163], v[162:163], v[120:121] op_sel:[0,1] op_sel_hi:[1,1]
    v_pk_mul_f32 v[164:165], v[164:165], v[120:121] op_sel:[0,1] op_sel_hi:[1,1]
    v_pk_mul_f32 v[166:167], v[166:167], v[120:121] op_sel:[0,1] op_sel_hi:[1,1]
    v_cvt_pk_bf16_f32 v96, v160, v161
    v_cvt_pk_bf16_f32 v97, v162, v163
    v_cvt_pk_bf16_f32 v98, v164, v165
    v_cvt_pk_bf16_f32 v99, v166, v167
    ds_write_b128 v22, v[96:99] offset:16384
    v_pk_mul_f32 v[168:169], v[168:169], v[120:121] op_sel:[0,1] op_sel_hi:[1,1]
    v_pk_mul_f32 v[170:171], v[170:171], v[120:121] op_sel:[0,1] op_sel_hi:[1,1]
    v_pk_mul_f32 v[172:173], v[172:173], v[120:121] op_sel:[0,1] op_sel_hi:[1,1]
    v_pk_mul_f32 v[174:175], v[174:175], v[120:121] op_sel:[0,1] op_sel_hi:[1,1]
    v_cvt_pk_bf16_f32 v100, v168, v169
    v_cvt_pk_bf16_f32 v101, v170, v171
    v_cvt_pk_bf16_f32 v102, v172, v173
    v_cvt_pk_bf16_f32 v103, v174, v175
    ds_write_b128 v22, v[100:103] offset:17408
    v_pk_mul_f32 v[176:177], v[176:177], v[120:121] op_sel:[0,1] op_sel_hi:[1,1]
    v_pk_mul_f32 v[178:179], v[178:179], v[120:121] op_sel:[0,1] op_sel_hi:[1,1]
    v_pk_mul_f32 v[180:181], v[180:181], v[120:121] op_sel:[0,1] op_sel_hi:[1,1]
    v_pk_mul_f32 v[182:183], v[182:183], v[120:121] op_sel:[0,1] op_sel_hi:[1,1]
    v_cvt_pk_bf16_f32 v104, v176, v177
    v_cvt_pk_bf16_f32 v105, v178, v179
    v_cvt_pk_bf16_f32 v106, v180, v181
    v_cvt_pk_bf16_f32 v107, v182, v183
    ds_write_b128 v22, v[104:107] offset:18432
    v_pk_mul_f32 v[184:185], v[184:185], v[120:121] op_sel:[0,1] op_sel_hi:[1,1]
    v_pk_mul_f32 v[186:187], v[186:187], v[120:121] op_sel:[0,1] op_sel_hi:[1,1]
    v_pk_mul_f32 v[188:189], v[188:189], v[120:121] op_sel:[0,1] op_sel_hi:[1,1]
    v_pk_mul_f32 v[190:191], v[190:191], v[120:121] op_sel:[0,1] op_sel_hi:[1,1]
    v_cvt_pk_bf16_f32 v108, v184, v185
    v_cvt_pk_bf16_f32 v109, v186, v187
    v_cvt_pk_bf16_f32 v110, v188, v189
    v_cvt_pk_bf16_f32 v111, v190, v191
    ds_write_b128 v22, v[108:111] offset:19456
    v_pk_mul_f32 v[192:193], v[192:193], v[122:123] op_sel_hi:[1,0]
    v_pk_mul_f32 v[194:195], v[194:195], v[122:123] op_sel_hi:[1,0]
    v_pk_mul_f32 v[196:197], v[196:197], v[122:123] op_sel_hi:[1,0]
    v_pk_mul_f32 v[198:199], v[198:199], v[122:123] op_sel_hi:[1,0]
    v_cvt_pk_bf16_f32 v96, v192, v193
    v_cvt_pk_bf16_f32 v97, v194, v195
    v_cvt_pk_bf16_f32 v98, v196, v197
    v_cvt_pk_bf16_f32 v99, v198, v199
    ds_write_b128 v22, v[96:99] offset:32768
    v_pk_mul_f32 v[200:201], v[200:201], v[122:123] op_sel_hi:[1,0]
    v_pk_mul_f32 v[202:203], v[202:203], v[122:123] op_sel_hi:[1,0]
    v_pk_mul_f32 v[204:205], v[204:205], v[122:123] op_sel_hi:[1,0]
    v_pk_mul_f32 v[206:207], v[206:207], v[122:123] op_sel_hi:[1,0]
    v_cvt_pk_bf16_f32 v100, v200, v201
    v_cvt_pk_bf16_f32 v101, v202, v203
    v_cvt_pk_bf16_f32 v102, v204, v205
    v_cvt_pk_bf16_f32 v103, v206, v207
    ds_write_b128 v22, v[100:103] offset:33792
    v_pk_mul_f32 v[208:209], v[208:209], v[122:123] op_sel_hi:[1,0]
    v_pk_mul_f32 v[210:211], v[210:211], v[122:123] op_sel_hi:[1,0]
    v_pk_mul_f32 v[212:213], v[212:213], v[122:123] op_sel_hi:[1,0]
    v_pk_mul_f32 v[214:215], v[214:215], v[122:123] op_sel_hi:[1,0]
    v_cvt_pk_bf16_f32 v104, v208, v209
    v_cvt_pk_bf16_f32 v105, v210, v211
    v_cvt_pk_bf16_f32 v106, v212, v213
    v_cvt_pk_bf16_f32 v107, v214, v215
    ds_write_b128 v22, v[104:107] offset:34816
    v_pk_mul_f32 v[216:217], v[216:217], v[122:123] op_sel_hi:[1,0]
    v_pk_mul_f32 v[218:219], v[218:219], v[122:123] op_sel_hi:[1,0]
    v_pk_mul_f32 v[220:221], v[220:221], v[122:123] op_sel_hi:[1,0]
    v_pk_mul_f32 v[222:223], v[222:223], v[122:123] op_sel_hi:[1,0]
    v_cvt_pk_bf16_f32 v108, v216, v217
    v_cvt_pk_bf16_f32 v109, v218, v219
    v_cvt_pk_bf16_f32 v110, v220, v221
    v_cvt_pk_bf16_f32 v111, v222, v223
    ds_write_b128 v22, v[108:111] offset:35840
    v_pk_mul_f32 v[224:225], v[224:225], v[122:123] op_sel:[0,1] op_sel_hi:[1,1]
    v_pk_mul_f32 v[226:227], v[226:227], v[122:123] op_sel:[0,1] op_sel_hi:[1,1]
    v_pk_mul_f32 v[228:229], v[228:229], v[122:123] op_sel:[0,1] op_sel_hi:[1,1]
    v_pk_mul_f32 v[230:231], v[230:231], v[122:123] op_sel:[0,1] op_sel_hi:[1,1]
    v_cvt_pk_bf16_f32 v96, v224, v225
    v_cvt_pk_bf16_f32 v97, v226, v227
    v_cvt_pk_bf16_f32 v98, v228, v229
    v_cvt_pk_bf16_f32 v99, v230, v231
    ds_write_b128 v22, v[96:99] offset:49152
    v_pk_mul_f32 v[232:233], v[232:233], v[122:123] op_sel:[0,1] op_sel_hi:[1,1]
    v_pk_mul_f32 v[234:235], v[234:235], v[122:123] op_sel:[0,1] op_sel_hi:[1,1]
    v_pk_mul_f32 v[236:237], v[236:237], v[122:123] op_sel:[0,1] op_sel_hi:[1,1]
    v_pk_mul_f32 v[238:239], v[238:239], v[122:123] op_sel:[0,1] op_sel_hi:[1,1]
    v_cvt_pk_bf16_f32 v100, v232, v233
    v_cvt_pk_bf16_f32 v101, v234, v235
    v_cvt_pk_bf16_f32 v102, v236, v237
    v_cvt_pk_bf16_f32 v103, v238, v239
    ds_write_b128 v22, v[100:103] offset:50176
    v_pk_mul_f32 v[240:241], v[240:241], v[122:123] op_sel:[0,1] op_sel_hi:[1,1]
    v_pk_mul_f32 v[242:243], v[242:243], v[122:123] op_sel:[0,1] op_sel_hi:[1,1]
    v_pk_mul_f32 v[244:245], v[244:245], v[122:123] op_sel:[0,1] op_sel_hi:[1,1]
    v_pk_mul_f32 v[246:247], v[246:247], v[122:123] op_sel:[0,1] op_sel_hi:[1,1]
    v_cvt_pk_bf16_f32 v104, v240, v241
    v_cvt_pk_bf16_f32 v105, v242, v243
    v_cvt_pk_bf16_f32 v106, v244, v245
    v_cvt_pk_bf16_f32 v107, v246, v247
    ds_write_b128 v22, v[104:107] offset:51200
    v_pk_mul_f32 v[248:249], v[248:249], v[122:123] op_sel:[0,1] op_sel_hi:[1,1]
    v_pk_mul_f32 v[250:251], v[250:251], v[122:123] op_sel:[0,1] op_sel_hi:[1,1]
    v_pk_mul_f32 v[252:253], v[252:253], v[122:123] op_sel:[0,1] op_sel_hi:[1,1]
    v_pk_mul_f32 v[254:255], v[254:255], v[122:123] op_sel:[0,1] op_sel_hi:[1,1]
    v_cvt_pk_bf16_f32 v108, v248, v249
    v_cvt_pk_bf16_f32 v109, v250, v251
    v_cvt_pk_bf16_f32 v110, v252, v253
    v_cvt_pk_bf16_f32 v111, v254, v255
    ds_write_b128 v22, v[108:111] offset:52224
    s_waitcnt vmcnt(0) lgkmcnt(0)
    s_nop 15
    s_nop 3
    s_branch L_join
L_redo_44:
    s_mov_b32 s98, 0x100000
L_rl_103:
    s_add_u32 s58, s81, 0
    buffer_load_dwordx4 v[192:195], v10, s[48:51], s58 offen offset:0 sc1
    buffer_load_dwordx4 v[196:199], v10, s[48:51], s58 offen offset:1024 sc1
    buffer_load_dwordx4 v[200:203], v10, s[48:51], s58 offen offset:2048 sc1
    buffer_load_dwordx4 v[204:207], v10, s[48:51], s58 offen offset:3072 sc1
    s_add_u32 s58, s81, 4096
    buffer_load_dwordx4 v[208:211], v10, s[48:51], s58 offen offset:0 sc1
    buffer_load_dwordx4 v[212:215], v10, s[48:51], s58 offen offset:1024 sc1
    buffer_load_dwordx4 v[216:219], v10, s[48:51], s58 offen offset:2048 sc1
    buffer_load_dwordx4 v[220:223], v10, s[48:51], s58 offen offset:3072 sc1
    s_add_u32 s58, s81, 8192
    buffer_load_dwordx4 v[96:99], v10, s[48:51], s58 offen offset:0 sc1
    buffer_load_dwordx4 v[100:103], v10, s[48:51], s58 offen offset:1024 sc1
    buffer_load_dwordx4 v[104:107], v10, s[48:51], s58 offen offset:2048 sc1
    buffer_load_dwordx4 v[108:111], v10, s[48:51], s58 offen offset:3072 sc1
    s_add_u32 s58, s81, 12288
    buffer_load_dwordx4 v[112:115], v10, s[48:51], s58 offen offset:0 sc1
    buffer_load_dwordx4 v[116:119], v10, s[48:51], s58 offen offset:1024 sc1
    s_sub_u32 s98, s98, 1
    s_waitcnt vmcnt(0)
    s_cbranch_scc1 L_redoj_45
    v_min3_u32 v160, v192, v193, v194
    v_min3_u32 v161, v195, v196, v197
    v_min3_u32 v160, v160, v198, v199
    v_min_u32 v160, v160, v161
    v_cmp_eq_u32 vcc, 0, v160
    s_nop 0
    s_cbranch_vccnz L_rl_103
    s_branch L_redoj_45
L_redo_46:
    s_mov_b32 s98, 0x100000
L_rl_104:
    s_add_u32 s58, s81, 0
    buffer_load_dwordx4 v[200:203], v10, s[48:51], s58 offen offset:2048 sc1
    buffer_load_dwordx4 v[204:207], v10, s[48:51], s58 offen offset:3072 sc1
    s_add_u32 s58, s81, 4096
    buffer_load_dwordx4 v[208:211], v10, s[48:51], s58 offen offset:0 sc1
    buffer_load_dwordx4 v[212:215], v10, s[48:51], s58 offen offset:1024 sc1
    buffer_load_dwordx4 v[216:219], v10, s[48:51], s58 offen offset:2048 sc1
    buffer_load_dwordx4 v[220:223], v10, s[48:51], s58 offen offset:3072 sc1
    s_add_u32 s58, s81, 8192
    buffer_load_dwordx4 v[96:99], v10, s[48:51], s58 offen offset:0 sc1
    buffer_load_dwordx4 v[100:103], v10, s[48:51], s58 offen offset:1024 sc1
    buffer_load_dwordx4 v[104:107], v10, s[48:51], s58 offen offset:2048 sc1
    buffer_load_dwordx4 v[108:111], v10, s[48:51], s58 offen offset:3072 sc1
    s_add_u32 s58, s81, 12288
    buffer_load_dwordx4 v[112:115], v10, s[48:51], s58 offen offset:0 sc1
    buffer_load_dwordx4 v[116:119], v10, s[48:51], s58 offen offset:1024 sc1
    s_sub_u32 s98, s98, 1
    s_waitcnt vmcnt(0)
    s_cbranch_scc1 L_redoj_47
    v_min3_u32 v162, v200, v201, v202
    v_min3_u32 v163, v203, v204, v205
    v_min3_u32 v162, v162, v206, v207
    v_min_u32 v162, v162, v163
    v_cmp_eq_u32 vcc, 0, v162
    s_nop 0
    s_cbranch_vccnz L_rl_104
    s_branch L_redoj_47
L_redo_48:
    s_mov_b32 s98, 0x100000
L_rl_105:
    s_add_u32 s58, s81, 4096
    buffer_load_dwordx4 v[208:211], v10, s[48:51], s58 offen offset:0 sc1
    buffer_load_dwordx4 v[212:215], v10, s[48:51], s58 offen offset:1024 sc1
    buffer_load_dwordx4 v[216:219], v10, s[48:51], s58 offen offset:2048 sc1
    buffer_load_dwordx4 v[220:223], v10, s[48:51], s58 offen offset:3072 sc1
    s_add_u32 s58, s81, 8192
    buffer_load_dwordx4 v[96:99], v10, s[48:51], s58 offen offset:0 sc1
    buffer_load_dwordx4 v[100:103], v10, s[48:51], s58 offen offset:1024 sc1
    buffer_load_dwordx4 v[104:107], v10, s[48:51], s58 offen offset:2048 sc1
    buffer_load_dwordx4 v[108:111], v10, s[48:51], s58 offen offset:3072 sc1
    s_add_u32 s58, s81, 12288
    buffer_load_dwordx4 v[112:115], v10, s[48:51], s58 offen offset:0 sc1
    buffer_load_dwordx4 v[116:119], v10, s[48:51], s58 offen offset:1024 sc1
    s_sub_u32 s98, s98, 1
    s_waitcnt vmcnt(0)
    s_cbranch_scc1 L_redoj_49
    v_min3_u32 v160, v208, v209, v210
    v_min3_u32 v161, v211, v212, v213
    v_min3_u32 v160, v160, v214, v215
    v_min_u32 v160, v160, v161
    v_cmp_eq_u32 vcc, 0, v160
    s_nop 0
    s_cbranch_vccnz L_rl_105
    s_branch L_redoj_49
L_redo_50:
    s_mov_b32 s98, 0x100000
L_rl_106:
    s_add_u32 s58, s81, 4096
    buffer_load_dwordx4 v[216:219], v10, s[48:51], s58 offen offset:2048 sc1
    buffer_load_dwordx4 v[220:223], v10, s[48:51], s58 offen offset:3072 sc1
    s_add_u32 s58, s81, 8192
    buffer_load_dwordx4 v[96:99], v10, s[48:51], s58 offen offset:0 sc1
    buffer_load_dwordx4 v[100:103], v10, s[48:51], s58 offen offset:1024 sc1
    buffer_load_dwordx4 v[104:107], v10, s[48:51], s58 offen offset:2048 sc1
    buffer_load_dwordx4 v[108:111], v10, s[48:51], s58 offen offset:3072 sc1
    s_add_u32 s58, s81, 12288
    buffer_load_dwordx4 v[112:115], v10, s[48:51], s58 offen offset:0 sc1
    buffer_load_dwordx4 v[116:119], v10, s[48:51], s58 offen offset:1024 sc1
    s_add_u32 s58, s81, 57344
    buffer_load_dwordx4 v[120:123], v10, s[48:51], s58 offen offset:0 sc1
    buffer_load_dwordx4 v[124:127], v10, s[48:51], s58 offen offset:1024 sc1
    s_sub_u32 s98, s98, 1
    s_waitcnt vmcnt(0)
    s_cbranch_scc1 L_redoj_51
    v_min3_u32 v162, v216, v217, v218
    v_min3_u32 v163, v219, v220, v221
    v_min3_u32 v162, v162, v222, v223
    v_min_u32 v162, v162, v163
    v_cmp_eq_u32 vcc, 0, v162
    s_nop 0
    s_cbranch_vccnz L_rl_106
    s_branch L_redoj_51
L_redo_52:
    s_mov_b32 s98, 0x100000
L_rl_107:
    s_add_u32 s58, s81, 8192
    buffer_load_dwordx4 v[96:99], v10, s[48:51], s58 offen offset:0 sc1
    buffer_load_dwordx4 v[100:103], v10, s[48:51], s58 offen offset:1024 sc1
    buffer_load_dwordx4 v[104:107], v10, s[48:51], s58 offen offset:2048 sc1
    buffer_load_dwordx4 v[108:111], v10, s[48:51], s58 offen offset:3072 sc1
    s_add_u32 s58, s81, 12288
    buffer_load_dwordx4 v[112:115], v10, s[48:51], s58 offen offset:0 sc1
    buffer_load_dwordx4 v[116:119], v10, s[48:51], s58 offen offset:1024 sc1
    s_add_u32 s58, s81, 57344
    buffer_load_dwordx4 v[120:123], v10, s[48:51], s58 offen offset:0 sc1
    buffer_load_dwordx4 v[124:127], v10, s[48:51], s58 offen offset:1024 sc1
    buffer_load_dwordx4 v[192:195], v10, s[48:51], s58 offen offset:2048 sc1
    buffer_load_dwordx4 v[196:199], v10, s[48:51], s58 offen offset:3072 sc1
    s_sub_u32 s98, s98, 1
    s_waitcnt vmcnt(0)
    s_cbranch_scc1 L_redoj_53
    v_min3_u32 v160, v96, v97, v98
    v_min3_u32 v161, v99, v100, v101
    v_min3_u32 v160, v160, v102, v103
    v_min_u32 v160, v160, v161
    v_cmp_eq_u32 vcc, 0, v160
    s_nop 0
    s_cbranch_vccnz L_rl_107
    s_branch L_redoj_53
L_redo_54:
    s_mov_b32 s98, 0x100000
L_rl_108:
    s_add_u32 s58, s81, 8192
    buffer_load_dwordx4 v[104:107], v10, s[48:51], s58 offen offset:2048 sc1
    buffer_load_dwordx4 v[108:111], v10, s[48:51], s58 offen offset:3072 sc1
    s_add_u32 s58, s81, 12288
    buffer_load_dwordx4 v[112:115], v10, s[48:51], s58 offen offset:0 sc1
    buffer_load_dwordx4 v[116:119], v10, s[48:51], s58 offen offset:1024 sc1
    s_add_u32 s58, s81, 57344
    buffer_load_dwordx4 v[120:123], v10, s[48:51], s58 offen offset:0 sc1
    buffer_load_dwordx4 v[124:127], v10, s[48:51], s58 offen offset:1024 sc1
    buffer_load_dwordx4 v[192:195], v10, s[48:51], s58 offen offset:2048 sc1
    buffer_load_dwordx4 v[196:199], v10, s[48:51], s58 offen offset:3072 sc1
    s_add_u32 s58, s81, 61440
    buffer_load_dwordx4 v[200:203], v10, s[48:51], s58 offen offset:0 sc1
    buffer_load_dwordx4 v[204:207], v10, s[48:51], s58 offen offset:1024 sc1
    s_sub_u32 s98, s98, 1
    s_waitcnt vmcnt(0)
    s_cbranch_scc1 L_redoj_55
    v_min3_u32 v162, v104, v105, v106
    v_min3_u32 v163, v107, v108, v109
    v_min3_u32 v162, v162, v110, v111
    v_min_u32 v162, v162, v163
    v_cmp_eq_u32 vcc, 0, v162
    s_nop 0
    s_cbranch_vccnz L_rl_108
    s_branch L_redoj_55
L_redo_56:
    s_mov_b32 s98, 0x100000
L_rl_109:
    s_add_u32 s58, s81, 12288
    buffer_load_dwordx4 v[112:115], v10, s[48:51], s58 offen offset:0 sc1
    buffer_load_dwordx4 v[116:119], v10, s[48:51], s58 offen offset:1024 sc1
    s_add_u32 s58, s81, 57344
    buffer_load_dwordx4 v[120:123], v10, s[48:51], s58 offen offset:0 sc1
    buffer_load_dwordx4 v[124:127], v10, s[48:51], s58 offen offset:1024 sc1
    buffer_load_dwordx4 v[192:195], v10, s[48:51], s58 offen offset:2048 sc1
    buffer_load_dwordx4 v[196:199], v10, s[48:51], s58 offen offset:3072 sc1
    s_add_u32 s58, s81, 61440
    buffer_load_dwordx4 v[200:203], v10, s[48:51], s58 offen offset:0 sc1
    buffer_load_dwordx4 v[204:207], v10, s[48:51], s58 offen offset:1024 sc1
    buffer_load_dwordx4 v[208:211], v10, s[48:51], s58 offen offset:2048 sc1
    buffer_load_dwordx4 v[212:215], v10, s[48:51], s58 offen offset:3072 sc1
    s_sub_u32 s98, s98, 1
    s_waitcnt vmcnt(0)
    s_cbranch_scc1 L_redoj_57
    v_min3_u32 v160, v112, v113, v114
    v_min3_u32 v161, v115, v116, v117
    v_min3_u32 v160, v160, v118, v119
    v_min_u32 v160, v160, v161
    v_cmp_eq_u32 vcc, 0, v160
    s_nop 0
    s_cbranch_vccnz L_rl_109
    s_branch L_redoj_57
L_redo_58:
    s_mov_b32 s98, 0x100000
L_rl_110:
    s_add_u32 s58, s81, 57344
    buffer_load_dwordx4 v[120:123], v10, s[48:51], s58 offen offset:0 sc1
    buffer_load_dwordx4 v[124:127], v10, s[48:51], s58 offen offset:1024 sc1
    buffer_load_dwordx4 v[192:195], v10, s[48:51], s58 offen offset:2048 sc1
    buffer_load_dwordx4 v[196:199], v10, s[48:51], s58 offen offset:3072 sc1
    s_add_u32 s58, s81, 61440
    buffer_load_dwordx4 v[200:203], v10, s[48:51], s58 offen offset:0 sc1
    buffer_load_dwordx4 v[204:207], v10, s[48:51], s58 offen offset:1024 sc1
    buffer_load_dwordx4 v[208:211], v10, s[48:51], s58 offen offset:2048 sc1
    buffer_load_dwordx4 v[212:215], v10, s[48:51], s58 offen offset:3072 sc1
    s_add_u32 s58, s81, 65536
    buffer_load_dwordx4 v[216:219], v10, s[48:51], s58 offen offset:0 sc1
    buffer_load_dwordx4 v[220:223], v10, s[48:51], s58 offen offset:1024 sc1
    s_sub_u32 s98, s98, 1
    s_waitcnt vmcnt(0)
    s_cbranch_scc1 L_redoj_59
    v_min3_u32 v162, v120, v121, v122
    v_min3_u32 v163, v123, v124, v125
    v_min3_u32 v162, v162, v126, v127
    v_min_u32 v162, v162, v163
    v_cmp_eq_u32 vcc, 0, v162
    s_nop 0
    s_cbranch_vccnz L_rl_110
    s_branch L_redoj_59
L_redo_60:
    s_mov_b32 s98, 0x100000
L_rl_111:
    s_add_u32 s58, s81, 57344
    buffer_load_dwordx4 v[192:195], v10, s[48:51], s58 offen offset:2048 sc1
    buffer_load_dwordx4 v[196:199], v10, s[48:51], s58 offen offset:3072 sc1
    s_add_u32 s58, s81, 61440
    buffer_load_dwordx4 v[200:203], v10, s[48:51], s58 offen offset:0 sc1
    buffer_load_dwordx4 v[204:207], v10, s[48:51], s58 offen offset:1024 sc1
    buffer_load_dwordx4 v[208:211], v10, s[48:51], s58 offen offset:2048 sc1
    buffer_load_dwordx4 v[212:215], v10, s[48:51], s58 offen offset:3072 sc1
    s_add_u32 s58, s81, 65536
    buffer_load_dwordx4 v[216:219], v10, s[48:51], s58 offen offset:0 sc1
    buffer_load_dwordx4 v[220:223], v10, s[48:51], s58 offen offset:1024 sc1
    buffer_load_dwordx4 v[96:99], v10, s[48:51], s58 offen offset:2048 sc1
    buffer_load_dwordx4 v[100:103], v10, s[48:51], s58 offen offset:3072 sc1
    s_sub_u32 s98, s98, 1
    s_waitcnt vmcnt(0)
    s_cbranch_scc1 L_redoj_61
    v_min3_u32 v160, v192, v193, v194
    v_min3_u32 v161, v195, v196, v197
    v_min3_u32 v160, v160, v198, v199
    v_min_u32 v160, v160, v161
    v_cmp_eq_u32 vcc, 0, v160
    s_nop 0
    s_cbranch_vccnz L_rl_111
    s_branch L_redoj_61
L_redo_62:
    s_mov_b32 s98, 0x100000
L_rl_112:
    s_add_u32 s58, s81, 61440
    buffer_load_dwordx4 v[200:203], v10, s[48:51], s58 offen offset:0 sc1
    buffer_load_dwordx4 v[204:207], v10, s[48:51], s58 offen offset:1024 sc1
    buffer_load_dwordx4 v[208:211], v10, s[48:51], s58 offen offset:2048 sc1
    buffer_load_dwordx4 v[212:215], v10, s[48:51], s58 offen offset:3072 sc1
    s_add_u32 s58, s81, 65536
    buffer_load_dwordx4 v[216:219], v10, s[48:51], s58 offen offset:0 sc1
    buffer_load_dwordx4 v[220:223], v10, s[48:51], s58 offen offset:1024 sc1
    buffer_load_dwordx4 v[96:99], v10, s[48:51], s58 offen offset:2048 sc1
    buffer_load_dwordx4 v[100:103], v10, s[48:51], s58 offen offset:3072 sc1
    s_add_u32 s58, s81, 69632
    buffer_load_dwordx4 v[104:107], v10, s[48:51], s58 offen offset:0 sc1
    buffer_load_dwordx4 v[108:111], v10, s[48:51], s58 offen offset:1024 sc1
    s_sub_u32 s98, s98, 1
    s_waitcnt vmcnt(0)
    s_cbranch_scc1 L_redoj_63
    v_min3_u32 v162, v200, v201, v202
    v_min3_u32 v163, v203, v204, v205
    v_min3_u32 v162, v162, v206, v207
    v_min_u32 v162, v162, v163
    v_cmp_eq_u32 vcc, 0, v162
    s_nop 0
    s_cbranch_vccnz L_rl_112
    s_branch L_redoj_63
L_redo_64:
    s_mov_b32 s98, 0x100000
L_rl_113:
    s_add_u32 s58, s81, 61440
    buffer_load_dwordx4 v[208:211], v10, s[48:51], s58 offen offset:2048 sc1
    buffer_load_dwordx4 v[212:215], v10, s[48:51], s58 offen offset:3072 sc1
    s_add_u32 s58, s81, 65536
    buffer_load_dwordx4 v[216:219], v10, s[48:51], s58 offen offset:0 sc1
    buffer_load_dwordx4 v[220:223], v10, s[48:51], s58 offen offset:1024 sc1
    buffer_load_dwordx4 v[96:99], v10, s[48:51], s58 offen offset:2048 sc1
    buffer_load_dwordx4 v[100:103], v10, s[48:51], s58 offen offset:3072 sc1
    s_add_u32 s58, s81, 69632
    buffer_load_dwordx4 v[104:107], v10, s[48:51], s58 offen offset:0 sc1
    buffer_load_dwordx4 v[108:111], v10, s[48:51], s58 offen offset:1024 sc1
    s_add_u32 s58, s81, 114688
    buffer_load_dwordx4 v[112:115], v10, s[48:51], s58 offen offset:0 sc1
    buffer_load_dwordx4 v[116:119], v10, s[48:51], s58 offen offset:1024 sc1
    s_sub_u32 s98, s98, 1
    s_waitcnt vmcnt(0)
    s_cbranch_scc1 L_redoj_65
    v_min3_u32 v160, v208, v209, v210
    v_min3_u32 v161, v211, v212, v213
    v_min3_u32 v160, v160, v214, v215
    v_min_u32 v160, v160, v161
    v_cmp_eq_u32 vcc, 0, v160
    s_nop 0
    s_cbranch_vccnz L_rl_113
    s_branch L_redoj_65
L_redo_66:
    s_mov_b32 s98, 0x100000
L_rl_114:
    s_add_u32 s58, s81, 65536
    buffer_load_dwordx4 v[216:219], v10, s[48:51], s58 offen offset:0 sc1
    buffer_load_dwordx4 v[220:223], v10, s[48:51], s58 offen offset:1024 sc1
    buffer_load_dwordx4 v[96:99], v10, s[48:51], s58 offen offset:2048 sc1
    buffer_load_dwordx4 v[100:103], v10, s[48:51], s58 offen offset:3072 sc1
    s_add_u32 s58, s81, 69632
    buffer_load_dwordx4 v[104:107], v10, s[48:51], s58 offen offset:0 sc1
    buffer_load_dwordx4 v[108:111], v10, s[48:51], s58 offen offset:1024 sc1
    s_add_u32 s58, s81, 114688
    buffer_load_dwordx4 v[112:115], v10, s[48:51], s58 offen offset:0 sc1
    buffer_load_dwordx4 v[116:119], v10, s[48:51], s58 offen offset:1024 sc1
    buffer_load_dwordx4 v[120:123], v10, s[48:51], s58 offen offset:2048 sc1
    buffer_load_dwordx4 v[124:127], v10, s[48:51], s58 offen offset:3072 sc1
    s_sub_u32 s98, s98, 1
    s_waitcnt vmcnt(0)
    s_cbranch_scc1 L_redoj_67
    v_min3_u32 v162, v216, v217, v218
    v_min3_u32 v163, v219, v220, v221
    v_min3_u32 v162, v162, v222, v223
    v_min_u32 v162, v162, v163
    v_cmp_eq_u32 vcc, 0, v162
    s_nop 0
    s_cbranch_vccnz L_rl_114
    s_branch L_redoj_67
L_redo_68:
    s_mov_b32 s98, 0x100000
L_rl_115:
    s_add_u32 s58, s81, 65536
    buffer_load_dwordx4 v[96:99], v10, s[48:51], s58 offen offset:2048 sc1
    buffer_load_dwordx4 v[100:103], v10, s[48:51], s58 offen offset:3072 sc1
    s_add_u32 s58, s81, 69632
    buffer_load_dwordx4 v[104:107], v10, s[48:51], s58 offen offset:0 sc1
    buffer_load_dwordx4 v[108:111], v10, s[48:51], s58 offen offset:1024 sc1
    s_add_u32 s58, s81, 114688
    buffer_load_dwordx4 v[112:115], v10, s[48:51], s58 offen offset:0 sc1
    buffer_load_dwordx4 v[116:119], v10, s[48:51], s58 offen offset:1024 sc1
    buffer_load_dwordx4 v[120:123], v10, s[48:51], s58 offen offset:2048 sc1
    buffer_load_dwordx4 v[124:127], v10, s[48:51], s58 offen offset:3072 sc1
    s_add_u32 s58, s81, 118784
    buffer_load_dwordx4 v[192:195], v10, s[48:51], s58 offen offset:0 sc1
    buffer_load_dwordx4 v[196:199], v10, s[48:51], s58 offen offset:1024 sc1
    s_sub_u32 s98, s98, 1
    s_waitcnt vmcnt(0)
    s_cbranch_scc1 L_redoj_69
    v_min3_u32 v160, v96, v97, v98
    v_min3_u32 v161, v99, v100, v101
    v_min3_u32 v160, v160, v102, v103
    v_min_u32 v160, v160, v161
    v_cmp_eq_u32 vcc, 0, v160
    s_nop 0
    s_cbranch_vccnz L_rl_115
    s_branch L_redoj_69
L_redo_70:
    s_mov_b32 s98, 0x100000
L_rl_116:
    s_add_u32 s58, s81, 69632
    buffer_load_dwordx4 v[104:107], v10, s[48:51], s58 offen offset:0 sc1
    buffer_load_dwordx4 v[108:111], v10, s[48:51], s58 offen offset:1024 sc1
    s_add_u32 s58, s81, 114688
    buffer_load_dwordx4 v[112:115], v10, s[48:51], s58 offen offset:0 sc1
    buffer_load_dwordx4 v[116:119], v10, s[48:51], s58 offen offset:1024 sc1
    buffer_load_dwordx4 v[120:123], v10, s[48:51], s58 offen offset:2048 sc1
    buffer_load_dwordx4 v[124:127], v10, s[48:51], s58 offen offset:3072 sc1
    s_add_u32 s58, s81, 118784
    buffer_load_dwordx4 v[192:195], v10, s[48:51], s58 offen offset:0 sc1
    buffer_load_dwordx4 v[196:199], v10, s[48:51], s58 offen offset:1024 sc1
    buffer_load_dwordx4 v[200:203], v10, s[48:51], s58 offen offset:2048 sc1
    buffer_load_dwordx4 v[204:207], v10, s[48:51], s58 offen offset:3072 sc1
    s_sub_u32 s98, s98, 1
    s_waitcnt vmcnt(0)
    s_cbranch_scc1 L_redoj_71
    v_min3_u32 v162, v104, v105, v106
    v_min3_u32 v163, v107, v108, v109
    v_min3_u32 v162, v162, v110, v111
    v_min_u32 v162, v162, v163
    v_cmp_eq_u32 vcc, 0, v162
    s_nop 0
    s_cbranch_vccnz L_rl_116
    s_branch L_redoj_71
L_redo_72:
    s_mov_b32 s98, 0x100000
L_rl_117:
    s_add_u32 s58, s81, 114688
    buffer_load_dwordx4 v[112:115], v10, s[48:51], s58 offen offset:0 sc1
    buffer_load_dwordx4 v[116:119], v10, s[48:51], s58 offen offset:1024 sc1
    buffer_load_dwordx4 v[120:123], v10, s[48:51], s58 offen offset:2048 sc1
    buffer_load_dwordx4 v[124:127], v10, s[48:51], s58 offen offset:3072 sc1
    s_add_u32 s58, s81, 118784
    buffer_load_dwordx4 v[192:195], v10, s[48:51], s58 offen offset:0 sc1
    buffer_load_dwordx4 v[196:199], v10, s[48:51], s58 offen offset:1024 sc1
    buffer_load_dwordx4 v[200:203], v10, s[48:51], s58 offen offset:2048 sc1
    buffer_load_dwordx4 v[204:207], v10, s[48:51], s58 offen offset:3072 sc1
    s_add_u32 s58, s81, 122880
    buffer_load_dwordx4 v[208:211], v10, s[48:51], s58 offen offset:0 sc1
    buffer_load_dwordx4 v[212:215], v10, s[48:51], s58 offen offset:1024 sc1
    s_sub_u32 s98, s98, 1
    s_waitcnt vmcnt(0)
    s_cbranch_scc1 L_redoj_73
    v_min3_u32 v160, v112, v113, v114
    v_min3_u32 v161, v115, v116, v117
    v_min3_u32 v160, v160, v118, v119
    v_min_u32 v160, v160, v161
    v_cmp_eq_u32 vcc, 0, v160
    s_nop 0
    s_cbranch_vccnz L_rl_117
    s_branch L_redoj_73
L_redo_74:
    s_mov_b32 s98, 0x100000
L_rl_118:
    s_add_u32 s58, s81, 114688
    buffer_load_dwordx4 v[120:123], v10, s[48:51], s58 offen offset:2048 sc1
    buffer_load_dwordx4 v[124:127], v10, s[48:51], s58 offen offset:3072 sc1
    s_add_u32 s58, s81, 118784
    buffer_load_dwordx4 v[192:195], v10, s[48:51], s58 offen offset:0 sc1
    buffer_load_dwordx4 v[196:199], v10, s[48:51], s58 offen offset:1024 sc1
    buffer_load_dwordx4 v[200:203], v10, s[48:51], s58 offen offset:2048 sc1
    buffer_load_dwordx4 v[204:207], v10, s[48:51], s58 offen offset:3072 sc1
    s_add_u32 s58, s81, 122880
    buffer_load_dwordx4 v[208:211], v10, s[48:51], s58 offen offset:0 sc1
    buffer_load_dwordx4 v[212:215], v10, s[48:51], s58 offen offset:1024 sc1
    buffer_load_dwordx4 v[216:219], v10, s[48:51], s58 offen offset:2048 sc1
    buffer_load_dwordx4 v[220:223], v10, s[48:51], s58 offen offset:3072 sc1
    s_sub_u32 s98, s98, 1
    s_waitcnt vmcnt(0)
    s_cbranch_scc1 L_redoj_75
    v_min3_u32 v162, v120, v121, v122
    v_min3_u32 v163, v123, v124, v125
    v_min3_u32 v162, v162, v126, v127
    v_min_u32 v162, v162, v163
    v_cmp_eq_u32 vcc, 0, v162
    s_nop 0
    s_cbranch_vccnz L_rl_118
    s_branch L_redoj_75
L_redo_76:
    s_mov_b32 s98, 0x100000
L_rl_119:
    s_add_u32 s58, s81, 118784
    buffer_load_dwordx4 v[192:195], v10, s[48:51], s58 offen offset:0 sc1
    buffer_load_dwordx4 v[196:199], v10, s[48:51], s58 offen offset:1024 sc1
    buffer_load_dwordx4 v[200:203], v10, s[48:51], s58 offen offset:2048 sc1
    buffer_load_dwordx4 v[204:207], v10, s[48:51], s58 offen offset:3072 sc1
    s_add_u32 s58, s81, 122880
    buffer_load_dwordx4 v[208:211], v10, s[48:51], s58 offen offset:0 sc1
    buffer_load_dwordx4 v[212:215], v10, s[48:51], s58 offen offset:1024 sc1
    buffer_load_dwordx4 v[216:219], v10, s[48:51], s58 offen offset:2048 sc1
    buffer_load_dwordx4 v[220:223], v10, s[48:51], s58 offen offset:3072 sc1
    s_add_u32 s58, s81, 126976
    buffer_load_dwordx4 v[96:99], v10, s[48:51], s58 offen offset:0 sc1
    buffer_load_dwordx4 v[100:103], v10, s[48:51], s58 offen offset:1024 sc1
    s_sub_u32 s98, s98, 1
    s_waitcnt vmcnt(0)
    s_cbranch_scc1 L_redoj_77
    v_min3_u32 v160, v192, v193, v194
    v_min3_u32 v161, v195, v196, v197
    v_min3_u32 v160, v160, v198, v199
    v_min_u32 v160, v160, v161
    v_cmp_eq_u32 vcc, 0, v160
    s_nop 0
    s_cbranch_vccnz L_rl_119
    s_branch L_redoj_77
L_redo_78:
    s_mov_b32 s98, 0x100000
L_rl_120:
    s_add_u32 s58, s81, 118784
    buffer_load_dwordx4 v[200:203], v10, s[48:51], s58 offen offset:2048 sc1
    buffer_load_dwordx4 v[204:207], v10, s[48:51], s58 offen offset:3072 sc1
    s_add_u32 s58, s81, 122880
    buffer_load_dwordx4 v[208:211], v10, s[48:51], s58 offen offset:0 sc1
    buffer_load_dwordx4 v[212:215], v10, s[48:51], s58 offen offset:1024 sc1
    buffer_load_dwordx4 v[216:219], v10, s[48:51], s58 offen offset:2048 sc1
    buffer_load_dwordx4 v[220:223], v10, s[48:51], s58 offen offset:3072 sc1
    s_add_u32 s58, s81, 126976
    buffer_load_dwordx4 v[96:99], v10, s[48:51], s58 offen offset:0 sc1
    buffer_load_dwordx4 v[100:103], v10, s[48:51], s58 offen offset:1024 sc1
    s_add_u32 s58, s81, 172032
    buffer_load_dwordx4 v[104:107], v10, s[48:51], s58 offen offset:0 sc1
    buffer_load_dwordx4 v[108:111], v10, s[48:51], s58 offen offset:1024 sc1
    s_sub_u32 s98, s98, 1
    s_waitcnt vmcnt(0)
    s_cbranch_scc1 L_redoj_79
    v_min3_u32 v162, v200, v201, v202
    v_min3_u32 v163, v203, v204, v205
    v_min3_u32 v162, v162, v206, v207
    v_min_u32 v162, v162, v163
    v_cmp_eq_u32 vcc, 0, v162
    s_nop 0
    s_cbranch_vccnz L_rl_120
    s_branch L_redoj_79
L_redo_80:
    s_mov_b32 s98, 0x100000
L_rl_121:
    s_add_u32 s58, s81, 122880
    buffer_load_dwordx4 v[208:211], v10, s[48:51], s58 offen offset:0 sc1
    buffer_load_dwordx4 v[212:215], v10, s[48:51], s58 offen offset:1024 sc1
    buffer_load_dwordx4 v[216:219], v10, s[48:51], s58 offen offset:2048 sc1
    buffer_load_dwordx4 v[220:223], v10, s[48:51], s58 offen offset:3072 sc1
    s_add_u32 s58, s81, 126976
    buffer_load_dwordx4 v[96:99], v10, s[48:51], s58 offen offset:0 sc1
    buffer_load_dwordx4 v[100:103], v10, s[48:51], s58 offen offset:1024 sc1
    s_add_u32 s58, s81, 172032
    buffer_load_dwordx4 v[104:107], v10, s[48:51], s58 offen offset:0 sc1
    buffer_load_dwordx4 v[108:111], v10, s[48:51], s58 offen offset:1024 sc1
    buffer_load_dwordx4 v[112:115], v10, s[48:51], s58 offen offset:2048 sc1
    buffer_load_dwordx4 v[116:119], v10, s[48:51], s58 offen offset:3072 sc1
    s_sub_u32 s98, s98, 1
    s_waitcnt vmcnt(0)
    s_cbranch_scc1 L_redoj_81
    v_min3_u32 v160, v208, v209, v210
    v_min3_u32 v161, v211, v212, v213
    v_min3_u32 v160, v160, v214, v215
    v_min_u32 v160, v160, v161
    v_cmp_eq_u32 vcc, 0, v160
    s_nop 0
    s_cbranch_vccnz L_rl_121
    s_branch L_redoj_81
L_redo_82:
    s_mov_b32 s98, 0x100000
L_rl_122:
    s_add_u32 s58, s81, 122880
    buffer_load_dwordx4 v[216:219], v10, s[48:51], s58 offen offset:2048 sc1
    buffer_load_dwordx4 v[220:223], v10, s[48:51], s58 offen offset:3072 sc1
    s_add_u32 s58, s81, 126976
    buffer_load_dwordx4 v[96:99], v10, s[48:51], s58 offen offset:0 sc1
    buffer_load_dwordx4 v[100:103], v10, s[48:51], s58 offen offset:1024 sc1
    s_add_u32 s58, s81, 172032
    buffer_load_dwordx4 v[104:107], v10, s[48:51], s58 offen offset:0 sc1
    buffer_load_dwordx4 v[108:111], v10, s[48:51], s58 offen offset:1024 sc1
    buffer_load_dwordx4 v[112:115], v10, s[48:51], s58 offen offset:2048 sc1
    buffer_load_dwordx4 v[116:119], v10, s[48:51], s58 offen offset:3072 sc1
    s_add_u32 s58, s81, 176128
    buffer_load_dwordx4 v[120:123], v10, s[48:51], s58 offen offset:0 sc1
    buffer_load_dwordx4 v[124:127], v10, s[48:51], s58 offen offset:1024 sc1
    s_sub_u32 s98, s98, 1
    s_waitcnt vmcnt(0)
    s_cbranch_scc1 L_redoj_83
    v_min3_u32 v162, v216, v217, v218
    v_min3_u32 v163, v219, v220, v221
    v_min3_u32 v162, v162, v222, v223
    v_min_u32 v162, v162, v163
    v_cmp_eq_u32 vcc, 0, v162
    s_nop 0
    s_cbranch_vccnz L_rl_122
    s_branch L_redoj_83
L_redo_84:
    s_mov_b32 s98, 0x100000
L_rl_123:
    s_add_u32 s58, s81, 126976
    buffer_load_dwordx4 v[96:99], v10, s[48:51], s58 offen offset:0 sc1
    buffer_load_dwordx4 v[100:103], v10, s[48:51], s58 offen offset:1024 sc1
    s_add_u32 s58, s81, 172032
    buffer_load_dwordx4 v[104:107], v10, s[48:51], s58 offen offset:0 sc1
    buffer_load_dwordx4 v[108:111], v10, s[48:51], s58 offen offset:1024 sc1
    buffer_load_dwordx4 v[112:115], v10, s[48:51], s58 offen offset:2048 sc1
    buffer_load_dwordx4 v[116:119], v10, s[48:51], s58 offen offset:3072 sc1
    s_add_u32 s58, s81, 176128
    buffer_load_dwordx4 v[120:123], v10, s[48:51], s58 offen offset:0 sc1
    buffer_load_dwordx4 v[124:127], v10, s[48:51], s58 offen offset:1024 sc1
    buffer_load_dwordx4 v[192:195], v10, s[48:51], s58 offen offset:2048 sc1
    buffer_load_dwordx4 v[196:199], v10, s[48:51], s58 offen offset:3072 sc1
    s_sub_u32 s98, s98, 1
    s_waitcnt vmcnt(0)
    s_cbranch_scc1 L_redoj_85
    v_min3_u32 v160, v96, v97, v98
    v_min3_u32 v161, v99, v100, v101
    v_min3_u32 v160, v160, v102, v103
    v_min_u32 v160, v160, v161
    v_cmp_eq_u32 vcc, 0, v160
    s_nop 0
    s_cbranch_vccnz L_rl_123
    s_branch L_redoj_85
L_redo_86:
    s_mov_b32 s98, 0x100000
L_rl_124:
    s_add_u32 s58, s81, 172032
    buffer_load_dwordx4 v[104:107], v10, s[48:51], s58 offen offset:0 sc1
    buffer_load_dwordx4 v[108:111], v10, s[48:51], s58 offen offset:1024 sc1
    buffer_load_dwordx4 v[112:115], v10, s[48:51], s58 offen offset:2048 sc1
    buffer_load_dwordx4 v[116:119], v10, s[48:51], s58 offen offset:3072 sc1
    s_add_u32 s58, s81, 176128
    buffer_load_dwordx4 v[120:123], v10, s[48:51], s58 offen offset:0 sc1
    buffer_load_dwordx4 v[124:127], v10, s[48:51], s58 offen offset:1024 sc1
    buffer_load_dwordx4 v[192:195], v10, s[48:51], s58 offen offset:2048 sc1
    buffer_load_dwordx4 v[196:199], v10, s[48:51], s58 offen offset:3072 sc1
    s_add_u32 s58, s81, 180224
    buffer_load_dwordx4 v[200:203], v10, s[48:51], s58 offen offset:0 sc1
    buffer_load_dwordx4 v[204:207], v10, s[48:51], s58 offen offset:1024 sc1
    s_sub_u32 s98, s98, 1
    s_waitcnt vmcnt(0)
    s_cbranch_scc1 L_redoj_87
    v_min3_u32 v162, v104, v105, v106
    v_min3_u32 v163, v107, v108, v109
    v_min3_u32 v162, v162, v110, v111
    v_min_u32 v162, v162, v163
    v_cmp_eq_u32 vcc, 0, v162
    s_nop 0
    s_cbranch_vccnz L_rl_124
    s_branch L_redoj_87
L_redo_88:
    s_mov_b32 s98, 0x100000
L_rl_125:
    s_add_u32 s58, s81, 172032
    buffer_load_dwordx4 v[112:115], v10, s[48:51], s58 offen offset:2048 sc1
    buffer_load_dwordx4 v[116:119], v10, s[48:51], s58 offen offset:3072 sc1
    s_add_u32 s58, s81, 176128
    buffer_load_dwordx4 v[120:123], v10, s[48:51], s58 offen offset:0 sc1
    buffer_load_dwordx4 v[124:127], v10, s[48:51], s58 offen offset:1024 sc1
    buffer_load_dwordx4 v[192:195], v10, s[48:51], s58 offen offset:2048 sc1
    buffer_load_dwordx4 v[196:199], v10, s[48:51], s58 offen offset:3072 sc1
    s_add_u32 s58, s81, 180224
    buffer_load_dwordx4 v[200:203], v10, s[48:51], s58 offen offset:0 sc1
    buffer_load_dwordx4 v[204:207], v10, s[48:51], s58 offen offset:1024 sc1
    buffer_load_dwordx4 v[208:211], v10, s[48:51], s58 offen offset:2048 sc1
    buffer_load_dwordx4 v[212:215], v10, s[48:51], s58 offen offset:3072 sc1
    s_sub_u32 s98, s98, 1
    s_waitcnt vmcnt(0)
    s_cbranch_scc1 L_redoj_89
    v_min3_u32 v160, v112, v113, v114
    v_min3_u32 v161, v115, v116, v117
    v_min3_u32 v160, v160, v118, v119
    v_min_u32 v160, v160, v161
    v_cmp_eq_u32 vcc, 0, v160
    s_nop 0
    s_cbranch_vccnz L_rl_125
    s_branch L_redoj_89
L_redo_90:
    s_mov_b32 s98, 0x100000
L_rl_126:
    s_add_u32 s58, s81, 176128
    buffer_load_dwordx4 v[120:123], v10, s[48:51], s58 offen offset:0 sc1
    buffer_load_dwordx4 v[124:127], v10, s[48:51], s58 offen offset:1024 sc1
    buffer_load_dwordx4 v[192:195], v10, s[48:51], s58 offen offset:2048 sc1
    buffer_load_dwordx4 v[196:199], v10, s[48:51], s58 offen offset:3072 sc1
    s_add_u32 s58, s81, 180224
    buffer_load_dwordx4 v[200:203], v10, s[48:51], s58 offen offset:0 sc1
    buffer_load_dwordx4 v[204:207], v10, s[48:51], s58 offen offset:1024 sc1
    buffer_load_dwordx4 v[208:211], v10, s[48:51], s58 offen offset:2048 sc1
    buffer_load_dwordx4 v[212:215], v10, s[48:51], s58 offen offset:3072 sc1
    s_add_u32 s58, s81, 184320
    buffer_load_dwordx4 v[216:219], v10, s[48:51], s58 offen offset:0 sc1
    buffer_load_dwordx4 v[220:223], v10, s[48:51], s58 offen offset:1024 sc1
    s_sub_u32 s98, s98, 1
    s_waitcnt vmcnt(0)
    s_cbranch_scc1 L_redoj_91
    v_min3_u32 v162, v120, v121, v122
    v_min3_u32 v163, v123, v124, v125
    v_min3_u32 v162, v162, v126, v127
    v_min_u32 v162, v162, v163
    v_cmp_eq_u32 vcc, 0, v162
    s_nop 0
    s_cbranch_vccnz L_rl_126
    s_branch L_redoj_91
L_redo_92:
    s_mov_b32 s98, 0x100000
L_rl_127:
    s_add_u32 s58, s81, 176128
    buffer_load_dwordx4 v[192:195], v10, s[48:51], s58 offen offset:2048 sc1
    buffer_load_dwordx4 v[196:199], v10, s[48:51], s58 offen offset:3072 sc1
    s_add_u32 s58, s81, 180224
    buffer_load_dwordx4 v[200:203], v10, s[48:51], s58 offen offset:0 sc1
    buffer_load_dwordx4 v[204:207], v10, s[48:51], s58 offen offset:1024 sc1
    buffer_load_dwordx4 v[208:211], v10, s[48:51], s58 offen offset:2048 sc1
    buffer_load_dwordx4 v[212:215], v10, s[48:51], s58 offen offset:3072 sc1
    s_add_u32 s58, s81, 184320
    buffer_load_dwordx4 v[216:219], v10, s[48:51], s58 offen offset:0 sc1
    buffer_load_dwordx4 v[220:223], v10, s[48:51], s58 offen offset:1024 sc1
    s_sub_u32 s98, s98, 1
    s_waitcnt vmcnt(0)
    s_cbranch_scc1 L_redoj_93
    v_min3_u32 v160, v192, v193, v194
    v_min3_u32 v161, v195, v196, v197
    v_min3_u32 v160, v160, v198, v199
    v_min_u32 v160, v160, v161
    v_cmp_eq_u32 vcc, 0, v160
    s_nop 0
    s_cbranch_vccnz L_rl_127
    s_branch L_redoj_93
L_redo_94:
    s_mov_b32 s98, 0x100000
L_rl_128:
    s_add_u32 s58, s81, 180224
    buffer_load_dwordx4 v[200:203], v10, s[48:51], s58 offen offset:0 sc1
    buffer_load_dwordx4 v[204:207], v10, s[48:51], s58 offen offset:1024 sc1
    buffer_load_dwordx4 v[208:211], v10, s[48:51], s58 offen offset:2048 sc1
    buffer_load_dwordx4 v[212:215], v10, s[48:51], s58 offen offset:3072 sc1
    s_add_u32 s58, s81, 184320
    buffer_load_dwordx4 v[216:219], v10, s[48:51], s58 offen offset:0 sc1
    buffer_load_dwordx4 v[220:223], v10, s[48:51], s58 offen offset:1024 sc1
    s_sub_u32 s98, s98, 1
    s_waitcnt vmcnt(0)
    s_cbranch_scc1 L_redoj_95
    v_min3_u32 v162, v200, v201, v202
    v_min3_u32 v163, v203, v204, v205
    v_min3_u32 v162, v162, v206, v207
    v_min_u32 v162, v162, v163
    v_cmp_eq_u32 vcc, 0, v162
    s_nop 0
    s_cbranch_vccnz L_rl_128
    s_branch L_redoj_95
L_redo_96:
    s_mov_b32 s98, 0x100000
L_rl_129:
    s_add_u32 s58, s81, 180224
    buffer_load_dwordx4 v[208:211], v10, s[48:51], s58 offen offset:2048 sc1
    buffer_load_dwordx4 v[212:215], v10, s[48:51], s58 offen offset:3072 sc1
    s_add_u32 s58, s81, 184320
    buffer_load_dwordx4 v[216:219], v10, s[48:51], s58 offen offset:0 sc1
    buffer_load_dwordx4 v[220:223], v10, s[48:51], s58 offen offset:1024 sc1
    s_sub_u32 s98, s98, 1
    s_waitcnt vmcnt(0)
    s_cbranch_scc1 L_redoj_97
    v_min3_u32 v160, v208, v209, v210
    v_min3_u32 v161, v211, v212, v213
    v_min3_u32 v160, v160, v214, v215
    v_min_u32 v160, v160, v161
    v_cmp_eq_u32 vcc, 0, v160
    s_nop 0
    s_cbranch_vccnz L_rl_129
    s_branch L_redoj_97
L_redo_98:
    s_mov_b32 s98, 0x100000
L_rl_130:
    s_add_u32 s58, s81, 184320
    buffer_load_dwordx4 v[216:219], v10, s[48:51], s58 offen offset:0 sc1
    buffer_load_dwordx4 v[220:223], v10, s[48:51], s58 offen offset:1024 sc1
    s_sub_u32 s98, s98, 1
    s_waitcnt vmcnt(0)
    s_cbranch_scc1 L_redoj_99
    v_min3_u32 v162, v216, v217, v218
    v_min3_u32 v163, v219, v220, v221
    v_min3_u32 v162, v162, v222, v223
    v_min_u32 v162, v162, v163
    v_cmp_eq_u32 vcc, 0, v162
    s_nop 0
    s_cbranch_vccnz L_rl_130
    s_branch L_redoj_99
L_mod2:
    s_mov_b64 exec, 0x3
    s_mov_b32 s98, 0x200000
L_poll_131:
    buffer_load_dword v29, v31, s[44:47], 0 offen offset:132 sc1
    s_sub_u32 s98, s98, 1
    s_cbranch_scc1 L_pollout_132
    s_waitcnt vmcnt(0)
    v_cmp_gt_u32 vcc, v123, v29
    s_nop 0
    s_cbranch_vccnz L_poll_131
L_pollout_132:
    s_waitcnt vmcnt(0)
    s_mov_b64 exec, -1
    s_branch L_mod2j
.section .rodata,"a"
.p2align 6
.amdhsa_kernel adaLN_cond__sliding_block_cached__dense_activation_silu__prompt_kernel
  .amdhsa_next_free_vgpr 512
  .amdhsa_next_free_sgpr 102
  .amdhsa_accum_offset 256
  .amdhsa_group_segment_fixed_size 0
  .amdhsa_kernarg_size 104
  .amdhsa_user_sgpr_count 2
  .amdhsa_user_sgpr_kernarg_segment_ptr 1
  .amdhsa_system_sgpr_workgroup_id_x 1
.end_amdhsa_kernel
```
